```python
import torch

def _softmax(x, axis=-1):
    return torch.softmax(x, dim=axis)
def _gelu(x):
    return torch.nn.functional.gelu(x, approximate="tanh")
def _silu(x):
    return torch.nn.functional.silu(x)
def _sigmoid(x):
    return torch.sigmoid(x)
def _layernorm(x, axis=-1, eps=1e-5):
    m = x.mean(dim=axis, keepdim=True)
    v = x.var(dim=axis, keepdim=True, unbiased=False)
    return (x - m) / torch.sqrt(v + eps)
def _scatter_add(tgt, idx, src, axis=0):
    return tgt.clone().index_add_(axis, idx, src)
def _segment_sum(src, seg, n):
    out = torch.zeros((n,) + src.shape[1:], dtype=src.dtype)
    return out.index_add_(0, seg, src)
def _pad(x, pw):
    flat = tuple(v for pair in reversed(pw) for v in pair)
    return torch.nn.functional.pad(x, flat)

kernel_name = 'interleave_layers__sliding_block__dense_activation_silu__prompt'

def setup_inputs():

    _w = (lambda a: (lambda t: t.to(torch.bfloat16) if t.is_floating_point() else t)(torch.as_tensor(a)))
    def _A_setup():
        B, S, D = 1, 2048, 640
        return {
            "x": _w((lambda *s: torch.randn(*s, dtype=torch.bfloat16) * 0.05)(B, S, D)),
            "wqkv": _w((lambda *s: torch.randn(*s, dtype=torch.bfloat16) * 0.05)(D, 3 * D)),
            "wo": _w((lambda *s: torch.randn(*s, dtype=torch.bfloat16) * 0.05)(D, D)),
        }
    _A_in = _A_setup()

    def _B_setup():
        B, S, D, F = 1, 2048, 640, 1728
        return {
            "x": _w((lambda *s: torch.randn(*s, dtype=torch.bfloat16) * 0.05)(B, S, D)),
            "w1": _w((lambda *s: torch.randn(*s, dtype=torch.bfloat16) * 0.8)(D, F) * (D ** -0.5)),
            "w2": _w((lambda *s: torch.randn(*s, dtype=torch.bfloat16) * 0.8)(F, D) * (F ** -0.5)),
        }
    _B_in = _B_setup()

    return {
        "A_x": _A_in["x"],
        "A_wqkv": _A_in["wqkv"],
        "A_wo": _A_in["wo"],
        "B_x": _B_in["x"],
        "B_w1": _B_in["w1"],
        "B_w2": _B_in["w2"],
    }

def reference(A_x, A_wqkv, A_wo, B_x, B_w1, B_w2):
    def _A_ref(x, wqkv, wo):
        B, S, D = x.shape
        H = 32; Dh = D // H; W = 256
        qkv = (lambda x, *d: x.permute(*d))((x @ wqkv).reshape(B, S, 3, H, Dh), 2, 0, 3, 1, 4)
        q, k, v = qkv[0], qkv[1], qkv[2]
        scores = torch.einsum("bhqd,bhkd->bhqk", q, k) * (Dh ** -0.5)
        idx = torch.arange(S)
        mask = (idx[:, None] - idx[None, :] >= 0) & (idx[:, None] - idx[None, :] < W)
        scores = torch.where(mask[None, None], scores, -1e9)
        p = _softmax(scores, axis=-1)
        o = torch.einsum("bhqk,bhkd->bhqd", p, v)
        return (lambda x, *d: x.permute(*d))(o, 0, 2, 1, 3).reshape(B, S, D) @ wo

    def _B_ref(x, w1, w2):
        h = torch.einsum("bsd,df->bsf", x, w1)
        h = _silu(h)
        out = torch.einsum("bsf,fd->bsd", h, w2)
        return out

    x = A_x
    x = x + _A_ref(_layernorm(x, axis=-1), A_wqkv, A_wo)
    x = x + _B_ref(_layernorm(x, axis=-1), B_w1, B_w2)
    x = x + _A_ref(_layernorm(x, axis=-1), A_wqkv, A_wo)
    x = x + _B_ref(_layernorm(x, axis=-1), B_w1, B_w2)
    return x
```

```asm
; @launch grid=(256,1,1) block=(256,1,1) lds=163840
.amdgcn_target "amdgcn-amd-amdhsa--gfx950"
.text
.globl interleave_layers__sliding_block__dense_activation_silu__prompt_kernel
.p2align 8
.type interleave_layers__sliding_block__dense_activation_silu__prompt_kernel,@function
interleave_layers__sliding_block__dense_activation_silu__prompt_kernel:
    s_cmp_ge_u32 s2, 256
    s_cbranch_scc1 L_end
    s_load_dwordx16 s[20:35], s[0:1], 0
    s_load_dwordx2 s[4:5], s[0:1], 64
    s_getpc_b64 s[68:69]
    v_lshrrev_b32 v30, 2, v0
    v_lshlrev_b32 v30, 7, v30
    global_load_dword a252, v30, s[68:69]
    v_lshrrev_b32 v26, 6, v0
    v_and_b32 v21, 63, v0
    v_readfirstlane_b32 s36, v26
    s_and_b32 s37, s2, 7
    s_lshr_b32 s38, s2, 3
    v_lshrrev_b32 v61, 3, v21
    v_mul_u32_u24 v61, 3840, v61
    v_and_b32 v26, 7, v21
    v_lshl_add_u32 v61, v26, 4, v61
    s_cmp_lt_u32 s38, 30
    s_cselect_b32 s14, 2457600, 0
    s_mov_b32 s15, 0x20000
    s_mul_i32 s57, s37, 10
    s_add_u32 s57, s57, s36
    s_mulk_i32 s57, 240
    s_add_u32 s57, s57, s38
    s_lshl_b32 s57, s57, 7
    s_min_u32 s57, s57, s14
    s_lshl_b32 s56, s36, 10
    s_add_u32 m0, s56, 1024
    s_waitcnt lgkmcnt(0)
    s_mov_b64 s[12:13], s[22:23]
    buffer_load_dwordx4 v61, s[12:15], s57 offen offset:0 nt lds
    s_addk_i32 m0, 4096
    s_add_u32 s57, s57, 122880
    s_min_u32 s57, s57, s14
    buffer_load_dwordx4 v61, s[12:15], s57 offen offset:0 nt lds
    s_addk_i32 m0, 4096
    s_add_u32 s57, s57, 122880
    s_cmp_lt_u32 s36, 2
    s_cselect_b32 s57, s57, -1
    s_min_u32 s57, s57, s14
    buffer_load_dwordx4 v61, s[12:15], s57 offen offset:0 nt lds
    s_lshr_b32 s39, s2, 6
    s_and_b32 s40, s38, 7
    v_lshrrev_b32 v82, 2, v21
    v_mul_u32_u24 v82, 1280, v82
    v_and_b32 v26, 3, v21
    v_lshl_add_u32 v60, v26, 4, v82
    s_lshl2_add_u32 s54, s37, s39
    s_lshl2_add_u32 s54, s54, s36
    s_lshl_b32 s54, s54, 7
    s_add_u32 s54, s54, s40
    s_mulk_i32 s54, 160
    s_mov_b32 s10, 2621440
    s_mov_b32 s11, 0x20000
    s_lshl_b32 s55, s36, 12
    s_add_u32 m0, s55, 94208
    s_mov_b64 s[8:9], s[20:21]
    buffer_load_dwordx4 v60, s[8:11], s54 offen offset:0 lds
    s_addk_i32 m0, 960
    s_nop 0
    buffer_load_dwordx4 v60, s[8:11], s54 offen offset:64 lds
    s_addk_i32 m0, 960
    v_and_b32 v82, 0xffffffdf, v60
    buffer_load_dwordx4 v82, s[8:11], s54 offen offset:128 lds
    v_and_b32 v56, 15, v21
    v_lshrrev_b32 v58, 5, v21
    v_bfe_u32 v59, v21, 4, 1
    s_load_dword s48, s[4:5], 0
    s_mov_b32 s6, 0x10000000
    s_mov_b32 s7, 0x20000
    v_lshrrev_b32 v57, 4, v21
    v_lshlrev_b32 v1, 4, v21
    s_mul_i32 s45, s37, 4194304
    s_add_u32 s45, s45, 16777216
    s_getpc_b64 s[68:69]
L_pc_1:
    s_add_u32 s68, s68, L_p1first-L_pc_1
    s_addc_u32 s69, s69, 0
    v_and_b32 v27, 3, v21
    v_lshl_add_u32 v27, s36, 2, v27
    v_lshl_add_u32 v27, s38, 4, v27
    v_lshlrev_b32 v27, 7, v27
    v_min_u32 v27, L_layer1-L_p1first, v27
    global_load_dword a252, v27, s[68:69]
    v_lshlrev_b32 v22, 4, v57
    v_lshlrev_b32 v23, 4, v58
    v_bfe_u32 v78, v21, 2, 2
    v_and_b32 v28, 1, v21
    v_lshl_add_u32 v28, v28, 3, v78
    v_lshl_add_u32 v79, v28, 7, v22
    s_and_b32 s54, s36, 1
    s_lshl_b32 s54, s54, 6
    s_add_u32 s54, s54, 1024
    v_and_b32 v28, 2, v21
    v_lshlrev_b32 v28, 2, v28
    v_add3_u32 v79, v79, v28, s54
    v_mov_b32 v84, 0x3f803f80
    v_bfe_u32 v28, v21, 2, 1
    v_cmp_eq_u32 vcc, v28, v58
    v_lshlrev_b32 v75, 4, v56
    v_lshl_add_u32 v75, v58, 8, v75
    v_cndmask_b32 v96, 0, v84, vcc
    v_cndmask_b32 v97, 0, v84, vcc
    v_cndmask_b32 v98, 0, v84, vcc
    v_cndmask_b32 v99, 0, v84, vcc
    v_lshl_add_u32 v3, v59, 9, v75
    v_lshl_add_u32 v4, v59, 31, v75
    v_lshlrev_b32 v28, 3, v56
    v_min_u32 v29, 1, v57
    v_lshl_add_u32 v8, v29, 31, v28
    s_lshl_b32 s56, s39, 2
    s_add_u32 s56, s56, s36
    s_mul_i32 s34, s56, 20480
    s_mul_i32 s35, s40, 2560
    s_add_u32 s34, s34, s35
    s_mul_i32 s35, s37, 327680
    s_add_u32 s34, s34, s35
    s_lshl_b32 s35, s56, 3
    s_add_u32 s35, s35, s40
    s_lshl_b32 s35, s35, 7
    s_add_u32 s35, s35, s45
    s_add_u32 s35, s35, 327680
    s_cmp_ge_u32 s2, 108
    s_cbranch_scc1 L_uwo_2
    s_mul_i32 s63, s2, 2428
    s_lshr_b32 s63, s63, 16
    s_mul_i32 s64, s63, 27
    s_sub_u32 s64, s2, s64
    s_mov_b32 s16, s28
    s_mov_b32 s17, s29
    s_mov_b32 s18, 2211840
    s_mov_b32 s62, 3456
    s_mov_b32 s42, 0
    s_mov_b32 s66, 7168
    s_lshl_b32 s68, s64, 2
    s_add_u32 s68, s68, s36
    s_mul_i32 s60, s68, 2428
    s_lshr_b32 s60, s60, 16
    s_add_u32 s60, s60, s68
    s_mul_i32 s61, s60, 9363
    s_lshr_b32 s61, s61, 16
    s_mul_i32 s61, s61, 133
    s_add_u32 s60, s60, s61
    s_mul_i32 s65, s63, 35
    s_add_u32 s65, s65, s60
    s_lshl_b32 s65, s65, 10
    s_add_u32 s65, s65, 5242880
    s_mul_i32 s69, s63, 7168
    s_lshl_b32 s68, s68, 6
    s_add_u32 s69, s69, s68
    s_add_u32 s69, s69, 262144
    s_mul_i32 s63, s63, 160
    s_branch L_uj_4
L_uwo_2:
    s_cmp_ge_u32 s2, 148
    s_cbranch_scc1 L_uw2_3
    s_sub_u32 s64, s2, 108
    s_mul_i32 s63, s64, 6554
    s_lshr_b32 s63, s63, 16
    s_mul_i32 s68, s63, 10
    s_sub_u32 s64, s64, s68
    s_mov_b32 s16, s24
    s_mov_b32 s17, s25
    s_mov_b32 s18, 819200
    s_mov_b32 s62, 1280
    s_mov_b32 s42, 1
    s_mov_b32 s66, 1024
    s_lshl_b32 s68, s64, 2
    s_add_u32 s68, s68, s36
    s_mul_i32 s68, s68, 20
    s_mul_i32 s65, s63, 5
    s_add_u32 s65, s65, s68
    s_lshl_b32 s65, s65, 10
    s_add_u32 s65, s65, 4194304
    s_mov_b32 s69, 0
    s_mul_i32 s63, s63, 160
    s_branch L_uj_4
L_uw2_3:
    s_sub_u32 s64, s2, 148
    s_mul_i32 s63, s64, 6554
    s_lshr_b32 s63, s63, 16
    s_mul_i32 s68, s63, 10
    s_sub_u32 s64, s64, s68
    s_mov_b32 s16, s30
    s_mov_b32 s17, s31
    s_mov_b32 s18, 2211840
    s_cmp_ge_u32 s2, 238
    s_addc_u32 s42, 2, 0
    s_mov_b32 s62, 1280
    s_mov_b32 s66, 1024
    s_lshl_b32 s68, s64, 2
    s_add_u32 s68, s68, s36
    s_mul_i32 s68, s68, 54
    s_mul_i32 s65, s63, 6
    s_add_u32 s65, s65, s68
    s_lshl_b32 s65, s65, 10
    s_add_u32 s65, s65, 7864320
    s_mov_b32 s69, 0
    s_mul_i32 s63, s63, 192
L_uj_4:
    s_mov_b32 s19, 0x20000
    v_lshrrev_b32 v74, 3, v21
    v_mul_lo_u32 v74, v74, s62
    v_and_b32 v28, 7, v21
    v_lshl_add_u32 v74, v28, 4, v74
    s_lshl_b32 s68, s36, 3
    s_add_u32 s63, s63, s68
    s_mul_i32 s63, s63, s62
    s_lshl_b32 s64, s64, 7
    s_add_u32 s63, s63, s64
    s_lshl_b32 s62, s62, 5
    s_cmp_eq_u32 s42, 3
    s_cselect_b32 s63, s18, s63
    s_cselect_b32 s62, 0, s62
    s_sub_u32 s68, s2, 238
    s_cmp_ge_u32 s68, 4
    s_cbranch_scc1 L_nozero_5
    s_lshl_b32 s68, s68, 4
    s_add_u32 s68, s68, s36
    s_mul_i32 s68, s68, 35840
    s_add_u32 s65, s68, 5679104
    s_mov_b32 s66, 7168
    s_mov_b32 s42, 1
L_nozero_5:
    s_mov_b32 s64, s69
    s_and_b32 s57, s36, 1
    s_lshl_b32 s56, s38, 1
    s_add_u32 s57, s57, s56
    s_mul_i32 s58, s37, 5
    s_lshr_b32 s56, s36, 1
    s_mul_i32 s56, s56, 3
    s_add_u32 s58, s58, s56
    s_mul_i32 s58, s58, 60
    s_add_u32 s58, s58, s57
    s_lshl_b32 s58, s58, 10
    s_add_u32 s58, s58, 1048576
    s_mul_i32 s61, s37, 60
    s_add_u32 s61, s61, s57
    s_lshl_b32 s61, s61, 8
    s_add_u32 s61, s61, 524288
    s_add_u32 s59, s58, 61440
    s_add_u32 s60, s58, 122880
    v_lshlrev_b32 v28, 2, v21
    s_cmp_lt_u32 s38, 30
    s_cselect_b32 s58, s58, s6
    s_cselect_b32 s59, s59, s6
    s_cselect_b32 s60, s60, s6
    s_cselect_b32 s61, s61, s6
    s_waitcnt vmcnt(4)
    s_barrier
    ds_read_b64_tr_b16 v[152:153], v79 offset:0
    ds_read_b64_tr_b16 v[154:155], v79 offset:512
    ds_read_b64_tr_b16 v[156:157], v79 offset:2048
    ds_read_b64_tr_b16 v[158:159], v79 offset:2560
    ds_read_b64_tr_b16 v[160:161], v79 offset:4096
    ds_read_b64_tr_b16 v[162:163], v79 offset:4608
    ds_read_b64_tr_b16 v[164:165], v79 offset:6144
    ds_read_b64_tr_b16 v[166:167], v79 offset:6656
    ds_read_b64_tr_b16 v[168:169], v79 offset:8192
    ds_read_b64_tr_b16 v[170:171], v79 offset:8704
    s_cmp_ge_u32 s36, 2
    s_cbranch_scc1 L_q23_6
    s_waitcnt lgkmcnt(0)
    buffer_store_dwordx4 v[152:155], v1, s[4:7], s58 offen offset:0 sc1
    buffer_store_dwordx4 v[156:159], v1, s[4:7], s59 offen offset:0 sc1
    buffer_store_dwordx4 v[160:163], v1, s[4:7], s60 offen offset:0 sc1
    s_branch L_qj_7
L_q23_6:
    s_waitcnt lgkmcnt(0)
    buffer_store_dwordx4 v[164:167], v1, s[4:7], s58 offen offset:0 sc1
    buffer_store_dwordx4 v[168:171], v1, s[4:7], s59 offen offset:0 sc1
    v_mfma_f32_32x32x16_bf16 v[184:199], v[96:99], v[152:155], 0
    v_mfma_f32_32x32x16_bf16 v[184:199], v[96:99], v[156:159], v[184:199]
    v_mfma_f32_32x32x16_bf16 v[184:199], v[96:99], v[160:163], v[184:199]
    v_mfma_f32_32x32x16_bf16 v[184:199], v[96:99], v[164:167], v[184:199]
    v_mfma_f32_32x32x16_bf16 v[184:199], v[96:99], v[168:171], v[184:199]
    s_nop 11
    ds_swizzle_b32 v185, v184 offset:0x101F
    s_waitcnt lgkmcnt(0)
    v_add_f32 v184, v184, v185
    buffer_store_dword v184, v28, s[4:7], s61 offen offset:0 sc1
L_qj_7:
    s_lshl_b32 s57, s36, 12
    s_add_u32 s57, s57, 94208
    v_lshl_add_u32 v82, v56, 6, v23
    v_add_u32 v82, s57, v82
    v_lshl_add_u32 v60, v59, 5, v82
    s_mov_b64 s[8:9], s[32:33]
    s_waitcnt vmcnt(4)
    ds_read_b128 v[120:123], v60 offset:0
    ds_read_b128 v[124:127], v60 offset:1024
    ds_read_b128 v[128:131], v82 offset:2048
    s_waitcnt lgkmcnt(0)
    buffer_store_dwordx4 v[120:123], v3, s[8:11], s34 offen offset:0 sc1
    buffer_store_dwordx4 v[124:127], v3, s[8:11], s34 offen offset:1024 sc1
    buffer_store_dwordx4 v[128:131], v4, s[8:11], s34 offen offset:2048 sc1
    v_permlane16_swap_b32 v120, v122
    v_permlane16_swap_b32 v121, v123
    v_permlane16_swap_b32 v124, v126
    v_permlane16_swap_b32 v125, v127
    v_permlane16_swap_b32 v128, v130
    v_permlane16_swap_b32 v129, v131
    v_lshlrev_b32 v32, 16, v120
    v_and_b32 v33, 0xffff0000, v120
    v_lshlrev_b32 v34, 16, v121
    v_and_b32 v35, 0xffff0000, v121
    v_lshlrev_b32 v36, 16, v122
    v_and_b32 v37, 0xffff0000, v122
    v_lshlrev_b32 v38, 16, v123
    v_and_b32 v39, 0xffff0000, v123
    v_lshlrev_b32 v40, 16, v124
    v_and_b32 v41, 0xffff0000, v124
    v_lshlrev_b32 v42, 16, v125
    v_and_b32 v43, 0xffff0000, v125
    v_lshlrev_b32 v44, 16, v126
    v_and_b32 v45, 0xffff0000, v126
    v_lshlrev_b32 v46, 16, v127
    v_and_b32 v47, 0xffff0000, v127
    v_lshlrev_b32 v48, 16, v128
    v_and_b32 v49, 0xffff0000, v128
    v_lshlrev_b32 v50, 16, v129
    v_and_b32 v51, 0xffff0000, v129
    v_pk_add_f32 v[132:133], v[32:33], v[34:35]
    v_pk_mul_f32 v[134:135], v[32:33], v[32:33]
    v_pk_fma_f32 v[134:135], v[34:35], v[34:35], v[134:135]
    v_pk_add_f32 v[132:133], v[132:133], v[36:37]
    v_pk_fma_f32 v[134:135], v[36:37], v[36:37], v[134:135]
    v_pk_add_f32 v[132:133], v[132:133], v[38:39]
    v_pk_fma_f32 v[134:135], v[38:39], v[38:39], v[134:135]
    v_pk_add_f32 v[132:133], v[132:133], v[40:41]
    v_pk_fma_f32 v[134:135], v[40:41], v[40:41], v[134:135]
    v_pk_add_f32 v[132:133], v[132:133], v[42:43]
    v_pk_fma_f32 v[134:135], v[42:43], v[42:43], v[134:135]
    v_pk_add_f32 v[132:133], v[132:133], v[44:45]
    v_pk_fma_f32 v[134:135], v[44:45], v[44:45], v[134:135]
    v_pk_add_f32 v[132:133], v[132:133], v[46:47]
    v_pk_fma_f32 v[134:135], v[46:47], v[46:47], v[134:135]
    v_pk_add_f32 v[132:133], v[132:133], v[48:49]
    v_pk_fma_f32 v[134:135], v[48:49], v[48:49], v[134:135]
    v_pk_add_f32 v[132:133], v[132:133], v[50:51]
    v_pk_fma_f32 v[134:135], v[50:51], v[50:51], v[134:135]
    v_add_f32 v132, v132, v133
    v_add_f32 v133, v134, v135
    s_nop 1
    v_permlane16_swap_b32 v132, v133
    v_add_f32 v132, v132, v133
    v_mov_b32 v133, v132
    s_nop 1
    v_permlane32_swap_b32 v132, v133
    v_add_f32 v132, v132, v133
    v_mov_b32 v133, v132
    s_nop 1
    v_permlane16_swap_b32 v132, v133
    buffer_store_dwordx2 v[132:133], v8, s[4:7], s35 offen offset:0 sc1
    s_barrier
    s_lshl_b32 s59, s36, 10
    s_add_u32 m0, s59, 114688
    s_nop 0
    buffer_load_dwordx4 v74, s[16:19], s63 offen offset:0 nt lds
    s_add_u32 s63, s63, s62
    s_add_u32 m0, m0, 4096
    s_nop 0
    buffer_load_dwordx4 v74, s[16:19], s63 offen offset:0 nt lds
    s_add_u32 s63, s63, s62
    s_add_u32 m0, m0, 4096
    s_nop 0
    buffer_load_dwordx4 v74, s[16:19], s63 offen offset:0 nt lds
    s_add_u32 s63, s63, s62
    s_add_u32 m0, m0, 4096
    s_nop 0
    buffer_load_dwordx4 v74, s[16:19], s63 offen offset:0 nt lds
    s_add_u32 s63, s63, s62
    s_add_u32 m0, m0, 4096
    s_nop 0
    buffer_load_dwordx4 v74, s[16:19], s63 offen offset:0 nt lds
    s_add_u32 s63, s63, s62
    s_add_u32 m0, m0, 4096
    s_cmp_eq_u32 s42, 2
    s_cselect_b32 s63, s63, s18
    buffer_load_dwordx4 v74, s[16:19], s63 offen offset:0 nt lds
    s_and_b32 s52, s39, 1
    s_getreg_b32 s49, hwreg(HW_REG_XCC_ID, 0, 4)
    s_mov_b32 s43, 0
    s_mov_b32 s44, 0x20000
    s_mov_b32 s50, 0
    s_mov_b32 s51, -1
    s_add_u32 s46, s45, 344064
    s_bfe_u32 s54, s38, 0x20002
    s_mul_i32 s54, s54, 27
    s_and_b32 s55, s38, 3
    s_mul_i32 s55, s55, 7
    s_add_u32 s47, s54, s55
    v_mul_u32_u24 v29, 20480, v59
    v_add_u32 v2, v29, v75
    v_mul_u32_u24 v29, 640, v59
    v_add_u32 v5, v29, v75
    v_lshl_add_u32 v6, v56, 3, v29
    v_lshl_add_u32 v6, v58, 31, v6
    v_lshlrev_b32 v28, 3, v56
    v_mul_u32_u24 v7, 55296, v57
    v_add_u32 v7, v7, v28
    v_lshlrev_b32 v9, 3, v21
    v_lshl_add_u32 v10, v59, 10, v28
    v_lshl_add_u32 v10, v58, 9, v10
    s_lshl_b32 s54, s36, 12
    s_add_u32 s54, s54, 86016
    v_add_u32 v10, s54, v10
    v_and_b32 v76, 31, v21
    v_lshlrev_b32 v24, 2, v76
    v_lshl_add_u32 v24, v58, 31, v24
    v_ashrrev_i32 v13, 1, v8
    v_and_b32 v28, 7, v21
    v_lshlrev_b32 v28, 2, v28
    v_lshl_add_u32 v28, v58, 31, v28
    v_bfe_u32 v29, v21, 3, 1
    v_lshl_add_u32 v12, v29, 7, v28
    v_mul_u32_u24 v28, 7, v59
    v_xor_b32 v28, s36, v28
    v_lshl_add_u32 v12, v28, 8, v12
    s_lshl_b32 s53, s38, 2
    s_add_u32 s53, s53, s36
    s_lshl_b32 s53, s53, 2
    s_add_u32 s53, s53, s46
    v_min_u32 v14, 1, v21
    v_lshlrev_b32 v14, 31, v14
    s_cmp_eq_u32 s36, 3
    s_cselect_b32 s54, 2147483648, 0
    v_add_u32 v25, s54, v1
    v_add_u32 v16, 114688, v1
    v_lshlrev_b32 v28, 2, v58
    v_xor_b32 v28, v28, v76
    v_lshlrev_b32 v28, 4, v28
    v_lshl_add_u32 v28, v58, 9, v28
    v_add_u32 v17, 115712, v28
    v_xor_b32 v28, 128, v28
    v_add_u32 v18, 116736, v28
    v_and_b32 v77, 3, v21
    v_lshl_add_u32 v77, v59, 2, v77
    v_lshlrev_b32 v28, 2, v77
    s_mov_b32 s54, 2004181298
    v_lshrrev_b32 v28, v28, s54
    v_bfe_u32 v29, v28, 1, 2
    v_and_b32 v28, 1, v28
    v_xor_b32 v30, v29, v58
    v_lshl_add_u32 v30, v30, 2, v78
    v_lshlrev_b32 v30, 4, v30
    v_lshl_add_u32 v30, v29, 9, v30
    v_lshl_add_u32 v30, v28, 3, v30
    v_add_u32 v19, 115712, v30
    v_xor_b32 v20, 128, v19
    s_add_u32 s54, s36, 1
    s_and_b32 s54, s54, 3
    s_mul_i32 s54, s54, 15360
    s_add_u32 s54, s54, 102400
    v_add_u32 v52, s54, v1
    s_add_u32 s54, s36, 2
    s_and_b32 s54, s54, 3
    s_mul_i32 s54, s54, 15360
    s_add_u32 s54, s54, 107520
    v_add_u32 v53, s54, v1
    s_add_u32 s54, s36, 3
    s_and_b32 s54, s54, 3
    s_mul_i32 s54, s54, 15360
    s_add_u32 s54, s54, 112640
    v_add_u32 v54, s54, v1
    s_add_u32 s54, s36, 4
    s_and_b32 s54, s54, 3
    s_mul_i32 s54, s54, 15360
    s_add_u32 s54, s54, 102400
    v_add_u32 v55, s54, v1
    v_and_b32 v28, 3, v21
    v_lshlrev_b32 v28, 3, v28
    v_lshl_add_u32 v28, v78, 7, v28
    s_lshl_b32 s54, s36, 5
    s_add_u32 s54, s54, 114688
    v_add_u32 v28, s54, v28
    s_cmp_eq_u32 s42, 1
    s_cselect_b32 s54, 20, 16
    s_lshl_b32 s54, s54, 7
    v_mul_u32_u24 v29, s54, v58
    v_lshl_add_u32 v29, v59, 10, v29
    v_add_u32 v80, v28, v29
    v_mul_u32_u24 v29, 5120, v57
    v_add_u32 v81, v28, v29
    v_mov_b32 v85, v84
    v_mov_b32 v86, v84
    v_mov_b32 v87, v84
    v_lshlrev_b32 v28, 2, v57
    v_sub_u32 v28, v56, v28
    v_cmp_gt_u32 vcc, 4, v28
    v_mov_b32 v88, 0x3f80
    v_mov_b32 v89, 0
    v_cndmask_b32 v88, 0, v88, vcc
    v_lshlrev_b32 v28, 4, v28
    v_lshlrev_b64 v[88:89], v28, v[88:89]
    v_accvgpr_write_b32 a240, 0
    v_accvgpr_write_b32 a241, 0
    v_accvgpr_write_b32 a242, v88
    v_accvgpr_write_b32 a243, v89
    v_accvgpr_write_b32 a244, 0
    v_accvgpr_write_b32 a245, 0
    s_waitcnt lgkmcnt(0)
    s_add_u32 s41, s48, 1
    s_mul_i32 s41, s41, 0x9e3779b1
    s_lshl_b32 s41, s41, 4
    s_xor_b32 s41, s41, 0x5bd1e990
    v_mov_b32 v15, s41
    v_add_u32 v0, s49, v15
    v_mad_u32_u24 v95, v59, s49, v15
    v_add_u32 v90, 56, v21
    v_lshrrev_b32 v90, 6, v90
    v_lshl_add_u32 v90, v90, 28, v1
    v_lshlrev_b32 v90, 3, v90
    v_and_b32 v29, 0x380, v90
    v_mad_u32_u24 v90, v29, 7, v90
    s_mul_i32 s57, s36, 12
    v_add_u32 v28, s57, v21
    v_lshrrev_b32 v29, 4, v28
    v_bfe_u32 v30, v28, 3, 1
    v_mul_u32_u24 v29, 640, v29
    v_mad_u32_u24 v29, v30, 19, v29
    s_mul_i32 s57, s38, 20
    v_add_u32 v29, s57, v29
    v_lshrrev_b32 v29, 6, v29
    v_and_b32 v30, 7, v28
    v_lshl_add_u32 v29, v29, 3, v30
    v_cmp_lt_u32 vcc, 11, v21
    v_mov_b32 v30, 16777216
    s_nop 0
    v_cndmask_b32 v29, v29, v30, vcc
    v_lshlrev_b32 v91, 7, v29
    s_lshl_b32 s54, s36, 6
    s_add_u32 s54, s54, s37
    s_lshl_b32 s54, s54, 7
    s_add_u32 s54, s54, 32768
    s_mov_b32 s55, 32768
    v_lshrrev_b32 v28, 3, v21
    s_mul_i32 s57, s38, 5
    v_mov_b32 v238, s36
    v_and_b32 v238, 1, v238
    v_mul_u32_u24 v29, 160, v238
    v_mad_u32_u24 v30, v238, 3, v28
    v_min_u32 v30, 9, v30
    v_add_u32 v30, 315, v30
    v_add_u32 v29, v29, v28
    v_cmp_lt_u32 vcc, 4, v28
    s_nop 1
    v_cndmask_b32 v29, v29, v30, vcc
    v_add_u32 v11, s57, v29
    v_bfe_u32 v29, v21, 2, 1
    v_xor_b32 v29, v29, v59
    v_lshl_add_u32 v11, v11, 1, v29
    v_and_b32 v239, 3, v21
    v_lshl_add_u32 v11, v11, 2, v239
    v_lshlrev_b32 v11, 4, v11
    v_add_u32 v29, v28, v238
    v_lshrrev_b32 v29, 3, v29
    v_lshl_add_u32 v11, v29, 31, v11
    v_bfe_u32 v28, v21, 2, 3
    v_mul_u32_u24 v29, 160, v58
    v_mad_u32_u24 v30, v58, 3, v28
    v_min_u32 v30, 9, v30
    v_add_u32 v30, 315, v30
    v_add_u32 v29, v29, v28
    v_cmp_lt_u32 vcc, 4, v28
    s_nop 1
    v_cndmask_b32 v29, v29, v30, vcc
    v_add_u32 v238, s57, v29
    v_lshl_add_u32 v238, v238, 3, v239
    v_lshlrev_b32 v238, 2, v238
    v_lshlrev_b32 v236, 1, v21
    v_xor_b32 v236, v236, v23
    v_and_b32 v236, 16, v236
    v_and_b32 v237, 28, v21
    v_lshl_add_u32 v236, v237, 3, v236
    v_and_b32 v237, 48, v1
    v_lshl_add_u32 v236, v236, 2, v237
    v_add_u32 v237, 41984, v236
    v_add_u32 v236, 1024, v236
    s_mul_i32 s30, s36, 40960
    s_sub_u32 s31, 286720, s30
    s_mul_i32 s32, s37, 327680
    s_add_u32 s30, s30, s32
    s_add_u32 s31, s31, s32
    s_lshl_b32 s32, s36, 11
    s_sub_u32 s33, 342016, s32
    s_add_u32 s32, s32, 327680
    s_add_u32 s32, s32, s45
    s_add_u32 s33, s33, s45
    s_waitcnt vmcnt(6)
    s_barrier
    s_cmp_lg_u32 s36, 0
    s_cbranch_scc1 L_nopost_8
    s_lshl_b32 s69, s2, 7
    s_add_u32 s69, s69, 32768
    buffer_store_dword v95, v24, s[4:7], s69 offen offset:0 sc1
L_nopost_8:
    s_lshl_b32 s68, s38, 2
    s_add_u32 s68, s68, s36
    s_mul_i32 s68, s68, 256
    s_add_u32 s68, s68, s45
    s_add_u32 s68, s68, 327680
    v_add_u32 v63, 62, v21
    v_lshrrev_b32 v63, 6, v63
    v_lshl_add_u32 v63, v63, 28, v1
    v_lshlrev_b32 v63, 3, v63
    buffer_load_dword a252, v63, s[4:7], s68 offen offset:0 sc1
    s_cmp_eq_u32 s36, 0
    s_cbranch_scc1 L_chain0_0_0
    s_cmp_eq_u32 s36, 1
    s_cbranch_scc1 L_chain0_1_0
    s_cmp_eq_u32 s36, 2
    s_cbranch_scc1 L_chain0_2_0
    s_branch L_chain0_3_0
L_chainret0:
    s_waitcnt vmcnt(1)
    s_barrier
    s_cmp_eq_u32 s42, 1
    s_cbranch_scc1 L_trwo_9
    ds_read_b64_tr_b16 a[0:1], v80 offset:0
    ds_read_b64_tr_b16 a[2:3], v80 offset:512
    ds_read_b64_tr_b16 a[4:5], v80 offset:4096
    ds_read_b64_tr_b16 a[6:7], v80 offset:4608
    ds_read_b64_tr_b16 a[8:9], v80 offset:8192
    ds_read_b64_tr_b16 a[10:11], v80 offset:8704
    ds_read_b64_tr_b16 a[12:13], v80 offset:12288
    ds_read_b64_tr_b16 a[14:15], v80 offset:12800
    ds_read_b64_tr_b16 a[16:17], v80 offset:16384
    ds_read_b64_tr_b16 a[18:19], v80 offset:16896
    ds_read_b64_tr_b16 a[20:21], v80 offset:20480
    ds_read_b64_tr_b16 a[22:23], v80 offset:20992
    s_branch L_trst_10
L_trwo_9:
    ds_read_b64_tr_b16 a[0:1], v80 offset:0
    ds_read_b64_tr_b16 a[2:3], v80 offset:512
    ds_read_b64_tr_b16 a[4:5], v80 offset:5120
    ds_read_b64_tr_b16 a[6:7], v80 offset:5632
    ds_read_b64_tr_b16 a[8:9], v80 offset:10240
    ds_read_b64_tr_b16 a[10:11], v80 offset:10752
    ds_read_b64_tr_b16 a[12:13], v80 offset:15360
    ds_read_b64_tr_b16 a[14:15], v80 offset:15872
    ds_read_b64_tr_b16 a[16:17], v81 offset:2048
    ds_read_b64_tr_b16 a[18:19], v81 offset:4608
L_trst_10:
    s_waitcnt lgkmcnt(0)
    v_mfma_f32_16x16x32_bf16 a[24:27], v[84:87], a[0:3], 0
    v_mfma_f32_16x16x32_bf16 a[24:27], v[84:87], a[4:7], a[24:27]
    v_mfma_f32_16x16x32_bf16 a[24:27], v[84:87], a[8:11], a[24:27]
    v_mfma_f32_16x16x32_bf16 a[24:27], v[84:87], a[12:15], a[24:27]
    v_mfma_f32_16x16x32_bf16 a[24:27], v[84:87], a[16:19], a[24:27]
    s_cmp_eq_u32 s42, 3
    s_cbranch_scc1 L_nost_11
    buffer_store_dwordx4 a[0:3], v1, s[4:7], s65 offen offset:0 sc1
    s_add_u32 s65, s65, s66
L_nost_11:
    s_cmp_eq_u32 s42, 3
    s_cbranch_scc1 L_nost_12
    buffer_store_dwordx4 a[4:7], v1, s[4:7], s65 offen offset:0 sc1
    s_add_u32 s65, s65, s66
L_nost_12:
    s_cmp_eq_u32 s42, 3
    s_cbranch_scc1 L_nost_13
    buffer_store_dwordx4 a[8:11], v1, s[4:7], s65 offen offset:0 sc1
    s_add_u32 s65, s65, s66
L_nost_13:
    s_cmp_eq_u32 s42, 3
    s_cbranch_scc1 L_nost_14
    buffer_store_dwordx4 a[12:15], v1, s[4:7], s65 offen offset:0 sc1
    s_add_u32 s65, s65, s66
L_nost_14:
    s_cmp_eq_u32 s42, 3
    s_cbranch_scc1 L_nost_15
    buffer_store_dwordx4 a[16:19], v1, s[4:7], s65 offen offset:0 sc1
    s_add_u32 s65, s65, s66
L_nost_15:
    s_cmp_lg_u32 s42, 2
    s_cbranch_scc1 L_nost_16
    buffer_store_dwordx4 a[20:23], v1, s[4:7], s65 offen offset:0 sc1
    s_add_u32 s65, s65, s66
L_nost_16:
    s_cmp_lg_u32 s42, 0
    s_cbranch_scc1 L_nost_17
    buffer_store_dword a24, v13, s[4:7], s64 offen offset:0 sc1
L_nost_17:
    buffer_load_dword v93, v91, s[4:7], s55 offen offset:0 sc1
    buffer_load_dword v92, v90, s[4:7], s54 offen offset:0 sc1
    s_waitcnt vmcnt(1)
    v_cmp_ne_u32 vcc, v93, v15
    s_nop 0
    s_and_b32 vcc_hi, vcc_lo, 4095
    s_cbranch_scc0 L_stok_18
L_poll_19:
    buffer_load_dword v93, v91, s[4:7], s55 offen offset:0 sc1
    s_waitcnt vmcnt(0)
    v_cmp_ne_u32 vcc, v93, v15
    s_nop 0
    s_and_b32 vcc_hi, vcc_lo, 4095
    s_cbranch_scc0 L_polled_20
    s_sub_u32 s44, s44, 1
    s_cbranch_scc0 L_poll_19
    s_mov_b32 s44, 0
L_polled_20:
L_stok_18:
    s_waitcnt vmcnt(0)
    v_cmp_ne_u32 vcc, v92, v15
    s_nop 0
    s_and_b32 vcc_hi, vcc_lo, 255
    s_cbranch_scc0 L_stok_21
L_poll_22:
    buffer_load_dword v92, v90, s[4:7], s54 offen offset:0 sc1
    s_waitcnt vmcnt(0)
    v_cmp_ne_u32 vcc, v92, v15
    s_nop 0
    s_and_b32 vcc_hi, vcc_lo, 255
    s_cbranch_scc0 L_polled_23
    s_sub_u32 s44, s44, 1
    s_cbranch_scc0 L_poll_22
    s_mov_b32 s44, 0
L_polled_23:
L_stok_21:
    s_barrier
    s_branch L_p1first
    .p2align 12
L_p1first:
L_ph0:
    s_lshr_b32 s28, s36, 1
    s_mul_i32 s28, s28, 61440
    s_add_u32 s28, s28, 1048576
    s_lshl_b32 s29, s36, 10
    s_add_u32 m0, s29, 1024
    s_nop 0
    buffer_load_dwordx4 v11, s[4:7], s28 offen offset:0 sc1 lds
    buffer_load_dwordx4 v[144:147], v2, s[8:11], s31 offen offset:0 sc1
    s_add_u32 s28, s28, 122880
    s_add_u32 m0, s29, 5120
    s_nop 0
    buffer_load_dwordx4 v11, s[4:7], s28 offen offset:0 sc1 lds
    buffer_load_dwordx4 v[148:151], v2, s[8:11], s30 offen offset:0 sc1
    s_add_u32 s28, s28, 122880
    s_add_u32 m0, s29, 9216
    s_nop 0
    buffer_load_dwordx4 v11, s[4:7], s28 offen offset:0 sc1 lds
    buffer_load_dwordx4 v[152:155], v2, s[8:11], s31 offen offset:512 sc1
    buffer_load_dwordx4 v[156:159], v2, s[8:11], s30 offen offset:512 sc1
    buffer_load_dwordx4 v[160:163], v2, s[8:11], s31 offen offset:1024 sc1
    buffer_load_dwordx4 v[164:167], v2, s[8:11], s30 offen offset:1024 sc1
    buffer_load_dwordx4 v[168:171], v2, s[8:11], s31 offen offset:1536 sc1
    buffer_load_dwordx4 v[172:175], v2, s[8:11], s30 offen offset:1536 sc1
    s_waitcnt vmcnt(8)
    s_barrier
    ds_read_b128 v[120:123], v236 offset:0
    ds_read_b128 v[124:127], v236 offset:1024
    s_cmp_lg_u32 s36, 3
    s_cbranch_scc1 L_nofw_24
    s_lshl_b32 s69, s2, 7
    s_add_u32 s69, s69, 65536
    buffer_store_dword v15, v24, s[4:7], s69 offen offset:0 sc1
L_nofw_24:
    s_waitcnt lgkmcnt(0)
    v_mfma_f32_32x32x16_bf16 v[88:103], v[120:123], v[144:147], 0
    ds_read_b128 v[128:131], v236 offset:2048
    s_add_u32 s28, s28, 122880
    s_add_u32 m0, s29, 13312
    s_nop 0
    buffer_load_dwordx4 v11, s[4:7], s28 offen offset:0 sc1 lds
    v_mfma_f32_32x32x16_bf16 v[104:119], v[124:127], v[144:147], 0
    ds_read_b128 v[132:135], v236 offset:3072
    buffer_load_dwordx4 v[176:179], v2, s[8:11], s31 offen offset:2048 sc1
    buffer_load_dwordx4 v[180:183], v2, s[8:11], s30 offen offset:2048 sc1
    s_waitcnt vmcnt(10)
    v_mfma_f32_32x32x16_bf16 v[56:71], v[120:123], v[148:151], 0
    v_mfma_f32_32x32x16_bf16 v[72:87], v[124:127], v[148:151], 0
    buffer_load_dwordx4 v[184:187], v2, s[8:11], s31 offen offset:2560 sc1
    buffer_load_dwordx4 v[188:191], v2, s[8:11], s30 offen offset:2560 sc1
    s_waitcnt vmcnt(10) lgkmcnt(0)
    v_mfma_f32_32x32x16_bf16 v[88:103], v[128:131], v[152:155], v[88:103]
    ds_read_b128 v[136:139], v236 offset:4096
    s_add_u32 s28, s28, 122880
    s_add_u32 m0, s29, 17408
    s_nop 0
    buffer_load_dwordx4 v11, s[4:7], s28 offen offset:0 sc1 lds
    v_mfma_f32_32x32x16_bf16 v[104:119], v[132:135], v[152:155], v[104:119]
    ds_read_b128 v[140:143], v236 offset:5120
    buffer_load_dwordx4 v[144:147], v2, s[8:11], s31 offen offset:3072 sc1
    buffer_load_dwordx4 v[148:151], v2, s[8:11], s30 offen offset:3072 sc1
    s_waitcnt vmcnt(12)
    v_mfma_f32_32x32x16_bf16 v[56:71], v[128:131], v[156:159], v[56:71]
    v_mfma_f32_32x32x16_bf16 v[72:87], v[132:135], v[156:159], v[72:87]
    buffer_load_dwordx4 v[152:155], v2, s[8:11], s31 offen offset:3584 sc1
    buffer_load_dwordx4 v[156:159], v2, s[8:11], s30 offen offset:3584 sc1
    s_waitcnt vmcnt(13) lgkmcnt(0)
    v_mfma_f32_32x32x16_bf16 v[88:103], v[136:139], v[160:163], v[88:103]
    ds_read_b128 v[120:123], v236 offset:6144
    s_add_u32 s28, s28, 122880
    s_add_u32 m0, s29, 21504
    s_nop 0
    buffer_load_dwordx4 v11, s[4:7], s28 offen offset:0 sc1 lds
    v_mfma_f32_32x32x16_bf16 v[104:119], v[140:143], v[160:163], v[104:119]
    ds_read_b128 v[124:127], v236 offset:7168
    s_add_u32 s31, s31, 4096
    buffer_load_dwordx4 v[160:163], v2, s[8:11], s31 offen offset:0 sc1
    s_waitcnt vmcnt(14)
    v_mfma_f32_32x32x16_bf16 v[56:71], v[136:139], v[164:167], v[56:71]
    v_mfma_f32_32x32x16_bf16 v[72:87], v[140:143], v[164:167], v[72:87]
    s_add_u32 s30, s30, 4096
    buffer_load_dwordx4 v[164:167], v2, s[8:11], s30 offen offset:0 sc1
    s_waitcnt vmcnt(12)
    s_barrier
    s_waitcnt lgkmcnt(0)
    v_mfma_f32_32x32x16_bf16 v[88:103], v[120:123], v[168:171], v[88:103]
    ds_read_b128 v[128:131], v236 offset:8192
    v_mfma_f32_32x32x16_bf16 v[104:119], v[124:127], v[168:171], v[104:119]
    ds_read_b128 v[132:135], v236 offset:9216
    buffer_load_dwordx4 v[168:171], v2, s[8:11], s31 offen offset:512 sc1
    v_mfma_f32_32x32x16_bf16 v[56:71], v[120:123], v[172:175], v[56:71]
    s_add_u32 s28, s28, 122880
    s_add_u32 m0, s29, 25600
    s_nop 0
    buffer_load_dwordx4 v11, s[4:7], s28 offen offset:0 sc1 lds
    v_mfma_f32_32x32x16_bf16 v[72:87], v[124:127], v[172:175], v[72:87]
    buffer_load_dwordx4 v[172:175], v2, s[8:11], s30 offen offset:512 sc1
    s_waitcnt vmcnt(14) lgkmcnt(0)
    v_mfma_f32_32x32x16_bf16 v[88:103], v[128:131], v[176:179], v[88:103]
    ds_read_b128 v[136:139], v236 offset:10240
    v_mfma_f32_32x32x16_bf16 v[104:119], v[132:135], v[176:179], v[104:119]
    ds_read_b128 v[140:143], v236 offset:11264
    buffer_load_dwordx4 v[176:179], v2, s[8:11], s31 offen offset:1024 sc1
    s_waitcnt vmcnt(14)
    v_mfma_f32_32x32x16_bf16 v[56:71], v[128:131], v[180:183], v[56:71]
    s_add_u32 s28, s28, 122880
    s_add_u32 m0, s29, 29696
    s_nop 0
    buffer_load_dwordx4 v11, s[4:7], s28 offen offset:0 sc1 lds
    v_mfma_f32_32x32x16_bf16 v[72:87], v[132:135], v[180:183], v[72:87]
    buffer_load_dwordx4 v[180:183], v2, s[8:11], s30 offen offset:1024 sc1
    s_waitcnt vmcnt(15) lgkmcnt(0)
    v_mfma_f32_32x32x16_bf16 v[88:103], v[136:139], v[184:187], v[88:103]
    ds_read_b128 v[120:123], v236 offset:12288
    v_mfma_f32_32x32x16_bf16 v[104:119], v[140:143], v[184:187], v[104:119]
    ds_read_b128 v[124:127], v236 offset:13312
    buffer_load_dwordx4 v[184:187], v2, s[8:11], s31 offen offset:1536 sc1
    s_waitcnt vmcnt(15)
    v_mfma_f32_32x32x16_bf16 v[56:71], v[136:139], v[188:191], v[56:71]
    s_add_u32 s28, s28, 122880
    s_add_u32 m0, s29, 33792
    s_nop 0
    buffer_load_dwordx4 v11, s[4:7], s28 offen offset:0 sc1 lds
    v_mfma_f32_32x32x16_bf16 v[72:87], v[140:143], v[188:191], v[72:87]
    buffer_load_dwordx4 v[188:191], v2, s[8:11], s30 offen offset:1536 sc1
    s_waitcnt vmcnt(15) lgkmcnt(0)
    v_mfma_f32_32x32x16_bf16 v[88:103], v[120:123], v[144:147], v[88:103]
    ds_read_b128 v[128:131], v236 offset:14336
    v_mfma_f32_32x32x16_bf16 v[104:119], v[124:127], v[144:147], v[104:119]
    ds_read_b128 v[132:135], v236 offset:15360
    buffer_load_dwordx4 v[144:147], v2, s[8:11], s31 offen offset:2048 sc1
    s_waitcnt vmcnt(15)
    v_mfma_f32_32x32x16_bf16 v[56:71], v[120:123], v[148:151], v[56:71]
    v_mfma_f32_32x32x16_bf16 v[72:87], v[124:127], v[148:151], v[72:87]
    buffer_load_dwordx4 v[148:151], v2, s[8:11], s30 offen offset:2048 sc1
    s_waitcnt vmcnt(13)
    s_barrier
    s_waitcnt lgkmcnt(0)
    v_mfma_f32_32x32x16_bf16 v[88:103], v[128:131], v[152:155], v[88:103]
    ds_read_b128 v[136:139], v236 offset:16384
    s_add_u32 s28, s28, 122880
    s_add_u32 m0, s29, 37888
    s_nop 0
    buffer_load_dwordx4 v11, s[4:7], s28 offen offset:0 sc1 lds
    v_mfma_f32_32x32x16_bf16 v[104:119], v[132:135], v[152:155], v[104:119]
    ds_read_b128 v[140:143], v236 offset:17408
    buffer_load_dwordx4 v[152:155], v2, s[8:11], s31 offen offset:2560 sc1
    v_mfma_f32_32x32x16_bf16 v[56:71], v[128:131], v[156:159], v[56:71]
    v_mfma_f32_32x32x16_bf16 v[72:87], v[132:135], v[156:159], v[72:87]
    buffer_load_dwordx4 v[156:159], v2, s[8:11], s30 offen offset:2560 sc1
    s_waitcnt vmcnt(15) lgkmcnt(0)
    v_mfma_f32_32x32x16_bf16 v[88:103], v[136:139], v[160:163], v[88:103]
    ds_read_b128 v[120:123], v236 offset:18432
    s_add_u32 s28, s28, 122880
    s_add_u32 m0, s29, 41984
    s_nop 0
    buffer_load_dwordx4 v11, s[4:7], s28 offen offset:0 sc1 lds
    v_mfma_f32_32x32x16_bf16 v[104:119], v[140:143], v[160:163], v[104:119]
    ds_read_b128 v[124:127], v236 offset:19456
    buffer_load_dwordx4 v[160:163], v2, s[8:11], s31 offen offset:3072 sc1
    s_waitcnt vmcnt(16)
    v_mfma_f32_32x32x16_bf16 v[56:71], v[136:139], v[164:167], v[56:71]
    v_mfma_f32_32x32x16_bf16 v[72:87], v[140:143], v[164:167], v[72:87]
    buffer_load_dwordx4 v[164:167], v2, s[8:11], s30 offen offset:3072 sc1
    s_waitcnt vmcnt(16) lgkmcnt(0)
    v_mfma_f32_32x32x16_bf16 v[88:103], v[120:123], v[168:171], v[88:103]
    ds_read_b128 v[128:131], v236 offset:20480
    s_add_u32 s28, s28, 122880
    s_add_u32 m0, s29, 46080
    s_nop 0
    buffer_load_dwordx4 v11, s[4:7], s28 offen offset:0 sc1 lds
    s_lshl_b32 s67, s36, 12
    s_add_u32 m0, s67, 96256
    s_nop 0
    buffer_load_dwordx4 v1, s[4:7], s33 offen offset:0 sc1 lds
    buffer_load_dwordx4 v1, s[4:7], s33 offen offset:1024 sc1 lds
    v_mfma_f32_32x32x16_bf16 v[104:119], v[124:127], v[168:171], v[104:119]
    ds_read_b128 v[132:135], v236 offset:21504
    buffer_load_dwordx4 v[168:171], v2, s[8:11], s31 offen offset:3584 sc1
    s_waitcnt vmcnt(18)
    v_mfma_f32_32x32x16_bf16 v[56:71], v[120:123], v[172:175], v[56:71]
    s_lshl_b32 s67, s36, 12
    s_add_u32 m0, s67, 94208
    s_nop 0
    buffer_load_dwordx4 v1, s[4:7], s32 offen offset:0 sc1 lds
    buffer_load_dwordx4 v1, s[4:7], s32 offen offset:1024 sc1 lds
    v_mfma_f32_32x32x16_bf16 v[72:87], v[124:127], v[172:175], v[72:87]
    buffer_load_dwordx4 v[172:175], v2, s[8:11], s30 offen offset:3584 sc1
    s_waitcnt vmcnt(20) lgkmcnt(0)
    v_mfma_f32_32x32x16_bf16 v[88:103], v[128:131], v[176:179], v[88:103]
    ds_read_b128 v[136:139], v236 offset:22528
    s_mul_i32 s58, s36, 30720
    s_add_u32 s58, s58, 524288
    buffer_load_dword v208, v238, s[4:7], s58 offen offset:0 sc1
    s_add_u32 s58, s58, 15360
    buffer_load_dword v209, v238, s[4:7], s58 offen offset:0 sc1
    s_mul_i32 s56, s36, 3072
    s_sub_u32 s57, 21504, s56
    s_mul_i32 s58, s38, 27648
    s_add_u32 s63, s58, s45
    s_add_u32 s58, s63, 4440064
    s_cmp_eq_u32 s37, 7
    s_cselect_b32 s61, 0x10000000, s58
    v_mfma_f32_32x32x16_bf16 v[104:119], v[132:135], v[176:179], v[104:119]
    ds_read_b128 v[140:143], v236 offset:23552
    s_add_u32 s31, s31, 4096
    buffer_load_dwordx4 v[176:179], v2, s[8:11], s31 offen offset:0 sc1
    s_sub_u32 s59, s53, s46
    s_lshl_b32 s59, s59, 6
    s_mul_i32 s60, s37, 131072
    s_add_u32 s59, s59, s60
    s_add_u32 s59, s59, 10518528
    s_sub_u32 s60, s59, 131072
    v_mov_b32 v31, 0x3f80
    s_waitcnt vmcnt(21)
    v_mfma_f32_32x32x16_bf16 v[56:71], v[128:131], v[180:183], v[56:71]
    s_add_u32 s28, s28, 122880
    s_add_u32 m0, s29, 50176
    s_nop 0
    buffer_load_dwordx4 v11, s[4:7], s28 offen offset:0 sc1 lds
    s_cmp_eq_u32 s37, 0
    s_cselect_b32 s62, 2147483648, 0
    s_cselect_b32 s60, s6, s60
    s_add_u32 s63, s63, 372736
    v_mul_u32_u24 v255, 1696, v23
    v_add_u32 v255, v255, v1
    s_and_b32 s21, s38, 15
    v_mfma_f32_32x32x16_bf16 v[72:87], v[132:135], v[180:183], v[72:87]
    s_add_u32 s30, s30, 4096
    buffer_load_dwordx4 v[180:183], v2, s[8:11], s30 offen offset:0 sc1
    s_mul_i32 s21, s21, 143360
    s_lshl_b32 s22, s36, 12
    s_add_u32 s21, s21, s22
    s_barrier
    s_waitcnt vmcnt(22) lgkmcnt(0)
    v_mfma_f32_32x32x16_bf16 v[88:103], v[136:139], v[184:187], v[88:103]
    ds_read_b128 v[120:123], v236 offset:24576
    s_add_u32 s21, s21, 5226496
    s_mul_i32 s18, s36, 221184
    s_add_u32 s18, s18, s45
    v_mfma_f32_32x32x16_bf16 v[104:119], v[140:143], v[184:187], v[104:119]
    ds_read_b128 v[124:127], v236 offset:25600
    buffer_load_dwordx4 v[184:187], v2, s[8:11], s31 offen offset:512 sc1
    s_add_u32 s18, s18, 372736
    s_lshl_b32 s19, s39, 2
    s_add_u32 s12, s36, 1
    s_waitcnt vmcnt(21)
    v_mfma_f32_32x32x16_bf16 v[56:71], v[136:139], v[188:191], v[56:71]
    s_add_u32 s28, s28, 122880
    s_add_u32 m0, s29, 54272
    s_nop 0
    buffer_load_dwordx4 v11, s[4:7], s28 offen offset:0 sc1 lds
    s_and_b32 s12, s12, 3
    s_add_u32 s12, s12, s19
    s_mul_i32 s12, s12, 640
    v_mfma_f32_32x32x16_bf16 v[72:87], v[140:143], v[188:191], v[72:87]
    buffer_load_dwordx4 v[188:191], v2, s[8:11], s30 offen offset:512 sc1
    s_add_u32 s12, s12, s18
    s_add_u32 s13, s36, 2
    s_and_b32 s13, s13, 3
    s_waitcnt vmcnt(22) lgkmcnt(0)
    v_mfma_f32_32x32x16_bf16 v[88:103], v[120:123], v[144:147], v[88:103]
    ds_read_b128 v[128:131], v236 offset:26624
    s_add_u32 s13, s13, s19
    s_mul_i32 s13, s13, 640
    s_add_u32 s13, s13, s18
    v_mfma_f32_32x32x16_bf16 v[104:119], v[124:127], v[144:147], v[104:119]
    ds_read_b128 v[132:135], v236 offset:27648
    buffer_load_dwordx4 v[144:147], v2, s[8:11], s31 offen offset:1024 sc1
    s_add_u32 s14, s36, 3
    s_and_b32 s14, s14, 3
    s_add_u32 s14, s14, s19
    s_waitcnt vmcnt(22)
    v_mfma_f32_32x32x16_bf16 v[56:71], v[120:123], v[148:151], v[56:71]
    s_add_u32 s28, s28, 122880
    s_add_u32 m0, s29, 58368
    s_nop 0
    buffer_load_dwordx4 v11, s[4:7], s28 offen offset:0 sc1 lds
    s_mul_i32 s14, s14, 640
    s_add_u32 s14, s14, s18
    s_add_u32 s15, s36, 4
    v_mfma_f32_32x32x16_bf16 v[72:87], v[124:127], v[148:151], v[72:87]
    buffer_load_dwordx4 v[148:151], v2, s[8:11], s30 offen offset:1024 sc1
    s_and_b32 s15, s15, 3
    s_add_u32 s15, s15, s19
    s_mul_i32 s15, s15, 640
    s_waitcnt vmcnt(22) lgkmcnt(0)
    v_mfma_f32_32x32x16_bf16 v[88:103], v[128:131], v[152:155], v[88:103]
    ds_read_b128 v[136:139], v236 offset:28672
    s_add_u32 s15, s15, s18
    s_lshr_b32 s19, s39, 1
    s_sub_u32 s16, 2, s19
    v_mfma_f32_32x32x16_bf16 v[104:119], v[132:135], v[152:155], v[104:119]
    ds_read_b128 v[140:143], v236 offset:29696
    buffer_load_dwordx4 v[152:155], v2, s[8:11], s31 offen offset:1536 sc1
    s_add_u32 s18, s39, 1
    s_bfe_u32 s18, s18, 0x10001
    s_lshl_b32 s18, s18, 9
    s_waitcnt vmcnt(22)
    v_mfma_f32_32x32x16_bf16 v[56:71], v[128:131], v[156:159], v[56:71]
    s_lshl_b32 s19, s36, 7
    s_add_u32 s18, s18, s19
    s_add_u32 s17, s18, s46
    v_mfma_f32_32x32x16_bf16 v[72:87], v[132:135], v[156:159], v[72:87]
    buffer_load_dwordx4 v[156:159], v2, s[8:11], s30 offen offset:1536 sc1
    s_lshr_b32 s41, s36, 1
    s_lshl_b32 s41, s41, 2
    s_add_u32 s41, s41, s39
    s_waitcnt vmcnt(21) lgkmcnt(0)
    v_mfma_f32_32x32x16_bf16 v[88:103], v[136:139], v[160:163], v[88:103]
    ds_read_b128 v[120:123], v236 offset:30720
    s_add_u32 s28, s28, 122880
    s_add_u32 m0, s29, 62464
    s_nop 0
    buffer_load_dwordx4 v11, s[4:7], s28 offen offset:0 sc1 lds
    s_lshl_b32 s41, s41, 4
    s_add_u32 s41, s41, s40
    s_lshl_b32 s41, s41, 1
    v_mfma_f32_32x32x16_bf16 v[104:119], v[140:143], v[160:163], v[104:119]
    ds_read_b128 v[124:127], v236 offset:31744
    buffer_load_dwordx4 v[160:163], v2, s[8:11], s31 offen offset:2048 sc1
    s_and_b32 s18, s36, 1
    s_add_u32 s41, s41, s18
    s_lshl_b32 s41, s41, 2
    s_waitcnt vmcnt(22)
    v_mfma_f32_32x32x16_bf16 v[56:71], v[136:139], v[164:167], v[56:71]
    s_add_u32 s41, s41, s46
    s_add_u32 s41, s41, 1024
    s_lshl_b32 s49, s39, 2
    v_mfma_f32_32x32x16_bf16 v[72:87], v[140:143], v[164:167], v[72:87]
    buffer_load_dwordx4 v[164:167], v2, s[8:11], s30 offen offset:2048 sc1
    s_add_u32 s49, s49, s36
    s_lshl_b32 s49, s49, 5
    s_add_u32 s49, s49, s40
    s_barrier
    s_waitcnt vmcnt(19) lgkmcnt(0)
    v_mfma_f32_32x32x16_bf16 v[88:103], v[120:123], v[168:171], v[88:103]
    ds_read_b128 v[128:131], v236 offset:32768
    s_add_u32 s28, s28, 122880
    s_add_u32 m0, s29, 66560
    s_nop 0
    buffer_load_dwordx4 v11, s[4:7], s28 offen offset:0 sc1 lds
    s_lshl_b32 s49, s49, 2
    s_add_u32 s49, s49, s46
    s_add_u32 s49, s49, 2048
    v_mfma_f32_32x32x16_bf16 v[104:119], v[124:127], v[168:171], v[104:119]
    ds_read_b128 v[132:135], v236 offset:33792
    buffer_load_dwordx4 v[168:171], v2, s[8:11], s31 offen offset:2560 sc1
    s_waitcnt vmcnt(18)
    v_mfma_f32_32x32x16_bf16 v[56:71], v[120:123], v[172:175], v[56:71]
    v_mfma_f32_32x32x16_bf16 v[72:87], v[124:127], v[172:175], v[72:87]
    buffer_load_dwordx4 v[172:175], v2, s[8:11], s30 offen offset:2560 sc1
    s_waitcnt vmcnt(16) lgkmcnt(0)
    v_mfma_f32_32x32x16_bf16 v[88:103], v[128:131], v[176:179], v[88:103]
    ds_read_b128 v[136:139], v236 offset:34816
    s_add_u32 s28, s28, 122880
    s_add_u32 m0, s29, 70656
    s_nop 0
    buffer_load_dwordx4 v11, s[4:7], s28 offen offset:0 sc1 lds
    v_mfma_f32_32x32x16_bf16 v[104:119], v[132:135], v[176:179], v[104:119]
    ds_read_b128 v[140:143], v236 offset:35840
    buffer_load_dwordx4 v[176:179], v2, s[8:11], s31 offen offset:3072 sc1
    s_waitcnt vmcnt(16)
    v_mfma_f32_32x32x16_bf16 v[56:71], v[128:131], v[180:183], v[56:71]
    v_mfma_f32_32x32x16_bf16 v[72:87], v[132:135], v[180:183], v[72:87]
    buffer_load_dwordx4 v[180:183], v2, s[8:11], s30 offen offset:3072 sc1
    s_waitcnt vmcnt(16) lgkmcnt(0)
    v_mfma_f32_32x32x16_bf16 v[88:103], v[136:139], v[184:187], v[88:103]
    ds_read_b128 v[120:123], v236 offset:36864
    v_mfma_f32_32x32x16_bf16 v[104:119], v[140:143], v[184:187], v[104:119]
    ds_read_b128 v[124:127], v236 offset:37888
    buffer_load_dwordx4 v[184:187], v2, s[8:11], s31 offen offset:3584 sc1
    s_waitcnt vmcnt(15)
    v_mfma_f32_32x32x16_bf16 v[56:71], v[136:139], v[188:191], v[56:71]
    s_add_u32 s28, s28, 122880
    s_add_u32 m0, s29, 74752
    s_nop 0
    buffer_load_dwordx4 v11, s[4:7], s28 offen offset:0 sc1 lds
    v_mfma_f32_32x32x16_bf16 v[72:87], v[140:143], v[188:191], v[72:87]
    buffer_load_dwordx4 v[188:191], v2, s[8:11], s30 offen offset:3584 sc1
    s_waitcnt vmcnt(16) lgkmcnt(0)
    v_mfma_f32_32x32x16_bf16 v[88:103], v[120:123], v[144:147], v[88:103]
    ds_read_b128 v[128:131], v236 offset:38912
    s_mul_i32 s64, s40, 5
    s_lshr_b32 s64, s64, 2
    s_add_u32 s65, s64, 108
    v_and_b32 v240, 3, v21
    v_bfe_u32 v241, v21, 2, 2
    v_and_b32_e64 v242, 1, v241
    v_mad_u32_u24 v244, v240, 10, v242
    v_add_u32 v244, s65, v244
    s_lshr_b32 s65, s47, 2
    v_min_u32 v241, 2, v241
    v_add_u32 v241, s65, v241
    v_min_u32_e64 v241, 26, v241
    v_mad_u32_u24 v241, v240, 27, v241
    v_cmp_lt_u32_e64 vcc, 15, v21
    s_mul_i32 s65, s52, 40
    s_add_u32 s65, s65, s64
    s_add_u32 s65, s65, 148
    v_cndmask_b32_e64 v244, v244, v241, vcc
    v_bfe_u32 v241, v21, 1, 3
    v_min_u32 v241, 4, v241
    v_and_b32 v242, 1, v21
    v_mad_u32_u24 v241, v241, 10, v242
    v_add_u32_e64 v241, s65, v241
    v_cndmask_b32 v244, v244, v241, s[50:51]
    v_cmp_lt_u32 vcc, 47, v21
    v_and_b32 v241, 7, v21
    v_lshl_add_u32 v241, s38, 3, v241
    v_cndmask_b32 v244, v244, v241, vcc
    v_lshlrev_b32 v244, 7, v244
    s_mov_b32 s64, 65536
    s_lshl_b32 s65, s37, 7
    s_add_u32 s65, s65, 32768
    v_lshlrev_b32 v241, 10, v21
    v_lshl_add_u32 v241, v23, 27, v241
    buffer_load_dword v240, v244, s[4:7], s64 offen offset:0 sc1
    buffer_load_dword v241, v241, s[4:7], s65 offen offset:64 sc1
    v_add_f32 v208, v208, v209
    v_lshlrev_b32 v238, 2, v21
    v_add_u32 v238, 110592, v238
    v_lshl_add_u32 v239, s36, 8, v238
    v_mfma_f32_32x32x16_bf16 v[104:119], v[124:127], v[144:147], v[104:119]
    ds_read_b128 v[132:135], v236 offset:39936
    s_add_u32 s31, s31, 4096
    buffer_load_dwordx4 v[144:147], v2, s[8:11], s31 offen offset:0 sc1
    ds_write_b32 v239, v208
    ds_read_b64 v[200:201], v10 offset:10240
    ds_read_b64 v[202:203], v10 offset:10368
    s_waitcnt vmcnt(17)
    v_mfma_f32_32x32x16_bf16 v[56:71], v[120:123], v[148:151], v[56:71]
    s_add_u32 s28, s28, 122880
    s_add_u32 m0, s29, 78848
    s_nop 0
    buffer_load_dwordx4 v11, s[4:7], s28 offen offset:0 sc1 lds
    ds_read_b64 v[204:205], v10 offset:10496
    ds_read_b64 v[206:207], v10 offset:10624
    ds_read_b64 v[192:193], v10 offset:8192
    v_mfma_f32_32x32x16_bf16 v[72:87], v[124:127], v[148:151], v[72:87]
    s_add_u32 s30, s30, 4096
    buffer_load_dwordx4 v[148:151], v2, s[8:11], s30 offen offset:0 sc1
    ds_read_b64 v[194:195], v10 offset:8320
    ds_read_b64 v[196:197], v10 offset:8448
    ds_read_b64 v[198:199], v10 offset:8576
    s_waitcnt vmcnt(18) lgkmcnt(9)
    v_mfma_f32_32x32x16_bf16 v[88:103], v[128:131], v[152:155], v[88:103]
    ds_read_b128 v[136:139], v237 offset:0
    v_mfma_f32_32x32x16_bf16 v[104:119], v[132:135], v[152:155], v[104:119]
    ds_read_b128 v[140:143], v237 offset:1024
    buffer_load_dwordx4 v[152:155], v2, s[8:11], s31 offen offset:512 sc1
    s_waitcnt vmcnt(18)
    v_mfma_f32_32x32x16_bf16 v[56:71], v[128:131], v[156:159], v[56:71]
    s_waitcnt lgkmcnt(2)
    v_add_f32 v200, v200, v204
    v_add_f32_e64 v201, v201, v205
    v_mfma_f32_32x32x16_bf16 v[72:87], v[132:135], v[156:159], v[72:87]
    buffer_load_dwordx4 v[156:159], v2, s[8:11], s30 offen offset:512 sc1
    v_add_f32 v202, v202, v206
    v_add_f32 v203, v203, v207
    v_add_f32 v200, v200, v202
    s_waitcnt vmcnt(17) lgkmcnt(0)
    v_mfma_f32_32x32x16_bf16 v[88:103], v[136:139], v[160:163], v[88:103]
    ds_read_b128 v[120:123], v237 offset:2048
    v_add_f32 v201, v201, v203
    s_nop 1
    v_permlane32_swap_b32 v200, v201
    v_add_f32 v200, v200, v201
    v_mfma_f32_32x32x16_bf16 v[104:119], v[140:143], v[160:163], v[104:119]
    ds_read_b128 v[124:127], v237 offset:3072
    buffer_load_dwordx4 v[160:163], v2, s[8:11], s31 offen offset:1024 sc1
    v_mov_b32_e64 v201, v200
    s_nop 1
    v_permlane32_swap_b32 v200, v201
    v_mul_f32 v228, 0xbacccccd, v200
    s_waitcnt vmcnt(17)
    v_mfma_f32_32x32x16_bf16 v[56:71], v[136:139], v[164:167], v[56:71]
    v_mul_f32 v201, 0x3acccccd, v201
    v_fma_f32 v201, -v228, v228, v201
    v_max_f32 v201, 0, v201
    v_mfma_f32_32x32x16_bf16 v[72:87], v[140:143], v[164:167], v[72:87]
    buffer_load_dwordx4 v[164:167], v2, s[8:11], s31 offen offset:1536 sc1
    v_add_f32 v201, 0x3727c5ac, v201
    v_rsq_f32_e64 v229, v201
    v_cvt_pk_bf16_f32 v234, v228, v228
    s_barrier
    s_waitcnt vmcnt(16) lgkmcnt(0)
    v_mfma_f32_32x32x16_bf16 v[88:103], v[120:123], v[168:171], v[88:103]
    ds_read_b128 v[128:131], v237 offset:4096
    v_lshlrev_b32 v235, 16, v234
    v_sub_f32 v235, v228, v235
    v_cvt_pk_bf16_f32 v235, v235, 0
    v_mfma_f32_32x32x16_bf16 v[104:119], v[124:127], v[168:171], v[104:119]
    ds_read_b128 v[132:135], v237 offset:5120
    buffer_load_dwordx4 v[168:171], v2, s[8:11], s31 offen offset:2048 sc1
    v_mul_f32 v230, 0x3ea52b5c, v229
    v_cndmask_b32 v231, v230, 0, s[50:51]
    v_add_f32 v192, v192, v196
    s_waitcnt vmcnt(16)
    v_mfma_f32_32x32x16_bf16 v[56:71], v[120:123], v[172:175], v[56:71]
    v_add_f32 v193, v193, v197
    v_add_f32 v194, v194, v198
    v_add_f32_e64 v195, v195, v199
    v_mfma_f32_32x32x16_bf16 v[72:87], v[124:127], v[172:175], v[72:87]
    buffer_load_dwordx4 v[172:175], v2, s[8:11], s31 offen offset:2560 sc1
    v_add_f32_e64 v192, v192, v194
    v_add_f32 v193, v193, v195
    s_nop 1
    v_permlane32_swap_b32 v192, v193
    s_waitcnt vmcnt(15) lgkmcnt(0)
    v_mfma_f32_32x32x16_bf16 v[88:103], v[128:131], v[176:179], v[88:103]
    ds_read_b128 v[136:139], v237 offset:6144
    v_add_f32 v192, v192, v193
    v_mov_b32 v193, v192
    s_nop 1
    v_permlane32_swap_b32 v192, v193
    v_mfma_f32_32x32x16_bf16 v[104:119], v[132:135], v[176:179], v[104:119]
    ds_read_b128 v[140:143], v237 offset:7168
    buffer_load_dwordx4 v[176:179], v2, s[8:11], s31 offen offset:3072 sc1
    v_mul_f32 v224, 0xbacccccd, v192
    v_mul_f32 v193, 0x3acccccd, v193
    v_fma_f32 v193, -v224, v224, v193
    s_waitcnt vmcnt(15)
    v_mfma_f32_32x32x16_bf16 v[56:71], v[128:131], v[180:183], v[56:71]
    v_max_f32 v193, 0, v193
    v_add_f32 v193, 0x3727c5ac, v193
    v_rsq_f32_e64 v225, v193
    v_mfma_f32_32x32x16_bf16 v[72:87], v[132:135], v[180:183], v[72:87]
    buffer_load_dwordx4 v[180:183], v2, s[8:11], s31 offen offset:3584 sc1
    v_cvt_pk_bf16_f32 v232, v224, v224
    v_lshlrev_b32_e64 v233, 16, v232
    v_sub_f32 v233, v224, v233
    s_waitcnt vmcnt(15) lgkmcnt(0)
    v_mfma_f32_32x32x16_bf16 v[88:103], v[136:139], v[184:187], v[88:103]
    ds_read_b128 v[120:123], v237 offset:8192
    v_cvt_pk_bf16_f32 v233, v233, 0
    v_mul_f32 v226, 0x3ea52b5c, v225
    v_cndmask_b32 v227, v226, 0, s[50:51]
    v_mfma_f32_32x32x16_bf16 v[104:119], v[140:143], v[184:187], v[104:119]
    ds_read_b128 v[124:127], v237 offset:9216
    s_add_u32 s31, s31, 4096
    buffer_load_dwordx4 v[184:187], v2, s[8:11], s31 offen offset:0 sc1
    ds_read_b32 v208, v238 offset:0
    ds_read_b32 v209, v238 offset:256
    ds_read_b32 v210, v238 offset:512
    ds_read_b32 v211, v238 offset:768
    s_waitcnt vmcnt(14)
    v_mfma_f32_32x32x16_bf16 v[56:71], v[136:139], v[188:191], v[56:71]
    v_mfma_f32_32x32x16_bf16 v[72:87], v[140:143], v[188:191], v[72:87]
    buffer_load_dwordx4 v[188:191], v2, s[8:11], s31 offen offset:512 sc1
    s_waitcnt lgkmcnt(0)
    v_add_f32 v208, v208, v209
    s_waitcnt vmcnt(12)
    v_mfma_f32_32x32x16_bf16 v[88:103], v[120:123], v[144:147], v[88:103]
    ds_read_b128 v[128:131], v237 offset:10240
    v_cmp_ne_u32 vcc, v0, v241
    s_nop 0
    s_cmp_eq_u32 vcc_lo, 0
    s_addc_u32 s43, 0, 0
    v_cmp_ne_u32 vcc, v240, v15
    s_cbranch_vccz L_polledw_25
L_poll_26:
    buffer_load_dword v240, v244, s[4:7], s64 offen offset:0 sc1
    s_waitcnt vmcnt(0)
    v_cmp_ne_u32 vcc, v240, v15
    s_cbranch_vccz L_polled_27
    s_sub_u32 s44, s44, 1
    s_cbranch_scc0 L_poll_26
    s_mov_b32 s44, 0
L_polled_27:
L_polledw_25:
    v_add_f32 v208, v208, v210
    v_add_f32 v208, v208, v211
    v_cvt_pk_bf16_f32 v209, v208, v208
    v_mfma_f32_32x32x16_bf16 v[104:119], v[124:127], v[144:147], v[104:119]
    ds_read_b128 v[132:135], v237 offset:11264
    buffer_load_dwordx4 v[144:147], v2, s[8:11], s31 offen offset:1024 sc1
    v_lshlrev_b32 v210, 16, v209
    v_sub_f32 v210, v208, v210
    v_cvt_pk_bf16_f32 v210, v208, v210
    s_waitcnt vmcnt(11)
    v_mfma_f32_32x32x16_bf16 v[56:71], v[120:123], v[148:151], v[56:71]
    v_and_b32 v209, 0xffff, v209
    v_cndmask_b32 v211, v210, 0, s[50:51]
    v_accvgpr_write_b32 a248, v211
    v_mfma_f32_32x32x16_bf16 v[72:87], v[124:127], v[148:151], v[72:87]
    buffer_load_dwordx4 v[148:151], v2, s[8:11], s31 offen offset:1536 sc1
    v_cndmask_b32 v211, v209, 0, s[50:51]
    v_accvgpr_write_b32 a249, v211
    v_cndmask_b32 v211, 0, v210, s[50:51]
    s_waitcnt vmcnt(11) lgkmcnt(0)
    v_mfma_f32_32x32x16_bf16 v[88:103], v[128:131], v[152:155], v[88:103]
    ds_read_b128 v[136:139], v237 offset:12288
    v_accvgpr_write_b32 a250, v211
    v_cndmask_b32 v211, 0, v209, s[50:51]
    v_accvgpr_write_b32 a251, v211
    v_mfma_f32_32x32x16_bf16 v[104:119], v[132:135], v[152:155], v[104:119]
    ds_read_b128 v[140:143], v237 offset:13312
    buffer_load_dwordx4 v[152:155], v2, s[8:11], s31 offen offset:2048 sc1
    v_and_b32 v28, 31, v21
    v_lshrrev_b32 v29, 2, v23
    v_sub_u32_e64 v28, v28, v29
    v_mov_b32 v29, 0xff800000
    v_cmp_gt_i32 s[24:25], 0, v28
    s_waitcnt vmcnt(11)
    v_mfma_f32_32x32x16_bf16 v[56:71], v[128:131], v[156:159], v[56:71]
    ds_read_b128 v[120:123], v237 offset:14336
    v_cndmask_b32 v192, 0, v29, s[24:25]
    v_xor_b32 v208, v192, v29
    v_cmp_gt_i32 s[24:25], 1, v28
    v_mfma_f32_32x32x16_bf16 v[72:87], v[132:135], v[156:159], v[72:87]
    ds_read_b128 v[124:127], v237 offset:15360
    buffer_load_dwordx4 v[156:159], v2, s[8:11], s31 offen offset:2560 sc1
    v_cndmask_b32 v193, 0, v29, s[24:25]
    v_xor_b32_e64 v209, v193, v29
    v_cmp_gt_i32 s[24:25], 2, v28
    s_waitcnt vmcnt(11) lgkmcnt(2)
    v_mfma_f32_32x32x16_bf16 v[88:103], v[136:139], v[160:163], v[88:103]
    ds_read_b128 v[128:131], v237 offset:16384
    s_getpc_b64 s[68:69]
L_pc_28:
    s_add_u32 s68, s68, L_layer1-L_pc_28
    s_addc_u32 s69, s69, 0
    v_and_b32 v30, 3, v21
    v_lshl_add_u32 v30, s36, 2, v30
    v_lshl_add_u32 v30, s38, 4, v30
    v_lshlrev_b32_e64 v30, 7, v30
    v_min_u32 v30, L_hotend-L_layer1-128, v30
    s_branch L_over_444
L_chain0_0_0:
    s_branch L_chain0_0_1
L_over_444:
    global_load_dword a252, v30, s[68:69]
    v_cndmask_b32 v194, 0, v29, s[24:25]
    v_xor_b32_e64 v210, v194, v29
    v_cmp_gt_i32 s[24:25], 3, v28
    v_mfma_f32_32x32x16_bf16 v[104:119], v[140:143], v[160:163], v[104:119]
    ds_read_b128 v[132:135], v237 offset:17408
    buffer_load_dwordx4 v[160:163], v2, s[8:11], s31 offen offset:3072 sc1
    v_cndmask_b32 v195, 0, v29, s[24:25]
    v_xor_b32_e64 v211, v195, v29
    v_cmp_gt_i32 s[24:25], 8, v28
    s_waitcnt vmcnt(12) lgkmcnt(2)
    v_mfma_f32_32x32x16_bf16 v[88:103], v[120:123], v[164:167], v[88:103]
    ds_read_b128 v[136:139], v237 offset:18432
    v_cndmask_b32 v196, 0, v29, s[24:25]
    v_xor_b32 v212, v196, v29
    v_cmp_gt_i32 s[24:25], 9, v28
    v_mfma_f32_32x32x16_bf16 v[104:119], v[124:127], v[164:167], v[104:119]
    ds_read_b128 v[140:143], v237 offset:19456
    buffer_load_dwordx4 v[164:167], v2, s[8:11], s31 offen offset:3584 sc1
    v_cndmask_b32 v197, 0, v29, s[24:25]
    v_xor_b32_e64 v213, v197, v29
    v_cmp_gt_i32 s[24:25], 10, v28
    s_waitcnt vmcnt(12) lgkmcnt(2)
    v_mfma_f32_32x32x16_bf16 v[88:103], v[128:131], v[168:171], v[88:103]
    ds_read_b128 v[120:123], v237 offset:20480
    v_cndmask_b32 v198, 0, v29, s[24:25]
    v_xor_b32 v214, v198, v29
    v_cmp_gt_i32 s[24:25], 11, v28
    v_mfma_f32_32x32x16_bf16 v[104:119], v[132:135], v[168:171], v[104:119]
    ds_read_b128 v[124:127], v237 offset:21504
    buffer_load_dwordx4 v[168:171], v2, s[8:11], s30 offen offset:1024 sc1
    v_cndmask_b32 v199, 0, v29, s[24:25]
    v_xor_b32_e64 v215, v199, v29
    v_cmp_gt_i32 s[24:25], 16, v28
    s_waitcnt vmcnt(12) lgkmcnt(2)
    v_mfma_f32_32x32x16_bf16 v[88:103], v[136:139], v[172:175], v[88:103]
    ds_read_b128 v[128:131], v237 offset:22528
    v_cndmask_b32 v200, 0, v29, s[24:25]
    v_xor_b32 v216, v200, v29
    v_cmp_gt_i32 s[24:25], 17, v28
    v_mfma_f32_32x32x16_bf16 v[104:119], v[140:143], v[172:175], v[104:119]
    ds_read_b128 v[132:135], v237 offset:23552
    buffer_load_dwordx4 v[172:175], v2, s[8:11], s30 offen offset:1536 sc1
    v_cndmask_b32 v201, 0, v29, s[24:25]
    v_xor_b32_e64 v217, v201, v29
    v_cmp_gt_i32 s[24:25], 18, v28
    s_barrier
    s_waitcnt vmcnt(12) lgkmcnt(2)
    v_mfma_f32_32x32x16_bf16 v[88:103], v[120:123], v[176:179], v[88:103]
    ds_read_b128 v[136:139], v237 offset:24576
    v_cndmask_b32 v202, 0, v29, s[24:25]
    v_xor_b32_e64 v218, v202, v29
    v_cmp_gt_i32 s[24:25], 19, v28
    v_mfma_f32_32x32x16_bf16 v[104:119], v[124:127], v[176:179], v[104:119]
    ds_read_b128 v[140:143], v237 offset:25600
    buffer_load_dwordx4 v[176:179], v2, s[8:11], s30 offen offset:2048 sc1
    v_cndmask_b32 v203, 0, v29, s[24:25]
    v_xor_b32_e64 v219, v203, v29
    v_cmp_gt_i32 s[24:25], 24, v28
    s_waitcnt vmcnt(12) lgkmcnt(2)
    v_mfma_f32_32x32x16_bf16 v[88:103], v[128:131], v[180:183], v[88:103]
    ds_read_b128 v[120:123], v237 offset:26624
    v_cndmask_b32 v204, 0, v29, s[24:25]
    v_xor_b32 v220, v204, v29
    v_cmp_gt_i32 s[24:25], 25, v28
    v_mfma_f32_32x32x16_bf16 v[104:119], v[132:135], v[180:183], v[104:119]
    ds_read_b128 v[124:127], v237 offset:27648
    buffer_load_dwordx4 v[180:183], v2, s[8:11], s30 offen offset:2560 sc1
    v_cndmask_b32 v205, 0, v29, s[24:25]
    v_xor_b32_e64 v221, v205, v29
    v_cmp_gt_i32 s[24:25], 26, v28
    s_waitcnt vmcnt(12) lgkmcnt(2)
    v_mfma_f32_32x32x16_bf16 v[88:103], v[136:139], v[184:187], v[88:103]
    ds_read_b128 v[128:131], v237 offset:28672
    v_cndmask_b32 v206, 0, v29, s[24:25]
    v_xor_b32 v222, v206, v29
    v_cmp_gt_i32 s[24:25], 27, v28
    v_mfma_f32_32x32x16_bf16 v[104:119], v[140:143], v[184:187], v[104:119]
    ds_read_b128 v[132:135], v237 offset:29696
    buffer_load_dwordx4 v[184:187], v2, s[8:11], s30 offen offset:3072 sc1
    v_cndmask_b32 v207, 0, v29, s[24:25]
    v_xor_b32 v223, v207, v29
    s_waitcnt vmcnt(12) lgkmcnt(2)
    v_mfma_f32_32x32x16_bf16 v[88:103], v[120:123], v[188:191], v[88:103]
    ds_read_b128 v[136:139], v237 offset:30720
    v_mfma_f32_32x32x16_bf16 v[104:119], v[124:127], v[188:191], v[104:119]
    ds_read_b128 v[140:143], v237 offset:31744
    buffer_load_dwordx4 v[188:191], v2, s[8:11], s30 offen offset:3584 sc1
    s_waitcnt vmcnt(12) lgkmcnt(2)
    v_mfma_f32_32x32x16_bf16 v[88:103], v[128:131], v[144:147], v[88:103]
    ds_read_b128 v[120:123], v237 offset:32768
    v_mfma_f32_32x32x16_bf16 v[104:119], v[132:135], v[144:147], v[104:119]
    ds_read_b128 v[124:127], v237 offset:33792
    s_add_u32 s30, s30, 4096
    buffer_load_dwordx4 v[144:147], v2, s[8:11], s30 offen offset:0 sc1
    s_waitcnt vmcnt(12) lgkmcnt(2)
    v_mfma_f32_32x32x16_bf16 v[88:103], v[136:139], v[148:151], v[88:103]
    ds_read_b128 v[128:131], v237 offset:34816
    v_mfma_f32_32x32x16_bf16 v[104:119], v[140:143], v[148:151], v[104:119]
    ds_read_b128 v[132:135], v237 offset:35840
    buffer_load_dwordx4 v[148:151], v2, s[8:11], s30 offen offset:512 sc1
    s_waitcnt vmcnt(12) lgkmcnt(2)
    v_mfma_f32_32x32x16_bf16 v[88:103], v[120:123], v[152:155], v[88:103]
    ds_read_b128 v[136:139], v237 offset:36864
    v_mfma_f32_32x32x16_bf16 v[104:119], v[124:127], v[152:155], v[104:119]
    ds_read_b128 v[140:143], v237 offset:37888
    buffer_load_dwordx4 v[152:155], v2, s[8:11], s30 offen offset:1024 sc1
    s_waitcnt vmcnt(12) lgkmcnt(2)
    v_mfma_f32_32x32x16_bf16 v[88:103], v[128:131], v[156:159], v[88:103]
    ds_read_b128 v[120:123], v237 offset:38912
    v_mfma_f32_32x32x16_bf16 v[104:119], v[132:135], v[156:159], v[104:119]
    ds_read_b128 v[124:127], v237 offset:39936
    buffer_load_dwordx4 v[156:159], v2, s[8:11], s30 offen offset:1536 sc1
    s_waitcnt vmcnt(11) lgkmcnt(2)
    v_mfma_f32_32x32x16_bf16 v[88:103], v[136:139], v[160:163], v[88:103]
    ds_read_b128 v[128:131], v237 offset:12288
    v_mfma_f32_32x32x16_bf16 v[104:119], v[140:143], v[160:163], v[104:119]
    ds_read_b128 v[132:135], v237 offset:13312
    buffer_load_dwordx4 v[160:163], v2, s[8:11], s30 offen offset:2048 sc1
    s_waitcnt vmcnt(11) lgkmcnt(2)
    v_mfma_f32_32x32x16_bf16 v[88:103], v[120:123], v[164:167], v[88:103]
    ds_read_b128 v[136:139], v237 offset:14336
    v_mfma_f32_32x32x16_bf16 v[104:119], v[124:127], v[164:167], v[104:119]
    ds_read_b128 v[140:143], v237 offset:15360
    buffer_load_dwordx4 v[164:167], v2, s[8:11], s30 offen offset:2560 sc1
    v_mfma_f32_32x32x8bf16_1k v[88:103], a[248:249], v[234:235], v[88:103]
    v_mfma_f32_32x32x8bf16_1k v[104:119], a[250:251], v[234:235], v[104:119]
    s_waitcnt vmcnt(11) lgkmcnt(2)
    v_mfma_f32_32x32x16_bf16 v[56:71], v[128:131], v[168:171], v[56:71]
    ds_read_b128 v[120:123], v237 offset:16384
    v_mfma_f32_32x32x16_bf16 v[72:87], v[132:135], v[168:171], v[72:87]
    ds_read_b128 v[124:127], v237 offset:17408
    buffer_load_dwordx4 v[168:171], v2, s[8:11], s30 offen offset:3072 sc1
    v_add_u32 v26, s57, v16
    v_add_u32_e64 v27, s57, v17
    v_add_u32 v28, s57, v18
    s_waitcnt vmcnt(11) lgkmcnt(2)
    v_mfma_f32_32x32x16_bf16 v[56:71], v[136:139], v[172:175], v[56:71]
    ds_read_b128 v[128:131], v237 offset:18432
    v_mul_f32 v104, v104, v229
    v_mul_f32 v105, v105, v229
    v_mul_f32 v106, v106, v229
    v_mul_f32 v107, v107, v229
    v_mul_f32_e64 v108, v108, v229
    v_mfma_f32_32x32x16_bf16 v[72:87], v[140:143], v[172:175], v[72:87]
    ds_read_b128 v[132:135], v237 offset:19456
    buffer_load_dwordx4 v[172:175], v2, s[8:11], s30 offen offset:3584 sc1
    v_mul_f32 v109, v109, v229
    v_mul_f32 v110, v110, v229
    v_mul_f32 v111, v111, v229
    v_mul_f32 v112, v112, v229
    v_mul_f32 v113, v113, v229
    s_waitcnt vmcnt(11) lgkmcnt(2)
    v_mfma_f32_32x32x16_bf16 v[56:71], v[120:123], v[176:179], v[56:71]
    ds_read_b128 v[136:139], v237 offset:20480
    v_mul_f32 v114, v114, v229
    v_mul_f32 v115, v115, v229
    v_mul_f32 v116, v116, v229
    v_mul_f32 v117, v117, v229
    v_mul_f32_e64 v118, v118, v229
    v_mfma_f32_32x32x16_bf16 v[72:87], v[124:127], v[176:179], v[72:87]
    ds_read_b128 v[140:143], v237 offset:21504
    v_mul_f32_e64 v119, v119, v229
    v_cvt_pk_bf16_f32 v104, v104, v105
    v_cvt_pk_bf16_f32 v105, v106, v107
    v_cvt_pk_bf16_f32 v106, v108, v109
    v_cvt_pk_bf16_f32 v107, v110, v111
    s_waitcnt vmcnt(10) lgkmcnt(2)
    v_mfma_f32_32x32x16_bf16 v[56:71], v[128:131], v[180:183], v[56:71]
    ds_read_b128 v[120:123], v237 offset:22528
    s_mul_i32 s20, s40, 100
    s_mul_i32 s67, s36, 5
    s_add_u32 s20, s20, s67
    s_lshl_b32 s20, s20, 10
    s_add_u32 s20, s20, 4194304
    buffer_load_dwordx4 a[0:3], v1, s[4:7], s20 offen offset:0 sc1
    v_cvt_pk_bf16_f32 v108, v112, v113
    v_cvt_pk_bf16_f32 v109, v114, v115
    v_cvt_pk_bf16_f32 v110, v116, v117
    v_cvt_pk_bf16_f32 v111, v118, v119
    v_cndmask_b32 v110, v110, v31, s[50:51]
    v_mfma_f32_32x32x16_bf16 v[72:87], v[132:135], v[180:183], v[72:87]
    ds_read_b128 v[124:127], v237 offset:23552
    v_cndmask_b32 v111, v111, 0, s[50:51]
    buffer_store_dwordx4 v[104:107], v26, s[4:7], s61 offen offset:0 sc1
    v_mul_f32 v112, v96, v229
    v_mul_f32 v113, v97, v229
    v_mul_f32 v114, v98, v229
    s_waitcnt vmcnt(11) lgkmcnt(2)
    v_mfma_f32_32x32x16_bf16 v[56:71], v[136:139], v[184:187], v[56:71]
    ds_read_b128 v[128:131], v237 offset:24576
    v_mul_f32 v115, v99, v229
    v_mul_f32 v116, v100, v229
    v_mul_f32 v117, v101, v229
    v_mul_f32 v118, v102, v229
    v_mul_f32_e64 v119, v103, v229
    v_mfma_f32_32x32x16_bf16 v[72:87], v[140:143], v[184:187], v[72:87]
    ds_read_b128 v[132:135], v237 offset:25600
    buffer_store_dwordx4 v[108:111], v28, s[4:7], s61 offen offset:0 sc1
    v_cvt_pk_bf16_f32 v112, v112, v113
    v_cvt_pk_bf16_f32 v113, v114, v115
    v_cvt_pk_bf16_f32 v114, v116, v117
    v_cvt_pk_bf16_f32 v115, v118, v119
    s_waitcnt vmcnt(11) lgkmcnt(2)
    v_mfma_f32_32x32x16_bf16 v[56:71], v[120:123], v[188:191], v[56:71]
    ds_read_b128 v[136:139], v237 offset:26624
    buffer_load_dwordx4 a[4:7], v1, s[4:7], s20 offen offset:1024 sc1
    ds_write_b128 v26, v[104:107] offset:24576
    buffer_store_dwordx4 v[112:115], v27, s[4:7], s61 offen offset:0 sc1
    v_mul_f32 v96, v96, v231
    v_mul_f32 v97, v97, v231
    v_mul_f32 v98, v98, v231
    v_mfma_f32_32x32x16_bf16 v[72:87], v[124:127], v[188:191], v[72:87]
    ds_read_b128 v[140:143], v237 offset:27648
    v_mul_f32_e64 v99, v99, v231
    ds_write_b128 v28, v[108:111] offset:24576
    v_mul_f32 v88, v88, v230
    v_mul_f32 v89, v89, v230
    v_mul_f32 v90, v90, v230
    s_waitcnt vmcnt(12) lgkmcnt(4)
    v_mfma_f32_32x32x16_bf16 v[56:71], v[128:131], v[144:147], v[56:71]
    ds_read_b128 v[120:123], v237 offset:28672
    v_mul_f32 v91, v91, v230
    v_mul_f32 v92, v92, v230
    v_mul_f32 v93, v93, v230
    v_mul_f32 v94, v94, v230
    v_mul_f32_e64 v95, v95, v230
    v_mfma_f32_32x32x16_bf16 v[72:87], v[132:135], v[144:147], v[72:87]
    ds_read_b128 v[124:127], v237 offset:29696
    ds_write_b128 v27, v[112:115] offset:24576
    v_cvt_pk_bf16_f32 v248, v88, v89
    v_cvt_pk_bf16_f32 v249, v90, v91
    v_cvt_pk_bf16_f32 v250, v92, v93
    v_cvt_pk_bf16_f32 v251, v94, v95
    s_waitcnt vmcnt(11) lgkmcnt(4)
    v_mfma_f32_32x32x16_bf16 v[56:71], v[136:139], v[148:151], v[56:71]
    ds_read_b128 v[128:131], v237 offset:30720
    buffer_load_dwordx4 a[8:11], v1, s[4:7], s20 offen offset:2048 sc1
    v_cvt_pk_bf16_f32 v252, v96, v97
    v_cvt_pk_bf16_f32 v253, v98, v99
    v_mfma_f32_32x32x16_bf16 v[72:87], v[140:143], v[148:151], v[72:87]
    ds_read_b128 v[132:135], v237 offset:31744
    s_waitcnt vmcnt(11) lgkmcnt(3)
    v_mfma_f32_32x32x16_bf16 v[56:71], v[120:123], v[152:155], v[56:71]
    ds_read_b128 v[136:139], v237 offset:32768
    v_mfma_f32_32x32x16_bf16 v[72:87], v[124:127], v[152:155], v[72:87]
    ds_read_b128 v[140:143], v237 offset:33792
    s_waitcnt vmcnt(10) lgkmcnt(2)
    v_mfma_f32_32x32x16_bf16 v[56:71], v[128:131], v[156:159], v[56:71]
    ds_read_b128 v[120:123], v237 offset:34816
    buffer_load_dwordx4 a[12:15], v1, s[4:7], s20 offen offset:3072 sc1
    v_mfma_f32_32x32x16_bf16 v[72:87], v[132:135], v[156:159], v[72:87]
    ds_read_b128 v[124:127], v237 offset:35840
    s_waitcnt vmcnt(10) lgkmcnt(2)
    v_mfma_f32_32x32x16_bf16 v[56:71], v[136:139], v[160:163], v[56:71]
    ds_read_b128 v[128:131], v237 offset:36864
    v_mfma_f32_32x32x16_bf16 v[72:87], v[140:143], v[160:163], v[72:87]
    ds_read_b128 v[132:135], v237 offset:37888
    s_waitcnt vmcnt(9) lgkmcnt(2)
    v_mfma_f32_32x32x16_bf16 v[56:71], v[120:123], v[164:167], v[56:71]
    ds_read_b128 v[136:139], v237 offset:38912
    v_mfma_f32_32x32x16_bf16 v[72:87], v[124:127], v[164:167], v[72:87]
    ds_read_b128 v[140:143], v237 offset:39936
    s_waitcnt vmcnt(8) lgkmcnt(2)
    v_mfma_f32_32x32x16_bf16 v[56:71], v[128:131], v[168:171], v[56:71]
    v_mfma_f32_32x32x16_bf16 v[72:87], v[132:135], v[168:171], v[72:87]
    s_waitcnt vmcnt(7) lgkmcnt(0)
    v_mfma_f32_32x32x16_bf16 v[56:71], v[136:139], v[172:175], v[56:71]
    s_waitcnt vmcnt(2)
    buffer_store_dword v15, v24, s[4:7], s59 offen offset:0 sc1
    v_mfma_f32_32x32x16_bf16 v[72:87], v[140:143], v[172:175], v[72:87]
    v_mfma_f32_32x32x8bf16_1k v[56:71], a[248:249], v[232:233], v[56:71]
    v_mfma_f32_32x32x8bf16_1k v[72:87], a[250:251], v[232:233], v[72:87]
L_ph1:
    s_cmp_eq_u32 s36, 1
    s_cbranch_scc1 L_att1_30
    s_cmp_eq_u32 s36, 2
    s_cbranch_scc1 L_att2_31
    s_cmp_eq_u32 s36, 3
    s_cbranch_scc1 L_att3_32
L_att0_29:
    ds_read_b128 v[136:139], v16 offset:46080
    ds_read_b64 v[140:141], v18 offset:46080
    ds_read_b64_tr_b16 v[152:153], v19 offset:46080
    ds_read_b64_tr_b16 v[154:155], v20 offset:46080
    ds_read_b64_tr_b16 v[156:157], v19 offset:46336
    ds_read_b64_tr_b16 v[158:159], v20 offset:46336
    v_add_u32 v26, s56, v16
    v_add_u32 v27, s56, v17
    v_add_u32_e64 v28, s56, v18
    v_pk_mul_f32 v[72:73], v[72:73], v[224:225] op_sel:[0,1] op_sel_hi:[1,1]
    v_pk_mul_f32 v[74:75], v[74:75], v[224:225] op_sel:[0,1] op_sel_hi:[1,1]
    v_pk_mul_f32 v[76:77], v[76:77], v[224:225] op_sel:[0,1] op_sel_hi:[1,1]
    v_pk_mul_f32 v[78:79], v[78:79], v[224:225] op_sel:[0,1] op_sel_hi:[1,1]
    v_pk_mul_f32 v[80:81], v[80:81], v[224:225] op_sel:[0,1] op_sel_hi:[1,1]
    v_pk_mul_f32 v[82:83], v[82:83], v[224:225] op_sel:[0,1] op_sel_hi:[1,1]
    v_pk_mul_f32 v[84:85], v[84:85], v[224:225] op_sel:[0,1] op_sel_hi:[1,1]
    v_pk_mul_f32 v[86:87], v[86:87], v[224:225] op_sel:[0,1] op_sel_hi:[1,1]
    v_cvt_pk_bf16_f32 v72, v72, v73
    v_cvt_pk_bf16_f32 v73, v74, v75
    v_cvt_pk_bf16_f32 v74, v76, v77
    v_cvt_pk_bf16_f32 v75, v78, v79
    v_cvt_pk_bf16_f32 v76, v80, v81
    v_cvt_pk_bf16_f32 v77, v82, v83
    v_cvt_pk_bf16_f32 v78, v84, v85
    v_cvt_pk_bf16_f32 v79, v86, v87
    v_cndmask_b32 v78, v78, v31, s[50:51]
    v_cndmask_b32 v79, v79, 0, s[50:51]
    buffer_store_dwordx4 v[72:75], v26, s[4:7], s61 offen offset:0 sc1
    v_pk_mul_f32 v[80:81], v[64:65], v[224:225] op_sel:[0,1] op_sel_hi:[1,1]
    v_pk_mul_f32 v[82:83], v[66:67], v[224:225] op_sel:[0,1] op_sel_hi:[1,1]
    v_pk_mul_f32 v[84:85], v[68:69], v[224:225] op_sel:[0,1] op_sel_hi:[1,1]
    v_pk_mul_f32 v[86:87], v[70:71], v[224:225] op_sel:[0,1] op_sel_hi:[1,1]
    buffer_store_dwordx4 v[76:79], v28, s[4:7], s61 offen offset:0 sc1
    v_cvt_pk_bf16_f32 v80, v80, v81
    v_cvt_pk_bf16_f32 v81, v82, v83
    v_cvt_pk_bf16_f32 v82, v84, v85
    v_cvt_pk_bf16_f32 v83, v86, v87
    ds_write_b128 v26, v[72:75] offset:24576
    buffer_store_dwordx4 v[80:83], v27, s[4:7], s61 offen offset:0 sc1
    v_pk_mul_f32 v[64:65], v[64:65], v[226:227] op_sel:[0,1] op_sel_hi:[1,1]
    v_pk_mul_f32 v[66:67], v[66:67], v[226:227] op_sel:[0,1] op_sel_hi:[1,1]
    ds_write_b128 v28, v[76:79] offset:24576
    v_pk_mul_f32 v[56:57], v[56:57], v[226:227] op_sel:[0,0] op_sel_hi:[1,0]
    v_pk_mul_f32 v[58:59], v[58:59], v[226:227] op_sel:[0,0] op_sel_hi:[1,0]
    v_pk_mul_f32 v[60:61], v[60:61], v[226:227] op_sel:[0,0] op_sel_hi:[1,0]
    v_pk_mul_f32 v[62:63], v[62:63], v[226:227] op_sel:[0,0] op_sel_hi:[1,0]
    ds_write_b128 v27, v[80:83] offset:24576
    s_waitcnt lgkmcnt(7)
    v_mfma_f32_32x32x16_bf16 v[88:103], v[136:139], v[248:251], v[192:207]
    v_mfma_f32_32x32x8bf16_1k v[88:103], v[140:141], v[252:253], v[88:103]
    s_waitcnt lgkmcnt(0)
    s_barrier
    ds_read_b128 v[144:147], v16 offset:43008
    ds_read_b64 v[148:149], v18 offset:43008
    v_cvt_pk_bf16_f32 v240, v56, v57
    v_cvt_pk_bf16_f32 v241, v58, v59
    v_cvt_pk_bf16_f32 v242, v60, v61
    v_cvt_pk_bf16_f32 v243, v62, v63
    v_cvt_pk_bf16_f32 v244, v64, v65
    v_cvt_pk_bf16_f32 v245, v66, v67
    s_add_u32 s61, s58, -4079616
    v_add_u32 v31, s62, v1
    s_mov_b32 s56, s63
    v_add_u32 v0, 1, v15
    v_exp_f32 v88, v88
    v_exp_f32 v89, v89
    v_exp_f32_e64 v90, v90
    v_exp_f32 v91, v91
    s_waitcnt lgkmcnt(0)
    v_mfma_f32_32x32x16_bf16 v[104:119], v[144:147], v[248:251], 0
    ds_read_b128 v[136:139], v16 offset:39936
    ds_read_b64 v[140:141], v18 offset:39936
    v_exp_f32 v92, v92
    v_exp_f32 v93, v93
    v_exp_f32 v94, v94
    v_exp_f32 v95, v95
    v_mfma_f32_32x32x8bf16_1k v[104:119], v[148:149], v[252:253], v[104:119]
    ds_read_b64_tr_b16 v[160:161], v19 offset:43008
    ds_read_b64_tr_b16 v[162:163], v20 offset:43008
    ds_read_b64_tr_b16 v[164:165], v19 offset:43264
    ds_read_b64_tr_b16 v[166:167], v20 offset:43264
    v_cvt_pk_bf16_f32 v120, v88, v89
    v_cvt_pk_bf16_f32 v121, v90, v91
    v_cvt_pk_bf16_f32 v122, v92, v93
    v_cvt_pk_bf16_f32 v123, v94, v95
    v_exp_f32 v96, v96
    v_exp_f32 v97, v97
    v_exp_f32 v98, v98
    v_exp_f32 v99, v99
    v_mfma_f32_32x32x16_bf16 v[72:87], v[152:155], v[120:123], 0
    s_waitcnt lgkmcnt(2)
    s_add_u32 s20, s20, 4096
    buffer_load_dwordx4 a[16:19], v1, s[4:7], s20 offen offset:0 sc1
    s_add_u32 s20, s20, 16384
    buffer_load_dwordx4 a[20:23], v1, s[4:7], s20 offen offset:0 sc1
    buffer_load_dwordx4 a[24:27], v1, s[4:7], s20 offen offset:1024 sc1
    v_exp_f32 v100, v100
    v_exp_f32 v101, v101
    v_exp_f32 v102, v102
    v_exp_f32_e64 v103, v103
    v_cvt_pk_bf16_f32 v124, v96, v97
    v_cvt_pk_bf16_f32 v125, v98, v99
    v_cvt_pk_bf16_f32 v126, v100, v101
    v_cvt_pk_bf16_f32 v127, v102, v103
    v_mfma_f32_32x32x16_bf16 v[88:103], v[136:139], v[248:251], 0
    ds_read_b128 v[144:147], v16 offset:36864
    ds_read_b64 v[148:149], v18 offset:36864
    v_exp_f32 v104, v104
    v_exp_f32 v105, v105
    v_exp_f32 v106, v106
    v_exp_f32 v107, v107
    v_mfma_f32_32x32x8bf16_1k v[88:103], v[140:141], v[252:253], v[88:103]
    ds_read_b64_tr_b16 v[152:153], v19 offset:39936
    ds_read_b64_tr_b16 v[154:155], v20 offset:39936
    v_exp_f32 v108, v108
    v_exp_f32 v109, v109
    v_exp_f32 v110, v110
    v_exp_f32 v111, v111
    v_mfma_f32_32x32x16_bf16 v[72:87], v[156:159], v[124:127], v[72:87]
    ds_read_b64_tr_b16 v[156:157], v19 offset:40192
    ds_read_b64_tr_b16 v[158:159], v20 offset:40192
    v_cvt_pk_bf16_f32 v128, v104, v105
    v_cvt_pk_bf16_f32 v129, v106, v107
    v_cvt_pk_bf16_f32 v130, v108, v109
    v_cvt_pk_bf16_f32 v131, v110, v111
    v_exp_f32 v112, v112
    v_exp_f32 v113, v113
    v_exp_f32 v114, v114
    v_exp_f32 v115, v115
    v_mfma_f32_32x32x16_bf16 v[72:87], v[160:163], v[128:131], v[72:87]
    s_waitcnt lgkmcnt(2)
    buffer_load_dwordx4 a[28:31], v1, s[4:7], s20 offen offset:2048 sc1
    buffer_load_dwordx4 a[32:35], v1, s[4:7], s20 offen offset:3072 sc1
    v_exp_f32 v116, v116
    v_exp_f32 v117, v117
    v_exp_f32 v118, v118
    v_exp_f32_e64 v119, v119
    v_cvt_pk_bf16_f32 v132, v112, v113
    v_cvt_pk_bf16_f32 v133, v114, v115
    v_cvt_pk_bf16_f32 v134, v116, v117
    v_cvt_pk_bf16_f32 v135, v118, v119
    s_waitcnt vmcnt(5)
    buffer_store_dword v15, v24, s[4:7], s59 offen offset:128 sc1
    buffer_load_dword v224, v14, s[4:7], s60 offen offset:0 sc1
    v_mfma_f32_32x32x16_bf16 v[104:119], v[144:147], v[248:251], 0
    ds_read_b128 v[136:139], v16 offset:33792
    ds_read_b64 v[140:141], v18 offset:33792
    v_exp_f32 v88, v88
    v_exp_f32 v89, v89
    v_exp_f32 v90, v90
    v_exp_f32_e64 v91, v91
    v_mfma_f32_32x32x8bf16_1k v[104:119], v[148:149], v[252:253], v[104:119]
    ds_read_b64_tr_b16 v[160:161], v19 offset:36864
    ds_read_b64_tr_b16 v[162:163], v20 offset:36864
    v_exp_f32 v92, v92
    v_exp_f32 v93, v93
    v_exp_f32 v94, v94
    v_exp_f32 v95, v95
    v_mfma_f32_32x32x16_bf16 v[72:87], v[164:167], v[132:135], v[72:87]
    ds_read_b64_tr_b16 v[164:165], v19 offset:37120
    ds_read_b64_tr_b16 v[166:167], v20 offset:37120
    v_cvt_pk_bf16_f32 v120, v88, v89
    v_cvt_pk_bf16_f32 v121, v90, v91
    v_cvt_pk_bf16_f32 v122, v92, v93
    v_cvt_pk_bf16_f32 v123, v94, v95
    v_exp_f32 v96, v96
    v_exp_f32 v97, v97
    v_exp_f32 v98, v98
    v_exp_f32 v99, v99
    v_mfma_f32_32x32x16_bf16 v[72:87], v[152:155], v[120:123], v[72:87]
    s_waitcnt lgkmcnt(2)
    s_add_u32 s20, s20, 4096
    buffer_load_dwordx4 a[36:39], v1, s[4:7], s20 offen offset:0 sc1
    s_add_u32 s20, s20, 16384
    buffer_load_dwordx4 a[40:43], v1, s[4:7], s20 offen offset:0 sc1
    buffer_load_dwordx4 a[44:47], v1, s[4:7], s20 offen offset:1024 sc1
    v_exp_f32 v100, v100
    v_exp_f32 v101, v101
    v_exp_f32 v102, v102
    v_exp_f32_e64 v103, v103
    v_cvt_pk_bf16_f32 v124, v96, v97
    v_cvt_pk_bf16_f32 v125, v98, v99
    v_cvt_pk_bf16_f32 v126, v100, v101
    v_cvt_pk_bf16_f32 v127, v102, v103
    v_mfma_f32_32x32x16_bf16 v[88:103], v[136:139], v[248:251], 0
    ds_read_b128 v[144:147], v16 offset:30720
    ds_read_b64 v[148:149], v18 offset:30720
    v_exp_f32 v104, v104
    v_exp_f32 v105, v105
    v_exp_f32 v106, v106
    v_exp_f32 v107, v107
    v_mfma_f32_32x32x8bf16_1k v[88:103], v[140:141], v[252:253], v[88:103]
    ds_read_b64_tr_b16 v[152:153], v19 offset:33792
    ds_read_b64_tr_b16 v[154:155], v20 offset:33792
    v_exp_f32 v108, v108
    v_exp_f32 v109, v109
    v_exp_f32 v110, v110
    v_exp_f32 v111, v111
    v_mfma_f32_32x32x16_bf16 v[72:87], v[156:159], v[124:127], v[72:87]
    ds_read_b64_tr_b16 v[156:157], v19 offset:34048
    ds_read_b64_tr_b16 v[158:159], v20 offset:34048
    v_cvt_pk_bf16_f32 v128, v104, v105
    v_cvt_pk_bf16_f32 v129, v106, v107
    v_cvt_pk_bf16_f32 v130, v108, v109
    v_cvt_pk_bf16_f32 v131, v110, v111
    v_exp_f32 v112, v112
    v_exp_f32 v113, v113
    v_exp_f32 v114, v114
    v_exp_f32 v115, v115
    v_mfma_f32_32x32x16_bf16 v[72:87], v[160:163], v[128:131], v[72:87]
    s_waitcnt lgkmcnt(2)
    buffer_load_dwordx4 a[48:51], v1, s[4:7], s20 offen offset:2048 sc1
    buffer_load_dwordx4 a[52:55], v1, s[4:7], s20 offen offset:3072 sc1
    v_exp_f32 v116, v116
    v_exp_f32 v117, v117
    v_exp_f32 v118, v118
    v_exp_f32_e64 v119, v119
    v_cvt_pk_bf16_f32 v132, v112, v113
    v_cvt_pk_bf16_f32 v133, v114, v115
    v_cvt_pk_bf16_f32 v134, v116, v117
    v_cvt_pk_bf16_f32 v135, v118, v119
    s_cmp_eq_u32 s37, 0
    s_cbranch_scc1 L_halook_34
    s_waitcnt vmcnt(5)
    v_cmp_ne_u32 vcc, v224, v15
    s_nop 0
    s_and_b32 vcc_hi, vcc_lo, 1
    s_cbranch_scc0 L_halook_34
L_poll_36:
    buffer_load_dword v26, v14, s[4:7], s60 offen offset:0 sc1
    s_waitcnt vmcnt(0)
    v_cmp_ne_u32_e64 vcc, v26, v15
    s_nop 0
    s_and_b32 vcc_hi, vcc_lo, 1
    s_cbranch_scc0 L_polled_37
    s_sub_u32 s44, s44, 1
    s_cbranch_scc0 L_poll_36
    s_mov_b32 s44, 0
L_polled_37:
L_halook_34:
    s_mov_b32 m0, 136192
    s_add_u32 s63, s61, 21504
    buffer_load_dwordx4 v31, s[4:7], s63 offen offset:0 sc1 lds
    buffer_load_dwordx4 v31, s[4:7], s63 offen offset:1024 sc1 lds
    buffer_load_dwordx4 v31, s[4:7], s63 offen offset:2048 sc1 lds
    v_mfma_f32_32x32x16_bf16 v[104:119], v[144:147], v[248:251], 0
    ds_read_b128 v[136:139], v16 offset:27648
    ds_read_b64 v[140:141], v18 offset:27648
    v_exp_f32 v88, v88
    v_exp_f32 v89, v89
    v_exp_f32 v90, v90
    v_exp_f32 v91, v91
    v_mfma_f32_32x32x8bf16_1k v[104:119], v[148:149], v[252:253], v[104:119]
    ds_read_b64_tr_b16 v[160:161], v19 offset:30720
    ds_read_b64_tr_b16 v[162:163], v20 offset:30720
    v_exp_f32 v92, v92
    v_exp_f32 v93, v93
    v_exp_f32 v94, v94
    v_exp_f32 v95, v95
    v_mfma_f32_32x32x16_bf16 v[72:87], v[164:167], v[132:135], v[72:87]
    ds_read_b64_tr_b16 v[164:165], v19 offset:30976
    ds_read_b64_tr_b16 v[166:167], v20 offset:30976
    v_cvt_pk_bf16_f32 v120, v88, v89
    v_cvt_pk_bf16_f32 v121, v90, v91
    v_cvt_pk_bf16_f32 v122, v92, v93
    v_cvt_pk_bf16_f32 v123, v94, v95
    v_exp_f32 v96, v96
    v_exp_f32 v97, v97
    v_exp_f32 v98, v98
    v_exp_f32 v99, v99
    v_mfma_f32_32x32x16_bf16 v[72:87], v[152:155], v[120:123], v[72:87]
    s_waitcnt lgkmcnt(2)
    s_add_u32 s20, s20, 4096
    buffer_load_dwordx4 a[56:59], v1, s[4:7], s20 offen offset:0 sc1
    s_add_u32 s20, s20, 16384
    buffer_load_dwordx4 a[60:63], v1, s[4:7], s20 offen offset:0 sc1
    buffer_load_dwordx4 a[64:67], v1, s[4:7], s20 offen offset:1024 sc1
    v_exp_f32 v100, v100
    v_exp_f32 v101, v101
    v_exp_f32 v102, v102
    v_exp_f32_e64 v103, v103
    v_cvt_pk_bf16_f32 v124, v96, v97
    v_cvt_pk_bf16_f32 v125, v98, v99
    v_cvt_pk_bf16_f32 v126, v100, v101
    v_cvt_pk_bf16_f32 v127, v102, v103
    v_mfma_f32_32x32x16_bf16 v[88:103], v[136:139], v[248:251], 0
    ds_read_b128 v[144:147], v16 offset:24576
    ds_read_b64 v[148:149], v18 offset:24576
    v_exp_f32 v104, v104
    v_exp_f32 v105, v105
    v_exp_f32 v106, v106
    v_exp_f32 v107, v107
    v_mfma_f32_32x32x8bf16_1k v[88:103], v[140:141], v[252:253], v[88:103]
    ds_read_b64_tr_b16 v[152:153], v19 offset:27648
    ds_read_b64_tr_b16 v[154:155], v20 offset:27648
    v_exp_f32 v108, v108
    v_exp_f32 v109, v109
    v_exp_f32 v110, v110
    v_exp_f32 v111, v111
    v_mfma_f32_32x32x16_bf16 v[72:87], v[156:159], v[124:127], v[72:87]
    ds_read_b64_tr_b16 v[156:157], v19 offset:27904
    ds_read_b64_tr_b16 v[158:159], v20 offset:27904
    v_cvt_pk_bf16_f32 v128, v104, v105
    v_cvt_pk_bf16_f32 v129, v106, v107
    v_cvt_pk_bf16_f32 v130, v108, v109
    v_cvt_pk_bf16_f32 v131, v110, v111
    v_exp_f32 v112, v112
    v_exp_f32 v113, v113
    v_exp_f32 v114, v114
    v_exp_f32 v115, v115
    v_mfma_f32_32x32x16_bf16 v[72:87], v[160:163], v[128:131], v[72:87]
    s_waitcnt lgkmcnt(2)
    buffer_load_dwordx4 a[68:71], v1, s[4:7], s20 offen offset:2048 sc1
    buffer_load_dwordx4 a[72:75], v1, s[4:7], s20 offen offset:3072 sc1
    v_exp_f32 v116, v116
    v_exp_f32 v117, v117
    v_exp_f32 v118, v118
    v_exp_f32_e64 v119, v119
    v_cvt_pk_bf16_f32 v132, v112, v113
    v_cvt_pk_bf16_f32 v133, v114, v115
    v_cvt_pk_bf16_f32 v134, v116, v117
    v_cvt_pk_bf16_f32 v135, v118, v119
    v_mfma_f32_32x32x16_bf16 v[104:119], v[144:147], v[248:251], 0
    s_add_u32 s20, s20, 4096
    buffer_load_dwordx4 a[76:79], v1, s[4:7], s20 offen offset:0 sc1
    v_exp_f32 v88, v88
    v_exp_f32 v89, v89
    v_exp_f32 v90, v90
    v_exp_f32 v91, v91
    v_mfma_f32_32x32x8bf16_1k v[104:119], v[148:149], v[252:253], v[104:119]
    s_branch L_over_445
L_chain0_1_0:
    s_branch L_chain0_1_1
L_over_445:
    ds_read_b64_tr_b16 v[160:161], v19 offset:24576
    ds_read_b64_tr_b16 v[162:163], v20 offset:24576
    v_exp_f32 v92, v92
    v_exp_f32 v93, v93
    v_exp_f32 v94, v94
    v_exp_f32 v95, v95
    v_mfma_f32_32x32x16_bf16 v[72:87], v[164:167], v[132:135], v[72:87]
    ds_read_b64_tr_b16 v[164:165], v19 offset:24832
    ds_read_b64_tr_b16 v[166:167], v20 offset:24832
    v_cvt_pk_bf16_f32 v120, v88, v89
    v_cvt_pk_bf16_f32 v121, v90, v91
    v_cvt_pk_bf16_f32 v122, v92, v93
    v_cvt_pk_bf16_f32 v123, v94, v95
    v_exp_f32 v96, v96
    v_exp_f32 v97, v97
    v_exp_f32 v98, v98
    v_exp_f32 v99, v99
    v_mfma_f32_32x32x16_bf16 v[72:87], v[152:155], v[120:123], v[72:87]
    s_waitcnt lgkmcnt(2)
    s_add_u32 s20, s20, 16384
    buffer_load_dwordx4 a[80:83], v1, s[4:7], s20 offen offset:0 sc1
    v_exp_f32 v100, v100
    v_exp_f32 v101, v101
    v_exp_f32 v102, v102
    v_exp_f32_e64 v103, v103
    v_cvt_pk_bf16_f32 v124, v96, v97
    v_cvt_pk_bf16_f32 v125, v98, v99
    v_cvt_pk_bf16_f32 v126, v100, v101
    v_cvt_pk_bf16_f32 v127, v102, v103
    buffer_load_dword v228, v14, s[4:7], s60 offen offset:128 sc1
    v_mfma_f32_32x32x16_bf16 v[88:103], v[144:147], v[240:243], v[192:207]
    buffer_load_dwordx4 a[84:87], v1, s[4:7], s20 offen offset:1024 sc1
    v_exp_f32 v104, v104
    v_exp_f32 v105, v105
    v_exp_f32 v106, v106
    v_exp_f32 v107, v107
    v_mfma_f32_32x32x8bf16_1k v[88:103], v[148:149], v[244:245], v[88:103]
    buffer_load_dwordx4 a[88:91], v1, s[4:7], s20 offen offset:2048 sc1
    v_exp_f32 v108, v108
    v_exp_f32 v109, v109
    v_exp_f32 v110, v110
    v_exp_f32 v111, v111
    v_mfma_f32_32x32x16_bf16 v[72:87], v[156:159], v[124:127], v[72:87]
    buffer_load_dwordx4 a[92:95], v1, s[4:7], s20 offen offset:3072 sc1
    v_cvt_pk_bf16_f32 v128, v104, v105
    v_cvt_pk_bf16_f32 v129, v106, v107
    v_cvt_pk_bf16_f32 v130, v108, v109
    v_cvt_pk_bf16_f32 v131, v110, v111
    v_exp_f32 v112, v112
    v_exp_f32 v113, v113
    v_exp_f32 v114, v114
    v_exp_f32 v115, v115
    v_mfma_f32_32x32x16_bf16 v[72:87], v[160:163], v[128:131], v[72:87]
    s_waitcnt lgkmcnt(0)
    v_exp_f32 v116, v116
    v_exp_f32 v117, v117
    v_exp_f32 v118, v118
    v_exp_f32_e64 v119, v119
    v_cvt_pk_bf16_f32 v132, v112, v113
    v_cvt_pk_bf16_f32 v133, v114, v115
    v_cvt_pk_bf16_f32 v134, v116, v117
    v_cvt_pk_bf16_f32 v135, v118, v119
    s_waitcnt vmcnt(11)
    s_barrier
    ds_read_b128 v[136:139], v16 offset:21504
    ds_read_b64 v[140:141], v18 offset:21504
    s_waitcnt lgkmcnt(0)
    v_mfma_f32_32x32x16_bf16 v[104:119], v[136:139], v[248:251], v[208:223]
    s_add_u32 s20, s20, 4096
    buffer_load_dwordx4 a[96:99], v1, s[4:7], s20 offen offset:0 sc1
    v_exp_f32 v88, v88
    v_exp_f32 v89, v89
    v_exp_f32 v90, v90
    v_exp_f32_e64 v91, v91
    v_mfma_f32_32x32x8bf16_1k v[104:119], v[140:141], v[252:253], v[104:119]
    ds_read_b64_tr_b16 v[152:153], v19 offset:21504
    ds_read_b64_tr_b16 v[154:155], v20 offset:21504
    v_exp_f32 v92, v92
    v_exp_f32 v93, v93
    v_exp_f32 v94, v94
    v_exp_f32 v95, v95
    v_mfma_f32_32x32x16_bf16 v[72:87], v[164:167], v[132:135], v[72:87]
    ds_read_b64_tr_b16 v[156:157], v19 offset:21760
    ds_read_b64_tr_b16 v[158:159], v20 offset:21760
    v_cvt_pk_bf16_f32 v120, v88, v89
    v_cvt_pk_bf16_f32 v121, v90, v91
    v_cvt_pk_bf16_f32 v122, v92, v93
    v_cvt_pk_bf16_f32 v123, v94, v95
    v_exp_f32 v96, v96
    v_exp_f32 v97, v97
    v_exp_f32 v98, v98
    v_exp_f32 v99, v99
    v_mfma_f32_32x32x16_bf16 v[56:71], v[160:163], v[120:123], 0
    s_waitcnt lgkmcnt(2)
    s_add_u32 m0, s22, 50176
    s_add_u32 s21, s21, 16384
    buffer_load_dwordx4 v1, s[4:7], s21 offen offset:0 sc1 lds
    v_exp_f32 v100, v100
    v_exp_f32 v101, v101
    v_exp_f32 v102, v102
    v_exp_f32_e64 v103, v103
    v_cvt_pk_bf16_f32 v124, v96, v97
    v_cvt_pk_bf16_f32 v125, v98, v99
    v_cvt_pk_bf16_f32 v126, v100, v101
    v_cvt_pk_bf16_f32 v127, v102, v103
    s_cmp_eq_u32 s37, 0
    s_cbranch_scc1 L_halook_38
    s_waitcnt vmcnt(5)
    v_cmp_ne_u32 vcc, v228, v15
    s_nop 0
    s_and_b32 vcc_hi, vcc_lo, 1
    s_cbranch_scc0 L_halook_38
L_poll_40:
    buffer_load_dword v26, v14, s[4:7], s60 offen offset:128 sc1
    s_waitcnt vmcnt(0)
    v_cmp_ne_u32_e64 vcc, v26, v15
    s_nop 0
    s_and_b32 vcc_hi, vcc_lo, 1
    s_cbranch_scc0 L_polled_41
    s_sub_u32 s44, s44, 1
    s_cbranch_scc0 L_poll_40
    s_mov_b32 s44, 0
L_polled_41:
L_halook_38:
    s_mov_b32 m0, 114688
    s_add_u32 s63, s61, 0
    buffer_load_dwordx4 v31, s[4:7], s63 offen offset:0 sc1 lds
    buffer_load_dwordx4 v31, s[4:7], s63 offen offset:1024 sc1 lds
    buffer_load_dwordx4 v31, s[4:7], s63 offen offset:2048 sc1 lds
    s_lshl_b32 s68, s38, 2
    s_add_u32 s68, s68, s36
    s_mul_i32 s68, s68, 2560
    s_mul_i32 s69, s38, 17408
    s_add_u32 s68, s68, s69
    s_add_u32 s68, s68, s45
    s_add_u32 s68, s68, 372736
    v_add_u32 v168, 44, v21
    v_lshrrev_b32_e64 v168, 6, v168
    v_lshl_add_u32 v168, v168, 28, v1
    v_lshlrev_b32_e64 v168, 3, v168
    buffer_load_dword a252, v168, s[4:7], s68 offen offset:0 sc1
    v_mfma_f32_32x32x16_bf16 v[88:103], v[136:139], v[240:243], 0
    ds_read_b128 v[144:147], v16 offset:18432
    ds_read_b64 v[148:149], v18 offset:18432
    v_exp_f32 v104, v104
    v_exp_f32 v105, v105
    v_exp_f32 v106, v106
    v_exp_f32 v107, v107
    v_mfma_f32_32x32x8bf16_1k v[88:103], v[140:141], v[244:245], v[88:103]
    s_add_u32 m0, s22, 50176
    s_nop 0
    buffer_load_dwordx4 v1, s[4:7], s21 offen offset:1024 sc1 lds
    v_exp_f32 v108, v108
    v_exp_f32 v109, v109
    v_exp_f32 v110, v110
    v_exp_f32_e64 v111, v111
    v_mfma_f32_32x32x16_bf16 v[56:71], v[164:167], v[124:127], v[56:71]
    buffer_load_dwordx4 v1, s[4:7], s21 offen offset:2048 sc1 lds
    v_cvt_pk_bf16_f32 v128, v104, v105
    v_cvt_pk_bf16_f32 v129, v106, v107
    v_cvt_pk_bf16_f32 v130, v108, v109
    v_cvt_pk_bf16_f32 v131, v110, v111
    v_exp_f32 v112, v112
    v_exp_f32 v113, v113
    v_exp_f32 v114, v114
    v_exp_f32 v115, v115
    v_mfma_f32_32x32x16_bf16 v[72:87], v[152:155], v[128:131], v[72:87]
    s_waitcnt lgkmcnt(0)
    buffer_load_dwordx4 v1, s[4:7], s21 offen offset:3072 sc1 lds
    v_exp_f32 v116, v116
    v_exp_f32 v117, v117
    v_exp_f32 v118, v118
    v_exp_f32_e64 v119, v119
    v_cvt_pk_bf16_f32 v132, v112, v113
    v_cvt_pk_bf16_f32 v133, v114, v115
    v_cvt_pk_bf16_f32 v134, v116, v117
    v_cvt_pk_bf16_f32 v135, v118, v119
    v_mfma_f32_32x32x16_bf16 v[104:119], v[144:147], v[240:243], 0
    ds_read_b128 v[136:139], v16 offset:15360
    ds_read_b64 v[140:141], v18 offset:15360
    v_exp_f32 v88, v88
    v_exp_f32 v89, v89
    v_exp_f32 v90, v90
    v_exp_f32 v91, v91
    v_mfma_f32_32x32x8bf16_1k v[104:119], v[148:149], v[244:245], v[104:119]
    ds_read_b64_tr_b16 v[160:161], v19 offset:18432
    ds_read_b64_tr_b16 v[162:163], v20 offset:18432
    v_exp_f32 v92, v92
    v_exp_f32 v93, v93
    v_exp_f32 v94, v94
    v_exp_f32 v95, v95
    v_mfma_f32_32x32x16_bf16 v[72:87], v[156:159], v[132:135], v[72:87]
    ds_read_b64_tr_b16 v[164:165], v19 offset:18688
    ds_read_b64_tr_b16 v[166:167], v20 offset:18688
    v_cvt_pk_bf16_f32 v120, v88, v89
    v_cvt_pk_bf16_f32 v121, v90, v91
    v_cvt_pk_bf16_f32 v122, v92, v93
    v_cvt_pk_bf16_f32 v123, v94, v95
    v_exp_f32 v96, v96
    v_exp_f32 v97, v97
    v_exp_f32 v98, v98
    v_exp_f32 v99, v99
    v_mfma_f32_32x32x16_bf16 v[56:71], v[152:155], v[120:123], v[56:71]
    s_waitcnt lgkmcnt(2)
    s_add_u32 m0, s22, 66560
    s_add_u32 s21, s21, 16384
    buffer_load_dwordx4 v1, s[4:7], s21 offen offset:0 sc1 lds
    buffer_load_dwordx4 v1, s[4:7], s21 offen offset:1024 sc1 lds
    v_exp_f32 v100, v100
    v_exp_f32 v101, v101
    v_exp_f32 v102, v102
    v_exp_f32_e64 v103, v103
    v_cvt_pk_bf16_f32 v124, v96, v97
    v_cvt_pk_bf16_f32 v125, v98, v99
    v_cvt_pk_bf16_f32 v126, v100, v101
    v_cvt_pk_bf16_f32 v127, v102, v103
    v_rcp_f32_e64 v86, v84
    s_add_u32 s54, s56, 8960
    v_pk_mul_f32 v[72:73], v[72:73], v[86:87] op_sel_hi:[1,0]
    v_pk_mul_f32 v[74:75], v[74:75], v[86:87] op_sel_hi:[1,0]
    v_pk_mul_f32 v[76:77], v[76:77], v[86:87] op_sel_hi:[1,0]
    v_pk_mul_f32 v[78:79], v[78:79], v[86:87] op_sel_hi:[1,0]
    v_pk_mul_f32 v[80:81], v[80:81], v[86:87] op_sel_hi:[1,0]
    v_pk_mul_f32 v[82:83], v[82:83], v[86:87] op_sel_hi:[1,0]
    v_cvt_pk_bf16_f32 v172, v72, v73
    v_cvt_pk_bf16_f32 v173, v74, v75
    v_cvt_pk_bf16_f32 v174, v76, v77
    v_cvt_pk_bf16_f32 v175, v78, v79
    v_cvt_pk_bf16_f32 v176, v80, v81
    v_cvt_pk_bf16_f32 v177, v82, v83
    s_cmp_eq_u32 s43, 0
    s_cbranch_scc1 L_safe_42
    buffer_store_dwordx4 v[172:175], v5, s[4:7], s54 offen offset:0
    buffer_store_dwordx2 v[176:177], v6, s[4:7], s54 offen offset:512
L_join_43:
    v_add_u32 v27, 3766484992, v84
    v_cmp_lt_u32 vcc, 1073741824, v27
    s_nop 0
    s_or_b32 s23, vcc_lo, vcc_hi
    s_mov_b32 s26, s23
    v_mfma_f32_32x32x16_bf16 v[88:103], v[136:139], v[240:243], 0
    ds_read_b128 v[144:147], v16 offset:12288
    ds_read_b64 v[148:149], v18 offset:12288
    v_exp_f32 v104, v104
    v_exp_f32 v105, v105
    v_exp_f32 v106, v106
    v_exp_f32 v107, v107
    v_mfma_f32_32x32x8bf16_1k v[88:103], v[140:141], v[244:245], v[88:103]
    ds_read_b64_tr_b16 v[152:153], v19 offset:15360
    ds_read_b64_tr_b16 v[154:155], v20 offset:15360
    v_exp_f32 v108, v108
    v_exp_f32 v109, v109
    v_exp_f32 v110, v110
    v_exp_f32 v111, v111
    v_mfma_f32_32x32x16_bf16 v[56:71], v[156:159], v[124:127], v[56:71]
    ds_read_b64_tr_b16 v[156:157], v19 offset:15616
    ds_read_b64_tr_b16 v[158:159], v20 offset:15616
    v_cvt_pk_bf16_f32 v128, v104, v105
    v_cvt_pk_bf16_f32 v129, v106, v107
    v_cvt_pk_bf16_f32 v130, v108, v109
    v_cvt_pk_bf16_f32 v131, v110, v111
    v_exp_f32 v112, v112
    v_exp_f32 v113, v113
    v_exp_f32 v114, v114
    v_exp_f32 v115, v115
    v_mfma_f32_32x32x16_bf16 v[56:71], v[160:163], v[128:131], v[56:71]
    s_waitcnt lgkmcnt(2)
    buffer_load_dwordx4 v1, s[4:7], s21 offen offset:2048 sc1 lds
    buffer_load_dwordx4 v1, s[4:7], s21 offen offset:3072 sc1 lds
    v_exp_f32 v116, v116
    v_exp_f32 v117, v117
    v_exp_f32 v118, v118
    v_exp_f32_e64 v119, v119
    v_cvt_pk_bf16_f32 v132, v112, v113
    v_cvt_pk_bf16_f32 v133, v114, v115
    v_cvt_pk_bf16_f32 v134, v116, v117
    v_cvt_pk_bf16_f32 v135, v118, v119
    v_mfma_f32_32x32x16_bf16 v[104:119], v[144:147], v[240:243], 0
    s_add_u32 m0, s22, 82944
    s_add_u32 s21, s21, 16384
    buffer_load_dwordx4 v1, s[4:7], s21 offen offset:0 sc1 lds
    v_exp_f32 v88, v88
    v_exp_f32 v89, v89
    v_exp_f32 v90, v90
    v_exp_f32 v91, v91
    v_mfma_f32_32x32x8bf16_1k v[104:119], v[148:149], v[244:245], v[104:119]
    ds_read_b64_tr_b16 v[160:161], v19 offset:12288
    ds_read_b64_tr_b16 v[162:163], v20 offset:12288
    v_exp_f32 v92, v92
    v_exp_f32 v93, v93
    v_exp_f32 v94, v94
    v_exp_f32 v95, v95
    v_mfma_f32_32x32x16_bf16 v[56:71], v[164:167], v[132:135], v[56:71]
    ds_read_b64_tr_b16 v[164:165], v19 offset:12544
    ds_read_b64_tr_b16 v[166:167], v20 offset:12544
    v_cvt_pk_bf16_f32 v120, v88, v89
    v_cvt_pk_bf16_f32 v121, v90, v91
    v_cvt_pk_bf16_f32 v122, v92, v93
    v_cvt_pk_bf16_f32 v123, v94, v95
    v_exp_f32 v96, v96
    v_exp_f32 v97, v97
    v_exp_f32 v98, v98
    v_exp_f32 v99, v99
    v_mfma_f32_32x32x16_bf16 v[56:71], v[152:155], v[120:123], v[56:71]
    s_waitcnt lgkmcnt(2)
    buffer_load_dwordx4 v1, s[4:7], s21 offen offset:1024 sc1 lds
    buffer_load_dwordx4 v1, s[4:7], s21 offen offset:2048 sc1 lds
    v_exp_f32 v100, v100
    v_exp_f32 v101, v101
    v_exp_f32 v102, v102
    v_exp_f32_e64 v103, v103
    v_cvt_pk_bf16_f32 v124, v96, v97
    v_cvt_pk_bf16_f32 v125, v98, v99
    v_cvt_pk_bf16_f32 v126, v100, v101
    v_cvt_pk_bf16_f32 v127, v102, v103
    s_waitcnt vmcnt(13)
    s_barrier
    s_cmp_lg_u32 s23, 0
    s_cbranch_scc1 L_nohi_44
    s_waitcnt vmcnt(5)
    s_cmp_eq_u32 s43, 0
    s_cbranch_scc1 L_safe_45
    buffer_store_dword v0, v14, s[4:7], s41 offen offset:0
L_join_46:
L_nohi_44:
    ds_read_b128 v[136:139], v16 offset:9216
    ds_read_b64 v[140:141], v18 offset:9216
    s_waitcnt lgkmcnt(0)
    v_mfma_f32_32x32x16_bf16 v[88:103], v[136:139], v[240:243], 0
    ds_read_b128 v[144:147], v16 offset:6144
    ds_read_b64 v[148:149], v18 offset:6144
    v_exp_f32 v104, v104
    v_exp_f32 v105, v105
    v_exp_f32 v106, v106
    v_exp_f32 v107, v107
    v_mfma_f32_32x32x8bf16_1k v[88:103], v[140:141], v[244:245], v[88:103]
    ds_read_b64_tr_b16 v[152:153], v19 offset:9216
    ds_read_b64_tr_b16 v[154:155], v20 offset:9216
    v_exp_f32 v108, v108
    v_exp_f32 v109, v109
    v_exp_f32 v110, v110
    v_exp_f32 v111, v111
    v_mfma_f32_32x32x16_bf16 v[56:71], v[156:159], v[124:127], v[56:71]
    ds_read_b64_tr_b16 v[156:157], v19 offset:9472
    ds_read_b64_tr_b16 v[158:159], v20 offset:9472
    v_cvt_pk_bf16_f32 v128, v104, v105
    v_cvt_pk_bf16_f32 v129, v106, v107
    v_cvt_pk_bf16_f32 v130, v108, v109
    v_cvt_pk_bf16_f32 v131, v110, v111
    v_exp_f32 v112, v112
    v_exp_f32 v113, v113
    v_exp_f32 v114, v114
    v_exp_f32 v115, v115
    v_mfma_f32_32x32x16_bf16 v[56:71], v[160:163], v[128:131], v[56:71]
    s_waitcnt lgkmcnt(2)
    buffer_load_dwordx4 v1, s[4:7], s21 offen offset:3072 sc1 lds
    s_mul_i32 s20, s40, 270
    s_mul_i32 s67, s36, 7
    s_add_u32 s20, s20, s67
    s_mul_i32 s67, s52, 27
    s_add_u32 s20, s20, s67
    s_lshl_b32 s20, s20, 10
    s_add_u32 s20, s20, 7864320
    buffer_load_dwordx4 a[100:103], v1, s[4:7], s20 offen offset:0 sc1
    v_exp_f32 v116, v116
    v_exp_f32 v117, v117
    v_exp_f32 v118, v118
    v_exp_f32 v119, v119
    v_cvt_pk_bf16_f32 v132, v112, v113
    v_cvt_pk_bf16_f32 v133, v114, v115
    v_cvt_pk_bf16_f32 v134, v116, v117
    v_cvt_pk_bf16_f32 v135, v118, v119
    s_lshl_b32 s68, s38, 2
    s_add_u32 s68, s68, s36
    s_mul_i32 s68, s68, 2560
    s_mul_i32 s69, s37, 327680
    s_add_u32 s68, s68, s69
    v_add_u32 v169, 44, v21
    v_lshrrev_b32_e64 v169, 6, v169
    v_lshl_add_u32 v169, v169, 28, v1
    v_lshlrev_b32_e64 v169, 3, v169
    buffer_load_dword a252, v169, s[8:11], s68 offen offset:0 sc1
    v_mfma_f32_32x32x16_bf16 v[104:119], v[144:147], v[240:243], 0
    ds_read_b128 v[136:139], v16 offset:3072
    ds_read_b64 v[140:141], v18 offset:3072
    v_exp_f32 v88, v88
    v_exp_f32 v89, v89
    v_exp_f32 v90, v90
    v_exp_f32 v91, v91
    v_mfma_f32_32x32x8bf16_1k v[104:119], v[148:149], v[244:245], v[104:119]
    ds_read_b64_tr_b16 v[160:161], v19 offset:6144
    ds_read_b64_tr_b16 v[162:163], v20 offset:6144
    v_exp_f32 v92, v92
    v_exp_f32 v93, v93
    v_exp_f32 v94, v94
    v_exp_f32 v95, v95
    v_mfma_f32_32x32x16_bf16 v[56:71], v[164:167], v[132:135], v[56:71]
    ds_read_b64_tr_b16 v[164:165], v19 offset:6400
    ds_read_b64_tr_b16 v[166:167], v20 offset:6400
    v_cvt_pk_bf16_f32 v120, v88, v89
    v_cvt_pk_bf16_f32 v121, v90, v91
    v_cvt_pk_bf16_f32 v122, v92, v93
    v_cvt_pk_bf16_f32 v123, v94, v95
    v_exp_f32 v96, v96
    v_exp_f32 v97, v97
    v_exp_f32 v98, v98
    v_exp_f32 v99, v99
    v_mfma_f32_32x32x16_bf16 v[56:71], v[152:155], v[120:123], v[56:71]
    s_waitcnt lgkmcnt(2)
    buffer_load_dwordx4 a[104:107], v1, s[4:7], s20 offen offset:1024 sc1
    buffer_load_dwordx4 a[108:111], v1, s[4:7], s20 offen offset:2048 sc1
    buffer_load_dwordx4 a[112:115], v1, s[4:7], s20 offen offset:3072 sc1
    v_exp_f32 v100, v100
    v_exp_f32 v101, v101
    v_exp_f32 v102, v102
    v_exp_f32_e64 v103, v103
    v_cvt_pk_bf16_f32 v124, v96, v97
    v_cvt_pk_bf16_f32 v125, v98, v99
    v_cvt_pk_bf16_f32 v126, v100, v101
    v_cvt_pk_bf16_f32 v127, v102, v103
    v_mfma_f32_32x32x16_bf16 v[88:103], v[136:139], v[240:243], 0
    ds_read_b128 v[144:147], v16 offset:0
    ds_read_b64 v[148:149], v18 offset:0
    v_exp_f32 v104, v104
    v_exp_f32 v105, v105
    v_exp_f32 v106, v106
    v_exp_f32 v107, v107
    v_mfma_f32_32x32x8bf16_1k v[88:103], v[140:141], v[244:245], v[88:103]
    ds_read_b64_tr_b16 v[152:153], v19 offset:3072
    ds_read_b64_tr_b16 v[154:155], v20 offset:3072
    v_exp_f32 v108, v108
    v_exp_f32 v109, v109
    v_exp_f32 v110, v110
    v_exp_f32 v111, v111
    v_mfma_f32_32x32x16_bf16 v[56:71], v[156:159], v[124:127], v[56:71]
    ds_read_b64_tr_b16 v[156:157], v19 offset:3328
    ds_read_b64_tr_b16 v[158:159], v20 offset:3328
    v_cvt_pk_bf16_f32 v128, v104, v105
    v_cvt_pk_bf16_f32 v129, v106, v107
    v_cvt_pk_bf16_f32 v130, v108, v109
    v_cvt_pk_bf16_f32 v131, v110, v111
    v_exp_f32 v112, v112
    v_exp_f32 v113, v113
    v_exp_f32 v114, v114
    v_exp_f32 v115, v115
    v_mfma_f32_32x32x16_bf16 v[56:71], v[160:163], v[128:131], v[56:71]
    s_waitcnt lgkmcnt(2)
    s_add_u32 s20, s20, 4096
    buffer_load_dwordx4 a[116:119], v1, s[4:7], s20 offen offset:0 sc1
    buffer_load_dwordx4 a[120:123], v1, s[4:7], s20 offen offset:1024 sc1
    v_exp_f32 v116, v116
    v_exp_f32 v117, v117
    v_exp_f32 v118, v118
    v_exp_f32_e64 v119, v119
    v_cvt_pk_bf16_f32 v132, v112, v113
    v_cvt_pk_bf16_f32 v133, v114, v115
    v_cvt_pk_bf16_f32 v134, v116, v117
    v_cvt_pk_bf16_f32 v135, v118, v119
    v_mfma_f32_32x32x16_bf16 v[104:119], v[144:147], v[240:243], v[208:223]
    buffer_load_dwordx4 a[124:127], v25, s[4:7], s20 offen offset:2048 sc1
    v_exp_f32 v88, v88
    v_exp_f32 v89, v89
    v_exp_f32 v90, v90
    v_exp_f32 v91, v91
    v_mfma_f32_32x32x8bf16_1k v[104:119], v[148:149], v[244:245], v[104:119]
    ds_read_b64_tr_b16 v[160:161], v19 offset:0
    ds_read_b64_tr_b16 v[162:163], v20 offset:0
    v_exp_f32 v92, v92
    v_exp_f32 v93, v93
    v_exp_f32 v94, v94
    v_exp_f32 v95, v95
    v_mfma_f32_32x32x16_bf16 v[56:71], v[164:167], v[132:135], v[56:71]
    ds_read_b64_tr_b16 v[164:165], v19 offset:256
    ds_read_b64_tr_b16 v[166:167], v20 offset:256
    v_cvt_pk_bf16_f32 v120, v88, v89
    v_cvt_pk_bf16_f32 v121, v90, v91
    v_cvt_pk_bf16_f32 v122, v92, v93
    v_cvt_pk_bf16_f32 v123, v94, v95
    v_exp_f32 v96, v96
    v_exp_f32 v97, v97
    v_exp_f32 v98, v98
    v_exp_f32 v99, v99
    v_mfma_f32_32x32x16_bf16 v[56:71], v[152:155], v[120:123], v[56:71]
    s_waitcnt lgkmcnt(2)
    s_add_u32 s20, s20, 51200
    buffer_load_dwordx4 a[128:131], v1, s[4:7], s20 offen offset:0 sc1
    v_exp_f32 v100, v100
    v_exp_f32 v101, v101
    v_exp_f32 v102, v102
    v_exp_f32_e64 v103, v103
    v_cvt_pk_bf16_f32 v124, v96, v97
    v_cvt_pk_bf16_f32 v125, v98, v99
    v_cvt_pk_bf16_f32 v126, v100, v101
    v_cvt_pk_bf16_f32 v127, v102, v103
    v_exp_f32 v104, v104
    v_exp_f32 v105, v105
    v_exp_f32 v106, v106
    v_exp_f32 v107, v107
    v_exp_f32 v108, v108
    v_exp_f32 v109, v109
    v_exp_f32 v110, v110
    v_exp_f32 v111, v111
    v_mfma_f32_32x32x16_bf16 v[56:71], v[156:159], v[124:127], v[56:71]
    v_cvt_pk_bf16_f32 v128, v104, v105
    v_cvt_pk_bf16_f32 v129, v106, v107
    v_cvt_pk_bf16_f32 v130, v108, v109
    v_cvt_pk_bf16_f32 v131, v110, v111
    v_exp_f32 v112, v112
    v_exp_f32 v113, v113
    v_exp_f32 v114, v114
    v_exp_f32 v115, v115
    v_mfma_f32_32x32x16_bf16 v[56:71], v[160:163], v[128:131], v[56:71]
    s_waitcnt lgkmcnt(0)
    v_exp_f32 v116, v116
    v_exp_f32 v117, v117
    v_exp_f32 v118, v118
    v_exp_f32_e64 v119, v119
    v_cvt_pk_bf16_f32 v132, v112, v113
    v_cvt_pk_bf16_f32 v133, v114, v115
    v_cvt_pk_bf16_f32 v134, v116, v117
    v_cvt_pk_bf16_f32 v135, v118, v119
    s_nop 1
    v_mfma_f32_32x32x16_bf16 v[56:71], v[164:167], v[132:135], v[56:71]
    s_nop 11
    v_rcp_f32 v70, v68
    s_add_u32 s54, s56, 0
    v_pk_mul_f32 v[56:57], v[56:57], v[70:71] op_sel_hi:[1,0]
    v_pk_mul_f32 v[58:59], v[58:59], v[70:71] op_sel_hi:[1,0]
    v_pk_mul_f32 v[60:61], v[60:61], v[70:71] op_sel_hi:[1,0]
    v_pk_mul_f32 v[62:63], v[62:63], v[70:71] op_sel_hi:[1,0]
    v_pk_mul_f32 v[64:65], v[64:65], v[70:71] op_sel_hi:[1,0]
    v_pk_mul_f32 v[66:67], v[66:67], v[70:71] op_sel_hi:[1,0]
    v_cvt_pk_bf16_f32 v172, v56, v57
    v_cvt_pk_bf16_f32 v173, v58, v59
    v_cvt_pk_bf16_f32 v174, v60, v61
    v_cvt_pk_bf16_f32 v175, v62, v63
    v_cvt_pk_bf16_f32 v176, v64, v65
    v_cvt_pk_bf16_f32 v177, v66, v67
    s_cmp_eq_u32 s43, 0
    s_cbranch_scc1 L_safe_49
    buffer_store_dwordx4 v[172:175], v5, s[4:7], s54 offen offset:0
    buffer_store_dwordx2 v[176:177], v6, s[4:7], s54 offen offset:512
L_join_50:
    v_add_u32 v27, 3766484992, v68
    v_cmp_lt_u32_e64 vcc, 1073741824, v27
    s_nop 0
    s_or_b32 s23, s23, vcc_lo
    s_or_b32 s23, s23, vcc_hi
    s_cmp_lg_u32 s23, 0
    s_cbranch_scc1 L_fallback_47
L_fbdone_48:
    s_branch L_attdone_33
L_chain0_2_0:
    s_branch L_chain0_2_1
    s_nop 0
L_att1_30:
    ds_read_b128 v[136:139], v16 offset:43008
    ds_read_b64 v[140:141], v18 offset:43008
    ds_read_b64_tr_b16 v[152:153], v19 offset:43008
    ds_read_b64_tr_b16 v[154:155], v20 offset:43008
    ds_read_b64_tr_b16 v[156:157], v19 offset:43264
    ds_read_b64_tr_b16 v[158:159], v20 offset:43264
    v_add_u32 v26, s56, v16
    v_add_u32 v27, s56, v17
    v_add_u32 v28, s56, v18
    s_nop 0
    v_pk_mul_f32 v[72:73], v[72:73], v[224:225] op_sel:[0,1] op_sel_hi:[1,1]
    v_pk_mul_f32 v[74:75], v[74:75], v[224:225] op_sel:[0,1] op_sel_hi:[1,1]
    v_pk_mul_f32 v[76:77], v[76:77], v[224:225] op_sel:[0,1] op_sel_hi:[1,1]
    v_pk_mul_f32 v[78:79], v[78:79], v[224:225] op_sel:[0,1] op_sel_hi:[1,1]
    v_pk_mul_f32 v[80:81], v[80:81], v[224:225] op_sel:[0,1] op_sel_hi:[1,1]
    v_pk_mul_f32 v[82:83], v[82:83], v[224:225] op_sel:[0,1] op_sel_hi:[1,1]
    v_pk_mul_f32 v[84:85], v[84:85], v[224:225] op_sel:[0,1] op_sel_hi:[1,1]
    v_pk_mul_f32 v[86:87], v[86:87], v[224:225] op_sel:[0,1] op_sel_hi:[1,1]
    v_cvt_pk_bf16_f32 v72, v72, v73
    v_cvt_pk_bf16_f32 v73, v74, v75
    v_cvt_pk_bf16_f32 v74, v76, v77
    v_cvt_pk_bf16_f32 v75, v78, v79
    v_cvt_pk_bf16_f32 v76, v80, v81
    v_cvt_pk_bf16_f32 v77, v82, v83
    v_cvt_pk_bf16_f32 v78, v84, v85
    v_cvt_pk_bf16_f32 v79, v86, v87
    v_cndmask_b32 v78, v78, v31, s[50:51]
    v_cndmask_b32 v79, v79, 0, s[50:51]
    buffer_store_dwordx4 v[72:75], v26, s[4:7], s61 offen offset:0 sc1
    v_pk_mul_f32 v[80:81], v[64:65], v[224:225] op_sel:[0,1] op_sel_hi:[1,1]
    v_pk_mul_f32 v[82:83], v[66:67], v[224:225] op_sel:[0,1] op_sel_hi:[1,1]
    v_pk_mul_f32 v[84:85], v[68:69], v[224:225] op_sel:[0,1] op_sel_hi:[1,1]
    v_pk_mul_f32 v[86:87], v[70:71], v[224:225] op_sel:[0,1] op_sel_hi:[1,1]
    buffer_store_dwordx4 v[76:79], v28, s[4:7], s61 offen offset:0 sc1
    v_cvt_pk_bf16_f32 v80, v80, v81
    v_cvt_pk_bf16_f32 v81, v82, v83
    v_cvt_pk_bf16_f32 v82, v84, v85
    v_cvt_pk_bf16_f32 v83, v86, v87
    ds_write_b128 v26, v[72:75] offset:24576
    buffer_store_dwordx4 v[80:83], v27, s[4:7], s61 offen offset:0 sc1
    v_pk_mul_f32 v[64:65], v[64:65], v[226:227] op_sel:[0,1] op_sel_hi:[1,1]
    v_pk_mul_f32 v[66:67], v[66:67], v[226:227] op_sel:[0,1] op_sel_hi:[1,1]
    ds_write_b128 v28, v[76:79] offset:24576
    v_pk_mul_f32 v[56:57], v[56:57], v[226:227] op_sel:[0,0] op_sel_hi:[1,0]
    v_pk_mul_f32 v[58:59], v[58:59], v[226:227] op_sel:[0,0] op_sel_hi:[1,0]
    v_pk_mul_f32 v[60:61], v[60:61], v[226:227] op_sel:[0,0] op_sel_hi:[1,0]
    v_pk_mul_f32 v[62:63], v[62:63], v[226:227] op_sel:[0,0] op_sel_hi:[1,0]
    ds_write_b128 v27, v[80:83] offset:24576
    s_waitcnt lgkmcnt(7)
    v_mfma_f32_32x32x16_bf16 v[88:103], v[136:139], v[248:251], v[192:207]
    v_mfma_f32_32x32x8bf16_1k v[88:103], v[140:141], v[252:253], v[88:103]
    s_waitcnt lgkmcnt(0)
    s_barrier
    ds_read_b128 v[144:147], v16 offset:39936
    ds_read_b64 v[148:149], v18 offset:39936
    v_cvt_pk_bf16_f32 v240, v56, v57
    v_cvt_pk_bf16_f32 v241, v58, v59
    v_cvt_pk_bf16_f32 v242, v60, v61
    v_cvt_pk_bf16_f32 v243, v62, v63
    v_cvt_pk_bf16_f32 v244, v64, v65
    v_cvt_pk_bf16_f32 v245, v66, v67
    s_add_u32 s61, s58, -4079616
    v_add_u32 v31, s62, v1
    s_mov_b32 s56, s63
    v_add_u32 v0, 1, v15
    v_exp_f32 v88, v88
    v_exp_f32 v89, v89
    v_exp_f32_e64 v90, v90
    v_exp_f32 v91, v91
    s_waitcnt lgkmcnt(0)
    v_mfma_f32_32x32x16_bf16 v[104:119], v[144:147], v[248:251], 0
    ds_read_b128 v[136:139], v16 offset:36864
    ds_read_b64 v[140:141], v18 offset:36864
    v_exp_f32 v92, v92
    v_exp_f32 v93, v93
    v_exp_f32 v94, v94
    v_exp_f32 v95, v95
    v_mfma_f32_32x32x8bf16_1k v[104:119], v[148:149], v[252:253], v[104:119]
    ds_read_b64_tr_b16 v[160:161], v19 offset:39936
    ds_read_b64_tr_b16 v[162:163], v20 offset:39936
    ds_read_b64_tr_b16 v[164:165], v19 offset:40192
    ds_read_b64_tr_b16 v[166:167], v20 offset:40192
    v_cvt_pk_bf16_f32 v120, v88, v89
    v_cvt_pk_bf16_f32 v121, v90, v91
    v_cvt_pk_bf16_f32 v122, v92, v93
    v_cvt_pk_bf16_f32 v123, v94, v95
    v_exp_f32 v96, v96
    v_exp_f32 v97, v97
    v_exp_f32 v98, v98
    v_exp_f32 v99, v99
    v_mfma_f32_32x32x16_bf16 v[72:87], v[152:155], v[120:123], 0
    s_waitcnt lgkmcnt(2)
    s_add_u32 s20, s20, 4096
    buffer_load_dwordx4 a[16:19], v1, s[4:7], s20 offen offset:0 sc1
    s_add_u32 s20, s20, 16384
    buffer_load_dwordx4 a[20:23], v1, s[4:7], s20 offen offset:0 sc1
    buffer_load_dwordx4 a[24:27], v1, s[4:7], s20 offen offset:1024 sc1
    v_exp_f32 v100, v100
    v_exp_f32 v101, v101
    v_exp_f32 v102, v102
    v_exp_f32_e64 v103, v103
    v_cvt_pk_bf16_f32 v124, v96, v97
    v_cvt_pk_bf16_f32 v125, v98, v99
    v_cvt_pk_bf16_f32 v126, v100, v101
    v_cvt_pk_bf16_f32 v127, v102, v103
    v_mfma_f32_32x32x16_bf16 v[88:103], v[136:139], v[248:251], 0
    s_branch L_over_446
L_chain0_3_0:
    s_branch L_chain0_3_1
L_over_446:
    ds_read_b128 v[144:147], v16 offset:33792
    ds_read_b64 v[148:149], v18 offset:33792
    v_exp_f32 v104, v104
    v_exp_f32 v105, v105
    v_exp_f32 v106, v106
    v_exp_f32 v107, v107
    v_mfma_f32_32x32x8bf16_1k v[88:103], v[140:141], v[252:253], v[88:103]
    ds_read_b64_tr_b16 v[152:153], v19 offset:36864
    ds_read_b64_tr_b16 v[154:155], v20 offset:36864
    v_exp_f32 v108, v108
    v_exp_f32 v109, v109
    v_exp_f32 v110, v110
    v_exp_f32 v111, v111
    v_mfma_f32_32x32x16_bf16 v[72:87], v[156:159], v[124:127], v[72:87]
    ds_read_b64_tr_b16 v[156:157], v19 offset:37120
    ds_read_b64_tr_b16 v[158:159], v20 offset:37120
    v_cvt_pk_bf16_f32 v128, v104, v105
    v_cvt_pk_bf16_f32 v129, v106, v107
    v_cvt_pk_bf16_f32 v130, v108, v109
    v_cvt_pk_bf16_f32 v131, v110, v111
    v_exp_f32 v112, v112
    v_exp_f32 v113, v113
    v_exp_f32 v114, v114
    v_exp_f32 v115, v115
    v_mfma_f32_32x32x16_bf16 v[72:87], v[160:163], v[128:131], v[72:87]
    s_waitcnt lgkmcnt(2)
    buffer_load_dwordx4 a[28:31], v1, s[4:7], s20 offen offset:2048 sc1
    buffer_load_dwordx4 a[32:35], v1, s[4:7], s20 offen offset:3072 sc1
    v_exp_f32 v116, v116
    v_exp_f32 v117, v117
    v_exp_f32 v118, v118
    v_exp_f32_e64 v119, v119
    v_cvt_pk_bf16_f32 v132, v112, v113
    v_cvt_pk_bf16_f32 v133, v114, v115
    v_cvt_pk_bf16_f32 v134, v116, v117
    v_cvt_pk_bf16_f32 v135, v118, v119
    s_waitcnt vmcnt(5)
    buffer_store_dword v15, v24, s[4:7], s59 offen offset:128 sc1
    buffer_load_dword v224, v14, s[4:7], s60 offen offset:0 sc1
    v_mfma_f32_32x32x16_bf16 v[104:119], v[144:147], v[248:251], 0
    ds_read_b128 v[136:139], v16 offset:30720
    ds_read_b64 v[140:141], v18 offset:30720
    v_exp_f32 v88, v88
    v_exp_f32 v89, v89
    v_exp_f32 v90, v90
    v_exp_f32_e64 v91, v91
    v_mfma_f32_32x32x8bf16_1k v[104:119], v[148:149], v[252:253], v[104:119]
    ds_read_b64_tr_b16 v[160:161], v19 offset:33792
    ds_read_b64_tr_b16 v[162:163], v20 offset:33792
    v_exp_f32 v92, v92
    v_exp_f32 v93, v93
    v_exp_f32 v94, v94
    v_exp_f32 v95, v95
    v_mfma_f32_32x32x16_bf16 v[72:87], v[164:167], v[132:135], v[72:87]
    ds_read_b64_tr_b16 v[164:165], v19 offset:34048
    ds_read_b64_tr_b16 v[166:167], v20 offset:34048
    v_cvt_pk_bf16_f32 v120, v88, v89
    v_cvt_pk_bf16_f32 v121, v90, v91
    v_cvt_pk_bf16_f32 v122, v92, v93
    v_cvt_pk_bf16_f32 v123, v94, v95
    v_exp_f32 v96, v96
    v_exp_f32 v97, v97
    v_exp_f32 v98, v98
    v_exp_f32 v99, v99
    v_mfma_f32_32x32x16_bf16 v[72:87], v[152:155], v[120:123], v[72:87]
    s_waitcnt lgkmcnt(2)
    s_add_u32 s20, s20, 4096
    buffer_load_dwordx4 a[36:39], v1, s[4:7], s20 offen offset:0 sc1
    s_add_u32 s20, s20, 16384
    buffer_load_dwordx4 a[40:43], v1, s[4:7], s20 offen offset:0 sc1
    buffer_load_dwordx4 a[44:47], v1, s[4:7], s20 offen offset:1024 sc1
    v_exp_f32 v100, v100
    v_exp_f32 v101, v101
    v_exp_f32 v102, v102
    v_exp_f32_e64 v103, v103
    v_cvt_pk_bf16_f32 v124, v96, v97
    v_cvt_pk_bf16_f32 v125, v98, v99
    v_cvt_pk_bf16_f32 v126, v100, v101
    v_cvt_pk_bf16_f32 v127, v102, v103
    v_mfma_f32_32x32x16_bf16 v[88:103], v[136:139], v[248:251], 0
    ds_read_b128 v[144:147], v16 offset:27648
    ds_read_b64 v[148:149], v18 offset:27648
    v_exp_f32 v104, v104
    v_exp_f32 v105, v105
    v_exp_f32 v106, v106
    v_exp_f32 v107, v107
    v_mfma_f32_32x32x8bf16_1k v[88:103], v[140:141], v[252:253], v[88:103]
    ds_read_b64_tr_b16 v[152:153], v19 offset:30720
    ds_read_b64_tr_b16 v[154:155], v20 offset:30720
    v_exp_f32 v108, v108
    v_exp_f32 v109, v109
    v_exp_f32 v110, v110
    v_exp_f32 v111, v111
    v_mfma_f32_32x32x16_bf16 v[72:87], v[156:159], v[124:127], v[72:87]
    ds_read_b64_tr_b16 v[156:157], v19 offset:30976
    ds_read_b64_tr_b16 v[158:159], v20 offset:30976
    v_cvt_pk_bf16_f32 v128, v104, v105
    v_cvt_pk_bf16_f32 v129, v106, v107
    v_cvt_pk_bf16_f32 v130, v108, v109
    v_cvt_pk_bf16_f32 v131, v110, v111
    v_exp_f32 v112, v112
    v_exp_f32 v113, v113
    v_exp_f32 v114, v114
    v_exp_f32 v115, v115
    v_mfma_f32_32x32x16_bf16 v[72:87], v[160:163], v[128:131], v[72:87]
    s_waitcnt lgkmcnt(2)
    buffer_load_dwordx4 a[48:51], v1, s[4:7], s20 offen offset:2048 sc1
    buffer_load_dwordx4 a[52:55], v1, s[4:7], s20 offen offset:3072 sc1
    v_exp_f32 v116, v116
    v_exp_f32 v117, v117
    v_exp_f32 v118, v118
    v_exp_f32_e64 v119, v119
    v_cvt_pk_bf16_f32 v132, v112, v113
    v_cvt_pk_bf16_f32 v133, v114, v115
    v_cvt_pk_bf16_f32 v134, v116, v117
    v_cvt_pk_bf16_f32 v135, v118, v119
    s_cmp_eq_u32 s37, 0
    s_cbranch_scc1 L_halook_51
    s_waitcnt vmcnt(5)
    v_cmp_ne_u32 vcc, v224, v15
    s_nop 0
    s_and_b32 vcc_hi, vcc_lo, 1
    s_cbranch_scc0 L_halook_51
L_poll_53:
    buffer_load_dword v26, v14, s[4:7], s60 offen offset:0 sc1
    s_waitcnt vmcnt(0)
    v_cmp_ne_u32_e64 vcc, v26, v15
    s_nop 0
    s_and_b32 vcc_hi, vcc_lo, 1
    s_cbranch_scc0 L_polled_54
    s_sub_u32 s44, s44, 1
    s_cbranch_scc0 L_poll_53
    s_mov_b32 s44, 0
L_polled_54:
L_halook_51:
    s_mov_b32 m0, 133120
    s_add_u32 s63, s61, 18432
    buffer_load_dwordx4 v31, s[4:7], s63 offen offset:0 sc1 lds
    buffer_load_dwordx4 v31, s[4:7], s63 offen offset:1024 sc1 lds
    buffer_load_dwordx4 v31, s[4:7], s63 offen offset:2048 sc1 lds
    v_mfma_f32_32x32x16_bf16 v[104:119], v[144:147], v[248:251], 0
    s_add_u32 s20, s20, 4096
    buffer_load_dwordx4 a[56:59], v1, s[4:7], s20 offen offset:0 sc1
    v_exp_f32 v88, v88
    v_exp_f32 v89, v89
    v_exp_f32 v90, v90
    v_exp_f32 v91, v91
    v_mfma_f32_32x32x8bf16_1k v[104:119], v[148:149], v[252:253], v[104:119]
    ds_read_b64_tr_b16 v[160:161], v19 offset:27648
    ds_read_b64_tr_b16 v[162:163], v20 offset:27648
    v_exp_f32 v92, v92
    v_exp_f32 v93, v93
    v_exp_f32 v94, v94
    v_exp_f32 v95, v95
    v_mfma_f32_32x32x16_bf16 v[72:87], v[164:167], v[132:135], v[72:87]
    ds_read_b64_tr_b16 v[164:165], v19 offset:27904
    ds_read_b64_tr_b16 v[166:167], v20 offset:27904
    v_cvt_pk_bf16_f32 v120, v88, v89
    v_cvt_pk_bf16_f32 v121, v90, v91
    v_cvt_pk_bf16_f32 v122, v92, v93
    v_cvt_pk_bf16_f32 v123, v94, v95
    v_exp_f32 v96, v96
    v_exp_f32 v97, v97
    v_exp_f32 v98, v98
    v_exp_f32 v99, v99
    v_mfma_f32_32x32x16_bf16 v[72:87], v[152:155], v[120:123], v[72:87]
    s_waitcnt lgkmcnt(2)
    s_add_u32 s20, s20, 16384
    buffer_load_dwordx4 a[60:63], v1, s[4:7], s20 offen offset:0 sc1
    buffer_load_dwordx4 a[64:67], v1, s[4:7], s20 offen offset:1024 sc1
    v_exp_f32 v100, v100
    v_exp_f32 v101, v101
    v_exp_f32 v102, v102
    v_exp_f32_e64 v103, v103
    v_cvt_pk_bf16_f32 v124, v96, v97
    v_cvt_pk_bf16_f32 v125, v98, v99
    v_cvt_pk_bf16_f32 v126, v100, v101
    v_cvt_pk_bf16_f32 v127, v102, v103
    v_mfma_f32_32x32x16_bf16 v[88:103], v[144:147], v[240:243], v[192:207]
    ds_read_b128 v[136:139], v16 offset:24576
    ds_read_b64 v[140:141], v18 offset:24576
    v_exp_f32 v104, v104
    v_exp_f32 v105, v105
    v_exp_f32 v106, v106
    v_exp_f32 v107, v107
    v_mfma_f32_32x32x8bf16_1k v[88:103], v[148:149], v[244:245], v[88:103]
    buffer_load_dwordx4 a[68:71], v1, s[4:7], s20 offen offset:2048 sc1
    v_exp_f32 v108, v108
    v_exp_f32 v109, v109
    v_exp_f32 v110, v110
    v_exp_f32 v111, v111
    v_mfma_f32_32x32x16_bf16 v[72:87], v[156:159], v[124:127], v[72:87]
    buffer_load_dwordx4 a[72:75], v1, s[4:7], s20 offen offset:3072 sc1
    v_cvt_pk_bf16_f32 v128, v104, v105
    v_cvt_pk_bf16_f32 v129, v106, v107
    v_cvt_pk_bf16_f32 v130, v108, v109
    v_cvt_pk_bf16_f32 v131, v110, v111
    v_exp_f32 v112, v112
    v_exp_f32 v113, v113
    v_exp_f32 v114, v114
    v_exp_f32 v115, v115
    v_mfma_f32_32x32x16_bf16 v[72:87], v[160:163], v[128:131], v[72:87]
    s_waitcnt lgkmcnt(0)
    v_exp_f32 v116, v116
    v_exp_f32 v117, v117
    v_exp_f32 v118, v118
    v_exp_f32_e64 v119, v119
    v_cvt_pk_bf16_f32 v132, v112, v113
    v_cvt_pk_bf16_f32 v133, v114, v115
    v_cvt_pk_bf16_f32 v134, v116, v117
    v_cvt_pk_bf16_f32 v135, v118, v119
    v_mfma_f32_32x32x16_bf16 v[104:119], v[136:139], v[248:251], 0
    s_add_u32 s20, s20, 4096
    buffer_load_dwordx4 a[76:79], v1, s[4:7], s20 offen offset:0 sc1
    v_exp_f32 v88, v88
    v_exp_f32 v89, v89
    v_exp_f32 v90, v90
    v_exp_f32 v91, v91
    v_mfma_f32_32x32x8bf16_1k v[104:119], v[140:141], v[252:253], v[104:119]
    ds_read_b64_tr_b16 v[152:153], v19 offset:24576
    ds_read_b64_tr_b16 v[154:155], v20 offset:24576
    v_exp_f32 v92, v92
    v_exp_f32 v93, v93
    v_exp_f32 v94, v94
    v_exp_f32 v95, v95
    v_mfma_f32_32x32x16_bf16 v[72:87], v[164:167], v[132:135], v[72:87]
    ds_read_b64_tr_b16 v[156:157], v19 offset:24832
    ds_read_b64_tr_b16 v[158:159], v20 offset:24832
    v_cvt_pk_bf16_f32 v120, v88, v89
    v_cvt_pk_bf16_f32 v121, v90, v91
    v_cvt_pk_bf16_f32 v122, v92, v93
    v_cvt_pk_bf16_f32 v123, v94, v95
    v_exp_f32 v96, v96
    v_exp_f32 v97, v97
    v_exp_f32 v98, v98
    v_exp_f32 v99, v99
    v_mfma_f32_32x32x16_bf16 v[56:71], v[160:163], v[120:123], 0
    s_waitcnt lgkmcnt(2)
    s_add_u32 s20, s20, 16384
    buffer_load_dwordx4 a[80:83], v1, s[4:7], s20 offen offset:0 sc1
    v_exp_f32 v100, v100
    v_exp_f32 v101, v101
    v_exp_f32 v102, v102
    v_exp_f32_e64 v103, v103
    v_cvt_pk_bf16_f32 v124, v96, v97
    v_cvt_pk_bf16_f32 v125, v98, v99
    v_cvt_pk_bf16_f32 v126, v100, v101
    v_cvt_pk_bf16_f32 v127, v102, v103
    buffer_load_dword v228, v14, s[4:7], s60 offen offset:128 sc1
    v_mfma_f32_32x32x16_bf16 v[88:103], v[136:139], v[240:243], 0
    buffer_load_dwordx4 a[84:87], v1, s[4:7], s20 offen offset:1024 sc1
    v_exp_f32 v104, v104
    v_exp_f32 v105, v105
    v_exp_f32 v106, v106
    v_exp_f32 v107, v107
    v_mfma_f32_32x32x8bf16_1k v[88:103], v[140:141], v[244:245], v[88:103]
    buffer_load_dwordx4 a[88:91], v1, s[4:7], s20 offen offset:2048 sc1
    v_exp_f32 v108, v108
    v_exp_f32 v109, v109
    v_exp_f32 v110, v110
    v_exp_f32 v111, v111
    v_mfma_f32_32x32x16_bf16 v[56:71], v[164:167], v[124:127], v[56:71]
    buffer_load_dwordx4 a[92:95], v1, s[4:7], s20 offen offset:3072 sc1
    v_cvt_pk_bf16_f32 v128, v104, v105
    v_cvt_pk_bf16_f32 v129, v106, v107
    v_cvt_pk_bf16_f32 v130, v108, v109
    v_cvt_pk_bf16_f32 v131, v110, v111
    v_exp_f32 v112, v112
    v_exp_f32 v113, v113
    v_exp_f32 v114, v114
    v_exp_f32 v115, v115
    v_mfma_f32_32x32x16_bf16 v[72:87], v[152:155], v[128:131], v[72:87]
    s_waitcnt lgkmcnt(0)
    v_exp_f32 v116, v116
    v_exp_f32 v117, v117
    v_exp_f32 v118, v118
    v_exp_f32_e64 v119, v119
    v_cvt_pk_bf16_f32 v132, v112, v113
    v_cvt_pk_bf16_f32 v133, v114, v115
    v_cvt_pk_bf16_f32 v134, v116, v117
    v_cvt_pk_bf16_f32 v135, v118, v119
    s_waitcnt vmcnt(11)
    s_barrier
    ds_read_b128 v[144:147], v16 offset:21504
    ds_read_b64 v[148:149], v18 offset:21504
    s_waitcnt lgkmcnt(0)
    v_mfma_f32_32x32x16_bf16 v[104:119], v[144:147], v[248:251], 0
    ds_read_b128 v[136:139], v16 offset:18432
    ds_read_b64 v[140:141], v18 offset:18432
    v_exp_f32 v88, v88
    v_exp_f32 v89, v89
    v_exp_f32 v90, v90
    v_exp_f32_e64 v91, v91
    v_mfma_f32_32x32x8bf16_1k v[104:119], v[148:149], v[252:253], v[104:119]
    ds_read_b64_tr_b16 v[160:161], v19 offset:21504
    ds_read_b64_tr_b16 v[162:163], v20 offset:21504
    v_exp_f32 v92, v92
    v_exp_f32 v93, v93
    v_exp_f32 v94, v94
    v_exp_f32 v95, v95
    v_mfma_f32_32x32x16_bf16 v[72:87], v[156:159], v[132:135], v[72:87]
    ds_read_b64_tr_b16 v[164:165], v19 offset:21760
    ds_read_b64_tr_b16 v[166:167], v20 offset:21760
    v_cvt_pk_bf16_f32 v120, v88, v89
    v_cvt_pk_bf16_f32 v121, v90, v91
    v_cvt_pk_bf16_f32 v122, v92, v93
    v_cvt_pk_bf16_f32 v123, v94, v95
    v_exp_f32 v96, v96
    v_exp_f32 v97, v97
    v_exp_f32 v98, v98
    v_exp_f32 v99, v99
    v_mfma_f32_32x32x16_bf16 v[56:71], v[152:155], v[120:123], v[56:71]
    s_waitcnt lgkmcnt(2)
    s_add_u32 s20, s20, 4096
    buffer_load_dwordx4 a[96:99], v1, s[4:7], s20 offen offset:0 sc1
    s_add_u32 m0, s22, 50176
    s_add_u32 s21, s21, 16384
    buffer_load_dwordx4 v1, s[4:7], s21 offen offset:0 sc1 lds
    v_exp_f32 v100, v100
    v_exp_f32 v101, v101
    v_exp_f32 v102, v102
    v_exp_f32_e64 v103, v103
    v_cvt_pk_bf16_f32 v124, v96, v97
    v_cvt_pk_bf16_f32 v125, v98, v99
    v_cvt_pk_bf16_f32 v126, v100, v101
    v_cvt_pk_bf16_f32 v127, v102, v103
    s_cmp_eq_u32 s37, 0
    s_cbranch_scc1 L_halook_55
    s_waitcnt vmcnt(5)
    v_cmp_ne_u32 vcc, v228, v15
    s_nop 0
    s_and_b32 vcc_hi, vcc_lo, 1
    s_cbranch_scc0 L_halook_55
L_poll_57:
    buffer_load_dword v26, v14, s[4:7], s60 offen offset:128 sc1
    s_waitcnt vmcnt(0)
    v_cmp_ne_u32_e64 vcc, v26, v15
    s_nop 0
    s_and_b32 vcc_hi, vcc_lo, 1
    s_cbranch_scc0 L_polled_58
    s_sub_u32 s44, s44, 1
    s_cbranch_scc0 L_poll_57
    s_mov_b32 s44, 0
L_polled_58:
L_halook_55:
    s_mov_b32 m0, 117760
    s_add_u32 s63, s61, 3072
    buffer_load_dwordx4 v31, s[4:7], s63 offen offset:0 sc1 lds
    buffer_load_dwordx4 v31, s[4:7], s63 offen offset:1024 sc1 lds
    buffer_load_dwordx4 v31, s[4:7], s63 offen offset:2048 sc1 lds
    s_lshl_b32 s68, s38, 2
    s_add_u32 s68, s68, s36
    s_mul_i32 s68, s68, 2560
    s_mul_i32 s69, s38, 17408
    s_add_u32 s68, s68, s69
    s_add_u32 s68, s68, s45
    s_add_u32 s68, s68, 372736
    v_add_u32 v168, 44, v21
    v_lshrrev_b32 v168, 6, v168
    v_lshl_add_u32 v168, v168, 28, v1
    v_lshlrev_b32_e64 v168, 3, v168
    buffer_load_dword a252, v168, s[4:7], s68 offen offset:0 sc1
    v_mfma_f32_32x32x16_bf16 v[88:103], v[136:139], v[248:251], v[208:223]
    ds_read_b128 v[144:147], v16 offset:21504
    ds_read_b64 v[148:149], v18 offset:21504
    v_exp_f32 v104, v104
    v_exp_f32 v105, v105
    v_exp_f32 v106, v106
    v_exp_f32 v107, v107
    v_mfma_f32_32x32x8bf16_1k v[88:103], v[140:141], v[252:253], v[88:103]
    ds_read_b64_tr_b16 v[152:153], v19 offset:18432
    ds_read_b64_tr_b16 v[154:155], v20 offset:18432
    v_exp_f32 v108, v108
    v_exp_f32 v109, v109
    v_exp_f32 v110, v110
    v_exp_f32 v111, v111
    v_mfma_f32_32x32x16_bf16 v[56:71], v[156:159], v[124:127], v[56:71]
    ds_read_b64_tr_b16 v[156:157], v19 offset:18688
    ds_read_b64_tr_b16 v[158:159], v20 offset:18688
    v_cvt_pk_bf16_f32 v128, v104, v105
    v_cvt_pk_bf16_f32 v129, v106, v107
    v_cvt_pk_bf16_f32 v130, v108, v109
    v_cvt_pk_bf16_f32 v131, v110, v111
    v_exp_f32 v112, v112
    v_exp_f32 v113, v113
    v_exp_f32 v114, v114
    v_exp_f32 v115, v115
    v_mfma_f32_32x32x16_bf16 v[72:87], v[160:163], v[128:131], v[72:87]
    s_waitcnt lgkmcnt(2)
    s_add_u32 m0, s22, 50176
    s_nop 0
    buffer_load_dwordx4 v1, s[4:7], s21 offen offset:1024 sc1 lds
    buffer_load_dwordx4 v1, s[4:7], s21 offen offset:2048 sc1 lds
    buffer_load_dwordx4 v1, s[4:7], s21 offen offset:3072 sc1 lds
    v_exp_f32 v116, v116
    v_exp_f32 v117, v117
    v_exp_f32 v118, v118
    v_exp_f32 v119, v119
    v_cvt_pk_bf16_f32 v132, v112, v113
    v_cvt_pk_bf16_f32 v133, v114, v115
    v_cvt_pk_bf16_f32 v134, v116, v117
    v_cvt_pk_bf16_f32 v135, v118, v119
    v_mfma_f32_32x32x16_bf16 v[104:119], v[144:147], v[240:243], 0
    ds_read_b128 v[136:139], v16 offset:18432
    ds_read_b64 v[140:141], v18 offset:18432
    v_exp_f32 v88, v88
    v_exp_f32 v89, v89
    v_exp_f32 v90, v90
    v_exp_f32 v91, v91
    v_mfma_f32_32x32x8bf16_1k v[104:119], v[148:149], v[244:245], v[104:119]
    ds_read_b64_tr_b16 v[160:161], v19 offset:21504
    ds_read_b64_tr_b16 v[162:163], v20 offset:21504
    v_exp_f32 v92, v92
    v_exp_f32 v93, v93
    v_exp_f32 v94, v94
    v_exp_f32 v95, v95
    v_mfma_f32_32x32x16_bf16 v[72:87], v[164:167], v[132:135], v[72:87]
    ds_read_b64_tr_b16 v[164:165], v19 offset:21760
    ds_read_b64_tr_b16 v[166:167], v20 offset:21760
    v_cvt_pk_bf16_f32 v120, v88, v89
    v_cvt_pk_bf16_f32 v121, v90, v91
    v_cvt_pk_bf16_f32 v122, v92, v93
    v_cvt_pk_bf16_f32 v123, v94, v95
    v_exp_f32 v96, v96
    v_exp_f32 v97, v97
    v_exp_f32 v98, v98
    v_exp_f32 v99, v99
    v_mfma_f32_32x32x16_bf16 v[72:87], v[152:155], v[120:123], v[72:87]
    s_waitcnt lgkmcnt(2)
    s_add_u32 m0, s22, 66560
    s_add_u32 s21, s21, 16384
    buffer_load_dwordx4 v1, s[4:7], s21 offen offset:0 sc1 lds
    buffer_load_dwordx4 v1, s[4:7], s21 offen offset:1024 sc1 lds
    v_exp_f32 v100, v100
    v_exp_f32 v101, v101
    v_exp_f32 v102, v102
    v_exp_f32_e64 v103, v103
    v_cvt_pk_bf16_f32 v124, v96, v97
    v_cvt_pk_bf16_f32 v125, v98, v99
    v_cvt_pk_bf16_f32 v126, v100, v101
    v_cvt_pk_bf16_f32 v127, v102, v103
    v_mfma_f32_32x32x16_bf16 v[88:103], v[136:139], v[240:243], 0
    ds_read_b128 v[144:147], v16 offset:15360
    ds_read_b64 v[148:149], v18 offset:15360
    v_exp_f32 v104, v104
    v_exp_f32 v105, v105
    v_exp_f32 v106, v106
    v_exp_f32 v107, v107
    v_mfma_f32_32x32x8bf16_1k v[88:103], v[140:141], v[244:245], v[88:103]
    ds_read_b64_tr_b16 v[152:153], v19 offset:18432
    ds_read_b64_tr_b16 v[154:155], v20 offset:18432
    v_exp_f32 v108, v108
    v_exp_f32 v109, v109
    v_exp_f32 v110, v110
    v_exp_f32 v111, v111
    v_mfma_f32_32x32x16_bf16 v[72:87], v[156:159], v[124:127], v[72:87]
    ds_read_b64_tr_b16 v[156:157], v19 offset:18688
    ds_read_b64_tr_b16 v[158:159], v20 offset:18688
    v_cvt_pk_bf16_f32 v128, v104, v105
    v_cvt_pk_bf16_f32 v129, v106, v107
    v_cvt_pk_bf16_f32 v130, v108, v109
    v_cvt_pk_bf16_f32 v131, v110, v111
    v_exp_f32 v112, v112
    v_exp_f32 v113, v113
    v_exp_f32 v114, v114
    v_exp_f32 v115, v115
    v_mfma_f32_32x32x16_bf16 v[56:71], v[160:163], v[128:131], v[56:71]
    s_waitcnt lgkmcnt(2)
    buffer_load_dwordx4 v1, s[4:7], s21 offen offset:2048 sc1 lds
    buffer_load_dwordx4 v1, s[4:7], s21 offen offset:3072 sc1 lds
    v_exp_f32 v116, v116
    v_exp_f32 v117, v117
    v_exp_f32 v118, v118
    v_exp_f32_e64 v119, v119
    v_cvt_pk_bf16_f32 v132, v112, v113
    v_cvt_pk_bf16_f32 v133, v114, v115
    v_cvt_pk_bf16_f32 v134, v116, v117
    v_cvt_pk_bf16_f32 v135, v118, v119
    v_rcp_f32_e64 v86, v84
    s_add_u32 s54, s56, 7680
    v_pk_mul_f32 v[72:73], v[72:73], v[86:87] op_sel_hi:[1,0]
    v_pk_mul_f32 v[74:75], v[74:75], v[86:87] op_sel_hi:[1,0]
    v_pk_mul_f32 v[76:77], v[76:77], v[86:87] op_sel_hi:[1,0]
    v_pk_mul_f32 v[78:79], v[78:79], v[86:87] op_sel_hi:[1,0]
    v_pk_mul_f32 v[80:81], v[80:81], v[86:87] op_sel_hi:[1,0]
    v_pk_mul_f32 v[82:83], v[82:83], v[86:87] op_sel_hi:[1,0]
    v_cvt_pk_bf16_f32 v172, v72, v73
    v_cvt_pk_bf16_f32 v173, v74, v75
    v_cvt_pk_bf16_f32 v174, v76, v77
    v_cvt_pk_bf16_f32 v175, v78, v79
    v_cvt_pk_bf16_f32 v176, v80, v81
    v_cvt_pk_bf16_f32 v177, v82, v83
    s_cmp_eq_u32 s43, 0
    s_cbranch_scc1 L_safe_59
    buffer_store_dwordx4 v[172:175], v5, s[4:7], s54 offen offset:0
    buffer_store_dwordx2 v[176:177], v6, s[4:7], s54 offen offset:512
L_join_60:
    v_add_u32 v27, 3766484992, v84
    v_cmp_lt_u32 vcc, 1073741824, v27
    s_nop 0
    s_or_b32 s23, vcc_lo, vcc_hi
    s_mov_b32 s26, s23
    v_mfma_f32_32x32x16_bf16 v[104:119], v[144:147], v[240:243], 0
    ds_read_b128 v[136:139], v16 offset:12288
    ds_read_b64 v[140:141], v18 offset:12288
    v_exp_f32 v88, v88
    v_exp_f32 v89, v89
    v_exp_f32 v90, v90
    v_exp_f32 v91, v91
    v_mfma_f32_32x32x8bf16_1k v[104:119], v[148:149], v[244:245], v[104:119]
    ds_read_b64_tr_b16 v[160:161], v19 offset:15360
    ds_read_b64_tr_b16 v[162:163], v20 offset:15360
    v_exp_f32 v92, v92
    v_exp_f32 v93, v93
    v_exp_f32 v94, v94
    v_exp_f32 v95, v95
    v_mfma_f32_32x32x16_bf16 v[56:71], v[164:167], v[132:135], v[56:71]
    ds_read_b64_tr_b16 v[164:165], v19 offset:15616
    ds_read_b64_tr_b16 v[166:167], v20 offset:15616
    v_cvt_pk_bf16_f32 v120, v88, v89
    v_cvt_pk_bf16_f32 v121, v90, v91
    v_cvt_pk_bf16_f32 v122, v92, v93
    v_cvt_pk_bf16_f32 v123, v94, v95
    v_exp_f32 v96, v96
    v_exp_f32 v97, v97
    v_exp_f32 v98, v98
    v_exp_f32 v99, v99
    v_mfma_f32_32x32x16_bf16 v[56:71], v[152:155], v[120:123], v[56:71]
    s_waitcnt lgkmcnt(2)
    s_add_u32 m0, s22, 82944
    s_add_u32 s21, s21, 16384
    buffer_load_dwordx4 v1, s[4:7], s21 offen offset:0 sc1 lds
    buffer_load_dwordx4 v1, s[4:7], s21 offen offset:1024 sc1 lds
    buffer_load_dwordx4 v1, s[4:7], s21 offen offset:2048 sc1 lds
    v_exp_f32 v100, v100
    v_exp_f32 v101, v101
    v_exp_f32 v102, v102
    v_exp_f32_e64 v103, v103
    v_cvt_pk_bf16_f32 v124, v96, v97
    v_cvt_pk_bf16_f32 v125, v98, v99
    v_cvt_pk_bf16_f32 v126, v100, v101
    v_cvt_pk_bf16_f32 v127, v102, v103
    s_waitcnt vmcnt(13)
    s_barrier
    v_mfma_f32_32x32x16_bf16 v[88:103], v[136:139], v[240:243], 0
    ds_read_b128 v[144:147], v16 offset:9216
    ds_read_b64 v[148:149], v18 offset:9216
    v_exp_f32 v104, v104
    v_exp_f32 v105, v105
    v_exp_f32 v106, v106
    v_exp_f32 v107, v107
    v_mfma_f32_32x32x8bf16_1k v[88:103], v[140:141], v[244:245], v[88:103]
    ds_read_b64_tr_b16 v[152:153], v19 offset:12288
    ds_read_b64_tr_b16 v[154:155], v20 offset:12288
    v_exp_f32 v108, v108
    v_exp_f32 v109, v109
    v_exp_f32 v110, v110
    v_exp_f32 v111, v111
    v_mfma_f32_32x32x16_bf16 v[56:71], v[156:159], v[124:127], v[56:71]
    ds_read_b64_tr_b16 v[156:157], v19 offset:12544
    ds_read_b64_tr_b16 v[158:159], v20 offset:12544
    v_cvt_pk_bf16_f32 v128, v104, v105
    v_cvt_pk_bf16_f32 v129, v106, v107
    v_cvt_pk_bf16_f32 v130, v108, v109
    v_cvt_pk_bf16_f32 v131, v110, v111
    v_exp_f32 v112, v112
    v_exp_f32 v113, v113
    v_exp_f32 v114, v114
    v_exp_f32 v115, v115
    v_mfma_f32_32x32x16_bf16 v[56:71], v[160:163], v[128:131], v[56:71]
    s_waitcnt lgkmcnt(2)
    buffer_load_dwordx4 v1, s[4:7], s21 offen offset:3072 sc1 lds
    s_mul_i32 s20, s40, 270
    s_mul_i32 s67, s36, 7
    s_add_u32 s20, s20, s67
    s_mul_i32 s67, s52, 27
    s_add_u32 s20, s20, s67
    s_lshl_b32 s20, s20, 10
    s_add_u32 s20, s20, 7864320
    buffer_load_dwordx4 a[100:103], v1, s[4:7], s20 offen offset:0 sc1
    v_exp_f32 v116, v116
    v_exp_f32 v117, v117
    v_exp_f32 v118, v118
    v_exp_f32 v119, v119
    v_cvt_pk_bf16_f32 v132, v112, v113
    v_cvt_pk_bf16_f32 v133, v114, v115
    v_cvt_pk_bf16_f32 v134, v116, v117
    v_cvt_pk_bf16_f32 v135, v118, v119
    s_lshl_b32 s68, s38, 2
    s_add_u32 s68, s68, s36
    s_mul_i32 s68, s68, 2560
    s_mul_i32 s69, s37, 327680
    s_add_u32 s68, s68, s69
    v_add_u32 v169, 44, v21
    v_lshrrev_b32_e64 v169, 6, v169
    v_lshl_add_u32 v169, v169, 28, v1
    v_lshlrev_b32_e64 v169, 3, v169
    buffer_load_dword a252, v169, s[8:11], s68 offen offset:0 sc1
    s_cmp_lg_u32 s23, 0
    s_cbranch_scc1 L_nohi_61
    s_waitcnt vmcnt(6)
    s_cmp_eq_u32 s43, 0
    s_cbranch_scc1 L_safe_62
    buffer_store_dword v0, v14, s[4:7], s41 offen offset:0
L_join_63:
L_nohi_61:
    v_mfma_f32_32x32x16_bf16 v[104:119], v[144:147], v[240:243], 0
    ds_read_b128 v[136:139], v16 offset:6144
    ds_read_b64 v[140:141], v18 offset:6144
    v_exp_f32 v88, v88
    v_exp_f32 v89, v89
    v_exp_f32 v90, v90
    v_exp_f32_e64 v91, v91
    v_mfma_f32_32x32x8bf16_1k v[104:119], v[148:149], v[244:245], v[104:119]
    ds_read_b64_tr_b16 v[160:161], v19 offset:9216
    ds_read_b64_tr_b16 v[162:163], v20 offset:9216
    v_exp_f32 v92, v92
    v_exp_f32 v93, v93
    v_exp_f32 v94, v94
    v_exp_f32 v95, v95
    v_mfma_f32_32x32x16_bf16 v[56:71], v[164:167], v[132:135], v[56:71]
    ds_read_b64_tr_b16 v[164:165], v19 offset:9472
    ds_read_b64_tr_b16 v[166:167], v20 offset:9472
    v_cvt_pk_bf16_f32 v120, v88, v89
    v_cvt_pk_bf16_f32 v121, v90, v91
    v_cvt_pk_bf16_f32 v122, v92, v93
    v_cvt_pk_bf16_f32 v123, v94, v95
    v_exp_f32 v96, v96
    v_exp_f32 v97, v97
    v_exp_f32 v98, v98
    v_exp_f32 v99, v99
    v_mfma_f32_32x32x16_bf16 v[56:71], v[152:155], v[120:123], v[56:71]
    s_waitcnt lgkmcnt(2)
    buffer_load_dwordx4 a[104:107], v1, s[4:7], s20 offen offset:1024 sc1
    buffer_load_dwordx4 a[108:111], v1, s[4:7], s20 offen offset:2048 sc1
    buffer_load_dwordx4 a[112:115], v1, s[4:7], s20 offen offset:3072 sc1
    v_exp_f32 v100, v100
    v_exp_f32 v101, v101
    v_exp_f32 v102, v102
    v_exp_f32_e64 v103, v103
    v_cvt_pk_bf16_f32 v124, v96, v97
    v_cvt_pk_bf16_f32 v125, v98, v99
    v_cvt_pk_bf16_f32 v126, v100, v101
    v_cvt_pk_bf16_f32 v127, v102, v103
    v_mfma_f32_32x32x16_bf16 v[88:103], v[136:139], v[240:243], 0
    ds_read_b128 v[144:147], v16 offset:3072
    ds_read_b64 v[148:149], v18 offset:3072
    v_exp_f32 v104, v104
    v_exp_f32 v105, v105
    v_exp_f32 v106, v106
    v_exp_f32 v107, v107
    v_mfma_f32_32x32x8bf16_1k v[88:103], v[140:141], v[244:245], v[88:103]
    ds_read_b64_tr_b16 v[152:153], v19 offset:6144
    ds_read_b64_tr_b16 v[154:155], v20 offset:6144
    v_exp_f32 v108, v108
    v_exp_f32 v109, v109
    v_exp_f32 v110, v110
    v_exp_f32 v111, v111
    v_mfma_f32_32x32x16_bf16 v[56:71], v[156:159], v[124:127], v[56:71]
    ds_read_b64_tr_b16 v[156:157], v19 offset:6400
    ds_read_b64_tr_b16 v[158:159], v20 offset:6400
    v_cvt_pk_bf16_f32 v128, v104, v105
    v_cvt_pk_bf16_f32 v129, v106, v107
    v_cvt_pk_bf16_f32 v130, v108, v109
    v_cvt_pk_bf16_f32 v131, v110, v111
    v_exp_f32 v112, v112
    s_branch L_over_447
L_chain0_0_1:
    s_branch L_chain0_0_2
L_over_447:
    v_exp_f32 v113, v113
    v_exp_f32 v114, v114
    v_exp_f32 v115, v115
    v_mfma_f32_32x32x16_bf16 v[56:71], v[160:163], v[128:131], v[56:71]
    s_waitcnt lgkmcnt(2)
    s_add_u32 s20, s20, 4096
    buffer_load_dwordx4 a[116:119], v1, s[4:7], s20 offen offset:0 sc1
    buffer_load_dwordx4 a[120:123], v1, s[4:7], s20 offen offset:1024 sc1
    v_exp_f32 v116, v116
    v_exp_f32 v117, v117
    v_exp_f32 v118, v118
    v_exp_f32_e64 v119, v119
    v_cvt_pk_bf16_f32 v132, v112, v113
    v_cvt_pk_bf16_f32 v133, v114, v115
    v_cvt_pk_bf16_f32 v134, v116, v117
    v_cvt_pk_bf16_f32 v135, v118, v119
    v_mfma_f32_32x32x16_bf16 v[104:119], v[144:147], v[240:243], v[208:223]
    buffer_load_dwordx4 a[124:127], v25, s[4:7], s20 offen offset:2048 sc1
    v_exp_f32 v88, v88
    v_exp_f32 v89, v89
    v_exp_f32 v90, v90
    v_exp_f32 v91, v91
    v_mfma_f32_32x32x8bf16_1k v[104:119], v[148:149], v[244:245], v[104:119]
    ds_read_b64_tr_b16 v[160:161], v19 offset:3072
    ds_read_b64_tr_b16 v[162:163], v20 offset:3072
    v_exp_f32 v92, v92
    v_exp_f32 v93, v93
    v_exp_f32 v94, v94
    v_exp_f32 v95, v95
    v_mfma_f32_32x32x16_bf16 v[56:71], v[164:167], v[132:135], v[56:71]
    ds_read_b64_tr_b16 v[164:165], v19 offset:3328
    ds_read_b64_tr_b16 v[166:167], v20 offset:3328
    v_cvt_pk_bf16_f32 v120, v88, v89
    v_cvt_pk_bf16_f32 v121, v90, v91
    v_cvt_pk_bf16_f32 v122, v92, v93
    v_cvt_pk_bf16_f32 v123, v94, v95
    v_exp_f32 v96, v96
    v_exp_f32 v97, v97
    v_exp_f32 v98, v98
    v_exp_f32 v99, v99
    v_mfma_f32_32x32x16_bf16 v[56:71], v[152:155], v[120:123], v[56:71]
    s_waitcnt lgkmcnt(2)
    s_add_u32 s20, s20, 51200
    buffer_load_dwordx4 a[128:131], v1, s[4:7], s20 offen offset:0 sc1
    v_exp_f32 v100, v100
    v_exp_f32 v101, v101
    v_exp_f32 v102, v102
    v_exp_f32_e64 v103, v103
    v_cvt_pk_bf16_f32 v124, v96, v97
    v_cvt_pk_bf16_f32 v125, v98, v99
    v_cvt_pk_bf16_f32 v126, v100, v101
    v_cvt_pk_bf16_f32 v127, v102, v103
    v_exp_f32 v104, v104
    v_exp_f32 v105, v105
    v_exp_f32 v106, v106
    v_exp_f32 v107, v107
    v_exp_f32 v108, v108
    v_exp_f32 v109, v109
    v_exp_f32 v110, v110
    v_exp_f32 v111, v111
    v_mfma_f32_32x32x16_bf16 v[56:71], v[156:159], v[124:127], v[56:71]
    v_cvt_pk_bf16_f32 v128, v104, v105
    v_cvt_pk_bf16_f32 v129, v106, v107
    v_cvt_pk_bf16_f32 v130, v108, v109
    v_cvt_pk_bf16_f32 v131, v110, v111
    v_exp_f32 v112, v112
    v_exp_f32 v113, v113
    v_exp_f32 v114, v114
    v_exp_f32 v115, v115
    v_mfma_f32_32x32x16_bf16 v[56:71], v[160:163], v[128:131], v[56:71]
    s_waitcnt lgkmcnt(0)
    v_exp_f32 v116, v116
    v_exp_f32 v117, v117
    v_exp_f32 v118, v118
    v_exp_f32_e64 v119, v119
    v_cvt_pk_bf16_f32 v132, v112, v113
    v_cvt_pk_bf16_f32 v133, v114, v115
    v_cvt_pk_bf16_f32 v134, v116, v117
    v_cvt_pk_bf16_f32 v135, v118, v119
    s_nop 1
    v_mfma_f32_32x32x16_bf16 v[56:71], v[164:167], v[132:135], v[56:71]
    s_nop 11
    v_rcp_f32_e64 v70, v68
    s_add_u32 s54, s56, 1280
    v_pk_mul_f32 v[56:57], v[56:57], v[70:71] op_sel_hi:[1,0]
    v_pk_mul_f32 v[58:59], v[58:59], v[70:71] op_sel_hi:[1,0]
    v_pk_mul_f32 v[60:61], v[60:61], v[70:71] op_sel_hi:[1,0]
    v_pk_mul_f32 v[62:63], v[62:63], v[70:71] op_sel_hi:[1,0]
    v_pk_mul_f32 v[64:65], v[64:65], v[70:71] op_sel_hi:[1,0]
    v_pk_mul_f32 v[66:67], v[66:67], v[70:71] op_sel_hi:[1,0]
    v_cvt_pk_bf16_f32 v172, v56, v57
    v_cvt_pk_bf16_f32 v173, v58, v59
    v_cvt_pk_bf16_f32 v174, v60, v61
    v_cvt_pk_bf16_f32 v175, v62, v63
    v_cvt_pk_bf16_f32 v176, v64, v65
    v_cvt_pk_bf16_f32 v177, v66, v67
    s_cmp_eq_u32 s43, 0
    s_cbranch_scc1 L_safe_66
    buffer_store_dwordx4 v[172:175], v5, s[4:7], s54 offen offset:0
    buffer_store_dwordx2 v[176:177], v6, s[4:7], s54 offen offset:512
L_join_67:
    v_add_u32 v27, 3766484992, v68
    v_cmp_lt_u32_e64 vcc, 1073741824, v27
    s_nop 0
    s_or_b32 s23, s23, vcc_lo
    s_or_b32 s23, s23, vcc_hi
    s_cmp_lg_u32 s23, 0
    s_cbranch_scc1 L_fallback_64
L_fbdone_65:
    s_branch L_attdone_33
L_chain0_1_1:
    s_branch L_chain0_1_2
    s_nop 0
L_att2_31:
    ds_read_b128 v[136:139], v16 offset:39936
    ds_read_b64 v[140:141], v18 offset:39936
    ds_read_b64_tr_b16 v[152:153], v19 offset:39936
    ds_read_b64_tr_b16 v[154:155], v20 offset:39936
    ds_read_b64_tr_b16 v[156:157], v19 offset:40192
    ds_read_b64_tr_b16 v[158:159], v20 offset:40192
    v_add_u32 v26, s56, v16
    v_add_u32 v27, s56, v17
    v_add_u32_e64 v28, s56, v18
    v_pk_mul_f32 v[72:73], v[72:73], v[224:225] op_sel:[0,1] op_sel_hi:[1,1]
    v_pk_mul_f32 v[74:75], v[74:75], v[224:225] op_sel:[0,1] op_sel_hi:[1,1]
    v_pk_mul_f32 v[76:77], v[76:77], v[224:225] op_sel:[0,1] op_sel_hi:[1,1]
    v_pk_mul_f32 v[78:79], v[78:79], v[224:225] op_sel:[0,1] op_sel_hi:[1,1]
    v_pk_mul_f32 v[80:81], v[80:81], v[224:225] op_sel:[0,1] op_sel_hi:[1,1]
    v_pk_mul_f32 v[82:83], v[82:83], v[224:225] op_sel:[0,1] op_sel_hi:[1,1]
    v_pk_mul_f32 v[84:85], v[84:85], v[224:225] op_sel:[0,1] op_sel_hi:[1,1]
    v_pk_mul_f32 v[86:87], v[86:87], v[224:225] op_sel:[0,1] op_sel_hi:[1,1]
    v_cvt_pk_bf16_f32 v72, v72, v73
    v_cvt_pk_bf16_f32 v73, v74, v75
    v_cvt_pk_bf16_f32 v74, v76, v77
    v_cvt_pk_bf16_f32 v75, v78, v79
    v_cvt_pk_bf16_f32 v76, v80, v81
    v_cvt_pk_bf16_f32 v77, v82, v83
    v_cvt_pk_bf16_f32 v78, v84, v85
    v_cvt_pk_bf16_f32 v79, v86, v87
    v_cndmask_b32 v78, v78, v31, s[50:51]
    v_cndmask_b32 v79, v79, 0, s[50:51]
    buffer_store_dwordx4 v[72:75], v26, s[4:7], s61 offen offset:0 sc1
    v_pk_mul_f32 v[80:81], v[64:65], v[224:225] op_sel:[0,1] op_sel_hi:[1,1]
    v_pk_mul_f32 v[82:83], v[66:67], v[224:225] op_sel:[0,1] op_sel_hi:[1,1]
    v_pk_mul_f32 v[84:85], v[68:69], v[224:225] op_sel:[0,1] op_sel_hi:[1,1]
    v_pk_mul_f32 v[86:87], v[70:71], v[224:225] op_sel:[0,1] op_sel_hi:[1,1]
    buffer_store_dwordx4 v[76:79], v28, s[4:7], s61 offen offset:0 sc1
    v_cvt_pk_bf16_f32 v80, v80, v81
    v_cvt_pk_bf16_f32 v81, v82, v83
    v_cvt_pk_bf16_f32 v82, v84, v85
    v_cvt_pk_bf16_f32 v83, v86, v87
    ds_write_b128 v26, v[72:75] offset:24576
    buffer_store_dwordx4 v[80:83], v27, s[4:7], s61 offen offset:0 sc1
    v_pk_mul_f32 v[64:65], v[64:65], v[226:227] op_sel:[0,1] op_sel_hi:[1,1]
    v_pk_mul_f32 v[66:67], v[66:67], v[226:227] op_sel:[0,1] op_sel_hi:[1,1]
    ds_write_b128 v28, v[76:79] offset:24576
    v_pk_mul_f32 v[56:57], v[56:57], v[226:227] op_sel:[0,0] op_sel_hi:[1,0]
    v_pk_mul_f32 v[58:59], v[58:59], v[226:227] op_sel:[0,0] op_sel_hi:[1,0]
    v_pk_mul_f32 v[60:61], v[60:61], v[226:227] op_sel:[0,0] op_sel_hi:[1,0]
    v_pk_mul_f32 v[62:63], v[62:63], v[226:227] op_sel:[0,0] op_sel_hi:[1,0]
    ds_write_b128 v27, v[80:83] offset:24576
    s_waitcnt lgkmcnt(7)
    v_mfma_f32_32x32x16_bf16 v[88:103], v[136:139], v[248:251], v[192:207]
    v_mfma_f32_32x32x8bf16_1k v[88:103], v[140:141], v[252:253], v[88:103]
    s_waitcnt lgkmcnt(0)
    s_barrier
    ds_read_b128 v[144:147], v16 offset:36864
    ds_read_b64 v[148:149], v18 offset:36864
    v_cvt_pk_bf16_f32 v240, v56, v57
    v_cvt_pk_bf16_f32 v241, v58, v59
    v_cvt_pk_bf16_f32 v242, v60, v61
    v_cvt_pk_bf16_f32 v243, v62, v63
    v_cvt_pk_bf16_f32 v244, v64, v65
    v_cvt_pk_bf16_f32 v245, v66, v67
    s_add_u32 s61, s58, -4079616
    v_add_u32 v31, s62, v1
    s_mov_b32 s56, s63
    v_add_u32 v0, 1, v15
    v_exp_f32 v88, v88
    v_exp_f32 v89, v89
    v_exp_f32_e64 v90, v90
    v_exp_f32 v91, v91
    s_waitcnt lgkmcnt(0)
    v_mfma_f32_32x32x16_bf16 v[104:119], v[144:147], v[248:251], 0
    ds_read_b128 v[136:139], v16 offset:33792
    ds_read_b64 v[140:141], v18 offset:33792
    v_exp_f32 v92, v92
    v_exp_f32 v93, v93
    v_exp_f32 v94, v94
    v_exp_f32 v95, v95
    v_mfma_f32_32x32x8bf16_1k v[104:119], v[148:149], v[252:253], v[104:119]
    ds_read_b64_tr_b16 v[160:161], v19 offset:36864
    ds_read_b64_tr_b16 v[162:163], v20 offset:36864
    ds_read_b64_tr_b16 v[164:165], v19 offset:37120
    ds_read_b64_tr_b16 v[166:167], v20 offset:37120
    v_cvt_pk_bf16_f32 v120, v88, v89
    v_cvt_pk_bf16_f32 v121, v90, v91
    v_cvt_pk_bf16_f32 v122, v92, v93
    v_cvt_pk_bf16_f32 v123, v94, v95
    v_exp_f32 v96, v96
    v_exp_f32 v97, v97
    v_exp_f32 v98, v98
    v_exp_f32 v99, v99
    v_mfma_f32_32x32x16_bf16 v[72:87], v[152:155], v[120:123], 0
    s_waitcnt lgkmcnt(2)
    s_add_u32 s20, s20, 4096
    buffer_load_dwordx4 a[16:19], v1, s[4:7], s20 offen offset:0 sc1
    s_add_u32 s20, s20, 16384
    buffer_load_dwordx4 a[20:23], v1, s[4:7], s20 offen offset:0 sc1
    buffer_load_dwordx4 a[24:27], v1, s[4:7], s20 offen offset:1024 sc1
    v_exp_f32 v100, v100
    v_exp_f32 v101, v101
    v_exp_f32 v102, v102
    v_exp_f32_e64 v103, v103
    v_cvt_pk_bf16_f32 v124, v96, v97
    v_cvt_pk_bf16_f32 v125, v98, v99
    v_cvt_pk_bf16_f32 v126, v100, v101
    v_cvt_pk_bf16_f32 v127, v102, v103
    v_mfma_f32_32x32x16_bf16 v[88:103], v[136:139], v[248:251], 0
    ds_read_b128 v[144:147], v16 offset:30720
    ds_read_b64 v[148:149], v18 offset:30720
    v_exp_f32 v104, v104
    v_exp_f32 v105, v105
    v_exp_f32 v106, v106
    v_exp_f32 v107, v107
    v_mfma_f32_32x32x8bf16_1k v[88:103], v[140:141], v[252:253], v[88:103]
    ds_read_b64_tr_b16 v[152:153], v19 offset:33792
    ds_read_b64_tr_b16 v[154:155], v20 offset:33792
    v_exp_f32 v108, v108
    v_exp_f32 v109, v109
    v_exp_f32 v110, v110
    v_exp_f32 v111, v111
    v_mfma_f32_32x32x16_bf16 v[72:87], v[156:159], v[124:127], v[72:87]
    ds_read_b64_tr_b16 v[156:157], v19 offset:34048
    ds_read_b64_tr_b16 v[158:159], v20 offset:34048
    v_cvt_pk_bf16_f32 v128, v104, v105
    v_cvt_pk_bf16_f32 v129, v106, v107
    v_cvt_pk_bf16_f32 v130, v108, v109
    v_cvt_pk_bf16_f32 v131, v110, v111
    v_exp_f32 v112, v112
    v_exp_f32 v113, v113
    v_exp_f32 v114, v114
    v_exp_f32 v115, v115
    v_mfma_f32_32x32x16_bf16 v[72:87], v[160:163], v[128:131], v[72:87]
    s_waitcnt lgkmcnt(2)
    buffer_load_dwordx4 a[28:31], v1, s[4:7], s20 offen offset:2048 sc1
    buffer_load_dwordx4 a[32:35], v1, s[4:7], s20 offen offset:3072 sc1
    v_exp_f32 v116, v116
    v_exp_f32 v117, v117
    v_exp_f32 v118, v118
    v_exp_f32_e64 v119, v119
    v_cvt_pk_bf16_f32 v132, v112, v113
    v_cvt_pk_bf16_f32 v133, v114, v115
    v_cvt_pk_bf16_f32 v134, v116, v117
    v_cvt_pk_bf16_f32 v135, v118, v119
    s_waitcnt vmcnt(5)
    buffer_store_dword v15, v24, s[4:7], s59 offen offset:128 sc1
    buffer_load_dword v224, v14, s[4:7], s60 offen offset:0 sc1
    v_mfma_f32_32x32x16_bf16 v[104:119], v[144:147], v[248:251], 0
    s_add_u32 s20, s20, 4096
    buffer_load_dwordx4 a[36:39], v1, s[4:7], s20 offen offset:0 sc1
    v_exp_f32 v88, v88
    v_exp_f32 v89, v89
    v_exp_f32 v90, v90
    v_exp_f32_e64 v91, v91
    v_mfma_f32_32x32x8bf16_1k v[104:119], v[148:149], v[252:253], v[104:119]
    ds_read_b64_tr_b16 v[160:161], v19 offset:30720
    ds_read_b64_tr_b16 v[162:163], v20 offset:30720
    v_exp_f32 v92, v92
    v_exp_f32 v93, v93
    v_exp_f32 v94, v94
    v_exp_f32 v95, v95
    v_mfma_f32_32x32x16_bf16 v[72:87], v[164:167], v[132:135], v[72:87]
    ds_read_b64_tr_b16 v[164:165], v19 offset:30976
    ds_read_b64_tr_b16 v[166:167], v20 offset:30976
    v_cvt_pk_bf16_f32 v120, v88, v89
    v_cvt_pk_bf16_f32 v121, v90, v91
    v_cvt_pk_bf16_f32 v122, v92, v93
    v_cvt_pk_bf16_f32 v123, v94, v95
    v_exp_f32 v96, v96
    v_exp_f32 v97, v97
    v_exp_f32 v98, v98
    v_exp_f32 v99, v99
    v_mfma_f32_32x32x16_bf16 v[72:87], v[152:155], v[120:123], v[72:87]
    s_waitcnt lgkmcnt(2)
    s_add_u32 s20, s20, 16384
    buffer_load_dwordx4 a[40:43], v1, s[4:7], s20 offen offset:0 sc1
    buffer_load_dwordx4 a[44:47], v1, s[4:7], s20 offen offset:1024 sc1
    v_exp_f32 v100, v100
    v_exp_f32 v101, v101
    v_exp_f32 v102, v102
    v_exp_f32_e64 v103, v103
    v_cvt_pk_bf16_f32 v124, v96, v97
    v_cvt_pk_bf16_f32 v125, v98, v99
    v_cvt_pk_bf16_f32 v126, v100, v101
    v_cvt_pk_bf16_f32 v127, v102, v103
    v_mfma_f32_32x32x16_bf16 v[88:103], v[144:147], v[240:243], v[192:207]
    ds_read_b128 v[136:139], v16 offset:27648
    ds_read_b64 v[140:141], v18 offset:27648
    v_exp_f32 v104, v104
    v_exp_f32 v105, v105
    v_exp_f32 v106, v106
    v_exp_f32 v107, v107
    v_mfma_f32_32x32x8bf16_1k v[88:103], v[148:149], v[244:245], v[88:103]
    buffer_load_dwordx4 a[48:51], v1, s[4:7], s20 offen offset:2048 sc1
    v_exp_f32 v108, v108
    v_exp_f32 v109, v109
    v_exp_f32 v110, v110
    v_exp_f32 v111, v111
    v_mfma_f32_32x32x16_bf16 v[72:87], v[156:159], v[124:127], v[72:87]
    buffer_load_dwordx4 a[52:55], v1, s[4:7], s20 offen offset:3072 sc1
    v_cvt_pk_bf16_f32 v128, v104, v105
    v_cvt_pk_bf16_f32 v129, v106, v107
    v_cvt_pk_bf16_f32 v130, v108, v109
    v_cvt_pk_bf16_f32 v131, v110, v111
    v_exp_f32 v112, v112
    v_exp_f32 v113, v113
    v_exp_f32 v114, v114
    v_exp_f32 v115, v115
    v_mfma_f32_32x32x16_bf16 v[72:87], v[160:163], v[128:131], v[72:87]
    s_waitcnt lgkmcnt(0)
    v_exp_f32 v116, v116
    v_exp_f32 v117, v117
    v_exp_f32 v118, v118
    v_exp_f32_e64 v119, v119
    v_cvt_pk_bf16_f32 v132, v112, v113
    v_cvt_pk_bf16_f32 v133, v114, v115
    v_cvt_pk_bf16_f32 v134, v116, v117
    v_cvt_pk_bf16_f32 v135, v118, v119
    s_cmp_eq_u32 s37, 0
    s_cbranch_scc1 L_halook_68
    s_waitcnt vmcnt(5)
    v_cmp_ne_u32 vcc, v224, v15
    s_nop 0
    s_and_b32 vcc_hi, vcc_lo, 1
    s_cbranch_scc0 L_halook_68
L_poll_70:
    buffer_load_dword v26, v14, s[4:7], s60 offen offset:0 sc1
    s_waitcnt vmcnt(0)
    v_cmp_ne_u32_e64 vcc, v26, v15
    s_nop 0
    s_and_b32 vcc_hi, vcc_lo, 1
    s_cbranch_scc0 L_polled_71
    s_sub_u32 s44, s44, 1
    s_cbranch_scc0 L_poll_70
    s_mov_b32 s44, 0
L_polled_71:
L_halook_68:
    s_mov_b32 m0, 130048
    s_add_u32 s63, s61, 15360
    buffer_load_dwordx4 v31, s[4:7], s63 offen offset:0 sc1 lds
    buffer_load_dwordx4 v31, s[4:7], s63 offen offset:1024 sc1 lds
    buffer_load_dwordx4 v31, s[4:7], s63 offen offset:2048 sc1 lds
    v_mfma_f32_32x32x16_bf16 v[104:119], v[136:139], v[248:251], 0
    s_add_u32 s20, s20, 4096
    buffer_load_dwordx4 a[56:59], v1, s[4:7], s20 offen offset:0 sc1
    v_exp_f32 v88, v88
    v_exp_f32 v89, v89
    v_exp_f32 v90, v90
    v_exp_f32 v91, v91
    v_mfma_f32_32x32x8bf16_1k v[104:119], v[140:141], v[252:253], v[104:119]
    ds_read_b64_tr_b16 v[152:153], v19 offset:27648
    ds_read_b64_tr_b16 v[154:155], v20 offset:27648
    v_exp_f32 v92, v92
    v_exp_f32 v93, v93
    v_exp_f32 v94, v94
    v_exp_f32 v95, v95
    v_mfma_f32_32x32x16_bf16 v[72:87], v[164:167], v[132:135], v[72:87]
    ds_read_b64_tr_b16 v[156:157], v19 offset:27904
    ds_read_b64_tr_b16 v[158:159], v20 offset:27904
    v_cvt_pk_bf16_f32 v120, v88, v89
    v_cvt_pk_bf16_f32 v121, v90, v91
    v_cvt_pk_bf16_f32 v122, v92, v93
    v_cvt_pk_bf16_f32 v123, v94, v95
    v_exp_f32 v96, v96
    v_exp_f32 v97, v97
    v_exp_f32 v98, v98
    v_exp_f32 v99, v99
    v_mfma_f32_32x32x16_bf16 v[56:71], v[160:163], v[120:123], 0
    s_waitcnt lgkmcnt(2)
    s_add_u32 s20, s20, 16384
    buffer_load_dwordx4 a[60:63], v1, s[4:7], s20 offen offset:0 sc1
    buffer_load_dwordx4 a[64:67], v1, s[4:7], s20 offen offset:1024 sc1
    v_exp_f32 v100, v100
    v_exp_f32 v101, v101
    v_exp_f32 v102, v102
    v_exp_f32_e64 v103, v103
    v_cvt_pk_bf16_f32 v124, v96, v97
    v_cvt_pk_bf16_f32 v125, v98, v99
    v_cvt_pk_bf16_f32 v126, v100, v101
    v_cvt_pk_bf16_f32 v127, v102, v103
    v_mfma_f32_32x32x16_bf16 v[88:103], v[136:139], v[240:243], 0
    ds_read_b128 v[144:147], v16 offset:24576
    ds_read_b64 v[148:149], v18 offset:24576
    v_exp_f32 v104, v104
    v_exp_f32 v105, v105
    v_exp_f32 v106, v106
    v_exp_f32 v107, v107
    v_mfma_f32_32x32x8bf16_1k v[88:103], v[140:141], v[244:245], v[88:103]
    buffer_load_dwordx4 a[68:71], v1, s[4:7], s20 offen offset:2048 sc1
    v_exp_f32 v108, v108
    v_exp_f32 v109, v109
    v_exp_f32 v110, v110
    v_exp_f32 v111, v111
    v_mfma_f32_32x32x16_bf16 v[56:71], v[164:167], v[124:127], v[56:71]
    buffer_load_dwordx4 a[72:75], v1, s[4:7], s20 offen offset:3072 sc1
    v_cvt_pk_bf16_f32 v128, v104, v105
    v_cvt_pk_bf16_f32 v129, v106, v107
    v_cvt_pk_bf16_f32 v130, v108, v109
    v_cvt_pk_bf16_f32 v131, v110, v111
    v_exp_f32 v112, v112
    v_exp_f32 v113, v113
    v_exp_f32 v114, v114
    v_exp_f32 v115, v115
    v_mfma_f32_32x32x16_bf16 v[72:87], v[152:155], v[128:131], v[72:87]
    s_waitcnt lgkmcnt(0)
    v_exp_f32 v116, v116
    v_exp_f32 v117, v117
    v_exp_f32 v118, v118
    v_exp_f32_e64 v119, v119
    v_cvt_pk_bf16_f32 v132, v112, v113
    v_cvt_pk_bf16_f32 v133, v114, v115
    v_cvt_pk_bf16_f32 v134, v116, v117
    v_cvt_pk_bf16_f32 v135, v118, v119
    v_mfma_f32_32x32x16_bf16 v[104:119], v[144:147], v[248:251], 0
    s_add_u32 s20, s20, 4096
    buffer_load_dwordx4 a[76:79], v1, s[4:7], s20 offen offset:0 sc1
    v_exp_f32 v88, v88
    v_exp_f32 v89, v89
    v_exp_f32 v90, v90
    v_exp_f32 v91, v91
    v_mfma_f32_32x32x8bf16_1k v[104:119], v[148:149], v[252:253], v[104:119]
    ds_read_b64_tr_b16 v[160:161], v19 offset:24576
    ds_read_b64_tr_b16 v[162:163], v20 offset:24576
    v_exp_f32 v92, v92
    v_exp_f32 v93, v93
    v_exp_f32 v94, v94
    v_exp_f32 v95, v95
    v_mfma_f32_32x32x16_bf16 v[72:87], v[156:159], v[132:135], v[72:87]
    ds_read_b64_tr_b16 v[164:165], v19 offset:24832
    ds_read_b64_tr_b16 v[166:167], v20 offset:24832
    v_cvt_pk_bf16_f32 v120, v88, v89
    v_cvt_pk_bf16_f32 v121, v90, v91
    v_cvt_pk_bf16_f32 v122, v92, v93
    v_cvt_pk_bf16_f32 v123, v94, v95
    v_exp_f32 v96, v96
    v_exp_f32 v97, v97
    v_exp_f32 v98, v98
    v_exp_f32 v99, v99
    v_mfma_f32_32x32x16_bf16 v[56:71], v[152:155], v[120:123], v[56:71]
    s_waitcnt lgkmcnt(2)
    s_add_u32 s20, s20, 16384
    buffer_load_dwordx4 a[80:83], v1, s[4:7], s20 offen offset:0 sc1
    v_exp_f32 v100, v100
    v_exp_f32 v101, v101
    v_exp_f32 v102, v102
    v_exp_f32_e64 v103, v103
    v_cvt_pk_bf16_f32 v124, v96, v97
    v_cvt_pk_bf16_f32 v125, v98, v99
    v_cvt_pk_bf16_f32 v126, v100, v101
    v_cvt_pk_bf16_f32 v127, v102, v103
    buffer_load_dword v228, v14, s[4:7], s60 offen offset:128 sc1
    v_mfma_f32_32x32x16_bf16 v[88:103], v[144:147], v[240:243], 0
    buffer_load_dwordx4 a[84:87], v1, s[4:7], s20 offen offset:1024 sc1
    v_exp_f32 v104, v104
    v_exp_f32 v105, v105
    v_exp_f32 v106, v106
    v_exp_f32 v107, v107
    v_mfma_f32_32x32x8bf16_1k v[88:103], v[148:149], v[244:245], v[88:103]
    buffer_load_dwordx4 a[88:91], v1, s[4:7], s20 offen offset:2048 sc1
    v_exp_f32 v108, v108
    v_exp_f32 v109, v109
    v_exp_f32 v110, v110
    v_exp_f32 v111, v111
    v_mfma_f32_32x32x16_bf16 v[56:71], v[156:159], v[124:127], v[56:71]
    buffer_load_dwordx4 a[92:95], v1, s[4:7], s20 offen offset:3072 sc1
    v_cvt_pk_bf16_f32 v128, v104, v105
    v_cvt_pk_bf16_f32 v129, v106, v107
    v_cvt_pk_bf16_f32 v130, v108, v109
    v_cvt_pk_bf16_f32 v131, v110, v111
    v_exp_f32 v112, v112
    v_exp_f32 v113, v113
    v_exp_f32 v114, v114
    v_exp_f32 v115, v115
    v_mfma_f32_32x32x16_bf16 v[72:87], v[160:163], v[128:131], v[72:87]
    s_waitcnt lgkmcnt(0)
    v_exp_f32 v116, v116
    v_exp_f32 v117, v117
    v_exp_f32 v118, v118
    v_exp_f32_e64 v119, v119
    v_cvt_pk_bf16_f32 v132, v112, v113
    v_cvt_pk_bf16_f32 v133, v114, v115
    v_cvt_pk_bf16_f32 v134, v116, v117
    v_cvt_pk_bf16_f32 v135, v118, v119
    s_waitcnt vmcnt(11)
    s_barrier
    ds_read_b128 v[136:139], v16 offset:21504
    ds_read_b64 v[140:141], v18 offset:21504
    s_waitcnt lgkmcnt(0)
    v_mfma_f32_32x32x16_bf16 v[104:119], v[136:139], v[248:251], 0
    ds_read_b128 v[144:147], v16 offset:18432
    ds_read_b64 v[148:149], v18 offset:18432
    v_exp_f32 v88, v88
    v_exp_f32 v89, v89
    v_exp_f32 v90, v90
    v_exp_f32_e64 v91, v91
    v_mfma_f32_32x32x8bf16_1k v[104:119], v[140:141], v[252:253], v[104:119]
    ds_read_b64_tr_b16 v[152:153], v19 offset:21504
    ds_read_b64_tr_b16 v[154:155], v20 offset:21504
    v_exp_f32 v92, v92
    v_exp_f32 v93, v93
    v_exp_f32 v94, v94
    v_exp_f32 v95, v95
    v_mfma_f32_32x32x16_bf16 v[72:87], v[164:167], v[132:135], v[72:87]
    ds_read_b64_tr_b16 v[156:157], v19 offset:21760
    ds_read_b64_tr_b16 v[158:159], v20 offset:21760
    v_cvt_pk_bf16_f32 v120, v88, v89
    v_cvt_pk_bf16_f32 v121, v90, v91
    v_cvt_pk_bf16_f32 v122, v92, v93
    v_cvt_pk_bf16_f32 v123, v94, v95
    v_exp_f32 v96, v96
    v_exp_f32 v97, v97
    v_exp_f32 v98, v98
    v_exp_f32 v99, v99
    v_mfma_f32_32x32x16_bf16 v[56:71], v[160:163], v[120:123], v[56:71]
    s_waitcnt lgkmcnt(2)
    s_add_u32 s20, s20, 4096
    buffer_load_dwordx4 a[96:99], v1, s[4:7], s20 offen offset:0 sc1
    s_add_u32 m0, s22, 50176
    s_add_u32 s21, s21, 16384
    buffer_load_dwordx4 v1, s[4:7], s21 offen offset:0 sc1 lds
    v_exp_f32 v100, v100
    v_exp_f32 v101, v101
    v_exp_f32 v102, v102
    v_exp_f32_e64 v103, v103
    v_cvt_pk_bf16_f32 v124, v96, v97
    v_cvt_pk_bf16_f32 v125, v98, v99
    v_cvt_pk_bf16_f32 v126, v100, v101
    v_cvt_pk_bf16_f32 v127, v102, v103
    s_cmp_eq_u32 s37, 0
    s_cbranch_scc1 L_halook_72
    s_waitcnt vmcnt(5)
    v_cmp_ne_u32 vcc, v228, v15
    s_nop 0
    s_and_b32 vcc_hi, vcc_lo, 1
    s_cbranch_scc0 L_halook_72
L_poll_74:
    buffer_load_dword v26, v14, s[4:7], s60 offen offset:128 sc1
    s_waitcnt vmcnt(0)
    v_cmp_ne_u32_e64 vcc, v26, v15
    s_nop 0
    s_and_b32 vcc_hi, vcc_lo, 1
    s_cbranch_scc0 L_polled_75
    s_sub_u32 s44, s44, 1
    s_cbranch_scc0 L_poll_74
    s_mov_b32 s44, 0
L_polled_75:
L_halook_72:
    s_mov_b32 m0, 120832
    s_add_u32 s63, s61, 6144
    buffer_load_dwordx4 v31, s[4:7], s63 offen offset:0 sc1 lds
    buffer_load_dwordx4 v31, s[4:7], s63 offen offset:1024 sc1 lds
    buffer_load_dwordx4 v31, s[4:7], s63 offen offset:2048 sc1 lds
    s_lshl_b32 s68, s38, 2
    s_add_u32 s68, s68, s36
    s_mul_i32 s68, s68, 2560
    s_mul_i32 s69, s38, 17408
    s_add_u32 s68, s68, s69
    s_add_u32 s68, s68, s45
    s_add_u32 s68, s68, 372736
    v_add_u32 v168, 44, v21
    v_lshrrev_b32 v168, 6, v168
    v_lshl_add_u32 v168, v168, 28, v1
    v_lshlrev_b32_e64 v168, 3, v168
    buffer_load_dword a252, v168, s[4:7], s68 offen offset:0 sc1
    v_mfma_f32_32x32x16_bf16 v[88:103], v[144:147], v[248:251], 0
    ds_read_b128 v[136:139], v16 offset:15360
    ds_read_b64 v[140:141], v18 offset:15360
    v_exp_f32 v104, v104
    v_exp_f32 v105, v105
    v_exp_f32 v106, v106
    v_exp_f32 v107, v107
    v_mfma_f32_32x32x8bf16_1k v[88:103], v[148:149], v[252:253], v[88:103]
    ds_read_b64_tr_b16 v[160:161], v19 offset:18432
    ds_read_b64_tr_b16 v[162:163], v20 offset:18432
    v_exp_f32 v108, v108
    v_exp_f32 v109, v109
    v_exp_f32 v110, v110
    v_exp_f32 v111, v111
    v_mfma_f32_32x32x16_bf16 v[56:71], v[164:167], v[124:127], v[56:71]
    ds_read_b64_tr_b16 v[164:165], v19 offset:18688
    ds_read_b64_tr_b16 v[166:167], v20 offset:18688
    v_cvt_pk_bf16_f32 v128, v104, v105
    v_cvt_pk_bf16_f32 v129, v106, v107
    v_cvt_pk_bf16_f32 v130, v108, v109
    v_cvt_pk_bf16_f32 v131, v110, v111
    v_exp_f32 v112, v112
    v_exp_f32 v113, v113
    v_exp_f32 v114, v114
    v_exp_f32 v115, v115
    v_mfma_f32_32x32x16_bf16 v[72:87], v[152:155], v[128:131], v[72:87]
    s_waitcnt lgkmcnt(2)
    s_add_u32 m0, s22, 50176
    s_nop 0
    buffer_load_dwordx4 v1, s[4:7], s21 offen offset:1024 sc1 lds
    buffer_load_dwordx4 v1, s[4:7], s21 offen offset:2048 sc1 lds
    buffer_load_dwordx4 v1, s[4:7], s21 offen offset:3072 sc1 lds
    v_exp_f32 v116, v116
    v_exp_f32 v117, v117
    v_exp_f32 v118, v118
    v_exp_f32 v119, v119
    v_cvt_pk_bf16_f32 v132, v112, v113
    v_cvt_pk_bf16_f32 v133, v114, v115
    v_cvt_pk_bf16_f32 v134, v116, v117
    v_cvt_pk_bf16_f32 v135, v118, v119
    v_mfma_f32_32x32x16_bf16 v[104:119], v[136:139], v[248:251], v[208:223]
    ds_read_b128 v[144:147], v16 offset:21504
    ds_read_b64 v[148:149], v18 offset:21504
    v_exp_f32 v88, v88
    v_exp_f32 v89, v89
    v_exp_f32 v90, v90
    v_exp_f32 v91, v91
    v_mfma_f32_32x32x8bf16_1k v[104:119], v[140:141], v[252:253], v[104:119]
    ds_read_b64_tr_b16 v[152:153], v19 offset:15360
    ds_read_b64_tr_b16 v[154:155], v20 offset:15360
    v_exp_f32 v92, v92
    v_exp_f32 v93, v93
    v_exp_f32 v94, v94
    v_exp_f32 v95, v95
    v_mfma_f32_32x32x16_bf16 v[72:87], v[156:159], v[132:135], v[72:87]
    ds_read_b64_tr_b16 v[156:157], v19 offset:15616
    ds_read_b64_tr_b16 v[158:159], v20 offset:15616
    v_cvt_pk_bf16_f32 v120, v88, v89
    v_cvt_pk_bf16_f32 v121, v90, v91
    v_cvt_pk_bf16_f32 v122, v92, v93
    v_cvt_pk_bf16_f32 v123, v94, v95
    v_exp_f32 v96, v96
    v_exp_f32 v97, v97
    v_exp_f32 v98, v98
    v_exp_f32 v99, v99
    v_mfma_f32_32x32x16_bf16 v[72:87], v[160:163], v[120:123], v[72:87]
    s_waitcnt lgkmcnt(2)
    s_add_u32 m0, s22, 66560
    s_add_u32 s21, s21, 16384
    buffer_load_dwordx4 v1, s[4:7], s21 offen offset:0 sc1 lds
    buffer_load_dwordx4 v1, s[4:7], s21 offen offset:1024 sc1 lds
    v_exp_f32 v100, v100
    v_exp_f32 v101, v101
    v_exp_f32 v102, v102
    v_exp_f32_e64 v103, v103
    v_cvt_pk_bf16_f32 v124, v96, v97
    v_cvt_pk_bf16_f32 v125, v98, v99
    v_cvt_pk_bf16_f32 v126, v100, v101
    v_cvt_pk_bf16_f32 v127, v102, v103
    v_mfma_f32_32x32x16_bf16 v[88:103], v[144:147], v[240:243], 0
    s_branch L_over_448
L_chain0_2_1:
    s_branch L_chain0_2_2
L_over_448:
    ds_read_b128 v[136:139], v16 offset:18432
    ds_read_b64 v[140:141], v18 offset:18432
    v_exp_f32 v104, v104
    v_exp_f32 v105, v105
    v_exp_f32 v106, v106
    v_exp_f32 v107, v107
    v_mfma_f32_32x32x8bf16_1k v[88:103], v[148:149], v[244:245], v[88:103]
    ds_read_b64_tr_b16 v[160:161], v19 offset:21504
    ds_read_b64_tr_b16 v[162:163], v20 offset:21504
    v_exp_f32 v108, v108
    v_exp_f32 v109, v109
    v_exp_f32 v110, v110
    v_exp_f32 v111, v111
    v_mfma_f32_32x32x16_bf16 v[72:87], v[164:167], v[124:127], v[72:87]
    ds_read_b64_tr_b16 v[164:165], v19 offset:21760
    ds_read_b64_tr_b16 v[166:167], v20 offset:21760
    v_cvt_pk_bf16_f32 v128, v104, v105
    v_cvt_pk_bf16_f32 v129, v106, v107
    v_cvt_pk_bf16_f32 v130, v108, v109
    v_cvt_pk_bf16_f32 v131, v110, v111
    v_exp_f32 v112, v112
    v_exp_f32 v113, v113
    v_exp_f32 v114, v114
    v_exp_f32 v115, v115
    v_mfma_f32_32x32x16_bf16 v[72:87], v[152:155], v[128:131], v[72:87]
    s_waitcnt lgkmcnt(2)
    buffer_load_dwordx4 v1, s[4:7], s21 offen offset:2048 sc1 lds
    buffer_load_dwordx4 v1, s[4:7], s21 offen offset:3072 sc1 lds
    v_exp_f32 v116, v116
    v_exp_f32 v117, v117
    v_exp_f32 v118, v118
    v_exp_f32_e64 v119, v119
    v_cvt_pk_bf16_f32 v132, v112, v113
    v_cvt_pk_bf16_f32 v133, v114, v115
    v_cvt_pk_bf16_f32 v134, v116, v117
    v_cvt_pk_bf16_f32 v135, v118, v119
    v_mfma_f32_32x32x16_bf16 v[104:119], v[136:139], v[240:243], 0
    ds_read_b128 v[144:147], v16 offset:15360
    ds_read_b64 v[148:149], v18 offset:15360
    v_exp_f32 v88, v88
    v_exp_f32 v89, v89
    v_exp_f32 v90, v90
    v_exp_f32 v91, v91
    v_mfma_f32_32x32x8bf16_1k v[104:119], v[140:141], v[244:245], v[104:119]
    ds_read_b64_tr_b16 v[152:153], v19 offset:18432
    ds_read_b64_tr_b16 v[154:155], v20 offset:18432
    v_exp_f32 v92, v92
    v_exp_f32 v93, v93
    v_exp_f32 v94, v94
    v_exp_f32 v95, v95
    v_mfma_f32_32x32x16_bf16 v[72:87], v[156:159], v[132:135], v[72:87]
    ds_read_b64_tr_b16 v[156:157], v19 offset:18688
    ds_read_b64_tr_b16 v[158:159], v20 offset:18688
    v_cvt_pk_bf16_f32 v120, v88, v89
    v_cvt_pk_bf16_f32 v121, v90, v91
    v_cvt_pk_bf16_f32 v122, v92, v93
    v_cvt_pk_bf16_f32 v123, v94, v95
    v_exp_f32 v96, v96
    v_exp_f32 v97, v97
    v_exp_f32 v98, v98
    v_exp_f32 v99, v99
    v_mfma_f32_32x32x16_bf16 v[56:71], v[160:163], v[120:123], v[56:71]
    s_waitcnt lgkmcnt(2)
    s_add_u32 m0, s22, 82944
    s_add_u32 s21, s21, 16384
    buffer_load_dwordx4 v1, s[4:7], s21 offen offset:0 sc1 lds
    buffer_load_dwordx4 v1, s[4:7], s21 offen offset:1024 sc1 lds
    buffer_load_dwordx4 v1, s[4:7], s21 offen offset:2048 sc1 lds
    v_exp_f32 v100, v100
    v_exp_f32 v101, v101
    v_exp_f32 v102, v102
    v_exp_f32_e64 v103, v103
    v_cvt_pk_bf16_f32 v124, v96, v97
    v_cvt_pk_bf16_f32 v125, v98, v99
    v_cvt_pk_bf16_f32 v126, v100, v101
    v_cvt_pk_bf16_f32 v127, v102, v103
    s_waitcnt vmcnt(11)
    s_barrier
    v_rcp_f32_e64 v86, v84
    s_add_u32 s54, s56, 6400
    v_pk_mul_f32 v[72:73], v[72:73], v[86:87] op_sel_hi:[1,0]
    v_pk_mul_f32 v[74:75], v[74:75], v[86:87] op_sel_hi:[1,0]
    v_pk_mul_f32 v[76:77], v[76:77], v[86:87] op_sel_hi:[1,0]
    v_pk_mul_f32 v[78:79], v[78:79], v[86:87] op_sel_hi:[1,0]
    v_pk_mul_f32 v[80:81], v[80:81], v[86:87] op_sel_hi:[1,0]
    v_pk_mul_f32 v[82:83], v[82:83], v[86:87] op_sel_hi:[1,0]
    v_cvt_pk_bf16_f32 v172, v72, v73
    v_cvt_pk_bf16_f32 v173, v74, v75
    v_cvt_pk_bf16_f32 v174, v76, v77
    v_cvt_pk_bf16_f32 v175, v78, v79
    v_cvt_pk_bf16_f32 v176, v80, v81
    v_cvt_pk_bf16_f32 v177, v82, v83
    s_cmp_eq_u32 s43, 0
    s_cbranch_scc1 L_safe_76
    buffer_store_dwordx4 v[172:175], v5, s[4:7], s54 offen offset:0
    buffer_store_dwordx2 v[176:177], v6, s[4:7], s54 offen offset:512
L_join_77:
    v_add_u32 v27, 3766484992, v84
    v_cmp_lt_u32 vcc, 1073741824, v27
    s_nop 0
    s_or_b32 s23, vcc_lo, vcc_hi
    s_mov_b32 s26, s23
    v_mfma_f32_32x32x16_bf16 v[88:103], v[144:147], v[240:243], 0
    ds_read_b128 v[136:139], v16 offset:12288
    ds_read_b64 v[140:141], v18 offset:12288
    v_exp_f32 v104, v104
    v_exp_f32 v105, v105
    v_exp_f32 v106, v106
    v_exp_f32 v107, v107
    v_mfma_f32_32x32x8bf16_1k v[88:103], v[148:149], v[244:245], v[88:103]
    ds_read_b64_tr_b16 v[160:161], v19 offset:15360
    ds_read_b64_tr_b16 v[162:163], v20 offset:15360
    v_exp_f32 v108, v108
    v_exp_f32 v109, v109
    v_exp_f32 v110, v110
    v_exp_f32 v111, v111
    v_mfma_f32_32x32x16_bf16 v[56:71], v[164:167], v[124:127], v[56:71]
    ds_read_b64_tr_b16 v[164:165], v19 offset:15616
    ds_read_b64_tr_b16 v[166:167], v20 offset:15616
    v_cvt_pk_bf16_f32 v128, v104, v105
    v_cvt_pk_bf16_f32 v129, v106, v107
    v_cvt_pk_bf16_f32 v130, v108, v109
    v_cvt_pk_bf16_f32 v131, v110, v111
    v_exp_f32 v112, v112
    v_exp_f32 v113, v113
    v_exp_f32 v114, v114
    v_exp_f32 v115, v115
    v_mfma_f32_32x32x16_bf16 v[56:71], v[152:155], v[128:131], v[56:71]
    s_waitcnt lgkmcnt(2)
    buffer_load_dwordx4 v1, s[4:7], s21 offen offset:3072 sc1 lds
    s_mul_i32 s20, s40, 270
    s_mul_i32 s67, s36, 7
    s_add_u32 s20, s20, s67
    s_mul_i32 s67, s52, 27
    s_add_u32 s20, s20, s67
    s_lshl_b32 s20, s20, 10
    s_add_u32 s20, s20, 7864320
    buffer_load_dwordx4 a[100:103], v1, s[4:7], s20 offen offset:0 sc1
    v_exp_f32 v116, v116
    v_exp_f32 v117, v117
    v_exp_f32 v118, v118
    v_exp_f32 v119, v119
    v_cvt_pk_bf16_f32 v132, v112, v113
    v_cvt_pk_bf16_f32 v133, v114, v115
    v_cvt_pk_bf16_f32 v134, v116, v117
    v_cvt_pk_bf16_f32 v135, v118, v119
    s_lshl_b32 s68, s38, 2
    s_add_u32 s68, s68, s36
    s_mul_i32 s68, s68, 2560
    s_mul_i32 s69, s37, 327680
    s_add_u32 s68, s68, s69
    v_add_u32 v169, 44, v21
    v_lshrrev_b32_e64 v169, 6, v169
    v_lshl_add_u32 v169, v169, 28, v1
    v_lshlrev_b32_e64 v169, 3, v169
    buffer_load_dword a252, v169, s[8:11], s68 offen offset:0 sc1
    v_mfma_f32_32x32x16_bf16 v[104:119], v[136:139], v[240:243], 0
    ds_read_b128 v[144:147], v16 offset:9216
    ds_read_b64 v[148:149], v18 offset:9216
    v_exp_f32 v88, v88
    v_exp_f32 v89, v89
    v_exp_f32 v90, v90
    v_exp_f32 v91, v91
    v_mfma_f32_32x32x8bf16_1k v[104:119], v[140:141], v[244:245], v[104:119]
    ds_read_b64_tr_b16 v[152:153], v19 offset:12288
    ds_read_b64_tr_b16 v[154:155], v20 offset:12288
    v_exp_f32 v92, v92
    v_exp_f32 v93, v93
    v_exp_f32 v94, v94
    v_exp_f32 v95, v95
    v_mfma_f32_32x32x16_bf16 v[56:71], v[156:159], v[132:135], v[56:71]
    ds_read_b64_tr_b16 v[156:157], v19 offset:12544
    ds_read_b64_tr_b16 v[158:159], v20 offset:12544
    v_cvt_pk_bf16_f32 v120, v88, v89
    v_cvt_pk_bf16_f32 v121, v90, v91
    v_cvt_pk_bf16_f32 v122, v92, v93
    v_cvt_pk_bf16_f32 v123, v94, v95
    v_exp_f32 v96, v96
    v_exp_f32 v97, v97
    v_exp_f32 v98, v98
    v_exp_f32 v99, v99
    v_mfma_f32_32x32x16_bf16 v[56:71], v[160:163], v[120:123], v[56:71]
    s_waitcnt lgkmcnt(2)
    buffer_load_dwordx4 a[104:107], v1, s[4:7], s20 offen offset:1024 sc1
    buffer_load_dwordx4 a[108:111], v1, s[4:7], s20 offen offset:2048 sc1
    buffer_load_dwordx4 a[112:115], v1, s[4:7], s20 offen offset:3072 sc1
    v_exp_f32 v100, v100
    v_exp_f32 v101, v101
    v_exp_f32 v102, v102
    v_exp_f32_e64 v103, v103
    v_cvt_pk_bf16_f32 v124, v96, v97
    v_cvt_pk_bf16_f32 v125, v98, v99
    v_cvt_pk_bf16_f32 v126, v100, v101
    v_cvt_pk_bf16_f32 v127, v102, v103
    s_cmp_lg_u32 s23, 0
    s_cbranch_scc1 L_nohi_78
    s_waitcnt vmcnt(6)
    s_cmp_eq_u32 s43, 0
    s_cbranch_scc1 L_safe_79
    buffer_store_dword v0, v14, s[4:7], s41 offen offset:0
L_join_80:
L_nohi_78:
    v_mfma_f32_32x32x16_bf16 v[88:103], v[144:147], v[240:243], 0
    ds_read_b128 v[136:139], v16 offset:6144
    ds_read_b64 v[140:141], v18 offset:6144
    v_exp_f32 v104, v104
    v_exp_f32 v105, v105
    v_exp_f32 v106, v106
    v_exp_f32_e64 v107, v107
    v_mfma_f32_32x32x8bf16_1k v[88:103], v[148:149], v[244:245], v[88:103]
    ds_read_b64_tr_b16 v[160:161], v19 offset:9216
    ds_read_b64_tr_b16 v[162:163], v20 offset:9216
    v_exp_f32 v108, v108
    v_exp_f32 v109, v109
    v_exp_f32 v110, v110
    v_exp_f32 v111, v111
    v_mfma_f32_32x32x16_bf16 v[56:71], v[164:167], v[124:127], v[56:71]
    ds_read_b64_tr_b16 v[164:165], v19 offset:9472
    ds_read_b64_tr_b16 v[166:167], v20 offset:9472
    v_cvt_pk_bf16_f32 v128, v104, v105
    v_cvt_pk_bf16_f32 v129, v106, v107
    v_cvt_pk_bf16_f32 v130, v108, v109
    v_cvt_pk_bf16_f32 v131, v110, v111
    v_exp_f32 v112, v112
    v_exp_f32 v113, v113
    v_exp_f32 v114, v114
    v_exp_f32 v115, v115
    v_mfma_f32_32x32x16_bf16 v[56:71], v[152:155], v[128:131], v[56:71]
    s_waitcnt lgkmcnt(2)
    s_add_u32 s20, s20, 4096
    buffer_load_dwordx4 a[116:119], v1, s[4:7], s20 offen offset:0 sc1
    buffer_load_dwordx4 a[120:123], v1, s[4:7], s20 offen offset:1024 sc1
    v_exp_f32 v116, v116
    v_exp_f32 v117, v117
    v_exp_f32 v118, v118
    v_exp_f32_e64 v119, v119
    v_cvt_pk_bf16_f32 v132, v112, v113
    v_cvt_pk_bf16_f32 v133, v114, v115
    v_cvt_pk_bf16_f32 v134, v116, v117
    v_cvt_pk_bf16_f32 v135, v118, v119
    v_mfma_f32_32x32x16_bf16 v[104:119], v[136:139], v[240:243], v[208:223]
    buffer_load_dwordx4 a[124:127], v25, s[4:7], s20 offen offset:2048 sc1
    v_exp_f32 v88, v88
    v_exp_f32 v89, v89
    v_exp_f32 v90, v90
    v_exp_f32 v91, v91
    v_mfma_f32_32x32x8bf16_1k v[104:119], v[140:141], v[244:245], v[104:119]
    ds_read_b64_tr_b16 v[152:153], v19 offset:6144
    ds_read_b64_tr_b16 v[154:155], v20 offset:6144
    v_exp_f32 v92, v92
    v_exp_f32 v93, v93
    v_exp_f32 v94, v94
    v_exp_f32 v95, v95
    v_mfma_f32_32x32x16_bf16 v[56:71], v[156:159], v[132:135], v[56:71]
    ds_read_b64_tr_b16 v[156:157], v19 offset:6400
    ds_read_b64_tr_b16 v[158:159], v20 offset:6400
    v_cvt_pk_bf16_f32 v120, v88, v89
    v_cvt_pk_bf16_f32 v121, v90, v91
    v_cvt_pk_bf16_f32 v122, v92, v93
    v_cvt_pk_bf16_f32 v123, v94, v95
    v_exp_f32 v96, v96
    v_exp_f32 v97, v97
    v_exp_f32 v98, v98
    v_exp_f32 v99, v99
    v_mfma_f32_32x32x16_bf16 v[56:71], v[160:163], v[120:123], v[56:71]
    s_waitcnt lgkmcnt(2)
    s_add_u32 s20, s20, 51200
    buffer_load_dwordx4 a[128:131], v1, s[4:7], s20 offen offset:0 sc1
    v_exp_f32 v100, v100
    v_exp_f32 v101, v101
    v_exp_f32 v102, v102
    v_exp_f32_e64 v103, v103
    v_cvt_pk_bf16_f32 v124, v96, v97
    v_cvt_pk_bf16_f32 v125, v98, v99
    v_cvt_pk_bf16_f32 v126, v100, v101
    v_cvt_pk_bf16_f32 v127, v102, v103
    v_exp_f32 v104, v104
    v_exp_f32 v105, v105
    v_exp_f32 v106, v106
    v_exp_f32 v107, v107
    v_exp_f32 v108, v108
    v_exp_f32 v109, v109
    v_exp_f32 v110, v110
    v_exp_f32 v111, v111
    v_mfma_f32_32x32x16_bf16 v[56:71], v[164:167], v[124:127], v[56:71]
    v_cvt_pk_bf16_f32 v128, v104, v105
    v_cvt_pk_bf16_f32 v129, v106, v107
    v_cvt_pk_bf16_f32 v130, v108, v109
    v_cvt_pk_bf16_f32 v131, v110, v111
    v_exp_f32 v112, v112
    v_exp_f32 v113, v113
    v_exp_f32 v114, v114
    v_exp_f32 v115, v115
    v_mfma_f32_32x32x16_bf16 v[56:71], v[152:155], v[128:131], v[56:71]
    s_waitcnt lgkmcnt(0)
    v_exp_f32 v116, v116
    v_exp_f32 v117, v117
    v_exp_f32 v118, v118
    v_exp_f32_e64 v119, v119
    v_cvt_pk_bf16_f32 v132, v112, v113
    v_cvt_pk_bf16_f32 v133, v114, v115
    v_cvt_pk_bf16_f32 v134, v116, v117
    v_cvt_pk_bf16_f32 v135, v118, v119
    s_nop 1
    v_mfma_f32_32x32x16_bf16 v[56:71], v[156:159], v[132:135], v[56:71]
    s_nop 11
    v_rcp_f32_e64 v70, v68
    s_add_u32 s54, s56, 2560
    v_pk_mul_f32 v[56:57], v[56:57], v[70:71] op_sel_hi:[1,0]
    v_pk_mul_f32 v[58:59], v[58:59], v[70:71] op_sel_hi:[1,0]
    v_pk_mul_f32 v[60:61], v[60:61], v[70:71] op_sel_hi:[1,0]
    v_pk_mul_f32 v[62:63], v[62:63], v[70:71] op_sel_hi:[1,0]
    v_pk_mul_f32 v[64:65], v[64:65], v[70:71] op_sel_hi:[1,0]
    v_pk_mul_f32 v[66:67], v[66:67], v[70:71] op_sel_hi:[1,0]
    v_cvt_pk_bf16_f32 v172, v56, v57
    v_cvt_pk_bf16_f32 v173, v58, v59
    v_cvt_pk_bf16_f32 v174, v60, v61
    v_cvt_pk_bf16_f32 v175, v62, v63
    v_cvt_pk_bf16_f32 v176, v64, v65
    v_cvt_pk_bf16_f32 v177, v66, v67
    s_cmp_eq_u32 s43, 0
    s_cbranch_scc1 L_safe_83
    buffer_store_dwordx4 v[172:175], v5, s[4:7], s54 offen offset:0
    buffer_store_dwordx2 v[176:177], v6, s[4:7], s54 offen offset:512
L_join_84:
    v_add_u32 v27, 3766484992, v68
    v_cmp_lt_u32_e64 vcc, 1073741824, v27
    s_nop 0
    s_or_b32 s23, s23, vcc_lo
    s_or_b32 s23, s23, vcc_hi
    s_cmp_lg_u32 s23, 0
    s_cbranch_scc1 L_fallback_81
L_fbdone_82:
    s_branch L_attdone_33
L_chain0_3_1:
    s_branch L_chain0_3_2
    s_nop 0
L_att3_32:
    ds_read_b128 v[136:139], v16 offset:36864
    ds_read_b64 v[140:141], v18 offset:36864
    ds_read_b64_tr_b16 v[152:153], v19 offset:36864
    ds_read_b64_tr_b16 v[154:155], v20 offset:36864
    ds_read_b64_tr_b16 v[156:157], v19 offset:37120
    ds_read_b64_tr_b16 v[158:159], v20 offset:37120
    v_add_u32 v26, s56, v16
    v_add_u32 v27, s56, v17
    v_add_u32_e64 v28, s56, v18
    v_pk_mul_f32 v[72:73], v[72:73], v[224:225] op_sel:[0,1] op_sel_hi:[1,1]
    v_pk_mul_f32 v[74:75], v[74:75], v[224:225] op_sel:[0,1] op_sel_hi:[1,1]
    v_pk_mul_f32 v[76:77], v[76:77], v[224:225] op_sel:[0,1] op_sel_hi:[1,1]
    v_pk_mul_f32 v[78:79], v[78:79], v[224:225] op_sel:[0,1] op_sel_hi:[1,1]
    v_pk_mul_f32 v[80:81], v[80:81], v[224:225] op_sel:[0,1] op_sel_hi:[1,1]
    v_pk_mul_f32 v[82:83], v[82:83], v[224:225] op_sel:[0,1] op_sel_hi:[1,1]
    v_pk_mul_f32 v[84:85], v[84:85], v[224:225] op_sel:[0,1] op_sel_hi:[1,1]
    v_pk_mul_f32 v[86:87], v[86:87], v[224:225] op_sel:[0,1] op_sel_hi:[1,1]
    v_cvt_pk_bf16_f32 v72, v72, v73
    v_cvt_pk_bf16_f32 v73, v74, v75
    v_cvt_pk_bf16_f32 v74, v76, v77
    v_cvt_pk_bf16_f32 v75, v78, v79
    v_cvt_pk_bf16_f32 v76, v80, v81
    v_cvt_pk_bf16_f32 v77, v82, v83
    v_cvt_pk_bf16_f32 v78, v84, v85
    v_cvt_pk_bf16_f32 v79, v86, v87
    v_cndmask_b32 v78, v78, v31, s[50:51]
    v_cndmask_b32 v79, v79, 0, s[50:51]
    buffer_store_dwordx4 v[72:75], v26, s[4:7], s61 offen offset:0 sc1
    v_pk_mul_f32 v[80:81], v[64:65], v[224:225] op_sel:[0,1] op_sel_hi:[1,1]
    v_pk_mul_f32 v[82:83], v[66:67], v[224:225] op_sel:[0,1] op_sel_hi:[1,1]
    v_pk_mul_f32 v[84:85], v[68:69], v[224:225] op_sel:[0,1] op_sel_hi:[1,1]
    v_pk_mul_f32 v[86:87], v[70:71], v[224:225] op_sel:[0,1] op_sel_hi:[1,1]
    buffer_store_dwordx4 v[76:79], v28, s[4:7], s61 offen offset:0 sc1
    v_cvt_pk_bf16_f32 v80, v80, v81
    v_cvt_pk_bf16_f32 v81, v82, v83
    v_cvt_pk_bf16_f32 v82, v84, v85
    v_cvt_pk_bf16_f32 v83, v86, v87
    ds_write_b128 v26, v[72:75] offset:24576
    buffer_store_dwordx4 v[80:83], v27, s[4:7], s61 offen offset:0 sc1
    v_pk_mul_f32 v[64:65], v[64:65], v[226:227] op_sel:[0,1] op_sel_hi:[1,1]
    v_pk_mul_f32 v[66:67], v[66:67], v[226:227] op_sel:[0,1] op_sel_hi:[1,1]
    ds_write_b128 v28, v[76:79] offset:24576
    v_pk_mul_f32 v[56:57], v[56:57], v[226:227] op_sel:[0,0] op_sel_hi:[1,0]
    v_pk_mul_f32 v[58:59], v[58:59], v[226:227] op_sel:[0,0] op_sel_hi:[1,0]
    v_pk_mul_f32 v[60:61], v[60:61], v[226:227] op_sel:[0,0] op_sel_hi:[1,0]
    v_pk_mul_f32 v[62:63], v[62:63], v[226:227] op_sel:[0,0] op_sel_hi:[1,0]
    ds_write_b128 v27, v[80:83] offset:24576
    s_waitcnt lgkmcnt(7)
    v_mfma_f32_32x32x16_bf16 v[88:103], v[136:139], v[248:251], v[192:207]
    v_mfma_f32_32x32x8bf16_1k v[88:103], v[140:141], v[252:253], v[88:103]
    s_waitcnt lgkmcnt(0)
    s_barrier
    ds_read_b128 v[144:147], v16 offset:33792
    ds_read_b64 v[148:149], v18 offset:33792
    v_cvt_pk_bf16_f32 v240, v56, v57
    v_cvt_pk_bf16_f32 v241, v58, v59
    v_cvt_pk_bf16_f32 v242, v60, v61
    v_cvt_pk_bf16_f32 v243, v62, v63
    v_cvt_pk_bf16_f32 v244, v64, v65
    v_cvt_pk_bf16_f32 v245, v66, v67
    s_add_u32 s61, s58, -4079616
    v_add_u32 v31, s62, v1
    s_mov_b32 s56, s63
    v_add_u32 v0, 1, v15
    v_exp_f32 v88, v88
    v_exp_f32 v89, v89
    v_exp_f32_e64 v90, v90
    v_exp_f32 v91, v91
    s_waitcnt lgkmcnt(0)
    v_mfma_f32_32x32x16_bf16 v[104:119], v[144:147], v[248:251], 0
    s_add_u32 s20, s20, 4096
    buffer_load_dwordx4 a[16:19], v1, s[4:7], s20 offen offset:0 sc1
    v_exp_f32 v92, v92
    v_exp_f32 v93, v93
    v_exp_f32 v94, v94
    v_exp_f32 v95, v95
    v_mfma_f32_32x32x8bf16_1k v[104:119], v[148:149], v[252:253], v[104:119]
    ds_read_b64_tr_b16 v[160:161], v19 offset:33792
    ds_read_b64_tr_b16 v[162:163], v20 offset:33792
    ds_read_b64_tr_b16 v[164:165], v19 offset:34048
    ds_read_b64_tr_b16 v[166:167], v20 offset:34048
    v_cvt_pk_bf16_f32 v120, v88, v89
    v_cvt_pk_bf16_f32 v121, v90, v91
    v_cvt_pk_bf16_f32 v122, v92, v93
    v_cvt_pk_bf16_f32 v123, v94, v95
    v_exp_f32 v96, v96
    v_exp_f32 v97, v97
    v_exp_f32 v98, v98
    v_exp_f32 v99, v99
    v_mfma_f32_32x32x16_bf16 v[72:87], v[152:155], v[120:123], 0
    s_waitcnt lgkmcnt(2)
    s_add_u32 s20, s20, 16384
    buffer_load_dwordx4 a[20:23], v1, s[4:7], s20 offen offset:0 sc1
    buffer_load_dwordx4 a[24:27], v1, s[4:7], s20 offen offset:1024 sc1
    v_exp_f32 v100, v100
    v_exp_f32 v101, v101
    v_exp_f32 v102, v102
    v_exp_f32_e64 v103, v103
    v_cvt_pk_bf16_f32 v124, v96, v97
    v_cvt_pk_bf16_f32 v125, v98, v99
    v_cvt_pk_bf16_f32 v126, v100, v101
    v_cvt_pk_bf16_f32 v127, v102, v103
    v_mfma_f32_32x32x16_bf16 v[88:103], v[144:147], v[240:243], v[192:207]
    ds_read_b128 v[136:139], v16 offset:30720
    ds_read_b64 v[140:141], v18 offset:30720
    v_exp_f32 v104, v104
    v_exp_f32 v105, v105
    v_exp_f32 v106, v106
    v_exp_f32 v107, v107
    v_mfma_f32_32x32x8bf16_1k v[88:103], v[148:149], v[244:245], v[88:103]
    buffer_load_dwordx4 a[28:31], v1, s[4:7], s20 offen offset:2048 sc1
    v_exp_f32 v108, v108
    v_exp_f32 v109, v109
    v_exp_f32 v110, v110
    v_exp_f32 v111, v111
    v_mfma_f32_32x32x16_bf16 v[72:87], v[156:159], v[124:127], v[72:87]
    buffer_load_dwordx4 a[32:35], v1, s[4:7], s20 offen offset:3072 sc1
    v_cvt_pk_bf16_f32 v128, v104, v105
    v_cvt_pk_bf16_f32 v129, v106, v107
    v_cvt_pk_bf16_f32 v130, v108, v109
    v_cvt_pk_bf16_f32 v131, v110, v111
    v_exp_f32 v112, v112
    v_exp_f32 v113, v113
    v_exp_f32 v114, v114
    v_exp_f32 v115, v115
    v_mfma_f32_32x32x16_bf16 v[72:87], v[160:163], v[128:131], v[72:87]
    s_waitcnt lgkmcnt(0)
    v_exp_f32 v116, v116
    v_exp_f32 v117, v117
    v_exp_f32 v118, v118
    v_exp_f32_e64 v119, v119
    v_cvt_pk_bf16_f32 v132, v112, v113
    v_cvt_pk_bf16_f32 v133, v114, v115
    v_cvt_pk_bf16_f32 v134, v116, v117
    v_cvt_pk_bf16_f32 v135, v118, v119
    s_waitcnt vmcnt(5)
    buffer_store_dword v15, v24, s[4:7], s59 offen offset:128 sc1
    buffer_load_dword v224, v14, s[4:7], s60 offen offset:0 sc1
    v_mfma_f32_32x32x16_bf16 v[104:119], v[136:139], v[248:251], 0
    s_add_u32 s20, s20, 4096
    buffer_load_dwordx4 a[36:39], v1, s[4:7], s20 offen offset:0 sc1
    v_exp_f32 v88, v88
    v_exp_f32 v89, v89
    v_exp_f32 v90, v90
    v_exp_f32_e64 v91, v91
    v_mfma_f32_32x32x8bf16_1k v[104:119], v[140:141], v[252:253], v[104:119]
    ds_read_b64_tr_b16 v[152:153], v19 offset:30720
    ds_read_b64_tr_b16 v[154:155], v20 offset:30720
    v_exp_f32 v92, v92
    v_exp_f32 v93, v93
    v_exp_f32 v94, v94
    v_exp_f32 v95, v95
    v_mfma_f32_32x32x16_bf16 v[72:87], v[164:167], v[132:135], v[72:87]
    ds_read_b64_tr_b16 v[156:157], v19 offset:30976
    ds_read_b64_tr_b16 v[158:159], v20 offset:30976
    v_cvt_pk_bf16_f32 v120, v88, v89
    v_cvt_pk_bf16_f32 v121, v90, v91
    v_cvt_pk_bf16_f32 v122, v92, v93
    v_cvt_pk_bf16_f32 v123, v94, v95
    v_exp_f32 v96, v96
    v_exp_f32 v97, v97
    v_exp_f32 v98, v98
    v_exp_f32 v99, v99
    v_mfma_f32_32x32x16_bf16 v[56:71], v[160:163], v[120:123], 0
    s_waitcnt lgkmcnt(2)
    s_add_u32 s20, s20, 16384
    buffer_load_dwordx4 a[40:43], v1, s[4:7], s20 offen offset:0 sc1
    buffer_load_dwordx4 a[44:47], v1, s[4:7], s20 offen offset:1024 sc1
    v_exp_f32 v100, v100
    v_exp_f32 v101, v101
    v_exp_f32 v102, v102
    v_exp_f32_e64 v103, v103
    v_cvt_pk_bf16_f32 v124, v96, v97
    v_cvt_pk_bf16_f32 v125, v98, v99
    v_cvt_pk_bf16_f32 v126, v100, v101
    v_cvt_pk_bf16_f32 v127, v102, v103
    v_mfma_f32_32x32x16_bf16 v[88:103], v[136:139], v[240:243], 0
    ds_read_b128 v[144:147], v16 offset:27648
    ds_read_b64 v[148:149], v18 offset:27648
    v_exp_f32 v104, v104
    v_exp_f32 v105, v105
    v_exp_f32 v106, v106
    v_exp_f32 v107, v107
    v_mfma_f32_32x32x8bf16_1k v[88:103], v[140:141], v[244:245], v[88:103]
    buffer_load_dwordx4 a[48:51], v1, s[4:7], s20 offen offset:2048 sc1
    v_exp_f32 v108, v108
    v_exp_f32 v109, v109
    v_exp_f32 v110, v110
    v_exp_f32 v111, v111
    v_mfma_f32_32x32x16_bf16 v[56:71], v[164:167], v[124:127], v[56:71]
    buffer_load_dwordx4 a[52:55], v1, s[4:7], s20 offen offset:3072 sc1
    v_cvt_pk_bf16_f32 v128, v104, v105
    v_cvt_pk_bf16_f32 v129, v106, v107
    v_cvt_pk_bf16_f32 v130, v108, v109
    v_cvt_pk_bf16_f32 v131, v110, v111
    v_exp_f32 v112, v112
    v_exp_f32 v113, v113
    v_exp_f32 v114, v114
    v_exp_f32 v115, v115
    v_mfma_f32_32x32x16_bf16 v[72:87], v[152:155], v[128:131], v[72:87]
    s_waitcnt lgkmcnt(0)
    v_exp_f32 v116, v116
    v_exp_f32 v117, v117
    v_exp_f32 v118, v118
    v_exp_f32_e64 v119, v119
    v_cvt_pk_bf16_f32 v132, v112, v113
    v_cvt_pk_bf16_f32 v133, v114, v115
    v_cvt_pk_bf16_f32 v134, v116, v117
    v_cvt_pk_bf16_f32 v135, v118, v119
    s_cmp_eq_u32 s37, 0
    s_cbranch_scc1 L_halook_85
    s_waitcnt vmcnt(5)
    v_cmp_ne_u32 vcc, v224, v15
    s_nop 0
    s_and_b32 vcc_hi, vcc_lo, 1
    s_cbranch_scc0 L_halook_85
L_poll_87:
    buffer_load_dword v26, v14, s[4:7], s60 offen offset:0 sc1
    s_waitcnt vmcnt(0)
    v_cmp_ne_u32_e64 vcc, v26, v15
    s_nop 0
    s_and_b32 vcc_hi, vcc_lo, 1
    s_cbranch_scc0 L_polled_88
    s_sub_u32 s44, s44, 1
    s_cbranch_scc0 L_poll_87
    s_mov_b32 s44, 0
L_polled_88:
L_halook_85:
    s_mov_b32 m0, 126976
    s_add_u32 s63, s61, 12288
    buffer_load_dwordx4 v31, s[4:7], s63 offen offset:0 sc1 lds
    buffer_load_dwordx4 v31, s[4:7], s63 offen offset:1024 sc1 lds
    buffer_load_dwordx4 v31, s[4:7], s63 offen offset:2048 sc1 lds
    v_mfma_f32_32x32x16_bf16 v[104:119], v[144:147], v[248:251], 0
    s_add_u32 s20, s20, 4096
    buffer_load_dwordx4 a[56:59], v1, s[4:7], s20 offen offset:0 sc1
    v_exp_f32 v88, v88
    v_exp_f32 v89, v89
    v_exp_f32 v90, v90
    v_exp_f32 v91, v91
    v_mfma_f32_32x32x8bf16_1k v[104:119], v[148:149], v[252:253], v[104:119]
    ds_read_b64_tr_b16 v[160:161], v19 offset:27648
    ds_read_b64_tr_b16 v[162:163], v20 offset:27648
    v_exp_f32 v92, v92
    v_exp_f32 v93, v93
    v_exp_f32 v94, v94
    v_exp_f32 v95, v95
    v_mfma_f32_32x32x16_bf16 v[72:87], v[156:159], v[132:135], v[72:87]
    ds_read_b64_tr_b16 v[164:165], v19 offset:27904
    ds_read_b64_tr_b16 v[166:167], v20 offset:27904
    v_cvt_pk_bf16_f32 v120, v88, v89
    v_cvt_pk_bf16_f32 v121, v90, v91
    v_cvt_pk_bf16_f32 v122, v92, v93
    v_cvt_pk_bf16_f32 v123, v94, v95
    v_exp_f32 v96, v96
    v_exp_f32 v97, v97
    v_exp_f32 v98, v98
    v_exp_f32 v99, v99
    v_mfma_f32_32x32x16_bf16 v[56:71], v[152:155], v[120:123], v[56:71]
    s_waitcnt lgkmcnt(2)
    s_add_u32 s20, s20, 16384
    buffer_load_dwordx4 a[60:63], v1, s[4:7], s20 offen offset:0 sc1
    buffer_load_dwordx4 a[64:67], v1, s[4:7], s20 offen offset:1024 sc1
    v_exp_f32 v100, v100
    v_exp_f32 v101, v101
    v_exp_f32 v102, v102
    v_exp_f32_e64 v103, v103
    v_cvt_pk_bf16_f32 v124, v96, v97
    v_cvt_pk_bf16_f32 v125, v98, v99
    v_cvt_pk_bf16_f32 v126, v100, v101
    v_cvt_pk_bf16_f32 v127, v102, v103
    v_mfma_f32_32x32x16_bf16 v[88:103], v[144:147], v[240:243], 0
    ds_read_b128 v[136:139], v16 offset:24576
    ds_read_b64 v[140:141], v18 offset:24576
    v_exp_f32 v104, v104
    v_exp_f32 v105, v105
    v_exp_f32 v106, v106
    v_exp_f32 v107, v107
    v_mfma_f32_32x32x8bf16_1k v[88:103], v[148:149], v[244:245], v[88:103]
    buffer_load_dwordx4 a[68:71], v1, s[4:7], s20 offen offset:2048 sc1
    v_exp_f32 v108, v108
    v_exp_f32 v109, v109
    v_exp_f32 v110, v110
    v_exp_f32 v111, v111
    v_mfma_f32_32x32x16_bf16 v[56:71], v[156:159], v[124:127], v[56:71]
    buffer_load_dwordx4 a[72:75], v1, s[4:7], s20 offen offset:3072 sc1
    v_cvt_pk_bf16_f32 v128, v104, v105
    v_cvt_pk_bf16_f32 v129, v106, v107
    v_cvt_pk_bf16_f32 v130, v108, v109
    v_cvt_pk_bf16_f32 v131, v110, v111
    v_exp_f32 v112, v112
    v_exp_f32 v113, v113
    v_exp_f32 v114, v114
    v_exp_f32 v115, v115
    v_mfma_f32_32x32x16_bf16 v[72:87], v[160:163], v[128:131], v[72:87]
    s_waitcnt lgkmcnt(0)
    v_exp_f32 v116, v116
    v_exp_f32 v117, v117
    v_exp_f32 v118, v118
    v_exp_f32_e64 v119, v119
    v_cvt_pk_bf16_f32 v132, v112, v113
    v_cvt_pk_bf16_f32 v133, v114, v115
    v_cvt_pk_bf16_f32 v134, v116, v117
    v_cvt_pk_bf16_f32 v135, v118, v119
    v_mfma_f32_32x32x16_bf16 v[104:119], v[136:139], v[248:251], 0
    s_add_u32 s20, s20, 4096
    buffer_load_dwordx4 a[76:79], v1, s[4:7], s20 offen offset:0 sc1
    v_exp_f32 v88, v88
    v_exp_f32 v89, v89
    v_exp_f32 v90, v90
    v_exp_f32 v91, v91
    v_mfma_f32_32x32x8bf16_1k v[104:119], v[140:141], v[252:253], v[104:119]
    ds_read_b64_tr_b16 v[152:153], v19 offset:24576
    ds_read_b64_tr_b16 v[154:155], v20 offset:24576
    v_exp_f32 v92, v92
    v_exp_f32 v93, v93
    v_exp_f32 v94, v94
    v_exp_f32 v95, v95
    v_mfma_f32_32x32x16_bf16 v[72:87], v[164:167], v[132:135], v[72:87]
    s_branch L_over_449
L_chain0_0_2:
    s_branch L_chain0_0_3
L_over_449:
    ds_read_b64_tr_b16 v[156:157], v19 offset:24832
    ds_read_b64_tr_b16 v[158:159], v20 offset:24832
    v_cvt_pk_bf16_f32 v120, v88, v89
    v_cvt_pk_bf16_f32 v121, v90, v91
    v_cvt_pk_bf16_f32 v122, v92, v93
    v_cvt_pk_bf16_f32 v123, v94, v95
    v_exp_f32 v96, v96
    v_exp_f32 v97, v97
    v_exp_f32 v98, v98
    v_exp_f32 v99, v99
    v_mfma_f32_32x32x16_bf16 v[56:71], v[160:163], v[120:123], v[56:71]
    s_waitcnt lgkmcnt(2)
    s_add_u32 s20, s20, 16384
    buffer_load_dwordx4 a[80:83], v1, s[4:7], s20 offen offset:0 sc1
    v_exp_f32 v100, v100
    v_exp_f32 v101, v101
    v_exp_f32 v102, v102
    v_exp_f32_e64 v103, v103
    v_cvt_pk_bf16_f32 v124, v96, v97
    v_cvt_pk_bf16_f32 v125, v98, v99
    v_cvt_pk_bf16_f32 v126, v100, v101
    v_cvt_pk_bf16_f32 v127, v102, v103
    buffer_load_dword v228, v14, s[4:7], s60 offen offset:128 sc1
    v_mfma_f32_32x32x16_bf16 v[88:103], v[136:139], v[240:243], 0
    buffer_load_dwordx4 a[84:87], v1, s[4:7], s20 offen offset:1024 sc1
    v_exp_f32 v104, v104
    v_exp_f32 v105, v105
    v_exp_f32 v106, v106
    v_exp_f32 v107, v107
    v_mfma_f32_32x32x8bf16_1k v[88:103], v[140:141], v[244:245], v[88:103]
    buffer_load_dwordx4 a[88:91], v1, s[4:7], s20 offen offset:2048 sc1
    v_exp_f32 v108, v108
    v_exp_f32 v109, v109
    v_exp_f32 v110, v110
    v_exp_f32 v111, v111
    v_mfma_f32_32x32x16_bf16 v[56:71], v[164:167], v[124:127], v[56:71]
    buffer_load_dwordx4 a[92:95], v1, s[4:7], s20 offen offset:3072 sc1
    v_cvt_pk_bf16_f32 v128, v104, v105
    v_cvt_pk_bf16_f32 v129, v106, v107
    v_cvt_pk_bf16_f32 v130, v108, v109
    v_cvt_pk_bf16_f32 v131, v110, v111
    v_exp_f32 v112, v112
    v_exp_f32 v113, v113
    v_exp_f32 v114, v114
    v_exp_f32 v115, v115
    v_mfma_f32_32x32x16_bf16 v[72:87], v[152:155], v[128:131], v[72:87]
    s_waitcnt lgkmcnt(0)
    v_exp_f32 v116, v116
    v_exp_f32 v117, v117
    v_exp_f32 v118, v118
    v_exp_f32_e64 v119, v119
    v_cvt_pk_bf16_f32 v132, v112, v113
    v_cvt_pk_bf16_f32 v133, v114, v115
    v_cvt_pk_bf16_f32 v134, v116, v117
    v_cvt_pk_bf16_f32 v135, v118, v119
    s_waitcnt vmcnt(11)
    s_barrier
    ds_read_b128 v[144:147], v16 offset:21504
    ds_read_b64 v[148:149], v18 offset:21504
    s_waitcnt lgkmcnt(0)
    v_mfma_f32_32x32x16_bf16 v[104:119], v[144:147], v[248:251], 0
    ds_read_b128 v[136:139], v16 offset:18432
    ds_read_b64 v[140:141], v18 offset:18432
    v_exp_f32 v88, v88
    v_exp_f32 v89, v89
    v_exp_f32 v90, v90
    v_exp_f32_e64 v91, v91
    v_mfma_f32_32x32x8bf16_1k v[104:119], v[148:149], v[252:253], v[104:119]
    ds_read_b64_tr_b16 v[160:161], v19 offset:21504
    ds_read_b64_tr_b16 v[162:163], v20 offset:21504
    v_exp_f32 v92, v92
    v_exp_f32 v93, v93
    v_exp_f32 v94, v94
    v_exp_f32 v95, v95
    v_mfma_f32_32x32x16_bf16 v[72:87], v[156:159], v[132:135], v[72:87]
    ds_read_b64_tr_b16 v[164:165], v19 offset:21760
    ds_read_b64_tr_b16 v[166:167], v20 offset:21760
    v_cvt_pk_bf16_f32 v120, v88, v89
    v_cvt_pk_bf16_f32 v121, v90, v91
    v_cvt_pk_bf16_f32 v122, v92, v93
    v_cvt_pk_bf16_f32 v123, v94, v95
    v_exp_f32 v96, v96
    v_exp_f32 v97, v97
    v_exp_f32 v98, v98
    v_exp_f32 v99, v99
    v_mfma_f32_32x32x16_bf16 v[56:71], v[152:155], v[120:123], v[56:71]
    s_waitcnt lgkmcnt(2)
    s_add_u32 s20, s20, 4096
    buffer_load_dwordx4 a[96:99], v1, s[4:7], s20 offen offset:0 sc1
    s_add_u32 m0, s22, 50176
    s_add_u32 s21, s21, 16384
    buffer_load_dwordx4 v1, s[4:7], s21 offen offset:0 sc1 lds
    v_exp_f32 v100, v100
    v_exp_f32 v101, v101
    v_exp_f32 v102, v102
    v_exp_f32_e64 v103, v103
    v_cvt_pk_bf16_f32 v124, v96, v97
    v_cvt_pk_bf16_f32 v125, v98, v99
    v_cvt_pk_bf16_f32 v126, v100, v101
    v_cvt_pk_bf16_f32 v127, v102, v103
    s_cmp_eq_u32 s37, 0
    s_cbranch_scc1 L_halook_89
    s_waitcnt vmcnt(5)
    v_cmp_ne_u32 vcc, v228, v15
    s_nop 0
    s_and_b32 vcc_hi, vcc_lo, 1
    s_cbranch_scc0 L_halook_89
L_poll_91:
    buffer_load_dword v26, v14, s[4:7], s60 offen offset:128 sc1
    s_waitcnt vmcnt(0)
    v_cmp_ne_u32_e64 vcc, v26, v15
    s_nop 0
    s_and_b32 vcc_hi, vcc_lo, 1
    s_cbranch_scc0 L_polled_92
    s_sub_u32 s44, s44, 1
    s_cbranch_scc0 L_poll_91
    s_mov_b32 s44, 0
L_polled_92:
L_halook_89:
    s_mov_b32 m0, 123904
    s_add_u32 s63, s61, 9216
    buffer_load_dwordx4 v31, s[4:7], s63 offen offset:0 sc1 lds
    buffer_load_dwordx4 v31, s[4:7], s63 offen offset:1024 sc1 lds
    buffer_load_dwordx4 v31, s[4:7], s63 offen offset:2048 sc1 lds
    s_lshl_b32 s68, s38, 2
    s_add_u32 s68, s68, s36
    s_mul_i32 s68, s68, 2560
    s_mul_i32 s69, s38, 17408
    s_add_u32 s68, s68, s69
    s_add_u32 s68, s68, s45
    s_add_u32 s68, s68, 372736
    v_add_u32 v168, 44, v21
    v_lshrrev_b32 v168, 6, v168
    v_lshl_add_u32 v168, v168, 28, v1
    v_lshlrev_b32_e64 v168, 3, v168
    buffer_load_dword a252, v168, s[4:7], s68 offen offset:0 sc1
    v_mfma_f32_32x32x16_bf16 v[88:103], v[136:139], v[248:251], 0
    ds_read_b128 v[144:147], v16 offset:15360
    ds_read_b64 v[148:149], v18 offset:15360
    v_exp_f32 v104, v104
    v_exp_f32 v105, v105
    v_exp_f32 v106, v106
    v_exp_f32 v107, v107
    v_mfma_f32_32x32x8bf16_1k v[88:103], v[140:141], v[252:253], v[88:103]
    ds_read_b64_tr_b16 v[152:153], v19 offset:18432
    ds_read_b64_tr_b16 v[154:155], v20 offset:18432
    v_exp_f32 v108, v108
    v_exp_f32 v109, v109
    v_exp_f32 v110, v110
    v_exp_f32 v111, v111
    v_mfma_f32_32x32x16_bf16 v[56:71], v[156:159], v[124:127], v[56:71]
    ds_read_b64_tr_b16 v[156:157], v19 offset:18688
    ds_read_b64_tr_b16 v[158:159], v20 offset:18688
    v_cvt_pk_bf16_f32 v128, v104, v105
    v_cvt_pk_bf16_f32 v129, v106, v107
    v_cvt_pk_bf16_f32 v130, v108, v109
    v_cvt_pk_bf16_f32 v131, v110, v111
    v_exp_f32 v112, v112
    v_exp_f32 v113, v113
    v_exp_f32 v114, v114
    v_exp_f32 v115, v115
    v_mfma_f32_32x32x16_bf16 v[72:87], v[160:163], v[128:131], v[72:87]
    s_waitcnt lgkmcnt(2)
    s_add_u32 m0, s22, 50176
    s_nop 0
    buffer_load_dwordx4 v1, s[4:7], s21 offen offset:1024 sc1 lds
    buffer_load_dwordx4 v1, s[4:7], s21 offen offset:2048 sc1 lds
    buffer_load_dwordx4 v1, s[4:7], s21 offen offset:3072 sc1 lds
    v_exp_f32 v116, v116
    v_exp_f32 v117, v117
    v_exp_f32 v118, v118
    v_exp_f32 v119, v119
    v_cvt_pk_bf16_f32 v132, v112, v113
    v_cvt_pk_bf16_f32 v133, v114, v115
    v_cvt_pk_bf16_f32 v134, v116, v117
    v_cvt_pk_bf16_f32 v135, v118, v119
    v_mfma_f32_32x32x16_bf16 v[104:119], v[144:147], v[248:251], 0
    ds_read_b128 v[136:139], v16 offset:12288
    ds_read_b64 v[140:141], v18 offset:12288
    v_exp_f32 v88, v88
    v_exp_f32 v89, v89
    v_exp_f32 v90, v90
    v_exp_f32 v91, v91
    v_mfma_f32_32x32x8bf16_1k v[104:119], v[148:149], v[252:253], v[104:119]
    ds_read_b64_tr_b16 v[160:161], v19 offset:15360
    ds_read_b64_tr_b16 v[162:163], v20 offset:15360
    v_exp_f32 v92, v92
    v_exp_f32 v93, v93
    v_exp_f32 v94, v94
    v_exp_f32 v95, v95
    v_mfma_f32_32x32x16_bf16 v[72:87], v[164:167], v[132:135], v[72:87]
    ds_read_b64_tr_b16 v[164:165], v19 offset:15616
    ds_read_b64_tr_b16 v[166:167], v20 offset:15616
    v_cvt_pk_bf16_f32 v120, v88, v89
    v_cvt_pk_bf16_f32 v121, v90, v91
    v_cvt_pk_bf16_f32 v122, v92, v93
    v_cvt_pk_bf16_f32 v123, v94, v95
    v_exp_f32 v96, v96
    v_exp_f32 v97, v97
    v_exp_f32 v98, v98
    v_exp_f32 v99, v99
    v_mfma_f32_32x32x16_bf16 v[72:87], v[152:155], v[120:123], v[72:87]
    s_waitcnt lgkmcnt(2)
    s_add_u32 m0, s22, 66560
    s_add_u32 s21, s21, 16384
    buffer_load_dwordx4 v1, s[4:7], s21 offen offset:0 sc1 lds
    buffer_load_dwordx4 v1, s[4:7], s21 offen offset:1024 sc1 lds
    v_exp_f32 v100, v100
    v_exp_f32 v101, v101
    v_exp_f32 v102, v102
    v_exp_f32_e64 v103, v103
    v_cvt_pk_bf16_f32 v124, v96, v97
    v_cvt_pk_bf16_f32 v125, v98, v99
    v_cvt_pk_bf16_f32 v126, v100, v101
    v_cvt_pk_bf16_f32 v127, v102, v103
    v_mfma_f32_32x32x16_bf16 v[88:103], v[136:139], v[248:251], v[208:223]
    ds_read_b128 v[144:147], v16 offset:21504
    ds_read_b64 v[148:149], v18 offset:21504
    v_exp_f32 v104, v104
    v_exp_f32 v105, v105
    v_exp_f32 v106, v106
    v_exp_f32 v107, v107
    v_mfma_f32_32x32x8bf16_1k v[88:103], v[140:141], v[252:253], v[88:103]
    ds_read_b64_tr_b16 v[152:153], v19 offset:12288
    ds_read_b64_tr_b16 v[154:155], v20 offset:12288
    v_exp_f32 v108, v108
    v_exp_f32 v109, v109
    v_exp_f32 v110, v110
    v_exp_f32 v111, v111
    v_mfma_f32_32x32x16_bf16 v[72:87], v[156:159], v[124:127], v[72:87]
    ds_read_b64_tr_b16 v[156:157], v19 offset:12544
    ds_read_b64_tr_b16 v[158:159], v20 offset:12544
    v_cvt_pk_bf16_f32 v128, v104, v105
    v_cvt_pk_bf16_f32 v129, v106, v107
    v_cvt_pk_bf16_f32 v130, v108, v109
    v_cvt_pk_bf16_f32 v131, v110, v111
    v_exp_f32 v112, v112
    v_exp_f32 v113, v113
    v_exp_f32 v114, v114
    v_exp_f32 v115, v115
    v_mfma_f32_32x32x16_bf16 v[72:87], v[160:163], v[128:131], v[72:87]
    s_waitcnt lgkmcnt(2)
    buffer_load_dwordx4 v1, s[4:7], s21 offen offset:2048 sc1 lds
    buffer_load_dwordx4 v1, s[4:7], s21 offen offset:3072 sc1 lds
    v_exp_f32 v116, v116
    v_exp_f32 v117, v117
    v_exp_f32 v118, v118
    v_exp_f32_e64 v119, v119
    v_cvt_pk_bf16_f32 v132, v112, v113
    v_cvt_pk_bf16_f32 v133, v114, v115
    v_cvt_pk_bf16_f32 v134, v116, v117
    v_cvt_pk_bf16_f32 v135, v118, v119
    v_mfma_f32_32x32x16_bf16 v[104:119], v[144:147], v[240:243], 0
    ds_read_b128 v[136:139], v16 offset:18432
    ds_read_b64 v[140:141], v18 offset:18432
    v_exp_f32 v88, v88
    v_exp_f32 v89, v89
    v_exp_f32 v90, v90
    v_exp_f32 v91, v91
    v_mfma_f32_32x32x8bf16_1k v[104:119], v[148:149], v[244:245], v[104:119]
    ds_read_b64_tr_b16 v[160:161], v19 offset:21504
    ds_read_b64_tr_b16 v[162:163], v20 offset:21504
    v_exp_f32 v92, v92
    v_exp_f32 v93, v93
    v_exp_f32 v94, v94
    v_exp_f32 v95, v95
    v_mfma_f32_32x32x16_bf16 v[72:87], v[164:167], v[132:135], v[72:87]
    ds_read_b64_tr_b16 v[164:165], v19 offset:21760
    ds_read_b64_tr_b16 v[166:167], v20 offset:21760
    v_cvt_pk_bf16_f32 v120, v88, v89
    v_cvt_pk_bf16_f32 v121, v90, v91
    v_cvt_pk_bf16_f32 v122, v92, v93
    v_cvt_pk_bf16_f32 v123, v94, v95
    v_exp_f32 v96, v96
    v_exp_f32 v97, v97
    v_exp_f32 v98, v98
    v_exp_f32 v99, v99
    v_mfma_f32_32x32x16_bf16 v[72:87], v[152:155], v[120:123], v[72:87]
    s_waitcnt lgkmcnt(2)
    s_add_u32 m0, s22, 82944
    s_add_u32 s21, s21, 16384
    buffer_load_dwordx4 v1, s[4:7], s21 offen offset:0 sc1 lds
    buffer_load_dwordx4 v1, s[4:7], s21 offen offset:1024 sc1 lds
    buffer_load_dwordx4 v1, s[4:7], s21 offen offset:2048 sc1 lds
    v_exp_f32 v100, v100
    v_exp_f32 v101, v101
    v_exp_f32 v102, v102
    v_exp_f32_e64 v103, v103
    v_cvt_pk_bf16_f32 v124, v96, v97
    v_cvt_pk_bf16_f32 v125, v98, v99
    v_cvt_pk_bf16_f32 v126, v100, v101
    v_cvt_pk_bf16_f32 v127, v102, v103
    s_waitcnt vmcnt(11)
    s_barrier
    v_mfma_f32_32x32x16_bf16 v[88:103], v[136:139], v[240:243], 0
    ds_read_b128 v[144:147], v16 offset:15360
    ds_read_b64 v[148:149], v18 offset:15360
    v_exp_f32 v104, v104
    v_exp_f32 v105, v105
    v_exp_f32 v106, v106
    v_exp_f32 v107, v107
    v_mfma_f32_32x32x8bf16_1k v[88:103], v[140:141], v[244:245], v[88:103]
    ds_read_b64_tr_b16 v[152:153], v19 offset:18432
    ds_read_b64_tr_b16 v[154:155], v20 offset:18432
    v_exp_f32 v108, v108
    v_exp_f32 v109, v109
    v_exp_f32 v110, v110
    v_exp_f32 v111, v111
    v_mfma_f32_32x32x16_bf16 v[72:87], v[156:159], v[124:127], v[72:87]
    ds_read_b64_tr_b16 v[156:157], v19 offset:18688
    ds_read_b64_tr_b16 v[158:159], v20 offset:18688
    v_cvt_pk_bf16_f32 v128, v104, v105
    v_cvt_pk_bf16_f32 v129, v106, v107
    v_cvt_pk_bf16_f32 v130, v108, v109
    v_cvt_pk_bf16_f32 v131, v110, v111
    v_exp_f32 v112, v112
    v_exp_f32 v113, v113
    v_exp_f32 v114, v114
    v_exp_f32 v115, v115
    v_mfma_f32_32x32x16_bf16 v[56:71], v[160:163], v[128:131], v[56:71]
    s_waitcnt lgkmcnt(2)
    buffer_load_dwordx4 v1, s[4:7], s21 offen offset:3072 sc1 lds
    s_mul_i32 s20, s40, 270
    s_mul_i32 s67, s36, 7
    s_add_u32 s20, s20, s67
    s_mul_i32 s67, s52, 27
    s_add_u32 s20, s20, s67
    s_lshl_b32 s20, s20, 10
    s_add_u32 s20, s20, 7864320
    buffer_load_dwordx4 a[100:103], v1, s[4:7], s20 offen offset:0 sc1
    v_exp_f32 v116, v116
    v_exp_f32 v117, v117
    v_exp_f32 v118, v118
    v_exp_f32 v119, v119
    v_cvt_pk_bf16_f32 v132, v112, v113
    v_cvt_pk_bf16_f32 v133, v114, v115
    v_cvt_pk_bf16_f32 v134, v116, v117
    v_cvt_pk_bf16_f32 v135, v118, v119
    s_lshl_b32 s68, s38, 2
    s_add_u32 s68, s68, s36
    s_mul_i32 s68, s68, 2560
    s_mul_i32 s69, s37, 327680
    s_add_u32 s68, s68, s69
    v_add_u32 v169, 44, v21
    v_lshrrev_b32_e64 v169, 6, v169
    v_lshl_add_u32 v169, v169, 28, v1
    v_lshlrev_b32_e64 v169, 3, v169
    buffer_load_dword a252, v169, s[8:11], s68 offen offset:0 sc1
    v_rcp_f32_e64 v86, v84
    s_add_u32 s54, s56, 5120
    v_pk_mul_f32 v[72:73], v[72:73], v[86:87] op_sel_hi:[1,0]
    v_pk_mul_f32 v[74:75], v[74:75], v[86:87] op_sel_hi:[1,0]
    v_pk_mul_f32 v[76:77], v[76:77], v[86:87] op_sel_hi:[1,0]
    v_pk_mul_f32 v[78:79], v[78:79], v[86:87] op_sel_hi:[1,0]
    v_pk_mul_f32 v[80:81], v[80:81], v[86:87] op_sel_hi:[1,0]
    v_pk_mul_f32 v[82:83], v[82:83], v[86:87] op_sel_hi:[1,0]
    v_cvt_pk_bf16_f32 v172, v72, v73
    v_cvt_pk_bf16_f32 v173, v74, v75
    v_cvt_pk_bf16_f32 v174, v76, v77
    v_cvt_pk_bf16_f32 v175, v78, v79
    v_cvt_pk_bf16_f32 v176, v80, v81
    v_cvt_pk_bf16_f32 v177, v82, v83
    s_cmp_eq_u32 s43, 0
    s_cbranch_scc1 L_safe_93
    buffer_store_dwordx4 v[172:175], v5, s[4:7], s54 offen offset:0
    buffer_store_dwordx2 v[176:177], v6, s[4:7], s54 offen offset:512
L_join_94:
    v_add_u32 v27, 3766484992, v84
    v_cmp_lt_u32 vcc, 1073741824, v27
    s_nop 0
    s_or_b32 s23, vcc_lo, vcc_hi
    s_mov_b32 s26, s23
    v_mfma_f32_32x32x16_bf16 v[104:119], v[144:147], v[240:243], 0
    ds_read_b128 v[136:139], v16 offset:12288
    ds_read_b64 v[140:141], v18 offset:12288
    v_exp_f32 v88, v88
    v_exp_f32 v89, v89
    v_exp_f32 v90, v90
    v_exp_f32 v91, v91
    v_mfma_f32_32x32x8bf16_1k v[104:119], v[148:149], v[244:245], v[104:119]
    ds_read_b64_tr_b16 v[160:161], v19 offset:15360
    ds_read_b64_tr_b16 v[162:163], v20 offset:15360
    v_exp_f32 v92, v92
    v_exp_f32 v93, v93
    v_exp_f32 v94, v94
    v_exp_f32 v95, v95
    v_mfma_f32_32x32x16_bf16 v[56:71], v[164:167], v[132:135], v[56:71]
    ds_read_b64_tr_b16 v[164:165], v19 offset:15616
    ds_read_b64_tr_b16 v[166:167], v20 offset:15616
    v_cvt_pk_bf16_f32 v120, v88, v89
    v_cvt_pk_bf16_f32 v121, v90, v91
    v_cvt_pk_bf16_f32 v122, v92, v93
    v_cvt_pk_bf16_f32 v123, v94, v95
    v_exp_f32 v96, v96
    v_exp_f32 v97, v97
    v_exp_f32 v98, v98
    v_exp_f32 v99, v99
    v_mfma_f32_32x32x16_bf16 v[56:71], v[152:155], v[120:123], v[56:71]
    s_waitcnt lgkmcnt(2)
    buffer_load_dwordx4 a[104:107], v1, s[4:7], s20 offen offset:1024 sc1
    buffer_load_dwordx4 a[108:111], v1, s[4:7], s20 offen offset:2048 sc1
    buffer_load_dwordx4 a[112:115], v1, s[4:7], s20 offen offset:3072 sc1
    v_exp_f32 v100, v100
    v_exp_f32 v101, v101
    v_exp_f32 v102, v102
    v_exp_f32_e64 v103, v103
    v_cvt_pk_bf16_f32 v124, v96, v97
    v_cvt_pk_bf16_f32 v125, v98, v99
    v_cvt_pk_bf16_f32 v126, v100, v101
    v_cvt_pk_bf16_f32 v127, v102, v103
    v_mfma_f32_32x32x16_bf16 v[88:103], v[136:139], v[240:243], 0
    ds_read_b128 v[144:147], v16 offset:9216
    ds_read_b64 v[148:149], v18 offset:9216
    v_exp_f32 v104, v104
    v_exp_f32 v105, v105
    v_exp_f32 v106, v106
    v_exp_f32 v107, v107
    v_mfma_f32_32x32x8bf16_1k v[88:103], v[140:141], v[244:245], v[88:103]
    ds_read_b64_tr_b16 v[152:153], v19 offset:12288
    ds_read_b64_tr_b16 v[154:155], v20 offset:12288
    v_exp_f32 v108, v108
    v_exp_f32 v109, v109
    v_exp_f32 v110, v110
    v_exp_f32 v111, v111
    v_mfma_f32_32x32x16_bf16 v[56:71], v[156:159], v[124:127], v[56:71]
    ds_read_b64_tr_b16 v[156:157], v19 offset:12544
    ds_read_b64_tr_b16 v[158:159], v20 offset:12544
    v_cvt_pk_bf16_f32 v128, v104, v105
    v_cvt_pk_bf16_f32 v129, v106, v107
    v_cvt_pk_bf16_f32 v130, v108, v109
    v_cvt_pk_bf16_f32 v131, v110, v111
    v_exp_f32 v112, v112
    v_exp_f32 v113, v113
    v_exp_f32 v114, v114
    v_exp_f32 v115, v115
    v_mfma_f32_32x32x16_bf16 v[56:71], v[160:163], v[128:131], v[56:71]
    s_waitcnt lgkmcnt(2)
    s_add_u32 s20, s20, 4096
    buffer_load_dwordx4 a[116:119], v1, s[4:7], s20 offen offset:0 sc1
    buffer_load_dwordx4 a[120:123], v1, s[4:7], s20 offen offset:1024 sc1
    v_exp_f32 v116, v116
    v_exp_f32 v117, v117
    v_exp_f32 v118, v118
    v_exp_f32_e64 v119, v119
    v_cvt_pk_bf16_f32 v132, v112, v113
    v_cvt_pk_bf16_f32 v133, v114, v115
    v_cvt_pk_bf16_f32 v134, v116, v117
    v_cvt_pk_bf16_f32 v135, v118, v119
    s_cmp_lg_u32 s23, 0
    s_cbranch_scc1 L_nohi_95
    s_waitcnt vmcnt(5)
    s_cmp_eq_u32 s43, 0
    s_cbranch_scc1 L_safe_96
    buffer_store_dword v0, v14, s[4:7], s41 offen offset:0
L_join_97:
L_nohi_95:
    v_mfma_f32_32x32x16_bf16 v[104:119], v[144:147], v[240:243], v[208:223]
    buffer_load_dwordx4 a[124:127], v25, s[4:7], s20 offen offset:2048 sc1
    v_exp_f32 v88, v88
    v_exp_f32 v89, v89
    v_exp_f32 v90, v90
    v_exp_f32_e64 v91, v91
    v_mfma_f32_32x32x8bf16_1k v[104:119], v[148:149], v[244:245], v[104:119]
    ds_read_b64_tr_b16 v[160:161], v19 offset:9216
    ds_read_b64_tr_b16 v[162:163], v20 offset:9216
    v_exp_f32 v92, v92
    v_exp_f32 v93, v93
    v_exp_f32 v94, v94
    v_exp_f32 v95, v95
    v_mfma_f32_32x32x16_bf16 v[56:71], v[164:167], v[132:135], v[56:71]
    ds_read_b64_tr_b16 v[164:165], v19 offset:9472
    ds_read_b64_tr_b16 v[166:167], v20 offset:9472
    v_cvt_pk_bf16_f32 v120, v88, v89
    v_cvt_pk_bf16_f32 v121, v90, v91
    v_cvt_pk_bf16_f32 v122, v92, v93
    v_cvt_pk_bf16_f32 v123, v94, v95
    v_exp_f32 v96, v96
    v_exp_f32 v97, v97
    v_exp_f32 v98, v98
    v_exp_f32 v99, v99
    v_mfma_f32_32x32x16_bf16 v[56:71], v[152:155], v[120:123], v[56:71]
    s_waitcnt lgkmcnt(2)
    s_add_u32 s20, s20, 51200
    buffer_load_dwordx4 a[128:131], v1, s[4:7], s20 offen offset:0 sc1
    v_exp_f32 v100, v100
    v_exp_f32 v101, v101
    v_exp_f32 v102, v102
    v_exp_f32_e64 v103, v103
    v_cvt_pk_bf16_f32 v124, v96, v97
    v_cvt_pk_bf16_f32 v125, v98, v99
    v_cvt_pk_bf16_f32 v126, v100, v101
    v_cvt_pk_bf16_f32 v127, v102, v103
    v_exp_f32 v104, v104
    v_exp_f32 v105, v105
    v_exp_f32 v106, v106
    v_exp_f32 v107, v107
    v_exp_f32 v108, v108
    v_exp_f32 v109, v109
    v_exp_f32 v110, v110
    v_exp_f32 v111, v111
    v_mfma_f32_32x32x16_bf16 v[56:71], v[156:159], v[124:127], v[56:71]
    v_cvt_pk_bf16_f32 v128, v104, v105
    v_cvt_pk_bf16_f32 v129, v106, v107
    v_cvt_pk_bf16_f32 v130, v108, v109
    v_cvt_pk_bf16_f32 v131, v110, v111
    v_exp_f32 v112, v112
    v_exp_f32 v113, v113
    v_exp_f32 v114, v114
    v_exp_f32 v115, v115
    v_mfma_f32_32x32x16_bf16 v[56:71], v[160:163], v[128:131], v[56:71]
    s_waitcnt lgkmcnt(0)
    v_exp_f32 v116, v116
    v_exp_f32 v117, v117
    v_exp_f32 v118, v118
    v_exp_f32_e64 v119, v119
    v_cvt_pk_bf16_f32 v132, v112, v113
    v_cvt_pk_bf16_f32 v133, v114, v115
    v_cvt_pk_bf16_f32 v134, v116, v117
    v_cvt_pk_bf16_f32 v135, v118, v119
    s_nop 1
    v_mfma_f32_32x32x16_bf16 v[56:71], v[164:167], v[132:135], v[56:71]
    s_nop 11
    v_rcp_f32_e64 v70, v68
    s_add_u32 s54, s56, 3840
    v_pk_mul_f32 v[56:57], v[56:57], v[70:71] op_sel_hi:[1,0]
    v_pk_mul_f32 v[58:59], v[58:59], v[70:71] op_sel_hi:[1,0]
    v_pk_mul_f32 v[60:61], v[60:61], v[70:71] op_sel_hi:[1,0]
    v_pk_mul_f32 v[62:63], v[62:63], v[70:71] op_sel_hi:[1,0]
    v_pk_mul_f32 v[64:65], v[64:65], v[70:71] op_sel_hi:[1,0]
    v_pk_mul_f32 v[66:67], v[66:67], v[70:71] op_sel_hi:[1,0]
    v_cvt_pk_bf16_f32 v172, v56, v57
    v_cvt_pk_bf16_f32 v173, v58, v59
    v_cvt_pk_bf16_f32 v174, v60, v61
    v_cvt_pk_bf16_f32 v175, v62, v63
    v_cvt_pk_bf16_f32 v176, v64, v65
    v_cvt_pk_bf16_f32 v177, v66, v67
    s_cmp_eq_u32 s43, 0
    s_cbranch_scc1 L_safe_100
    buffer_store_dwordx4 v[172:175], v5, s[4:7], s54 offen offset:0
    buffer_store_dwordx2 v[176:177], v6, s[4:7], s54 offen offset:512
L_join_101:
    v_add_u32 v27, 3766484992, v68
    v_cmp_lt_u32 vcc, 1073741824, v27
    s_nop 0
    s_or_b32 s23, s23, vcc_lo
    s_or_b32 s23, s23, vcc_hi
    s_cmp_lg_u32 s23, 0
    s_cbranch_scc1 L_fallback_98
L_fbdone_99:
    s_branch L_over_450
L_chain0_1_2:
    s_branch L_chain0_1_3
L_over_450:
L_attdone_33:
    v_add_u32 v0, 2, v15
    s_waitcnt vmcnt(0)
    s_cmp_eq_u32 s43, 0
    s_cbranch_scc1 L_safe_102
    buffer_store_dword v0, v14, s[4:7], s41 offen offset:0
L_join_103:
    s_cmp_eq_u32 s36, 0
    s_cbranch_scc1 L_chain6_0_0
    s_cmp_eq_u32 s36, 1
    s_cbranch_scc1 L_chain6_1_0
    s_cmp_eq_u32 s36, 2
    s_cbranch_scc1 L_chain6_2_0
    s_branch L_chain6_3_0
L_chainret6:
L_ph2:
L_poll_104:
    buffer_load_dword v26, v13, s[4:7], s17 offen offset:1024 sc1
    s_waitcnt vmcnt(0)
    v_sub_u32 v26, v26, v15
    v_subrev_u32 v26, s16, v26
    v_cmp_lt_u32 vcc, 1, v26
    s_nop 0
    s_and_b32 vcc_hi, vcc_lo, 65535
    s_cbranch_scc0 L_polled_105
    s_sub_u32 s44, s44, 1
    s_cbranch_scc0 L_poll_104
    s_mov_b32 s44, 0
L_polled_105:
    buffer_load_dwordx4 v[56:59], v255, s[4:7], s12 offen offset:0 sc1
    s_add_u32 s12, s12, 55296
    buffer_load_dwordx4 v[60:63], v255, s[4:7], s12 offen offset:0 sc1
    s_add_u32 s12, s12, 55296
    buffer_load_dwordx4 v[64:67], v255, s[4:7], s12 offen offset:0 sc1
    s_add_u32 s12, s12, 55296
    buffer_load_dwordx4 v[68:71], v255, s[4:7], s12 offen offset:0 sc1
    s_sub_u32 s12, s12, 165888
    buffer_load_dwordx2 v[72:73], v7, s[4:7], s12 offen offset:512 sc1
    s_add_u32 s12, s12, 27648
    buffer_load_dwordx2 v[74:75], v7, s[4:7], s12 offen offset:512 sc1
    buffer_load_dwordx4 v[76:79], v255, s[4:7], s13 offen offset:0 sc1
    s_add_u32 s13, s13, 55296
    buffer_load_dwordx4 v[80:83], v255, s[4:7], s13 offen offset:0 sc1
    s_waitcnt vmcnt(7)
    v_mfma_f32_16x16x32_bf16 v[136:139], a[0:3], v[56:59], 0
    s_add_u32 s13, s13, 55296
    buffer_load_dwordx4 v[84:87], v255, s[4:7], s13 offen offset:0 sc1
    v_mfma_f32_16x16x32_bf16 v[140:143], a[20:23], v[56:59], 0
    v_add_u32 v0, 2, v15
    v_add_u32 v236, 1024, v1
    v_add_u32 v237, 50176, v1
    v_mfma_f32_16x16x32_bf16 v[144:147], a[40:43], v[56:59], 0
    buffer_load_dwordx4 a[132:135], v1, s[4:7], s20 offen offset:1024 sc1
    v_mfma_f32_16x16x32_bf16 v[148:151], a[60:63], v[56:59], 0
    v_add_u32 v238, 99328, v1
    v_bfe_u32 v239, v21, 3, 1
    v_mul_u32_u24 v239, 480, v239
    v_mfma_f32_16x16x32_bf16 v[152:155], a[80:83], v[56:59], 0
    buffer_load_dwordx4 a[136:139], v1, s[4:7], s20 offen offset:2048 sc1
    s_waitcnt vmcnt(9)
    v_mfma_f32_16x16x32_bf16 v[136:139], a[4:7], v[60:63], v[136:139]
    s_add_u32 s13, s13, 55296
    buffer_load_dwordx4 v[88:91], v255, s[4:7], s13 offen offset:0 sc1
    v_mfma_f32_16x16x32_bf16 v[140:143], a[24:27], v[60:63], v[140:143]
    v_add_u32 v239, v239, v13
    s_lshl_b32 s61, s39, 2
    s_add_u32 s61, s61, s36
    v_mfma_f32_16x16x32_bf16 v[144:147], a[44:47], v[60:63], v[144:147]
    s_xor_b32 s60, s61, 4
    s_lshl_b32 s58, s47, 9
    s_add_u32 s58, s58, s45
    v_mfma_f32_16x16x32_bf16 v[148:151], a[64:67], v[60:63], v[148:151]
    s_add_u32 s58, s58, 360448
    s_add_u32 s59, s45, 327680
    s_lshl_b32 s54, s37, 4
    v_mfma_f32_16x16x32_bf16 v[152:155], a[84:87], v[60:63], v[152:155]
    buffer_load_dwordx4 a[140:143], v1, s[4:7], s20 offen offset:3072 sc1
    s_waitcnt vmcnt(10)
    v_mfma_f32_16x16x32_bf16 v[136:139], a[8:11], v[64:67], v[136:139]
    s_sub_u32 s13, s13, 165888
    buffer_load_dwordx2 v[92:93], v7, s[4:7], s13 offen offset:512 sc1
    s_add_u32 s13, s13, 27648
    buffer_load_dwordx2 v[94:95], v7, s[4:7], s13 offen offset:512 sc1
    v_mfma_f32_16x16x32_bf16 v[140:143], a[28:31], v[64:67], v[140:143]
    s_add_u32 s54, s54, s60
    s_mul_i32 s54, s54, 20480
    s_lshl_b32 s56, s60, 10
    v_mfma_f32_16x16x32_bf16 v[144:147], a[48:51], v[64:67], v[144:147]
    s_add_u32 s20, s20, 4096
    buffer_load_dwordx4 a[144:147], v1, s[4:7], s20 offen offset:0 sc1
    v_mfma_f32_16x16x32_bf16 v[148:151], a[68:71], v[64:67], v[148:151]
    s_add_u32 s56, s56, s59
    s_mul_i32 s62, s60, 55296
    s_add_u32 s62, s62, s58
    v_mfma_f32_16x16x32_bf16 v[152:155], a[88:91], v[64:67], v[152:155]
    s_waitcnt vmcnt(12)
    v_mfma_f32_16x16x32_bf16 v[136:139], a[12:15], v[68:71], v[136:139]
    buffer_load_dwordx4 v[96:99], v255, s[4:7], s14 offen offset:0 sc1
    v_mfma_f32_16x16x32_bf16 v[140:143], a[32:35], v[68:71], v[140:143]
    s_lshl_b32 s55, s37, 4
    s_add_u32 s55, s55, s61
    s_mul_i32 s55, s55, 20480
    v_mfma_f32_16x16x32_bf16 v[144:147], a[52:55], v[68:71], v[144:147]
    buffer_load_dwordx4 a[148:151], v1, s[4:7], s20 offen offset:1024 sc1
    v_mfma_f32_16x16x32_bf16 v[148:151], a[72:75], v[68:71], v[148:151]
    s_lshl_b32 s57, s61, 10
    s_add_u32 s57, s57, s59
    s_mul_i32 s63, s61, 55296
    v_mfma_f32_16x16x32_bf16 v[152:155], a[92:95], v[68:71], v[152:155]
    s_waitcnt vmcnt(12)
    v_mfma_f32_16x16x32_bf16 v[136:139], a[16:19], v[72:75], v[136:139]
    s_add_u32 s14, s14, 55296
    buffer_load_dwordx4 v[100:103], v255, s[4:7], s14 offen offset:0 sc1
    v_mfma_f32_16x16x32_bf16 v[140:143], a[36:39], v[72:75], v[140:143]
    s_branch L_over_451
L_chain0_2_2:
    s_branch L_chainret0
L_over_451:
    s_add_u32 s63, s63, s58
    s_and_b32 s59, s49, 4294966656
    s_xor_b32 s65, s59, 0x400
    v_mfma_f32_16x16x32_bf16 v[144:147], a[56:59], v[72:75], v[144:147]
    buffer_load_dwordx4 a[152:155], v25, s[4:7], s20 offen offset:2048 sc1
    v_mfma_f32_16x16x32_bf16 v[148:151], a[76:79], v[72:75], v[148:151]
    v_mfma_f32_16x16x32_bf16 v[152:155], a[96:99], v[72:75], v[152:155]
    s_add_u32 s20, s20, 51200
    buffer_load_dwordx4 a[156:159], v1, s[4:7], s20 offen offset:0 sc1
    s_waitcnt vmcnt(14)
    v_mfma_f32_16x16x32_bf16 v[156:159], a[0:3], v[76:79], 0
    s_add_u32 s14, s14, 55296
    buffer_load_dwordx4 v[104:107], v255, s[4:7], s14 offen offset:0 sc1
    v_mfma_f32_16x16x32_bf16 v[160:163], a[20:23], v[76:79], 0
    s_barrier
    v_mfma_f32_16x16x32_bf16 v[164:167], a[40:43], v[76:79], 0
    v_mfma_f32_16x16x32_bf16 v[168:171], a[60:63], v[76:79], 0
    ds_write_b128 v52, v[136:139] offset:0
    v_mfma_f32_16x16x32_bf16 v[172:175], a[80:83], v[76:79], 0
    buffer_load_dwordx4 a[160:163], v1, s[4:7], s20 offen offset:1024 sc1
    s_waitcnt vmcnt(15)
    v_mfma_f32_16x16x32_bf16 v[156:159], a[4:7], v[80:83], v[156:159]
    s_add_u32 s14, s14, 55296
    buffer_load_dwordx4 v[108:111], v255, s[4:7], s14 offen offset:0 sc1
    v_mfma_f32_16x16x32_bf16 v[160:163], a[24:27], v[80:83], v[160:163]
    ds_write_b128 v52, v[140:143] offset:1024
    v_mfma_f32_16x16x32_bf16 v[164:167], a[44:47], v[80:83], v[164:167]
    buffer_load_dwordx4 a[164:167], v1, s[4:7], s20 offen offset:2048 sc1
    v_mfma_f32_16x16x32_bf16 v[168:171], a[64:67], v[80:83], v[168:171]
    ds_write_b128 v52, v[144:147] offset:2048
    v_mfma_f32_16x16x32_bf16 v[172:175], a[84:87], v[80:83], v[172:175]
    s_waitcnt vmcnt(16)
    v_mfma_f32_16x16x32_bf16 v[156:159], a[8:11], v[84:87], v[156:159]
    s_sub_u32 s14, s14, 165888
    buffer_load_dwordx2 v[112:113], v7, s[4:7], s14 offen offset:512 sc1
    s_add_u32 s14, s14, 27648
    buffer_load_dwordx2 v[114:115], v7, s[4:7], s14 offen offset:512 sc1
    v_mfma_f32_16x16x32_bf16 v[160:163], a[28:31], v[84:87], v[160:163]
    ds_write_b128 v52, v[148:151] offset:3072
    v_mfma_f32_16x16x32_bf16 v[164:167], a[48:51], v[84:87], v[164:167]
    buffer_load_dwordx4 a[168:171], v1, s[4:7], s20 offen offset:3072 sc1
    v_mfma_f32_16x16x32_bf16 v[168:171], a[68:71], v[84:87], v[168:171]
    ds_write_b128 v52, v[152:155] offset:4096
    v_mfma_f32_16x16x32_bf16 v[172:175], a[88:91], v[84:87], v[172:175]
    s_waitcnt vmcnt(16)
    v_mfma_f32_16x16x32_bf16 v[156:159], a[12:15], v[88:91], v[156:159]
    buffer_load_dwordx4 v[116:119], v255, s[4:7], s15 offen offset:0 sc1
    v_mfma_f32_16x16x32_bf16 v[160:163], a[32:35], v[88:91], v[160:163]
    v_mfma_f32_16x16x32_bf16 v[164:167], a[52:55], v[88:91], v[164:167]
    s_add_u32 s20, s20, 4096
    buffer_load_dwordx4 a[172:175], v1, s[4:7], s20 offen offset:0 sc1
    v_mfma_f32_16x16x32_bf16 v[168:171], a[72:75], v[88:91], v[168:171]
    v_mfma_f32_16x16x32_bf16 v[172:175], a[92:95], v[88:91], v[172:175]
    buffer_load_dwordx4 a[176:179], v1, s[4:7], s20 offen offset:1024 sc1
    s_waitcnt vmcnt(16)
    v_mfma_f32_16x16x32_bf16 v[156:159], a[16:19], v[92:95], v[156:159]
    s_add_u32 s15, s15, 55296
    buffer_load_dwordx4 v[120:123], v255, s[4:7], s15 offen offset:0 sc1
    v_mfma_f32_16x16x32_bf16 v[160:163], a[36:39], v[92:95], v[160:163]
    v_mfma_f32_16x16x32_bf16 v[164:167], a[56:59], v[92:95], v[164:167]
    v_mfma_f32_16x16x32_bf16 v[168:171], a[76:79], v[92:95], v[168:171]
    v_mfma_f32_16x16x32_bf16 v[172:175], a[96:99], v[92:95], v[172:175]
    buffer_load_dwordx4 a[180:183], v25, s[4:7], s20 offen offset:2048 sc1
    s_waitcnt vmcnt(16)
    v_mfma_f32_16x16x32_bf16 v[136:139], a[0:3], v[96:99], 0
    s_add_u32 s15, s15, 55296
    buffer_load_dwordx4 v[124:127], v255, s[4:7], s15 offen offset:0 sc1
    v_mfma_f32_16x16x32_bf16 v[140:143], a[20:23], v[96:99], 0
    v_mfma_f32_16x16x32_bf16 v[144:147], a[40:43], v[96:99], 0
    s_add_u32 s20, s20, 51200
    buffer_load_dwordx4 a[184:187], v1, s[4:7], s20 offen offset:0 sc1
    v_mfma_f32_16x16x32_bf16 v[148:151], a[60:63], v[96:99], 0
    ds_write_b128 v53, v[156:159] offset:0
    v_mfma_f32_16x16x32_bf16 v[152:155], a[80:83], v[96:99], 0
    s_waitcnt vmcnt(16)
    v_mfma_f32_16x16x32_bf16 v[136:139], a[4:7], v[100:103], v[136:139]
    s_add_u32 s15, s15, 55296
    buffer_load_dwordx4 v[128:131], v255, s[4:7], s15 offen offset:0 sc1
    v_mfma_f32_16x16x32_bf16 v[140:143], a[24:27], v[100:103], v[140:143]
    ds_write_b128 v53, v[160:163] offset:1024
    v_mfma_f32_16x16x32_bf16 v[144:147], a[44:47], v[100:103], v[144:147]
    buffer_load_dwordx4 a[188:191], v1, s[4:7], s20 offen offset:1024 sc1
    v_mfma_f32_16x16x32_bf16 v[148:151], a[64:67], v[100:103], v[148:151]
    ds_write_b128 v53, v[164:167] offset:2048
    v_mfma_f32_16x16x32_bf16 v[152:155], a[84:87], v[100:103], v[152:155]
    s_waitcnt vmcnt(15)
    v_mfma_f32_16x16x32_bf16 v[136:139], a[8:11], v[104:107], v[136:139]
    s_sub_u32 s15, s15, 165888
    buffer_load_dwordx2 v[132:133], v7, s[4:7], s15 offen offset:512 sc1
    s_add_u32 s15, s15, 27648
    buffer_load_dwordx2 v[134:135], v7, s[4:7], s15 offen offset:512 sc1
    v_mfma_f32_16x16x32_bf16 v[140:143], a[28:31], v[104:107], v[140:143]
    ds_write_b128 v53, v[168:171] offset:3072
    v_mfma_f32_16x16x32_bf16 v[144:147], a[48:51], v[104:107], v[144:147]
    buffer_load_dwordx4 a[192:195], v1, s[4:7], s20 offen offset:2048 sc1
    v_mfma_f32_16x16x32_bf16 v[148:151], a[68:71], v[104:107], v[148:151]
    ds_write_b128 v53, v[172:175] offset:4096
    v_mfma_f32_16x16x32_bf16 v[152:155], a[88:91], v[104:107], v[152:155]
    buffer_load_dwordx4 a[196:199], v1, s[4:7], s20 offen offset:3072 sc1
    s_waitcnt vmcnt(17)
    v_mfma_f32_16x16x32_bf16 v[136:139], a[12:15], v[108:111], v[136:139]
    v_mfma_f32_16x16x32_bf16 v[140:143], a[32:35], v[108:111], v[140:143]
    v_mfma_f32_16x16x32_bf16 v[144:147], a[52:55], v[108:111], v[144:147]
    s_waitcnt lgkmcnt(0)
    s_barrier
    v_mfma_f32_16x16x32_bf16 v[148:151], a[72:75], v[108:111], v[148:151]
    ds_read_b128 v[176:179], v55 offset:0
    v_mfma_f32_16x16x32_bf16 v[152:155], a[92:95], v[108:111], v[152:155]
    s_add_u32 s20, s20, 4096
    buffer_load_dwordx4 a[200:203], v1, s[4:7], s20 offen offset:0 sc1
    s_waitcnt vmcnt(15)
    v_mfma_f32_16x16x32_bf16 v[136:139], a[16:19], v[112:115], v[136:139]
    ds_read_b128 v[180:183], v55 offset:1024
    v_mfma_f32_16x16x32_bf16 v[140:143], a[36:39], v[112:115], v[140:143]
    ds_read_b128 v[184:187], v55 offset:2048
    v_mfma_f32_16x16x32_bf16 v[144:147], a[56:59], v[112:115], v[144:147]
    buffer_load_dwordx4 a[204:207], v1, s[4:7], s20 offen offset:1024 sc1
    v_mfma_f32_16x16x32_bf16 v[148:151], a[76:79], v[112:115], v[148:151]
    ds_read_b128 v[188:191], v55 offset:3072
    v_mfma_f32_16x16x32_bf16 v[152:155], a[96:99], v[112:115], v[152:155]
    ds_read_b128 v[192:195], v55 offset:4096
    s_waitcnt vmcnt(14)
    v_mfma_f32_16x16x32_bf16 v[32:35], a[0:3], v[116:119], v[32:35]
    ds_read_b128 v[196:199], v55 offset:5120
    v_mfma_f32_16x16x32_bf16 v[36:39], a[20:23], v[116:119], v[36:39]
    ds_read_b128 v[200:203], v55 offset:6144
    v_mfma_f32_16x16x32_bf16 v[40:43], a[40:43], v[116:119], v[40:43]
    buffer_load_dwordx4 a[208:211], v25, s[4:7], s20 offen offset:2048 sc1
    v_mfma_f32_16x16x32_bf16 v[44:47], a[60:63], v[116:119], v[44:47]
    ds_write_b128 v54, v[136:139] offset:0
    v_mfma_f32_16x16x32_bf16 v[48:51], a[80:83], v[116:119], v[48:51]
    ds_read_b128 v[204:207], v55 offset:7168
    s_waitcnt vmcnt(12)
    v_mfma_f32_16x16x32_bf16 v[32:35], a[4:7], v[120:123], v[32:35]
    ds_read_b128 v[208:211], v55 offset:8192
    v_mfma_f32_16x16x32_bf16 v[36:39], a[24:27], v[120:123], v[36:39]
    ds_write_b128 v54, v[140:143] offset:1024
    v_mfma_f32_16x16x32_bf16 v[40:43], a[44:47], v[120:123], v[40:43]
    ds_read_b128 v[212:215], v55 offset:9216
    v_mfma_f32_16x16x32_bf16 v[44:47], a[64:67], v[120:123], v[44:47]
    ds_write_b128 v54, v[144:147] offset:2048
    v_mfma_f32_16x16x32_bf16 v[48:51], a[84:87], v[120:123], v[48:51]
    s_waitcnt lgkmcnt(6)
    v_add_f32_e64 v176, v176, v196
    v_add_f32 v177, v177, v197
    s_waitcnt vmcnt(10)
    v_mfma_f32_16x16x32_bf16 v[32:35], a[8:11], v[124:127], v[32:35]
    v_add_f32 v178, v178, v198
    v_add_f32 v179, v179, v199
    v_mfma_f32_16x16x32_bf16 v[36:39], a[28:31], v[124:127], v[36:39]
    ds_write_b128 v54, v[148:151] offset:3072
    v_mfma_f32_16x16x32_bf16 v[40:43], a[48:51], v[124:127], v[40:43]
    s_waitcnt lgkmcnt(5)
    v_add_f32 v180, v180, v200
    v_add_f32_e64 v181, v181, v201
    v_mfma_f32_16x16x32_bf16 v[44:47], a[68:71], v[124:127], v[44:47]
    ds_write_b128 v54, v[152:155] offset:4096
    v_mfma_f32_16x16x32_bf16 v[48:51], a[88:91], v[124:127], v[48:51]
    v_add_f32_e64 v182, v182, v202
    v_add_f32 v183, v183, v203
    s_waitcnt vmcnt(8)
    v_mfma_f32_16x16x32_bf16 v[32:35], a[12:15], v[128:131], v[32:35]
    s_waitcnt lgkmcnt(5)
    v_add_f32 v184, v184, v204
    v_add_f32_e64 v185, v185, v205
    v_mfma_f32_16x16x32_bf16 v[36:39], a[32:35], v[128:131], v[36:39]
    v_add_f32 v186, v186, v206
    v_add_f32 v187, v187, v207
    v_mfma_f32_16x16x32_bf16 v[40:43], a[52:55], v[128:131], v[40:43]
    s_waitcnt lgkmcnt(0)
    s_barrier
    v_mfma_f32_16x16x32_bf16 v[44:47], a[72:75], v[128:131], v[44:47]
    ds_read_b128 v[216:219], v55 offset:10240
    v_mfma_f32_16x16x32_bf16 v[48:51], a[92:95], v[128:131], v[48:51]
    ds_read_b128 v[220:223], v55 offset:11264
    s_waitcnt vmcnt(5)
    v_mfma_f32_16x16x32_bf16 v[32:35], a[16:19], v[132:135], v[32:35]
    ds_read_b128 v[224:227], v55 offset:12288
    v_mfma_f32_16x16x32_bf16 v[36:39], a[36:39], v[132:135], v[36:39]
    ds_read_b128 v[228:231], v55 offset:13312
    v_mfma_f32_16x16x32_bf16 v[40:43], a[56:59], v[132:135], v[40:43]
    ds_read_b128 v[232:235], v55 offset:14336
    v_mfma_f32_16x16x32_bf16 v[44:47], a[76:79], v[132:135], v[44:47]
    v_add_f32 v188, v188, v208
    v_add_f32_e64 v189, v189, v209
    v_mfma_f32_16x16x32_bf16 v[48:51], a[96:99], v[132:135], v[48:51]
    v_add_f32 v190, v190, v210
    v_add_f32 v191, v191, v211
    v_pk_add_f32 v[192:193], v[192:193], v[212:213]
    v_pk_add_f32 v[194:195], v[194:195], v[214:215]
    s_waitcnt lgkmcnt(3)
    v_pk_add_f32 v[176:177], v[176:177], v[216:217]
    v_pk_add_f32 v[178:179], v[178:179], v[218:219]
    s_waitcnt lgkmcnt(2)
    v_pk_add_f32 v[180:181], v[180:181], v[220:221]
    v_pk_add_f32 v[182:183], v[182:183], v[222:223]
    s_waitcnt lgkmcnt(1)
    v_pk_add_f32 v[184:185], v[184:185], v[224:225]
    v_pk_add_f32 v[186:187], v[186:187], v[226:227]
    s_waitcnt lgkmcnt(0)
    v_pk_add_f32 v[188:189], v[188:189], v[228:229]
    v_pk_add_f32 v[190:191], v[190:191], v[230:231]
    v_pk_add_f32 v[192:193], v[192:193], v[232:233]
    v_pk_add_f32 v[194:195], v[194:195], v[234:235]
    v_pk_add_f32 v[32:33], v[32:33], v[176:177]
    v_pk_add_f32 v[34:35], v[34:35], v[178:179]
    v_pk_add_f32 v[36:37], v[36:37], v[180:181]
    v_pk_add_f32 v[38:39], v[38:39], v[182:183]
    v_pk_add_f32 v[40:41], v[40:41], v[184:185]
    v_pk_add_f32 v[42:43], v[42:43], v[186:187]
    v_pk_add_f32 v[44:45], v[44:45], v[188:189]
    v_pk_add_f32 v[46:47], v[46:47], v[190:191]
    v_pk_add_f32 v[48:49], v[48:49], v[192:193]
    v_pk_add_f32 v[50:51], v[50:51], v[194:195]
L_ph3:
    s_cmp_eq_u32 s43, 0
    s_cbranch_scc1 L_safe_106
    v_cvt_pk_bf16_f32 v56, v32, v33
    v_cvt_pk_bf16_f32 v58, v36, v37
    v_cvt_pk_bf16_f32 v57, v34, v35
    v_cvt_pk_bf16_f32 v59, v38, v39
    v_permlane16_swap_b32 v56, v58
    v_cvt_pk_bf16_f32 v60, v40, v41
    v_cvt_pk_bf16_f32 v62, v44, v45
    v_cvt_pk_bf16_f32 v61, v42, v43
    v_cvt_pk_bf16_f32 v63, v46, v47
    v_permlane16_swap_b32 v57, v59
    buffer_store_dwordx4 v[56:59], v3, s[8:11], s34 offen offset:0
    v_permlane16_swap_b32 v60, v62
    v_cvt_pk_bf16_f32 v64, v48, v49
    v_cvt_pk_bf16_f32 v66, v48, v49
    v_cvt_pk_bf16_f32 v65, v50, v51
    v_cvt_pk_bf16_f32 v67, v50, v51
    v_permlane16_swap_b32 v61, v63
    buffer_store_dwordx4 v[60:63], v3, s[8:11], s34 offen offset:1024
    v_permlane16_swap_b32 v64, v66
    v_permlane16_swap_b32 v65, v67
    buffer_store_dwordx4 v[64:67], v4, s[8:11], s34 offen offset:2048
    v_pk_add_f32 v[68:69], v[32:33], v[34:35]
    v_pk_mul_f32 v[70:71], v[32:33], v[32:33]
    v_pk_fma_f32 v[70:71], v[34:35], v[34:35], v[70:71]
    v_pk_add_f32 v[68:69], v[68:69], v[36:37]
    v_pk_fma_f32 v[70:71], v[36:37], v[36:37], v[70:71]
    v_pk_add_f32 v[68:69], v[68:69], v[38:39]
    v_pk_fma_f32 v[70:71], v[38:39], v[38:39], v[70:71]
    v_pk_add_f32 v[68:69], v[68:69], v[40:41]
    v_pk_fma_f32 v[70:71], v[40:41], v[40:41], v[70:71]
    v_pk_add_f32 v[68:69], v[68:69], v[42:43]
    v_pk_fma_f32 v[70:71], v[42:43], v[42:43], v[70:71]
    v_pk_add_f32 v[68:69], v[68:69], v[44:45]
    v_pk_fma_f32 v[70:71], v[44:45], v[44:45], v[70:71]
    v_pk_add_f32 v[68:69], v[68:69], v[46:47]
    v_pk_fma_f32 v[70:71], v[46:47], v[46:47], v[70:71]
    v_pk_add_f32 v[68:69], v[68:69], v[48:49]
    v_pk_fma_f32 v[70:71], v[48:49], v[48:49], v[70:71]
    v_pk_add_f32 v[68:69], v[68:69], v[50:51]
    v_pk_fma_f32 v[70:71], v[50:51], v[50:51], v[70:71]
    v_add_f32 v68, v68, v69
    v_add_f32 v69, v70, v71
    s_nop 1
    v_permlane16_swap_b32 v68, v69
    v_add_f32 v68, v68, v69
    v_mov_b32 v69, v68
    s_nop 1
    v_permlane32_swap_b32 v68, v69
    v_add_f32 v68, v68, v69
    v_mov_b32 v69, v68
    s_nop 1
    v_permlane16_swap_b32 v68, v69
    buffer_store_dwordx2 v[68:69], v8, s[4:7], s35 offen offset:0
    ds_read_b128 v[112:115], v237 offset:0
    ds_read_b128 v[116:119], v237 offset:1024
    ds_read_b128 v[120:123], v237 offset:2048
    ds_read_b128 v[124:127], v237 offset:3072
    ds_read_b128 v[128:131], v237 offset:4096
    ds_read_b128 v[132:135], v237 offset:5120
    ds_read_b128 v[136:139], v237 offset:6144
    s_waitcnt vmcnt(1)
    buffer_store_dword v0, v14, s[4:7], s49 offen offset:0
L_join_107:
L_poll_108:
    buffer_load_dword v26, v239, s[4:7], s59 offen offset:0 sc1
    s_waitcnt vmcnt(0)
    v_sub_u32 v26, v26, v15
    v_subrev_u32 v26, 2, v26
    v_cmp_lt_u32 vcc, 1, v26
    s_nop 0
    s_and_b32 vcc_hi, vcc_lo, 65535
    s_cbranch_scc0 L_polled_109
    s_sub_u32 s44, s44, 1
    s_cbranch_scc0 L_poll_108
    s_mov_b32 s44, 0
L_polled_109:
    buffer_load_dwordx4 v[184:187], v1, s[8:11], s54 offen offset:0 sc1
    buffer_load_dwordx4 v[188:191], v1, s[8:11], s55 offen offset:0 sc1
    buffer_load_dwordx4 v[192:195], v1, s[8:11], s54 offen offset:1024 sc1
    buffer_load_dwordx4 v[196:199], v1, s[8:11], s55 offen offset:1024 sc1
    buffer_load_dwordx4 v[200:203], v1, s[8:11], s54 offen offset:2048 sc1
    buffer_load_dwordx4 v[204:207], v1, s[8:11], s55 offen offset:2048 sc1
    v_add_u32_e64 v0, 1, v0
    s_cmp_eq_u32 s43, 0
    s_cbranch_scc1 L_safe_110
    buffer_store_dword v0, v14, s[4:7], s49 offen offset:0
L_join_111:
    s_waitcnt vmcnt(5) lgkmcnt(0)
    v_mfma_f32_16x16x32_bf16 v[56:59], v[112:115], v[184:187], 0
    ds_read_b128 v[140:143], v237 offset:7168
    v_mfma_f32_16x16x32_bf16 v[84:87], v[112:115], v[188:191], 0
    ds_read_b128 v[144:147], v237 offset:8192
    v_mfma_f32_16x16x32_bf16 v[60:63], v[116:119], v[184:187], 0
    buffer_load_dwordx4 v[208:211], v1, s[8:11], s54 offen offset:3072 sc1
    v_mfma_f32_16x16x32_bf16 v[88:91], v[116:119], v[188:191], 0
    ds_read_b128 v[148:151], v237 offset:9216
    v_mfma_f32_16x16x32_bf16 v[64:67], v[120:123], v[184:187], 0
    ds_read_b128 v[152:155], v237 offset:10240
    v_mfma_f32_16x16x32_bf16 v[92:95], v[120:123], v[188:191], 0
    buffer_load_dwordx4 v[212:215], v1, s[8:11], s55 offen offset:3072 sc1
    v_mfma_f32_16x16x32_bf16 v[68:71], v[124:127], v[184:187], 0
    ds_read_b128 v[156:159], v237 offset:11264
    v_mfma_f32_16x16x32_bf16 v[96:99], v[124:127], v[188:191], 0
    ds_read_b128 v[160:163], v237 offset:12288
    v_mfma_f32_16x16x32_bf16 v[72:75], v[128:131], v[184:187], 0
    s_add_u32 s54, s54, 4096
    buffer_load_dwordx4 v[216:219], v1, s[8:11], s54 offen offset:0 sc1
    v_mfma_f32_16x16x32_bf16 v[100:103], v[128:131], v[188:191], 0
    ds_read_b128 v[164:167], v237 offset:13312
    v_mfma_f32_16x16x32_bf16 v[76:79], v[132:135], v[184:187], 0
    s_add_u32 s55, s55, 4096
    buffer_load_dwordx4 v[220:223], v1, s[8:11], s55 offen offset:0 sc1
    v_mfma_f32_16x16x32_bf16 v[104:107], v[132:135], v[188:191], 0
    v_mfma_f32_16x16x32_bf16 v[80:83], v[136:139], v[184:187], 0
    buffer_load_dwordx4 v[184:187], v1, s[8:11], s54 offen offset:1024 sc1
    v_mfma_f32_16x16x32_bf16 v[108:111], v[136:139], v[188:191], 0
    buffer_load_dwordx4 v[188:191], v1, s[8:11], s55 offen offset:1024 sc1
    s_barrier
    s_waitcnt vmcnt(9) lgkmcnt(0)
    v_mfma_f32_16x16x32_bf16 v[56:59], v[140:143], v[192:195], v[56:59]
    ds_read_b128 v[112:115], v237 offset:14336
    v_mfma_f32_16x16x32_bf16 v[84:87], v[140:143], v[196:199], v[84:87]
    ds_read_b128 v[116:119], v237 offset:15360
    v_mfma_f32_16x16x32_bf16 v[60:63], v[144:147], v[192:195], v[60:63]
    s_add_u32 m0, s22, 99328
    s_add_u32 s21, s21, 16384
    buffer_load_dwordx4 v1, s[4:7], s21 offen offset:0 sc1 lds
    v_mfma_f32_16x16x32_bf16 v[88:91], v[144:147], v[196:199], v[88:91]
    ds_read_b128 v[120:123], v237 offset:16384
    v_mfma_f32_16x16x32_bf16 v[64:67], v[148:151], v[192:195], v[64:67]
    ds_read_b128 v[124:127], v237 offset:17408
    v_mfma_f32_16x16x32_bf16 v[92:95], v[148:151], v[196:199], v[92:95]
    buffer_load_dwordx4 v1, s[4:7], s21 offen offset:1024 sc1 lds
    v_mfma_f32_16x16x32_bf16 v[68:71], v[152:155], v[192:195], v[68:71]
    ds_read_b128 v[128:131], v237 offset:18432
    v_mfma_f32_16x16x32_bf16 v[96:99], v[152:155], v[196:199], v[96:99]
    ds_read_b128 v[132:135], v237 offset:19456
    v_mfma_f32_16x16x32_bf16 v[72:75], v[156:159], v[192:195], v[72:75]
    v_mfma_f32_16x16x32_bf16 v[100:103], v[156:159], v[196:199], v[100:103]
    ds_read_b128 v[136:139], v237 offset:20480
    v_mfma_f32_16x16x32_bf16 v[76:79], v[160:163], v[192:195], v[76:79]
    v_mfma_f32_16x16x32_bf16 v[104:107], v[160:163], v[196:199], v[104:107]
    v_mfma_f32_16x16x32_bf16 v[80:83], v[164:167], v[192:195], v[80:83]
    buffer_load_dwordx4 v[192:195], v1, s[8:11], s54 offen offset:2048 sc1
    v_mfma_f32_16x16x32_bf16 v[108:111], v[164:167], v[196:199], v[108:111]
    buffer_load_dwordx4 v[196:199], v1, s[8:11], s55 offen offset:2048 sc1
    s_waitcnt vmcnt(11) lgkmcnt(0)
    v_mfma_f32_16x16x32_bf16 v[56:59], v[112:115], v[200:203], v[56:59]
    ds_read_b128 v[140:143], v237 offset:21504
    v_mfma_f32_16x16x32_bf16 v[84:87], v[112:115], v[204:207], v[84:87]
    ds_read_b128 v[144:147], v237 offset:22528
    v_mfma_f32_16x16x32_bf16 v[60:63], v[116:119], v[200:203], v[60:63]
    buffer_load_dword v29, v239, s[4:7], s59 offen offset:0 sc1
    v_mfma_f32_16x16x32_bf16 v[88:91], v[116:119], v[204:207], v[88:91]
    ds_read_b128 v[148:151], v237 offset:23552
    v_mfma_f32_16x16x32_bf16 v[64:67], v[120:123], v[200:203], v[64:67]
    ds_read_b128 v[152:155], v237 offset:24576
    v_mfma_f32_16x16x32_bf16 v[92:95], v[120:123], v[204:207], v[92:95]
    buffer_load_dwordx4 v1, s[4:7], s21 offen offset:2048 sc1 lds
    v_mfma_f32_16x16x32_bf16 v[68:71], v[124:127], v[200:203], v[68:71]
    ds_read_b128 v[156:159], v237 offset:25600
    v_mfma_f32_16x16x32_bf16 v[96:99], v[124:127], v[204:207], v[96:99]
    ds_read_b128 v[160:163], v237 offset:26624
    v_mfma_f32_16x16x32_bf16 v[72:75], v[128:131], v[200:203], v[72:75]
    buffer_load_dwordx4 v1, s[4:7], s21 offen offset:3072 sc1 lds
    v_mfma_f32_16x16x32_bf16 v[100:103], v[128:131], v[204:207], v[100:103]
    ds_read_b128 v[164:167], v237 offset:27648
    v_mfma_f32_16x16x32_bf16 v[76:79], v[132:135], v[200:203], v[76:79]
    v_mfma_f32_16x16x32_bf16 v[104:107], v[132:135], v[204:207], v[104:107]
    v_mfma_f32_16x16x32_bf16 v[80:83], v[136:139], v[200:203], v[80:83]
    buffer_load_dwordx4 v[200:203], v1, s[8:11], s54 offen offset:3072 sc1
    v_mfma_f32_16x16x32_bf16 v[108:111], v[136:139], v[204:207], v[108:111]
    buffer_load_dwordx4 v[204:207], v1, s[8:11], s55 offen offset:3072 sc1
    s_waitcnt vmcnt(13) lgkmcnt(0)
    v_mfma_f32_16x16x32_bf16 v[56:59], v[140:143], v[208:211], v[56:59]
    ds_read_b128 v[112:115], v237 offset:28672
    v_mfma_f32_16x16x32_bf16 v[84:87], v[140:143], v[212:215], v[84:87]
    ds_read_b128 v[116:119], v237 offset:29696
    v_mfma_f32_16x16x32_bf16 v[60:63], v[144:147], v[208:211], v[60:63]
    s_lshl_b32 s64, s47, 6
    s_add_u32 s64, s64, 262144
    buffer_load_dwordx2 v[228:229], v9, s[4:7], s64 offen offset:0 sc1
    s_add_u32 s64, s64, 7168
    buffer_load_dwordx2 v[230:231], v9, s[4:7], s64 offen offset:0 sc1
    s_add_u32 s64, s64, 7168
    buffer_load_dwordx2 v[232:233], v9, s[4:7], s64 offen offset:0 sc1
    s_add_u32 s64, s64, 7168
    buffer_load_dwordx2 v[234:235], v9, s[4:7], s64 offen offset:0 sc1
    v_mfma_f32_16x16x32_bf16 v[88:91], v[144:147], v[212:215], v[88:91]
    ds_read_b128 v[120:123], v237 offset:30720
    v_mfma_f32_16x16x32_bf16 v[64:67], v[148:151], v[208:211], v[64:67]
    ds_read_b128 v[124:127], v237 offset:31744
    v_mfma_f32_16x16x32_bf16 v[92:95], v[148:151], v[212:215], v[92:95]
    s_add_u32 m0, s22, 115712
    s_add_u32 s21, s21, 16384
    buffer_load_dwordx4 v1, s[4:7], s21 offen offset:0 sc1 lds
    v_mfma_f32_16x16x32_bf16 v[68:71], v[152:155], v[208:211], v[68:71]
    ds_read_b128 v[128:131], v237 offset:32768
    v_mfma_f32_16x16x32_bf16 v[96:99], v[152:155], v[212:215], v[96:99]
    ds_read_b128 v[132:135], v237 offset:33792
    v_mfma_f32_16x16x32_bf16 v[72:75], v[156:159], v[208:211], v[72:75]
    buffer_load_dwordx4 v1, s[4:7], s21 offen offset:1024 sc1 lds
    v_mfma_f32_16x16x32_bf16 v[100:103], v[156:159], v[212:215], v[100:103]
    ds_read_b128 v[136:139], v237 offset:34816
    v_mfma_f32_16x16x32_bf16 v[76:79], v[160:163], v[208:211], v[76:79]
    v_mfma_f32_16x16x32_bf16 v[104:107], v[160:163], v[212:215], v[104:107]
    v_mfma_f32_16x16x32_bf16 v[80:83], v[164:167], v[208:211], v[80:83]
    s_add_u32 s54, s54, 4096
    buffer_load_dwordx4 v[208:211], v1, s[8:11], s54 offen offset:0 sc1
    v_mfma_f32_16x16x32_bf16 v[108:111], v[164:167], v[212:215], v[108:111]
    s_add_u32 s55, s55, 4096
    buffer_load_dwordx4 v[212:215], v1, s[8:11], s55 offen offset:0 sc1
    s_waitcnt vmcnt(19) lgkmcnt(0)
    v_mfma_f32_16x16x32_bf16 v[56:59], v[112:115], v[216:219], v[56:59]
    ds_read_b128 v[140:143], v237 offset:35840
    v_mfma_f32_16x16x32_bf16 v[84:87], v[112:115], v[220:223], v[84:87]
    ds_read_b128 v[144:147], v237 offset:36864
    v_mfma_f32_16x16x32_bf16 v[60:63], v[116:119], v[216:219], v[60:63]
    buffer_load_dwordx4 v1, s[4:7], s21 offen offset:2048 sc1 lds
    v_mfma_f32_16x16x32_bf16 v[88:91], v[116:119], v[220:223], v[88:91]
    ds_read_b128 v[148:151], v237 offset:37888
    v_mfma_f32_16x16x32_bf16 v[64:67], v[120:123], v[216:219], v[64:67]
    ds_read_b128 v[152:155], v237 offset:38912
    v_mfma_f32_16x16x32_bf16 v[92:95], v[120:123], v[220:223], v[92:95]
    buffer_load_dwordx4 v1, s[4:7], s21 offen offset:3072 sc1 lds
    v_mfma_f32_16x16x32_bf16 v[68:71], v[124:127], v[216:219], v[68:71]
    ds_read_b128 v[156:159], v237 offset:39936
    v_mfma_f32_16x16x32_bf16 v[96:99], v[124:127], v[220:223], v[96:99]
    ds_read_b128 v[160:163], v237 offset:40960
    v_mfma_f32_16x16x32_bf16 v[72:75], v[128:131], v[216:219], v[72:75]
    v_mfma_f32_16x16x32_bf16 v[100:103], v[128:131], v[220:223], v[100:103]
    ds_read_b128 v[164:167], v237 offset:41984
    v_mfma_f32_16x16x32_bf16 v[76:79], v[132:135], v[216:219], v[76:79]
    v_mfma_f32_16x16x32_bf16 v[104:107], v[132:135], v[220:223], v[104:107]
    v_mfma_f32_16x16x32_bf16 v[80:83], v[136:139], v[216:219], v[80:83]
    buffer_load_dwordx4 v[216:219], v1, s[8:11], s54 offen offset:1024 sc1
    v_mfma_f32_16x16x32_bf16 v[108:111], v[136:139], v[220:223], v[108:111]
    buffer_load_dwordx4 v[220:223], v1, s[8:11], s55 offen offset:1024 sc1
    s_waitcnt vmcnt(14)
    s_barrier
    s_waitcnt lgkmcnt(0)
    v_mfma_f32_16x16x32_bf16 v[56:59], v[140:143], v[184:187], v[56:59]
    ds_read_b128 v[112:115], v237 offset:43008
    v_mfma_f32_16x16x32_bf16 v[84:87], v[140:143], v[188:191], v[84:87]
    ds_read_b128 v[116:119], v237 offset:44032
    v_mfma_f32_16x16x32_bf16 v[60:63], v[144:147], v[184:187], v[60:63]
    v_sub_u32_e64 v29, v29, v15
    v_cmp_ne_u32 vcc, 3, v29
    s_nop 0
    s_and_b32 vcc_hi, vcc_lo, 65535
    s_cbranch_scc0 L_stok_112
L_poll_113:
    buffer_load_dword v29, v239, s[4:7], s59 offen offset:0 sc1
    s_waitcnt vmcnt(0)
    v_sub_u32_e64 v29, v29, v15
    v_cmp_ne_u32 vcc, 3, v29
    s_nop 0
    s_and_b32 vcc_hi, vcc_lo, 65535
    s_cbranch_scc0 L_polled_114
    s_sub_u32 s44, s44, 1
    s_cbranch_scc0 L_poll_113
    s_mov_b32 s44, 0
L_polled_114:
L_stok_112:
    buffer_load_dwordx2 v[176:177], v9, s[4:7], s56 offen offset:0 sc1
    buffer_load_dwordx2 v[178:179], v9, s[4:7], s56 offen offset:512 sc1
    buffer_load_dwordx2 v[180:181], v9, s[4:7], s57 offen offset:0 sc1
    buffer_load_dwordx2 v[182:183], v9, s[4:7], s57 offen offset:512 sc1
    v_add_u32_e64 v0, 4, v15
    v_mfma_f32_16x16x32_bf16 v[88:91], v[144:147], v[188:191], v[88:91]
    ds_read_b128 v[120:123], v237 offset:45056
    v_mfma_f32_16x16x32_bf16 v[64:67], v[148:151], v[184:187], v[64:67]
    ds_read_b128 v[124:127], v237 offset:46080
    v_mfma_f32_16x16x32_bf16 v[92:95], v[148:151], v[188:191], v[92:95]
    s_add_u32 m0, s22, 132096
    s_add_u32 s21, s21, 16384
    buffer_load_dwordx4 v1, s[4:7], s21 offen offset:0 sc1 lds
    v_mfma_f32_16x16x32_bf16 v[68:71], v[152:155], v[184:187], v[68:71]
    ds_read_b128 v[128:131], v237 offset:47104
    v_mfma_f32_16x16x32_bf16 v[96:99], v[152:155], v[188:191], v[96:99]
    ds_read_b128 v[132:135], v237 offset:48128
    v_mfma_f32_16x16x32_bf16 v[72:75], v[156:159], v[184:187], v[72:75]
    buffer_load_dwordx4 v1, s[4:7], s21 offen offset:1024 sc1 lds
    v_mfma_f32_16x16x32_bf16 v[100:103], v[156:159], v[188:191], v[100:103]
    ds_read_b128 v[136:139], v238 offset:0
    v_mfma_f32_16x16x32_bf16 v[76:79], v[160:163], v[184:187], v[76:79]
    v_mfma_f32_16x16x32_bf16 v[104:107], v[160:163], v[188:191], v[104:107]
    v_mfma_f32_16x16x32_bf16 v[80:83], v[164:167], v[184:187], v[80:83]
    buffer_load_dwordx4 v[184:187], v1, s[8:11], s54 offen offset:2048 sc1
    v_mfma_f32_16x16x32_bf16 v[108:111], v[164:167], v[188:191], v[108:111]
    buffer_load_dwordx4 v[188:191], v1, s[8:11], s55 offen offset:2048 sc1
    s_waitcnt lgkmcnt(0)
    v_mfma_f32_16x16x32_bf16 v[56:59], v[112:115], v[192:195], v[56:59]
    ds_read_b128 v[140:143], v238 offset:1024
    v_mfma_f32_16x16x32_bf16 v[84:87], v[112:115], v[196:199], v[84:87]
    ds_read_b128 v[144:147], v238 offset:2048
    v_mfma_f32_16x16x32_bf16 v[60:63], v[116:119], v[192:195], v[60:63]
    buffer_load_dwordx4 v1, s[4:7], s21 offen offset:2048 sc1 lds
    v_mfma_f32_16x16x32_bf16 v[88:91], v[116:119], v[196:199], v[88:91]
    ds_read_b128 v[148:151], v238 offset:3072
    v_mfma_f32_16x16x32_bf16 v[64:67], v[120:123], v[192:195], v[64:67]
    ds_read_b128 v[152:155], v238 offset:4096
    v_mfma_f32_16x16x32_bf16 v[92:95], v[120:123], v[196:199], v[92:95]
    buffer_load_dwordx4 v1, s[4:7], s21 offen offset:3072 sc1 lds
    v_mfma_f32_16x16x32_bf16 v[68:71], v[124:127], v[192:195], v[68:71]
    ds_read_b128 v[156:159], v238 offset:5120
    v_mfma_f32_16x16x32_bf16 v[96:99], v[124:127], v[196:199], v[96:99]
    ds_read_b128 v[160:163], v238 offset:6144
    v_mfma_f32_16x16x32_bf16 v[72:75], v[128:131], v[192:195], v[72:75]
    v_mfma_f32_16x16x32_bf16 v[100:103], v[128:131], v[196:199], v[100:103]
    ds_read_b128 v[164:167], v238 offset:7168
    v_mfma_f32_16x16x32_bf16 v[76:79], v[132:135], v[192:195], v[76:79]
    v_mfma_f32_16x16x32_bf16 v[104:107], v[132:135], v[196:199], v[104:107]
    v_mfma_f32_16x16x32_bf16 v[80:83], v[136:139], v[192:195], v[80:83]
    buffer_load_dwordx4 v[192:195], v1, s[8:11], s54 offen offset:3072 sc1
    v_mfma_f32_16x16x32_bf16 v[108:111], v[136:139], v[196:199], v[108:111]
    buffer_load_dwordx4 v[196:199], v1, s[8:11], s55 offen offset:3072 sc1
    s_waitcnt vmcnt(24) lgkmcnt(0)
    v_mfma_f32_16x16x32_bf16 v[56:59], v[140:143], v[200:203], v[56:59]
    ds_read_b128 v[112:115], v238 offset:8192
    v_mfma_f32_16x16x32_bf16 v[84:87], v[140:143], v[204:207], v[84:87]
    ds_read_b128 v[116:119], v238 offset:9216
    v_mfma_f32_16x16x32_bf16 v[60:63], v[144:147], v[200:203], v[60:63]
    s_add_u32 m0, s22, 50176
    s_add_u32 s21, s21, 16384
    buffer_load_dwordx4 v1, s[4:7], s21 offen offset:0 sc1 lds
    v_mfma_f32_16x16x32_bf16 v[88:91], v[144:147], v[204:207], v[88:91]
    ds_read_b128 v[120:123], v238 offset:10240
    v_mfma_f32_16x16x32_bf16 v[64:67], v[148:151], v[200:203], v[64:67]
    ds_read_b128 v[124:127], v238 offset:11264
    v_mfma_f32_16x16x32_bf16 v[92:95], v[148:151], v[204:207], v[92:95]
    buffer_load_dwordx4 v1, s[4:7], s21 offen offset:1024 sc1 lds
    v_mfma_f32_16x16x32_bf16 v[68:71], v[152:155], v[200:203], v[68:71]
    ds_read_b128 v[128:131], v238 offset:12288
    v_mfma_f32_16x16x32_bf16 v[96:99], v[152:155], v[204:207], v[96:99]
    ds_read_b128 v[132:135], v238 offset:13312
    v_mfma_f32_16x16x32_bf16 v[72:75], v[156:159], v[200:203], v[72:75]
    v_mfma_f32_16x16x32_bf16 v[100:103], v[156:159], v[204:207], v[100:103]
    ds_read_b128 v[136:139], v238 offset:14336
    v_mfma_f32_16x16x32_bf16 v[76:79], v[160:163], v[200:203], v[76:79]
    v_mfma_f32_16x16x32_bf16 v[104:107], v[160:163], v[204:207], v[104:107]
    v_mfma_f32_16x16x32_bf16 v[80:83], v[164:167], v[200:203], v[80:83]
    s_add_u32 s54, s54, 4096
    buffer_load_dwordx4 v[200:203], v1, s[8:11], s54 offen offset:0 sc1
    v_mfma_f32_16x16x32_bf16 v[108:111], v[164:167], v[204:207], v[108:111]
    s_add_u32 s55, s55, 4096
    buffer_load_dwordx4 v[204:207], v1, s[8:11], s55 offen offset:0 sc1
    s_waitcnt vmcnt(18)
    s_barrier
    s_waitcnt lgkmcnt(0)
    v_mfma_f32_16x16x32_bf16 v[56:59], v[112:115], v[208:211], v[56:59]
    s_branch L_over_452
L_chain0_3_2:
    s_branch L_chainret0
L_over_452:
    ds_read_b128 v[140:143], v238 offset:15360
    v_mfma_f32_16x16x32_bf16 v[84:87], v[112:115], v[212:215], v[84:87]
    ds_read_b128 v[144:147], v238 offset:16384
    v_add_f32 v228, v228, v230
    v_add_f32_e64 v229, v229, v231
    v_mfma_f32_16x16x32_bf16 v[60:63], v[116:119], v[208:211], v[60:63]
    buffer_load_dwordx4 v1, s[4:7], s21 offen offset:2048 sc1 lds
    v_mfma_f32_16x16x32_bf16 v[88:91], v[116:119], v[212:215], v[88:91]
    ds_read_b128 v[148:151], v238 offset:17408
    v_add_f32 v228, v228, v232
    v_add_f32 v229, v229, v233
    v_mfma_f32_16x16x32_bf16 v[64:67], v[120:123], v[208:211], v[64:67]
    ds_read_b128 v[152:155], v238 offset:18432
    v_add_f32 v228, v228, v234
    v_add_f32 v229, v229, v235
    v_mfma_f32_16x16x32_bf16 v[92:95], v[120:123], v[212:215], v[92:95]
    buffer_load_dwordx4 v1, s[4:7], s21 offen offset:3072 sc1 lds
    v_mfma_f32_16x16x32_bf16 v[68:71], v[124:127], v[208:211], v[68:71]
    ds_read_b128 v[156:159], v238 offset:19456
    ds_write_b64 v9, v[228:229] offset:256
    v_mfma_f32_16x16x32_bf16 v[96:99], v[124:127], v[212:215], v[96:99]
    ds_read_b128 v[160:163], v238 offset:20480
    s_waitcnt vmcnt(14)
    v_mfma_f32_16x16x32_bf16 v[72:75], v[128:131], v[208:211], v[72:75]
    v_add_f32 v176, v176, v178
    v_add_f32_e64 v177, v177, v179
    s_nop 1
    v_permlane16_swap_b32 v176, v177
    v_mfma_f32_16x16x32_bf16 v[100:103], v[128:131], v[212:215], v[100:103]
    ds_read_b128 v[164:167], v238 offset:21504
    v_add_f32_e64 v176, v176, v177
    v_mfma_f32_16x16x32_bf16 v[76:79], v[132:135], v[208:211], v[76:79]
    v_mov_b32_e64 v177, v176
    s_nop 1
    v_permlane32_swap_b32 v176, v177
    v_mfma_f32_16x16x32_bf16 v[104:107], v[132:135], v[212:215], v[104:107]
    v_add_f32 v176, v176, v177
    v_mov_b32 v177, v176
    v_mfma_f32_16x16x32_bf16 v[80:83], v[136:139], v[208:211], v[80:83]
    buffer_load_dwordx4 v[208:211], v1, s[8:11], s54 offen offset:1024 sc1
    v_mfma_f32_16x16x32_bf16 v[108:111], v[136:139], v[212:215], v[108:111]
    buffer_load_dwordx4 v[212:215], v1, s[8:11], s55 offen offset:1024 sc1
    s_waitcnt lgkmcnt(0)
    v_mfma_f32_16x16x32_bf16 v[56:59], v[140:143], v[216:219], v[56:59]
    ds_read_b128 v[112:115], v238 offset:22528
    v_permlane16_swap_b32 v176, v177
    v_mfma_f32_16x16x32_bf16 v[84:87], v[140:143], v[220:223], v[84:87]
    ds_read_b128 v[116:119], v238 offset:23552
    v_mul_f32 v168, 0xbacccccd, v176
    v_mfma_f32_16x16x32_bf16 v[60:63], v[144:147], v[216:219], v[60:63]
    buffer_load_dword v28, v239, s[4:7], s65 offen offset:0 sc1
    s_add_u32 m0, s22, 66560
    s_add_u32 s21, s21, 16384
    buffer_load_dwordx4 v1, s[4:7], s21 offen offset:0 sc1 lds
    v_mfma_f32_16x16x32_bf16 v[88:91], v[144:147], v[220:223], v[88:91]
    ds_read_b128 v[120:123], v238 offset:24576
    v_mul_f32 v177, 0x3acccccd, v177
    v_mfma_f32_16x16x32_bf16 v[64:67], v[148:151], v[216:219], v[64:67]
    ds_read_b128 v[124:127], v238 offset:25600
    v_fma_f32 v177, -v168, v168, v177
    v_mfma_f32_16x16x32_bf16 v[92:95], v[148:151], v[220:223], v[92:95]
    buffer_load_dwordx4 v1, s[4:7], s21 offen offset:1024 sc1 lds
    v_mfma_f32_16x16x32_bf16 v[68:71], v[152:155], v[216:219], v[68:71]
    ds_read_b128 v[128:131], v238 offset:26624
    v_max_f32_e64 v177, 0, v177
    v_mfma_f32_16x16x32_bf16 v[96:99], v[152:155], v[220:223], v[96:99]
    ds_read_b128 v[132:135], v238 offset:27648
    v_add_f32 v177, 0x3727c5ac, v177
    v_mfma_f32_16x16x32_bf16 v[72:75], v[156:159], v[216:219], v[72:75]
    s_add_u32 s20, s20, 51200
    buffer_load_dwordx4 a[212:215], v1, s[4:7], s20 offen offset:0 sc1
    v_mfma_f32_16x16x32_bf16 v[100:103], v[156:159], v[220:223], v[100:103]
    ds_read_b128 v[136:139], v238 offset:28672
    v_rsq_f32_e64 v178, v177
    v_mfma_f32_16x16x32_bf16 v[76:79], v[160:163], v[216:219], v[76:79]
    v_mul_f32 v169, 0xbfb8aa3b, v178
    v_mul_f32_e64 v170, v177, v178
    v_mfma_f32_16x16x32_bf16 v[104:107], v[160:163], v[220:223], v[104:107]
    v_add_f32 v180, v180, v182
    v_add_f32 v181, v181, v183
    s_nop 1
    v_permlane16_swap_b32 v180, v181
    v_mfma_f32_16x16x32_bf16 v[80:83], v[164:167], v[216:219], v[80:83]
    buffer_load_dwordx4 v[216:219], v1, s[8:11], s54 offen offset:2048 sc1
    v_mfma_f32_16x16x32_bf16 v[108:111], v[164:167], v[220:223], v[108:111]
    buffer_load_dwordx4 v[220:223], v1, s[8:11], s55 offen offset:2048 sc1
    s_waitcnt vmcnt(16)
    s_barrier
    s_waitcnt lgkmcnt(0)
    v_mfma_f32_16x16x32_bf16 v[56:59], v[112:115], v[184:187], v[56:59]
    ds_read_b128 v[140:143], v238 offset:29696
    v_add_f32 v180, v180, v181
    v_mfma_f32_16x16x32_bf16 v[84:87], v[112:115], v[188:191], v[84:87]
    ds_read_b128 v[144:147], v238 offset:30720
    v_mov_b32_e64 v181, v180
    v_mfma_f32_16x16x32_bf16 v[60:63], v[116:119], v[184:187], v[60:63]
    buffer_load_dwordx4 v1, s[4:7], s21 offen offset:2048 sc1 lds
    v_mfma_f32_16x16x32_bf16 v[88:91], v[116:119], v[188:191], v[88:91]
    ds_read_b128 v[148:151], v238 offset:31744
    v_permlane32_swap_b32 v180, v181
    v_mfma_f32_16x16x32_bf16 v[64:67], v[120:123], v[184:187], v[64:67]
    ds_read_b128 v[152:155], v238 offset:32768
    v_add_f32 v180, v180, v181
    v_mfma_f32_16x16x32_bf16 v[92:95], v[120:123], v[188:191], v[92:95]
    buffer_load_dwordx4 v1, s[4:7], s21 offen offset:3072 sc1 lds
    v_mfma_f32_16x16x32_bf16 v[68:71], v[124:127], v[184:187], v[68:71]
    ds_read_b128 v[156:159], v238 offset:33792
    v_mov_b32_e64 v181, v180
    v_mfma_f32_16x16x32_bf16 v[96:99], v[124:127], v[188:191], v[96:99]
    ds_read_b128 v[160:163], v238 offset:34816
    v_permlane16_swap_b32 v180, v181
    v_mfma_f32_16x16x32_bf16 v[72:75], v[128:131], v[184:187], v[72:75]
    buffer_load_dwordx4 a[216:219], v1, s[4:7], s20 offen offset:1024 sc1
    v_mfma_f32_16x16x32_bf16 v[100:103], v[128:131], v[188:191], v[100:103]
    ds_read_b128 v[164:167], v238 offset:35840
    v_mul_f32 v172, 0xbacccccd, v180
    v_mfma_f32_16x16x32_bf16 v[76:79], v[132:135], v[184:187], v[76:79]
    v_mul_f32 v181, 0x3acccccd, v181
    v_fma_f32 v181, -v172, v172, v181
    v_mfma_f32_16x16x32_bf16 v[104:107], v[132:135], v[188:191], v[104:107]
    v_max_f32 v181, 0, v181
    v_add_f32 v181, 0x3727c5ac, v181
    v_mfma_f32_16x16x32_bf16 v[80:83], v[136:139], v[184:187], v[80:83]
    buffer_load_dwordx4 v[184:187], v1, s[8:11], s54 offen offset:3072 sc1
    v_mfma_f32_16x16x32_bf16 v[108:111], v[136:139], v[188:191], v[108:111]
    buffer_load_dwordx4 v[188:191], v1, s[8:11], s55 offen offset:3072 sc1
    s_waitcnt vmcnt(19) lgkmcnt(0)
    v_mfma_f32_16x16x32_bf16 v[56:59], v[140:143], v[192:195], v[56:59]
    ds_read_b128 v[112:115], v238 offset:36864
    v_rsq_f32 v182, v181
    v_mfma_f32_16x16x32_bf16 v[84:87], v[140:143], v[196:199], v[84:87]
    ds_read_b128 v[116:119], v238 offset:37888
    v_mul_f32 v173, 0xbfb8aa3b, v182
    v_mfma_f32_16x16x32_bf16 v[60:63], v[144:147], v[192:195], v[60:63]
    s_add_u32 m0, s22, 82944
    s_add_u32 s21, s21, 16384
    buffer_load_dwordx4 v25, s[4:7], s21 offen offset:0 sc1 lds
    v_mfma_f32_16x16x32_bf16 v[88:91], v[144:147], v[196:199], v[88:91]
    ds_read_b128 v[120:123], v238 offset:38912
    v_mul_f32_e64 v174, v181, v182
    v_mfma_f32_16x16x32_bf16 v[64:67], v[148:151], v[192:195], v[64:67]
    ds_read_b128 v[124:127], v238 offset:39936
    v_mfma_f32_16x16x32_bf16 v[92:95], v[148:151], v[196:199], v[92:95]
    buffer_load_dwordx4 v25, s[4:7], s21 offen offset:1024 sc1 lds
    v_mfma_f32_16x16x32_bf16 v[68:71], v[152:155], v[192:195], v[68:71]
    ds_read_b128 v[128:131], v238 offset:40960
    v_mfma_f32_16x16x32_bf16 v[96:99], v[152:155], v[196:199], v[96:99]
    ds_read_b128 v[132:135], v238 offset:41984
    v_mfma_f32_16x16x32_bf16 v[72:75], v[156:159], v[192:195], v[72:75]
    ds_read_b128 v[240:243], v22 offset:256
    v_mfma_f32_16x16x32_bf16 v[100:103], v[156:159], v[196:199], v[100:103]
    ds_read_b128 v[136:139], v238 offset:43008
    v_mfma_f32_16x16x32_bf16 v[76:79], v[160:163], v[192:195], v[76:79]
    v_mfma_f32_16x16x32_bf16 v[104:107], v[160:163], v[196:199], v[104:107]
    v_mfma_f32_16x16x32_bf16 v[80:83], v[164:167], v[192:195], v[80:83]
    s_add_u32 s54, s54, 4096
    buffer_load_dwordx4 v[192:195], v1, s[8:11], s54 offen offset:0 sc1
    v_mfma_f32_16x16x32_bf16 v[108:111], v[164:167], v[196:199], v[108:111]
    s_add_u32 s55, s55, 4096
    buffer_load_dwordx4 v[196:199], v1, s[8:11], s55 offen offset:0 sc1
    s_waitcnt vmcnt(17)
    s_barrier
    s_waitcnt lgkmcnt(0)
    v_mfma_f32_16x16x32_bf16 v[56:59], v[112:115], v[200:203], v[56:59]
    ds_read_b128 v[140:143], v238 offset:44032
    v_mfma_f32_16x16x32_bf16 v[84:87], v[112:115], v[204:207], v[84:87]
    ds_read_b128 v[144:147], v238 offset:45056
    v_mfma_f32_16x16x32_bf16 v[60:63], v[116:119], v[200:203], v[60:63]
    buffer_load_dwordx4 v25, s[4:7], s21 offen offset:2048 sc1 lds
    v_mfma_f32_16x16x32_bf16 v[88:91], v[116:119], v[204:207], v[88:91]
    ds_read_b128 v[148:151], v238 offset:46080
    v_mfma_f32_16x16x32_bf16 v[64:67], v[120:123], v[200:203], v[64:67]
    ds_read_b128 v[152:155], v238 offset:47104
    v_mfma_f32_16x16x32_bf16 v[92:95], v[120:123], v[204:207], v[92:95]
    buffer_load_dwordx4 v25, s[4:7], s21 offen offset:3072 sc1 lds
    v_fmac_f32 v56, v240, v168
    v_mfma_f32_16x16x32_bf16 v[68:71], v[124:127], v[200:203], v[68:71]
    ds_read_b128 v[156:159], v238 offset:48128
    v_fmac_f32_e64 v57, v241, v168
    v_mfma_f32_16x16x32_bf16 v[96:99], v[124:127], v[204:207], v[96:99]
    ds_read_b128 v[160:163], v237 offset:0
    v_fmac_f32_e64 v58, v242, v168
    v_mfma_f32_16x16x32_bf16 v[72:75], v[128:131], v[200:203], v[72:75]
    buffer_load_dwordx4 a[220:223], v1, s[4:7], s20 offen offset:2048 sc1
    v_fmac_f32_e64 v59, v243, v168
    ds_read_b128 v[244:247], v22 offset:320
    v_mfma_f32_16x16x32_bf16 v[100:103], v[128:131], v[204:207], v[100:103]
    ds_read_b128 v[164:167], v237 offset:1024
    v_fmac_f32_e64 v84, v240, v172
    v_mfma_f32_16x16x32_bf16 v[76:79], v[132:135], v[200:203], v[76:79]
    v_fmac_f32_e64 v85, v241, v172
    v_mfma_f32_16x16x32_bf16 v[104:107], v[132:135], v[204:207], v[104:107]
    v_fmac_f32_e64 v86, v242, v172
    v_mfma_f32_16x16x32_bf16 v[80:83], v[136:139], v[200:203], v[80:83]
    buffer_load_dwordx4 v[200:203], v1, s[8:11], s54 offen offset:1024 sc1
    v_fmac_f32_e64 v87, v243, v172
    v_mfma_f32_16x16x32_bf16 v[108:111], v[136:139], v[204:207], v[108:111]
    buffer_load_dwordx4 v[204:207], v1, s[8:11], s55 offen offset:1024 sc1
    s_waitcnt vmcnt(20) lgkmcnt(0)
    v_mfma_f32_16x16x32_bf16 v[56:59], v[140:143], v[208:211], v[56:59]
    ds_read_b128 v[112:115], v237 offset:2048
    v_mfma_f32_16x16x32_bf16 v[84:87], v[140:143], v[212:215], v[84:87]
    ds_read_b128 v[116:119], v237 offset:3072
    v_mfma_f32_16x16x32_bf16 v[60:63], v[144:147], v[208:211], v[60:63]
    buffer_load_dwordx4 a[224:227], v1, s[4:7], s20 offen offset:3072 sc1
    v_mfma_f32_16x16x32_bf16 v[88:91], v[144:147], v[212:215], v[88:91]
    ds_read_b128 v[120:123], v237 offset:4096
    v_mfma_f32_16x16x32_bf16 v[64:67], v[148:151], v[208:211], v[64:67]
    ds_read_b128 v[124:127], v237 offset:5120
    v_mfma_f32_16x16x32_bf16 v[92:95], v[148:151], v[212:215], v[92:95]
    v_mfma_f32_16x16x32_bf16 v[68:71], v[152:155], v[208:211], v[68:71]
    ds_read_b128 v[128:131], v237 offset:6144
    v_mfma_f32_16x16x32_bf16 v[96:99], v[152:155], v[212:215], v[96:99]
    ds_read_b128 v[132:135], v237 offset:7168
    v_fmac_f32 v60, v244, v168
    v_mfma_f32_16x16x32_bf16 v[72:75], v[156:159], v[208:211], v[72:75]
    v_fmac_f32_e64 v61, v245, v168
    ds_read_b128 v[240:243], v22 offset:384
    v_mfma_f32_16x16x32_bf16 v[100:103], v[156:159], v[212:215], v[100:103]
    ds_read_b128 v[136:139], v237 offset:8192
    v_fmac_f32_e64 v62, v246, v168
    v_mfma_f32_16x16x32_bf16 v[76:79], v[160:163], v[208:211], v[76:79]
    v_fmac_f32_e64 v63, v247, v168
    v_mfma_f32_16x16x32_bf16 v[104:107], v[160:163], v[212:215], v[104:107]
    v_fmac_f32_e64 v88, v244, v172
    v_mfma_f32_16x16x32_bf16 v[80:83], v[164:167], v[208:211], v[80:83]
    buffer_load_dwordx4 v[208:211], v1, s[8:11], s54 offen offset:2048 sc1
    v_fmac_f32_e64 v89, v245, v172
    v_mfma_f32_16x16x32_bf16 v[108:111], v[164:167], v[212:215], v[108:111]
    buffer_load_dwordx4 v[212:215], v1, s[8:11], s55 offen offset:2048 sc1
    v_fmac_f32 v90, v246, v172
    s_waitcnt vmcnt(17) lgkmcnt(0)
    v_mfma_f32_16x16x32_bf16 v[56:59], v[112:115], v[216:219], v[56:59]
    ds_read_b128 v[140:143], v237 offset:9216
    v_fmac_f32_e64 v91, v247, v172
    v_mfma_f32_16x16x32_bf16 v[84:87], v[112:115], v[220:223], v[84:87]
    ds_read_b128 v[144:147], v237 offset:10240
    v_mfma_f32_16x16x32_bf16 v[60:63], v[116:119], v[216:219], v[60:63]
    v_sub_u32 v28, v28, v15
    v_subrev_u32 v28, 2, v28
    v_cmp_lt_u32 vcc, 6, v28
    s_nop 0
    s_and_b32 vcc_hi, vcc_lo, 65535
    s_cbranch_scc0 L_stok_115
L_poll_116:
    buffer_load_dword v28, v239, s[4:7], s65 offen offset:0 sc1
    s_waitcnt vmcnt(0)
    v_sub_u32 v28, v28, v15
    v_subrev_u32 v28, 2, v28
    v_cmp_lt_u32 vcc, 6, v28
    s_nop 0
    s_and_b32 vcc_hi, vcc_lo, 65535
    s_cbranch_scc0 L_polled_117
    s_sub_u32 s44, s44, 1
    s_cbranch_scc0 L_poll_116
    s_mov_b32 s44, 0
L_polled_117:
L_stok_115:
    v_mfma_f32_16x16x32_bf16 v[88:91], v[116:119], v[220:223], v[88:91]
    ds_read_b128 v[148:151], v237 offset:11264
    v_mfma_f32_16x16x32_bf16 v[64:67], v[120:123], v[216:219], v[64:67]
    ds_read_b128 v[152:155], v237 offset:12288
    v_mfma_f32_16x16x32_bf16 v[92:95], v[120:123], v[220:223], v[92:95]
    v_mfma_f32_16x16x32_bf16 v[68:71], v[124:127], v[216:219], v[68:71]
    ds_read_b128 v[156:159], v237 offset:13312
    v_mfma_f32_16x16x32_bf16 v[96:99], v[124:127], v[220:223], v[96:99]
    ds_read_b128 v[160:163], v237 offset:14336
    v_mfma_f32_16x16x32_bf16 v[72:75], v[128:131], v[216:219], v[72:75]
    ds_read_b128 v[244:247], v22 offset:448
    v_mfma_f32_16x16x32_bf16 v[100:103], v[128:131], v[220:223], v[100:103]
    ds_read_b128 v[164:167], v237 offset:15360
    v_fmac_f32_e64 v64, v240, v168
    v_mfma_f32_16x16x32_bf16 v[76:79], v[132:135], v[216:219], v[76:79]
    v_fmac_f32_e64 v65, v241, v168
    v_mfma_f32_16x16x32_bf16 v[104:107], v[132:135], v[220:223], v[104:107]
    v_fmac_f32_e64 v66, v242, v168
    v_mfma_f32_16x16x32_bf16 v[80:83], v[136:139], v[216:219], v[80:83]
    buffer_load_dwordx4 v[216:219], v1, s[8:11], s54 offen offset:3072 sc1
    v_fmac_f32_e64 v67, v243, v168
    v_mfma_f32_16x16x32_bf16 v[108:111], v[136:139], v[220:223], v[108:111]
    buffer_load_dwordx4 v[220:223], v1, s[8:11], s55 offen offset:3072 sc1
    v_fmac_f32 v92, v240, v172
    s_waitcnt vmcnt(17)
    s_barrier
    s_waitcnt vmcnt(14) lgkmcnt(0)
    v_mfma_f32_16x16x32_bf16 v[56:59], v[140:143], v[184:187], v[56:59]
    ds_read_b128 v[112:115], v237 offset:16384
    v_fmac_f32_e64 v93, v241, v172
    v_mfma_f32_16x16x32_bf16 v[84:87], v[140:143], v[188:191], v[84:87]
    ds_read_b128 v[116:119], v237 offset:17408
    v_fmac_f32_e64 v94, v242, v172
    v_mfma_f32_16x16x32_bf16 v[60:63], v[144:147], v[184:187], v[60:63]
    s_add_u32 s20, s20, 4096
    buffer_load_dwordx4 a[228:231], v1, s[4:7], s20 offen offset:0 sc1
    v_fmac_f32_e64 v95, v243, v172
    v_mfma_f32_16x16x32_bf16 v[88:91], v[144:147], v[188:191], v[88:91]
    ds_read_b128 v[120:123], v237 offset:18432
    v_mfma_f32_16x16x32_bf16 v[64:67], v[148:151], v[184:187], v[64:67]
    ds_read_b128 v[124:127], v237 offset:19456
    v_mfma_f32_16x16x32_bf16 v[92:95], v[148:151], v[188:191], v[92:95]
    s_mul_i32 s66, s52, 27
    s_mul_i32 s65, s36, 7
    v_mfma_f32_16x16x32_bf16 v[68:71], v[152:155], v[184:187], v[68:71]
    ds_read_b128 v[128:131], v237 offset:20480
    v_mfma_f32_16x16x32_bf16 v[96:99], v[152:155], v[188:191], v[96:99]
    ds_read_b128 v[132:135], v237 offset:21504
    v_mfma_f32_16x16x32_bf16 v[72:75], v[156:159], v[184:187], v[72:75]
    s_add_u32 s66, s66, s65
    s_lshl_b32 s66, s66, 10
    ds_read_b128 v[240:243], v22 offset:512
    v_mfma_f32_16x16x32_bf16 v[100:103], v[156:159], v[188:191], v[100:103]
    ds_read_b128 v[136:139], v237 offset:22528
    v_mfma_f32_16x16x32_bf16 v[76:79], v[160:163], v[184:187], v[76:79]
    s_add_u32 s66, s66, s45
    s_add_u32 s66, s66, 360448
    v_mfma_f32_16x16x32_bf16 v[104:107], v[160:163], v[188:191], v[104:107]
    s_xor_b32 s65, s39, 1
    s_lshl_b32 s65, s65, 2
    v_fmac_f32 v68, v244, v168
    v_mfma_f32_16x16x32_bf16 v[80:83], v[164:167], v[184:187], v[80:83]
    s_add_u32 s58, s36, 1
    s_and_b32 s58, s58, 3
    v_fmac_f32_e64 v69, v245, v168
    v_mfma_f32_16x16x32_bf16 v[108:111], v[164:167], v[188:191], v[108:111]
    s_add_u32 s58, s58, s65
    s_mul_i32 s58, s58, 55296
    v_fmac_f32 v70, v246, v168
    s_waitcnt vmcnt(11) lgkmcnt(0)
    v_mfma_f32_16x16x32_bf16 v[56:59], v[112:115], v[192:195], v[56:59]
    ds_read_b128 v[140:143], v237 offset:23552
    v_fmac_f32 v71, v247, v168
    v_mfma_f32_16x16x32_bf16 v[84:87], v[112:115], v[196:199], v[84:87]
    ds_read_b128 v[144:147], v237 offset:24576
    v_fmac_f32_e64 v96, v244, v172
    v_mfma_f32_16x16x32_bf16 v[60:63], v[116:119], v[192:195], v[60:63]
    buffer_load_dwordx4 a[232:235], v1, s[4:7], s20 offen offset:1024 sc1
    v_fmac_f32_e64 v97, v245, v172
    v_mfma_f32_16x16x32_bf16 v[88:91], v[116:119], v[196:199], v[88:91]
    ds_read_b128 v[148:151], v237 offset:25600
    v_fmac_f32_e64 v98, v246, v172
    v_mfma_f32_16x16x32_bf16 v[64:67], v[120:123], v[192:195], v[64:67]
    ds_read_b128 v[152:155], v237 offset:26624
    v_fmac_f32_e64 v99, v247, v172
    v_mfma_f32_16x16x32_bf16 v[92:95], v[120:123], v[196:199], v[92:95]
    s_add_u32 s58, s58, s66
    s_add_u32 s59, s36, 2
    v_mfma_f32_16x16x32_bf16 v[68:71], v[124:127], v[192:195], v[68:71]
    ds_read_b128 v[156:159], v237 offset:27648
    v_mfma_f32_16x16x32_bf16 v[96:99], v[124:127], v[196:199], v[96:99]
    ds_read_b128 v[160:163], v237 offset:28672
    v_mfma_f32_16x16x32_bf16 v[72:75], v[128:131], v[192:195], v[72:75]
    s_and_b32 s59, s59, 3
    s_add_u32 s59, s59, s65
    ds_read_b128 v[244:247], v22 offset:576
    v_mfma_f32_16x16x32_bf16 v[100:103], v[128:131], v[196:199], v[100:103]
    ds_read_b128 v[164:167], v237 offset:29696
    v_mfma_f32_16x16x32_bf16 v[76:79], v[132:135], v[192:195], v[76:79]
    s_mul_i32 s59, s59, 55296
    s_add_u32 s59, s59, s66
    v_mfma_f32_16x16x32_bf16 v[104:107], v[132:135], v[196:199], v[104:107]
    s_add_u32 s60, s36, 3
    s_and_b32 s60, s60, 3
    v_mfma_f32_16x16x32_bf16 v[80:83], v[136:139], v[192:195], v[80:83]
    s_add_u32 s60, s60, s65
    s_mul_i32 s60, s60, 55296
    v_mfma_f32_16x16x32_bf16 v[108:111], v[136:139], v[196:199], v[108:111]
    s_add_u32 s60, s60, s66
    s_add_u32 s61, s36, 4
    v_fmac_f32 v72, v240, v168
    s_waitcnt vmcnt(10)
    s_barrier
    s_waitcnt vmcnt(7) lgkmcnt(0)
    v_mfma_f32_16x16x32_bf16 v[56:59], v[140:143], v[200:203], v[56:59]
    ds_read_b128 v[112:115], v237 offset:30720
    v_fmac_f32_e64 v73, v241, v168
    v_mfma_f32_16x16x32_bf16 v[84:87], v[140:143], v[204:207], v[84:87]
    ds_read_b128 v[116:119], v237 offset:31744
    v_fmac_f32_e64 v74, v242, v168
    v_mfma_f32_16x16x32_bf16 v[60:63], v[144:147], v[200:203], v[60:63]
    s_lshl_b32 s68, s38, 2
    s_add_u32 s68, s68, s36
    s_mul_i32 s68, s68, 6912
    s_add_u32 s68, s68, s45
    s_add_u32 s68, s68, 360448
    v_add_u32 v27, 10, v21
    v_lshrrev_b32_e64 v27, 6, v27
    v_lshl_add_u32 v27, v27, 28, v1
    v_lshlrev_b32_e64 v27, 3, v27
    buffer_load_dword a252, v27, s[4:7], s68 offen offset:0 sc1
    v_fmac_f32_e64 v75, v243, v168
    v_mfma_f32_16x16x32_bf16 v[88:91], v[144:147], v[204:207], v[88:91]
    ds_read_b128 v[120:123], v237 offset:32768
    v_fmac_f32_e64 v100, v240, v172
    v_mfma_f32_16x16x32_bf16 v[64:67], v[148:151], v[200:203], v[64:67]
    ds_read_b128 v[124:127], v237 offset:33792
    v_fmac_f32_e64 v101, v241, v172
    v_mfma_f32_16x16x32_bf16 v[92:95], v[148:151], v[204:207], v[92:95]
    s_and_b32 s61, s61, 3
    s_add_u32 s61, s61, s65
    v_fmac_f32_e64 v102, v242, v172
    v_mfma_f32_16x16x32_bf16 v[68:71], v[152:155], v[200:203], v[68:71]
    ds_read_b128 v[128:131], v237 offset:34816
    v_fmac_f32_e64 v103, v243, v172
    v_mfma_f32_16x16x32_bf16 v[96:99], v[152:155], v[204:207], v[96:99]
    ds_read_b128 v[132:135], v237 offset:35840
    v_mfma_f32_16x16x32_bf16 v[72:75], v[156:159], v[200:203], v[72:75]
    s_mul_i32 s61, s61, 55296
    s_add_u32 s61, s61, s66
    ds_read_b128 v[240:243], v22 offset:640
    v_mfma_f32_16x16x32_bf16 v[100:103], v[156:159], v[204:207], v[100:103]
    ds_read_b128 v[136:139], v237 offset:36864
    v_mfma_f32_16x16x32_bf16 v[76:79], v[160:163], v[200:203], v[76:79]
    s_mul_i32 s57, s52, 442368
    s_sub_u32 s57, s57, 225280
    v_mfma_f32_16x16x32_bf16 v[104:107], v[160:163], v[204:207], v[104:107]
    s_mul_i32 s64, s52, 163840
    s_sub_u32 s64, 81920, s64
    v_mfma_f32_16x16x32_bf16 v[80:83], v[164:167], v[200:203], v[80:83]
    s_add_u32 s64, s64, s34
    s_xor_b32 s65, s53, 128
    v_mfma_f32_16x16x32_bf16 v[108:111], v[164:167], v[204:207], v[108:111]
    s_and_b32 s66, s53, 4294967040
    s_and_b32 s56, s53, 4294967168
    s_waitcnt vmcnt(5) lgkmcnt(0)
    v_mfma_f32_16x16x32_bf16 v[56:59], v[112:115], v[208:211], v[56:59]
    ds_read_b128 v[140:143], v237 offset:37888
    v_mfma_f32_16x16x32_bf16 v[84:87], v[112:115], v[212:215], v[84:87]
    ds_read_b128 v[144:147], v237 offset:38912
    v_fmac_f32 v76, v244, v168
    v_mfma_f32_16x16x32_bf16 v[60:63], v[116:119], v[208:211], v[60:63]
    buffer_load_dwordx4 a[236:239], v25, s[4:7], s20 offen offset:2048 sc1
    v_fmac_f32_e64 v77, v245, v168
    v_mfma_f32_16x16x32_bf16 v[88:91], v[116:119], v[212:215], v[88:91]
    ds_read_b128 v[148:151], v237 offset:39936
    v_fmac_f32_e64 v78, v246, v168
    v_mfma_f32_16x16x32_bf16 v[64:67], v[120:123], v[208:211], v[64:67]
    ds_read_b128 v[152:155], v237 offset:40960
    v_fmac_f32_e64 v79, v247, v168
    v_mfma_f32_16x16x32_bf16 v[92:95], v[120:123], v[212:215], v[92:95]
    v_lshlrev_b32 v31, 2, v21
    v_fmac_f32 v104, v244, v172
    v_mfma_f32_16x16x32_bf16 v[68:71], v[124:127], v[208:211], v[68:71]
    ds_read_b128 v[156:159], v237 offset:41984
    v_fmac_f32_e64 v105, v245, v172
    v_mfma_f32_16x16x32_bf16 v[96:99], v[124:127], v[212:215], v[96:99]
    ds_read_b128 v[160:163], v237 offset:43008
    v_fmac_f32_e64 v106, v246, v172
    v_mfma_f32_16x16x32_bf16 v[72:75], v[128:131], v[208:211], v[72:75]
    v_fmac_f32_e64 v107, v247, v172
    v_mfma_f32_16x16x32_bf16 v[100:103], v[128:131], v[212:215], v[100:103]
    ds_read_b128 v[164:167], v237 offset:44032
    v_mfma_f32_16x16x32_bf16 v[76:79], v[132:135], v[208:211], v[76:79]
    v_mfma_f32_16x16x32_bf16 v[104:107], v[132:135], v[212:215], v[104:107]
    v_mfma_f32_16x16x32_bf16 v[80:83], v[136:139], v[208:211], v[80:83]
    v_mfma_f32_16x16x32_bf16 v[108:111], v[136:139], v[212:215], v[108:111]
    s_waitcnt vmcnt(4) lgkmcnt(0)
    v_mfma_f32_16x16x32_bf16 v[56:59], v[140:143], v[216:219], v[56:59]
    v_mfma_f32_16x16x32_bf16 v[84:87], v[140:143], v[220:223], v[84:87]
    v_mfma_f32_16x16x32_bf16 v[60:63], v[144:147], v[216:219], v[60:63]
    v_mfma_f32_16x16x32_bf16 v[88:91], v[144:147], v[220:223], v[88:91]
    s_nop 1
    v_fmac_f32_e64 v80, v240, v168
    v_mfma_f32_16x16x32_bf16 v[64:67], v[148:151], v[216:219], v[64:67]
    v_fmac_f32_e64 v81, v241, v168
    v_mfma_f32_16x16x32_bf16 v[92:95], v[148:151], v[220:223], v[92:95]
    v_fmac_f32_e64 v82, v242, v168
    v_mfma_f32_16x16x32_bf16 v[68:71], v[152:155], v[216:219], v[68:71]
    v_fmac_f32_e64 v83, v243, v168
    v_mfma_f32_16x16x32_bf16 v[96:99], v[152:155], v[220:223], v[96:99]
    v_fmac_f32_e64 v108, v240, v172
    v_mfma_f32_16x16x32_bf16 v[72:75], v[156:159], v[216:219], v[72:75]
    v_fmac_f32_e64 v109, v241, v172
    v_mfma_f32_16x16x32_bf16 v[100:103], v[156:159], v[220:223], v[100:103]
    v_fmac_f32_e64 v110, v242, v172
    v_mfma_f32_16x16x32_bf16 v[76:79], v[160:163], v[216:219], v[76:79]
    v_fmac_f32_e64 v111, v243, v172
    v_mfma_f32_16x16x32_bf16 v[104:107], v[160:163], v[220:223], v[104:107]
    v_mfma_f32_16x16x32_bf16 v[80:83], v[164:167], v[216:219], v[80:83]
    v_mfma_f32_16x16x32_bf16 v[108:111], v[164:167], v[220:223], v[108:111]
    s_waitcnt lgkmcnt(0)
    s_barrier
    s_cmp_eq_u32 s43, 0
    s_cbranch_scc1 L_safe_118
    s_and_b32 s67, s38, 3
    s_cmp_eq_u32 s67, 3
    s_cbranch_scc1 L_six_120
    v_pk_mul_f32 v[140:141], v[80:81], v[168:169] op_sel:[0,1] op_sel_hi:[1,1]
    v_pk_mul_f32 v[142:143], v[82:83], v[168:169] op_sel:[0,1] op_sel_hi:[1,1]
    v_exp_f32 v140, v140
    v_exp_f32 v141, v141
    v_exp_f32 v142, v142
    v_exp_f32_e64 v143, v143
    v_pk_fma_f32 v[140:141], v[140:141], v[170:171], v[170:171] op_sel_hi:[1,0,0]
    v_pk_fma_f32 v[142:143], v[142:143], v[170:171], v[170:171] op_sel_hi:[1,0,0]
    v_rcp_f32 v140, v140
    v_rcp_f32 v141, v141
    v_rcp_f32 v142, v142
    v_rcp_f32 v143, v143
    v_pk_mul_f32 v[80:81], v[80:81], v[140:141]
    v_pk_mul_f32 v[82:83], v[82:83], v[142:143]
    v_cvt_pk_bf16_f32 v156, v80, v81
    v_cvt_pk_bf16_f32 v158, v80, v81
    v_cvt_pk_bf16_f32 v157, v82, v83
    v_cvt_pk_bf16_f32 v159, v82, v83
    v_permlane16_swap_b32 v156, v158
    s_nop 0
    v_permlane16_swap_b32 v157, v159
    buffer_store_dwordx4 v[156:159], v4, s[4:7], s62 offen offset:3072
L_six_120:
    v_pk_mul_f32 v[148:149], v[56:57], v[168:169] op_sel:[0,1] op_sel_hi:[1,1]
    v_pk_mul_f32 v[150:151], v[58:59], v[168:169] op_sel:[0,1] op_sel_hi:[1,1]
    v_pk_mul_f32 v[152:153], v[60:61], v[168:169] op_sel:[0,1] op_sel_hi:[1,1]
    v_pk_mul_f32 v[154:155], v[62:63], v[168:169] op_sel:[0,1] op_sel_hi:[1,1]
    v_exp_f32 v148, v148
    v_exp_f32 v149, v149
    v_exp_f32 v150, v150
    v_exp_f32 v151, v151
    v_exp_f32 v152, v152
    v_exp_f32 v153, v153
    v_exp_f32 v154, v154
    v_exp_f32_e64 v155, v155
    v_pk_fma_f32 v[148:149], v[148:149], v[170:171], v[170:171] op_sel_hi:[1,0,0]
    v_pk_fma_f32 v[150:151], v[150:151], v[170:171], v[170:171] op_sel_hi:[1,0,0]
    v_pk_fma_f32 v[152:153], v[152:153], v[170:171], v[170:171] op_sel_hi:[1,0,0]
    v_pk_fma_f32 v[154:155], v[154:155], v[170:171], v[170:171] op_sel_hi:[1,0,0]
    v_rcp_f32 v148, v148
    v_rcp_f32 v149, v149
    v_rcp_f32 v150, v150
    v_rcp_f32 v151, v151
    v_rcp_f32 v152, v152
    v_rcp_f32 v153, v153
    v_rcp_f32 v154, v154
    v_rcp_f32 v155, v155
    v_pk_mul_f32 v[56:57], v[56:57], v[148:149]
    v_pk_mul_f32 v[58:59], v[58:59], v[150:151]
    v_pk_mul_f32 v[60:61], v[60:61], v[152:153]
    v_pk_mul_f32 v[62:63], v[62:63], v[154:155]
    v_cvt_pk_bf16_f32 v160, v56, v57
    v_cvt_pk_bf16_f32 v162, v60, v61
    v_cvt_pk_bf16_f32 v161, v58, v59
    v_cvt_pk_bf16_f32 v163, v62, v63
    v_permlane16_swap_b32 v160, v162
    s_nop 0
    v_permlane16_swap_b32 v161, v163
    buffer_store_dwordx4 v[160:163], v3, s[4:7], s62 offen offset:0
    v_pk_mul_f32 v[140:141], v[64:65], v[168:169] op_sel:[0,1] op_sel_hi:[1,1]
    v_pk_mul_f32 v[142:143], v[66:67], v[168:169] op_sel:[0,1] op_sel_hi:[1,1]
    v_pk_mul_f32 v[144:145], v[68:69], v[168:169] op_sel:[0,1] op_sel_hi:[1,1]
    v_pk_mul_f32 v[146:147], v[70:71], v[168:169] op_sel:[0,1] op_sel_hi:[1,1]
    v_exp_f32 v140, v140
    v_exp_f32 v141, v141
    v_exp_f32 v142, v142
    v_exp_f32 v143, v143
    v_exp_f32 v144, v144
    v_exp_f32 v145, v145
    v_exp_f32 v146, v146
    v_exp_f32_e64 v147, v147
    v_pk_fma_f32 v[140:141], v[140:141], v[170:171], v[170:171] op_sel_hi:[1,0,0]
    v_pk_fma_f32 v[142:143], v[142:143], v[170:171], v[170:171] op_sel_hi:[1,0,0]
    v_pk_fma_f32 v[144:145], v[144:145], v[170:171], v[170:171] op_sel_hi:[1,0,0]
    v_pk_fma_f32 v[146:147], v[146:147], v[170:171], v[170:171] op_sel_hi:[1,0,0]
    v_rcp_f32 v140, v140
    v_rcp_f32 v141, v141
    v_rcp_f32 v142, v142
    v_rcp_f32 v143, v143
    v_rcp_f32 v144, v144
    v_rcp_f32 v145, v145
    v_rcp_f32 v146, v146
    v_rcp_f32 v147, v147
    v_pk_mul_f32 v[64:65], v[64:65], v[140:141]
    v_pk_mul_f32 v[66:67], v[66:67], v[142:143]
    v_pk_mul_f32 v[68:69], v[68:69], v[144:145]
    v_pk_mul_f32 v[70:71], v[70:71], v[146:147]
    v_cvt_pk_bf16_f32 v156, v64, v65
    v_cvt_pk_bf16_f32 v158, v68, v69
    v_cvt_pk_bf16_f32 v157, v66, v67
    v_cvt_pk_bf16_f32 v159, v70, v71
    v_permlane16_swap_b32 v156, v158
    s_nop 0
    v_permlane16_swap_b32 v157, v159
    buffer_store_dwordx4 v[156:159], v3, s[4:7], s62 offen offset:1024
    v_pk_mul_f32 v[148:149], v[72:73], v[168:169] op_sel:[0,1] op_sel_hi:[1,1]
    v_pk_mul_f32 v[150:151], v[74:75], v[168:169] op_sel:[0,1] op_sel_hi:[1,1]
    v_pk_mul_f32 v[152:153], v[76:77], v[168:169] op_sel:[0,1] op_sel_hi:[1,1]
    v_pk_mul_f32 v[154:155], v[78:79], v[168:169] op_sel:[0,1] op_sel_hi:[1,1]
    v_exp_f32 v148, v148
    v_exp_f32 v149, v149
    v_exp_f32 v150, v150
    v_exp_f32 v151, v151
    v_exp_f32 v152, v152
    v_exp_f32 v153, v153
    v_exp_f32 v154, v154
    v_exp_f32_e64 v155, v155
    v_pk_fma_f32 v[148:149], v[148:149], v[170:171], v[170:171] op_sel_hi:[1,0,0]
    v_pk_fma_f32 v[150:151], v[150:151], v[170:171], v[170:171] op_sel_hi:[1,0,0]
    v_pk_fma_f32 v[152:153], v[152:153], v[170:171], v[170:171] op_sel_hi:[1,0,0]
    v_pk_fma_f32 v[154:155], v[154:155], v[170:171], v[170:171] op_sel_hi:[1,0,0]
    s_branch L_over_453
L_chain0_0_3:
    s_branch L_chainret0
L_over_453:
    v_rcp_f32 v148, v148
    v_rcp_f32 v149, v149
    v_rcp_f32 v150, v150
    v_rcp_f32 v151, v151
    v_rcp_f32 v152, v152
    v_rcp_f32 v153, v153
    v_rcp_f32 v154, v154
    v_rcp_f32 v155, v155
    v_pk_mul_f32 v[72:73], v[72:73], v[148:149]
    v_pk_mul_f32 v[74:75], v[74:75], v[150:151]
    v_pk_mul_f32 v[76:77], v[76:77], v[152:153]
    v_pk_mul_f32 v[78:79], v[78:79], v[154:155]
    v_cvt_pk_bf16_f32 v160, v72, v73
    v_cvt_pk_bf16_f32 v162, v76, v77
    v_cvt_pk_bf16_f32 v161, v74, v75
    v_cvt_pk_bf16_f32 v163, v78, v79
    v_permlane16_swap_b32 v160, v162
    s_nop 0
    v_permlane16_swap_b32 v161, v163
    buffer_store_dwordx4 v[160:163], v3, s[4:7], s62 offen offset:2048
    s_and_b32 s67, s38, 3
    s_cmp_eq_u32 s67, 3
    s_cbranch_scc1 L_six_121
    v_pk_mul_f32 v[140:141], v[108:109], v[172:173] op_sel:[0,1] op_sel_hi:[1,1]
    v_pk_mul_f32 v[142:143], v[110:111], v[172:173] op_sel:[0,1] op_sel_hi:[1,1]
    v_exp_f32 v140, v140
    v_exp_f32 v141, v141
    v_exp_f32 v142, v142
    v_exp_f32 v143, v143
    v_pk_fma_f32 v[140:141], v[140:141], v[174:175], v[174:175] op_sel_hi:[1,0,0]
    v_pk_fma_f32 v[142:143], v[142:143], v[174:175], v[174:175] op_sel_hi:[1,0,0]
    v_rcp_f32 v140, v140
    v_rcp_f32 v141, v141
    v_rcp_f32 v142, v142
    v_rcp_f32 v143, v143
    v_pk_mul_f32 v[108:109], v[108:109], v[140:141]
    v_pk_mul_f32 v[110:111], v[110:111], v[142:143]
    v_cvt_pk_bf16_f32 v156, v108, v109
    v_cvt_pk_bf16_f32 v158, v108, v109
    v_cvt_pk_bf16_f32 v157, v110, v111
    v_cvt_pk_bf16_f32 v159, v110, v111
    v_permlane16_swap_b32 v156, v158
    s_nop 0
    v_permlane16_swap_b32 v157, v159
    buffer_store_dwordx4 v[156:159], v4, s[4:7], s63 offen offset:3072
L_six_121:
    v_pk_mul_f32 v[148:149], v[84:85], v[172:173] op_sel:[0,1] op_sel_hi:[1,1]
    v_pk_mul_f32 v[150:151], v[86:87], v[172:173] op_sel:[0,1] op_sel_hi:[1,1]
    v_pk_mul_f32 v[152:153], v[88:89], v[172:173] op_sel:[0,1] op_sel_hi:[1,1]
    v_pk_mul_f32 v[154:155], v[90:91], v[172:173] op_sel:[0,1] op_sel_hi:[1,1]
    v_exp_f32 v148, v148
    v_exp_f32 v149, v149
    v_exp_f32 v150, v150
    v_exp_f32 v151, v151
    v_exp_f32 v152, v152
    v_exp_f32 v153, v153
    v_exp_f32 v154, v154
    v_exp_f32_e64 v155, v155
    v_pk_fma_f32 v[148:149], v[148:149], v[174:175], v[174:175] op_sel_hi:[1,0,0]
    v_pk_fma_f32 v[150:151], v[150:151], v[174:175], v[174:175] op_sel_hi:[1,0,0]
    v_pk_fma_f32 v[152:153], v[152:153], v[174:175], v[174:175] op_sel_hi:[1,0,0]
    v_pk_fma_f32 v[154:155], v[154:155], v[174:175], v[174:175] op_sel_hi:[1,0,0]
    v_rcp_f32 v148, v148
    v_rcp_f32 v149, v149
    v_rcp_f32 v150, v150
    v_rcp_f32 v151, v151
    v_rcp_f32 v152, v152
    v_rcp_f32 v153, v153
    v_rcp_f32 v154, v154
    v_rcp_f32 v155, v155
    v_pk_mul_f32 v[84:85], v[84:85], v[148:149]
    v_pk_mul_f32 v[86:87], v[86:87], v[150:151]
    v_pk_mul_f32 v[88:89], v[88:89], v[152:153]
    v_pk_mul_f32 v[90:91], v[90:91], v[154:155]
    v_cvt_pk_bf16_f32 v160, v84, v85
    v_cvt_pk_bf16_f32 v162, v88, v89
    v_cvt_pk_bf16_f32 v161, v86, v87
    v_cvt_pk_bf16_f32 v163, v90, v91
    v_permlane16_swap_b32 v160, v162
    s_nop 0
    v_permlane16_swap_b32 v161, v163
    buffer_store_dwordx4 v[160:163], v3, s[4:7], s63 offen offset:0
    s_waitcnt vmcnt(1)
    buffer_store_dword v0, v14, s[4:7], s53 offen offset:0
    v_pk_mul_f32 v[140:141], v[92:93], v[172:173] op_sel:[0,1] op_sel_hi:[1,1]
    v_pk_mul_f32 v[142:143], v[94:95], v[172:173] op_sel:[0,1] op_sel_hi:[1,1]
    v_pk_mul_f32 v[144:145], v[96:97], v[172:173] op_sel:[0,1] op_sel_hi:[1,1]
    v_pk_mul_f32 v[146:147], v[98:99], v[172:173] op_sel:[0,1] op_sel_hi:[1,1]
    v_exp_f32 v140, v140
    v_exp_f32 v141, v141
    v_exp_f32 v142, v142
    v_exp_f32 v143, v143
    v_exp_f32 v144, v144
    v_exp_f32 v145, v145
    v_exp_f32 v146, v146
    v_exp_f32 v147, v147
    v_pk_fma_f32 v[140:141], v[140:141], v[174:175], v[174:175] op_sel_hi:[1,0,0]
    v_pk_fma_f32 v[142:143], v[142:143], v[174:175], v[174:175] op_sel_hi:[1,0,0]
    v_pk_fma_f32 v[144:145], v[144:145], v[174:175], v[174:175] op_sel_hi:[1,0,0]
    v_pk_fma_f32 v[146:147], v[146:147], v[174:175], v[174:175] op_sel_hi:[1,0,0]
    v_rcp_f32 v140, v140
    v_rcp_f32 v141, v141
    v_rcp_f32 v142, v142
    v_rcp_f32 v143, v143
    v_rcp_f32 v144, v144
    v_rcp_f32 v145, v145
    v_rcp_f32 v146, v146
    v_rcp_f32 v147, v147
    v_pk_mul_f32 v[92:93], v[92:93], v[140:141]
    v_pk_mul_f32 v[94:95], v[94:95], v[142:143]
    v_pk_mul_f32 v[96:97], v[96:97], v[144:145]
    v_pk_mul_f32 v[98:99], v[98:99], v[146:147]
    v_cvt_pk_bf16_f32 v156, v92, v93
    v_cvt_pk_bf16_f32 v158, v96, v97
    v_cvt_pk_bf16_f32 v157, v94, v95
    v_cvt_pk_bf16_f32 v159, v98, v99
    v_permlane16_swap_b32 v156, v158
    s_nop 0
    v_permlane16_swap_b32 v157, v159
    buffer_store_dwordx4 v[156:159], v3, s[4:7], s63 offen offset:1024
    buffer_load_dword v29, v24, s[4:7], s56 offen offset:0 sc1
    v_pk_mul_f32 v[148:149], v[100:101], v[172:173] op_sel:[0,1] op_sel_hi:[1,1]
    v_pk_mul_f32 v[150:151], v[102:103], v[172:173] op_sel:[0,1] op_sel_hi:[1,1]
    v_pk_mul_f32 v[152:153], v[104:105], v[172:173] op_sel:[0,1] op_sel_hi:[1,1]
    v_pk_mul_f32 v[154:155], v[106:107], v[172:173] op_sel:[0,1] op_sel_hi:[1,1]
    v_exp_f32 v148, v148
    v_exp_f32 v149, v149
    v_exp_f32 v150, v150
    v_exp_f32 v151, v151
    v_exp_f32 v152, v152
    v_exp_f32 v153, v153
    v_exp_f32 v154, v154
    v_exp_f32_e64 v155, v155
    v_pk_fma_f32 v[148:149], v[148:149], v[174:175], v[174:175] op_sel_hi:[1,0,0]
    v_pk_fma_f32 v[150:151], v[150:151], v[174:175], v[174:175] op_sel_hi:[1,0,0]
    v_pk_fma_f32 v[152:153], v[152:153], v[174:175], v[174:175] op_sel_hi:[1,0,0]
    v_pk_fma_f32 v[154:155], v[154:155], v[174:175], v[174:175] op_sel_hi:[1,0,0]
    v_rcp_f32 v148, v148
    v_rcp_f32 v149, v149
    v_rcp_f32 v150, v150
    v_rcp_f32 v151, v151
    v_rcp_f32 v152, v152
    v_rcp_f32 v153, v153
    v_rcp_f32 v154, v154
    v_rcp_f32 v155, v155
    v_pk_mul_f32 v[100:101], v[100:101], v[148:149]
    v_pk_mul_f32 v[102:103], v[102:103], v[150:151]
    v_pk_mul_f32 v[104:105], v[104:105], v[152:153]
    v_pk_mul_f32 v[106:107], v[106:107], v[154:155]
    v_cvt_pk_bf16_f32 v160, v100, v101
    v_cvt_pk_bf16_f32 v162, v104, v105
    v_cvt_pk_bf16_f32 v161, v102, v103
    v_cvt_pk_bf16_f32 v163, v106, v107
    v_permlane16_swap_b32 v160, v162
    s_nop 0
    v_permlane16_swap_b32 v161, v163
    buffer_store_dwordx4 v[160:163], v3, s[4:7], s63 offen offset:2048
L_join_119:
    s_waitcnt vmcnt(1)
    v_sub_u32 v29, v29, v15
    v_subrev_u32 v29, 4, v29
    v_cmp_lt_u32 vcc, 1, v29
    s_nop 0
    s_and_b32 vcc_hi, vcc_lo, 4294967295
    s_cbranch_scc0 L_stok_122
L_poll_123:
    buffer_load_dword v29, v24, s[4:7], s56 offen offset:0 sc1
    s_waitcnt vmcnt(0)
    v_sub_u32 v29, v29, v15
    v_subrev_u32 v29, 4, v29
    v_cmp_lt_u32 vcc, 1, v29
    s_nop 0
    s_and_b32 vcc_hi, vcc_lo, 4294967295
    s_cbranch_scc0 L_polled_124
    s_sub_u32 s44, s44, 1
    s_cbranch_scc0 L_poll_123
    s_mov_b32 s44, 0
L_polled_124:
L_stok_122:
L_ph4:
    buffer_load_dwordx4 v[184:187], v1, s[4:7], s58 offen offset:0 sc1
    buffer_load_dwordx4 v[188:191], v1, s[4:7], s58 offen offset:1024 sc1
    buffer_load_dwordx4 v[192:195], v1, s[4:7], s58 offen offset:2048 sc1
    buffer_load_dwordx4 v[196:199], v1, s[4:7], s58 offen offset:3072 sc1
    s_add_u32 s58, s58, 4096
    buffer_load_dwordx4 v[200:203], v1, s[4:7], s58 offen offset:0 sc1
    buffer_load_dwordx4 v[204:207], v1, s[4:7], s58 offen offset:1024 sc1
    buffer_load_dwordx4 v[208:211], v25, s[4:7], s58 offen offset:2048 sc1
    s_waitcnt vmcnt(6)
    v_mfma_f32_16x16x32_bf16 v[72:75], a[100:103], v[184:187], 0
    buffer_load_dwordx4 v[212:215], v1, s[4:7], s59 offen offset:0 sc1
    v_mfma_f32_16x16x32_bf16 v[76:79], a[128:131], v[184:187], 0
    v_add_u32 v0, 1, v0
    s_cmp_eq_u32 s43, 0
    s_cbranch_scc1 L_safe_125
    buffer_store_dword v0, v14, s[4:7], s53 offen offset:0
L_join_126:
    v_add_u32_e64 v0, 6, v15
    v_mfma_f32_16x16x32_bf16 v[80:83], a[156:159], v[184:187], 0
    v_lshlrev_b32 v236, 1, v21
    v_xor_b32 v236, v236, v23
    v_and_b32_e64 v236, 16, v236
    v_mfma_f32_16x16x32_bf16 v[84:87], a[184:187], v[184:187], 0
    v_and_b32_e64 v237, 28, v21
    v_lshl_add_u32 v236, v237, 3, v236
    v_and_b32_e64 v237, 48, v1
    v_mfma_f32_16x16x32_bf16 v[88:91], a[212:215], v[184:187], 0
    s_waitcnt vmcnt(7)
    v_mfma_f32_16x16x32_bf16 v[72:75], a[104:107], v[188:191], v[72:75]
    buffer_load_dwordx4 v[216:219], v1, s[4:7], s59 offen offset:1024 sc1
    v_mfma_f32_16x16x32_bf16 v[76:79], a[132:135], v[188:191], v[76:79]
    v_lshl_add_u32 v236, v236, 2, v237
    v_add_u32 v237, 102400, v236
    v_add_u32 v236, 1024, v236
    v_mfma_f32_16x16x32_bf16 v[80:83], a[160:163], v[188:191], v[80:83]
    s_mul_i32 s30, s36, 40960
    s_sub_u32 s31, 286720, s30
    s_mul_i32 s32, s37, 327680
    v_mfma_f32_16x16x32_bf16 v[84:87], a[188:191], v[188:191], v[84:87]
    s_add_u32 s30, s30, s32
    s_add_u32 s31, s31, s32
    s_lshl_b32 s32, s36, 11
    v_mfma_f32_16x16x32_bf16 v[88:91], a[216:219], v[188:191], v[88:91]
    s_waitcnt vmcnt(7)
    v_mfma_f32_16x16x32_bf16 v[72:75], a[108:111], v[192:195], v[72:75]
    buffer_load_dwordx4 v[220:223], v1, s[4:7], s59 offen offset:2048 sc1
    v_mfma_f32_16x16x32_bf16 v[76:79], a[136:139], v[192:195], v[76:79]
    s_sub_u32 s33, 342016, s32
    s_add_u32 s32, s32, 327680
    s_add_u32 s32, s32, s45
    v_mfma_f32_16x16x32_bf16 v[80:83], a[164:167], v[192:195], v[80:83]
    s_add_u32 s33, s33, s45
    v_mfma_f32_16x16x32_bf16 v[84:87], a[192:195], v[192:195], v[84:87]
    v_mfma_f32_16x16x32_bf16 v[88:91], a[220:223], v[192:195], v[88:91]
    s_waitcnt vmcnt(7)
    v_mfma_f32_16x16x32_bf16 v[72:75], a[112:115], v[196:199], v[72:75]
    buffer_load_dwordx4 v[224:227], v1, s[4:7], s59 offen offset:3072 sc1
    v_mfma_f32_16x16x32_bf16 v[76:79], a[140:143], v[196:199], v[76:79]
    v_mfma_f32_16x16x32_bf16 v[80:83], a[168:171], v[196:199], v[80:83]
    v_mfma_f32_16x16x32_bf16 v[84:87], a[196:199], v[196:199], v[84:87]
    v_mfma_f32_16x16x32_bf16 v[88:91], a[224:227], v[196:199], v[88:91]
    s_waitcnt vmcnt(7)
    v_mfma_f32_16x16x32_bf16 v[72:75], a[116:119], v[200:203], v[72:75]
    s_add_u32 s59, s59, 4096
    buffer_load_dwordx4 v[228:231], v1, s[4:7], s59 offen offset:0 sc1
    v_mfma_f32_16x16x32_bf16 v[76:79], a[144:147], v[200:203], v[76:79]
    v_mfma_f32_16x16x32_bf16 v[80:83], a[172:175], v[200:203], v[80:83]
    v_mfma_f32_16x16x32_bf16 v[84:87], a[200:203], v[200:203], v[84:87]
    v_mfma_f32_16x16x32_bf16 v[88:91], a[228:231], v[200:203], v[88:91]
    s_waitcnt vmcnt(7)
    v_mfma_f32_16x16x32_bf16 v[72:75], a[120:123], v[204:207], v[72:75]
    buffer_load_dwordx4 v[184:187], v1, s[4:7], s59 offen offset:1024 sc1
    v_mfma_f32_16x16x32_bf16 v[76:79], a[148:151], v[204:207], v[76:79]
    v_mfma_f32_16x16x32_bf16 v[80:83], a[176:179], v[204:207], v[80:83]
    v_mfma_f32_16x16x32_bf16 v[84:87], a[204:207], v[204:207], v[84:87]
    v_mfma_f32_16x16x32_bf16 v[88:91], a[232:235], v[204:207], v[88:91]
    s_waitcnt vmcnt(7)
    v_mfma_f32_16x16x32_bf16 v[72:75], a[124:127], v[208:211], v[72:75]
    buffer_load_dwordx4 v[188:191], v25, s[4:7], s59 offen offset:2048 sc1
    v_mfma_f32_16x16x32_bf16 v[76:79], a[152:155], v[208:211], v[76:79]
    v_mfma_f32_16x16x32_bf16 v[80:83], a[180:183], v[208:211], v[80:83]
    v_mfma_f32_16x16x32_bf16 v[84:87], a[208:211], v[208:211], v[84:87]
    v_mfma_f32_16x16x32_bf16 v[88:91], a[236:239], v[208:211], v[88:91]
    s_waitcnt vmcnt(7)
    v_mfma_f32_16x16x32_bf16 v[92:95], a[100:103], v[212:215], 0
    buffer_load_dwordx4 v[192:195], v1, s[4:7], s60 offen offset:0 sc1
    v_mfma_f32_16x16x32_bf16 v[96:99], a[128:131], v[212:215], 0
    v_mfma_f32_16x16x32_bf16 v[100:103], a[156:159], v[212:215], 0
    v_mfma_f32_16x16x32_bf16 v[104:107], a[184:187], v[212:215], 0
    ds_write_b128 v52, v[72:75] offset:0
    v_mfma_f32_16x16x32_bf16 v[108:111], a[212:215], v[212:215], 0
    s_waitcnt vmcnt(6)
    v_mfma_f32_16x16x32_bf16 v[92:95], a[104:107], v[216:219], v[92:95]
    buffer_load_dwordx4 v[196:199], v1, s[4:7], s60 offen offset:1024 sc1
    v_mfma_f32_16x16x32_bf16 v[96:99], a[132:135], v[216:219], v[96:99]
    ds_write_b128 v52, v[76:79] offset:1024
    v_mfma_f32_16x16x32_bf16 v[100:103], a[160:163], v[216:219], v[100:103]
    v_mfma_f32_16x16x32_bf16 v[104:107], a[188:191], v[216:219], v[104:107]
    ds_write_b128 v52, v[80:83] offset:2048
    v_mfma_f32_16x16x32_bf16 v[108:111], a[216:219], v[216:219], v[108:111]
    s_waitcnt vmcnt(6)
    v_mfma_f32_16x16x32_bf16 v[92:95], a[108:111], v[220:223], v[92:95]
    buffer_load_dwordx4 v[200:203], v1, s[4:7], s60 offen offset:2048 sc1
    v_mfma_f32_16x16x32_bf16 v[96:99], a[136:139], v[220:223], v[96:99]
    ds_write_b128 v52, v[84:87] offset:3072
    v_mfma_f32_16x16x32_bf16 v[100:103], a[164:167], v[220:223], v[100:103]
    v_mfma_f32_16x16x32_bf16 v[104:107], a[192:195], v[220:223], v[104:107]
    ds_write_b128 v52, v[88:91] offset:4096
    v_mfma_f32_16x16x32_bf16 v[108:111], a[220:223], v[220:223], v[108:111]
    s_waitcnt vmcnt(6)
    v_mfma_f32_16x16x32_bf16 v[92:95], a[112:115], v[224:227], v[92:95]
    buffer_load_dwordx4 v[204:207], v1, s[4:7], s60 offen offset:3072 sc1
    v_mfma_f32_16x16x32_bf16 v[96:99], a[140:143], v[224:227], v[96:99]
    v_mfma_f32_16x16x32_bf16 v[100:103], a[168:171], v[224:227], v[100:103]
    v_mfma_f32_16x16x32_bf16 v[104:107], a[196:199], v[224:227], v[104:107]
    v_mfma_f32_16x16x32_bf16 v[108:111], a[224:227], v[224:227], v[108:111]
    s_waitcnt vmcnt(6)
    v_mfma_f32_16x16x32_bf16 v[92:95], a[116:119], v[228:231], v[92:95]
    s_add_u32 s60, s60, 4096
    buffer_load_dwordx4 v[208:211], v1, s[4:7], s60 offen offset:0 sc1
    v_mfma_f32_16x16x32_bf16 v[96:99], a[144:147], v[228:231], v[96:99]
    v_mfma_f32_16x16x32_bf16 v[100:103], a[172:175], v[228:231], v[100:103]
    v_mfma_f32_16x16x32_bf16 v[104:107], a[200:203], v[228:231], v[104:107]
    v_mfma_f32_16x16x32_bf16 v[108:111], a[228:231], v[228:231], v[108:111]
    s_waitcnt vmcnt(6)
    v_mfma_f32_16x16x32_bf16 v[92:95], a[120:123], v[184:187], v[92:95]
    buffer_load_dwordx4 v[212:215], v1, s[4:7], s60 offen offset:1024 sc1
    v_mfma_f32_16x16x32_bf16 v[96:99], a[148:151], v[184:187], v[96:99]
    v_mfma_f32_16x16x32_bf16 v[100:103], a[176:179], v[184:187], v[100:103]
    buffer_load_dword v29, v31, s[4:7], s66 offen offset:0 sc1
    v_mfma_f32_16x16x32_bf16 v[104:107], a[204:207], v[184:187], v[104:107]
    v_mfma_f32_16x16x32_bf16 v[108:111], a[232:235], v[184:187], v[108:111]
    s_waitcnt vmcnt(7)
    v_mfma_f32_16x16x32_bf16 v[92:95], a[124:127], v[188:191], v[92:95]
    buffer_load_dwordx4 v[216:219], v25, s[4:7], s60 offen offset:2048 sc1
    v_mfma_f32_16x16x32_bf16 v[96:99], a[152:155], v[188:191], v[96:99]
    v_mfma_f32_16x16x32_bf16 v[100:103], a[180:183], v[188:191], v[100:103]
    v_mfma_f32_16x16x32_bf16 v[104:107], a[208:211], v[188:191], v[104:107]
    v_mfma_f32_16x16x32_bf16 v[108:111], a[236:239], v[188:191], v[108:111]
    s_waitcnt vmcnt(7)
    v_mfma_f32_16x16x32_bf16 v[72:75], a[100:103], v[192:195], 0
    buffer_load_dwordx4 v[220:223], v1, s[4:7], s61 offen offset:0 sc1
    v_mfma_f32_16x16x32_bf16 v[76:79], a[128:131], v[192:195], 0
    v_mfma_f32_16x16x32_bf16 v[80:83], a[156:159], v[192:195], 0
    v_mfma_f32_16x16x32_bf16 v[84:87], a[184:187], v[192:195], 0
    ds_write_b128 v53, v[92:95] offset:0
    v_mfma_f32_16x16x32_bf16 v[88:91], a[212:215], v[192:195], 0
    s_waitcnt vmcnt(7)
    v_mfma_f32_16x16x32_bf16 v[72:75], a[104:107], v[196:199], v[72:75]
    buffer_load_dwordx4 v[224:227], v1, s[4:7], s61 offen offset:1024 sc1
    v_mfma_f32_16x16x32_bf16 v[76:79], a[132:135], v[196:199], v[76:79]
    ds_write_b128 v53, v[96:99] offset:1024
    v_mfma_f32_16x16x32_bf16 v[80:83], a[160:163], v[196:199], v[80:83]
    v_mfma_f32_16x16x32_bf16 v[84:87], a[188:191], v[196:199], v[84:87]
    ds_write_b128 v53, v[100:103] offset:2048
    v_mfma_f32_16x16x32_bf16 v[88:91], a[216:219], v[196:199], v[88:91]
    s_waitcnt vmcnt(7)
    v_mfma_f32_16x16x32_bf16 v[72:75], a[108:111], v[200:203], v[72:75]
    buffer_load_dwordx4 v[228:231], v1, s[4:7], s61 offen offset:2048 sc1
    v_mfma_f32_16x16x32_bf16 v[76:79], a[136:139], v[200:203], v[76:79]
    ds_write_b128 v53, v[104:107] offset:3072
    v_mfma_f32_16x16x32_bf16 v[80:83], a[164:167], v[200:203], v[80:83]
    v_mfma_f32_16x16x32_bf16 v[84:87], a[192:195], v[200:203], v[84:87]
    ds_write_b128 v53, v[108:111] offset:4096
    v_mfma_f32_16x16x32_bf16 v[88:91], a[220:223], v[200:203], v[88:91]
    s_waitcnt vmcnt(7)
    v_mfma_f32_16x16x32_bf16 v[72:75], a[112:115], v[204:207], v[72:75]
    buffer_load_dwordx4 v[184:187], v1, s[4:7], s61 offen offset:3072 sc1
    v_mfma_f32_16x16x32_bf16 v[76:79], a[140:143], v[204:207], v[76:79]
    v_mfma_f32_16x16x32_bf16 v[80:83], a[168:171], v[204:207], v[80:83]
    v_mfma_f32_16x16x32_bf16 v[84:87], a[196:199], v[204:207], v[84:87]
    v_mfma_f32_16x16x32_bf16 v[88:91], a[224:227], v[204:207], v[88:91]
    s_waitcnt lgkmcnt(0)
    s_barrier
    s_waitcnt vmcnt(7)
    v_mfma_f32_16x16x32_bf16 v[72:75], a[116:119], v[208:211], v[72:75]
    s_add_u32 s61, s61, 4096
    buffer_load_dwordx4 v[188:191], v1, s[4:7], s61 offen offset:0 sc1
    v_mfma_f32_16x16x32_bf16 v[76:79], a[144:147], v[208:211], v[76:79]
    ds_read_b128 v[112:115], v55 offset:0
    v_mfma_f32_16x16x32_bf16 v[80:83], a[172:175], v[208:211], v[80:83]
    ds_read_b128 v[116:119], v55 offset:1024
    v_mfma_f32_16x16x32_bf16 v[84:87], a[200:203], v[208:211], v[84:87]
    ds_read_b128 v[120:123], v55 offset:2048
    v_mfma_f32_16x16x32_bf16 v[88:91], a[228:231], v[208:211], v[88:91]
    ds_read_b128 v[124:127], v55 offset:3072
    s_waitcnt vmcnt(7)
    v_mfma_f32_16x16x32_bf16 v[72:75], a[120:123], v[212:215], v[72:75]
    buffer_load_dwordx4 v[192:195], v1, s[4:7], s61 offen offset:1024 sc1
    v_mfma_f32_16x16x32_bf16 v[76:79], a[148:151], v[212:215], v[76:79]
    ds_read_b128 v[128:131], v55 offset:4096
    v_mfma_f32_16x16x32_bf16 v[80:83], a[176:179], v[212:215], v[80:83]
    s_waitcnt vmcnt(7)
    v_sub_u32 v29, v29, v15
    v_subrev_u32_e64 v29, 5, v29
    v_cmp_lt_u32 vcc, 1, v29
    s_cbranch_vccz L_stok_127
L_poll_128:
    buffer_load_dword v29, v31, s[4:7], s66 offen offset:0 sc1
    s_waitcnt vmcnt(0)
    v_sub_u32 v29, v29, v15
    v_subrev_u32 v29, 5, v29
    v_cmp_lt_u32 vcc, 1, v29
    s_cbranch_vccz L_polled_129
    s_sub_u32 s44, s44, 1
    s_cbranch_scc0 L_poll_128
    s_mov_b32 s44, 0
L_polled_129:
L_stok_127:
    v_mfma_f32_16x16x32_bf16 v[84:87], a[204:207], v[212:215], v[84:87]
    ds_read_b128 v[132:135], v55 offset:5120
    v_mfma_f32_16x16x32_bf16 v[88:91], a[232:235], v[212:215], v[88:91]
    ds_read_b128 v[136:139], v55 offset:6144
    s_waitcnt vmcnt(6)
    v_mfma_f32_16x16x32_bf16 v[72:75], a[124:127], v[216:219], v[72:75]
    buffer_load_dwordx4 v[196:199], v25, s[4:7], s61 offen offset:2048 sc1
    v_mfma_f32_16x16x32_bf16 v[76:79], a[152:155], v[216:219], v[76:79]
    ds_read_b128 v[140:143], v55 offset:7168
    v_mfma_f32_16x16x32_bf16 v[80:83], a[180:183], v[216:219], v[80:83]
    ds_read_b128 v[144:147], v55 offset:8192
    v_mfma_f32_16x16x32_bf16 v[84:87], a[208:211], v[216:219], v[84:87]
    ds_read_b128 v[148:151], v55 offset:9216
    v_mfma_f32_16x16x32_bf16 v[88:91], a[236:239], v[216:219], v[88:91]
    s_waitcnt vmcnt(6) lgkmcnt(5)
    v_mfma_f32_16x16x32_bf16 v[112:115], a[100:103], v[220:223], v[112:115]
    s_add_u32 s58, s58, s57
    buffer_load_dwordx4 v[200:203], v1, s[4:7], s58 offen offset:0 sc1
    v_mfma_f32_16x16x32_bf16 v[116:119], a[128:131], v[220:223], v[116:119]
    v_mfma_f32_16x16x32_bf16 v[120:123], a[156:159], v[220:223], v[120:123]
    v_mfma_f32_16x16x32_bf16 v[124:127], a[184:187], v[220:223], v[124:127]
    ds_write_b128 v54, v[72:75] offset:0
    v_mfma_f32_16x16x32_bf16 v[128:131], a[212:215], v[220:223], v[128:131]
    s_waitcnt vmcnt(6)
    v_mfma_f32_16x16x32_bf16 v[112:115], a[104:107], v[224:227], v[112:115]
    buffer_load_dwordx4 v[204:207], v1, s[4:7], s58 offen offset:1024 sc1
    v_mfma_f32_16x16x32_bf16 v[116:119], a[132:135], v[224:227], v[116:119]
    ds_write_b128 v54, v[76:79] offset:1024
    v_mfma_f32_16x16x32_bf16 v[120:123], a[160:163], v[224:227], v[120:123]
    v_mfma_f32_16x16x32_bf16 v[124:127], a[188:191], v[224:227], v[124:127]
    ds_write_b128 v54, v[80:83] offset:2048
    v_mfma_f32_16x16x32_bf16 v[128:131], a[216:219], v[224:227], v[128:131]
    s_waitcnt vmcnt(6)
    v_mfma_f32_16x16x32_bf16 v[112:115], a[108:111], v[228:231], v[112:115]
    buffer_load_dwordx4 v[208:211], v1, s[4:7], s58 offen offset:2048 sc1
    v_mfma_f32_16x16x32_bf16 v[116:119], a[136:139], v[228:231], v[116:119]
    ds_write_b128 v54, v[84:87] offset:3072
    v_mfma_f32_16x16x32_bf16 v[120:123], a[164:167], v[228:231], v[120:123]
    v_mfma_f32_16x16x32_bf16 v[124:127], a[192:195], v[228:231], v[124:127]
    ds_write_b128 v54, v[88:91] offset:4096
    v_mfma_f32_16x16x32_bf16 v[128:131], a[220:223], v[228:231], v[128:131]
    s_waitcnt vmcnt(6)
    v_mfma_f32_16x16x32_bf16 v[112:115], a[112:115], v[184:187], v[112:115]
    buffer_load_dwordx4 v[212:215], v1, s[4:7], s58 offen offset:3072 sc1
    v_mfma_f32_16x16x32_bf16 v[116:119], a[140:143], v[184:187], v[116:119]
    v_mfma_f32_16x16x32_bf16 v[120:123], a[168:171], v[184:187], v[120:123]
    v_mfma_f32_16x16x32_bf16 v[124:127], a[196:199], v[184:187], v[124:127]
    v_mfma_f32_16x16x32_bf16 v[128:131], a[224:227], v[184:187], v[128:131]
    s_waitcnt lgkmcnt(0)
    s_barrier
    s_waitcnt vmcnt(6)
    v_mfma_f32_16x16x32_bf16 v[112:115], a[116:119], v[188:191], v[112:115]
    s_add_u32 s58, s58, 4096
    buffer_load_dwordx4 v[216:219], v1, s[4:7], s58 offen offset:0 sc1
    v_mfma_f32_16x16x32_bf16 v[116:119], a[144:147], v[188:191], v[116:119]
    ds_read_b128 v[152:155], v55 offset:10240
    v_mfma_f32_16x16x32_bf16 v[120:123], a[172:175], v[188:191], v[120:123]
    ds_read_b128 v[156:159], v55 offset:11264
    v_mfma_f32_16x16x32_bf16 v[124:127], a[200:203], v[188:191], v[124:127]
    ds_read_b128 v[160:163], v55 offset:12288
    v_mfma_f32_16x16x32_bf16 v[128:131], a[228:231], v[188:191], v[128:131]
    ds_read_b128 v[164:167], v55 offset:13312
    s_waitcnt vmcnt(6)
    v_mfma_f32_16x16x32_bf16 v[112:115], a[120:123], v[192:195], v[112:115]
    buffer_load_dwordx4 v[220:223], v1, s[4:7], s58 offen offset:1024 sc1
    v_mfma_f32_16x16x32_bf16 v[116:119], a[148:151], v[192:195], v[116:119]
    ds_read_b128 v[168:171], v55 offset:14336
    v_mfma_f32_16x16x32_bf16 v[120:123], a[176:179], v[192:195], v[120:123]
    v_mfma_f32_16x16x32_bf16 v[124:127], a[204:207], v[192:195], v[124:127]
    s_waitcnt lgkmcnt(3)
    v_add_f32 v132, v132, v152
    v_add_f32_e64 v133, v133, v153
    v_mfma_f32_16x16x32_bf16 v[128:131], a[232:235], v[192:195], v[128:131]
    v_add_f32_e64 v134, v134, v154
    v_add_f32 v135, v135, v155
    s_waitcnt vmcnt(6)
    v_mfma_f32_16x16x32_bf16 v[112:115], a[124:127], v[196:199], v[112:115]
    buffer_load_dwordx4 v[224:227], v25, s[4:7], s58 offen offset:2048 sc1
    v_mfma_f32_16x16x32_bf16 v[116:119], a[152:155], v[196:199], v[116:119]
    s_waitcnt lgkmcnt(2)
    v_add_f32 v136, v136, v156
    v_add_f32_e64 v137, v137, v157
    v_mfma_f32_16x16x32_bf16 v[120:123], a[180:183], v[196:199], v[120:123]
    v_add_f32 v138, v138, v158
    v_add_f32 v139, v139, v159
    v_mfma_f32_16x16x32_bf16 v[124:127], a[208:211], v[196:199], v[124:127]
    s_waitcnt lgkmcnt(1)
    v_add_f32 v140, v140, v160
    v_add_f32_e64 v141, v141, v161
    v_mfma_f32_16x16x32_bf16 v[128:131], a[236:239], v[196:199], v[128:131]
    v_add_f32_e64 v142, v142, v162
    v_add_f32 v143, v143, v163
    s_waitcnt vmcnt(6)
    v_mfma_f32_16x16x32_bf16 v[72:75], a[100:103], v[200:203], 0
    s_add_u32 s59, s59, s57
    buffer_load_dwordx4 v[228:231], v1, s[4:7], s59 offen offset:0 sc1
    v_mfma_f32_16x16x32_bf16 v[76:79], a[128:131], v[200:203], 0
    s_waitcnt lgkmcnt(0)
    v_add_f32 v144, v144, v164
    v_add_f32 v145, v145, v165
    v_mfma_f32_16x16x32_bf16 v[80:83], a[156:159], v[200:203], 0
    v_add_f32 v146, v146, v166
    v_add_f32 v147, v147, v167
    v_mfma_f32_16x16x32_bf16 v[84:87], a[184:187], v[200:203], 0
    v_add_f32 v148, v148, v168
    v_add_f32 v149, v149, v169
    v_mfma_f32_16x16x32_bf16 v[88:91], a[212:215], v[200:203], 0
    v_add_f32_e64 v150, v150, v170
    v_add_f32 v151, v151, v171
    s_waitcnt vmcnt(6)
    v_mfma_f32_16x16x32_bf16 v[72:75], a[104:107], v[204:207], v[72:75]
    buffer_load_dwordx4 v[184:187], v1, s[4:7], s59 offen offset:1024 sc1
    v_mfma_f32_16x16x32_bf16 v[76:79], a[132:135], v[204:207], v[76:79]
    v_add_f32 v112, v112, v132
    v_add_f32 v113, v113, v133
    v_mfma_f32_16x16x32_bf16 v[80:83], a[160:163], v[204:207], v[80:83]
    v_add_f32 v114, v114, v134
    v_add_f32 v115, v115, v135
    v_mfma_f32_16x16x32_bf16 v[84:87], a[188:191], v[204:207], v[84:87]
    v_add_f32 v116, v116, v136
    v_add_f32 v117, v117, v137
    v_mfma_f32_16x16x32_bf16 v[88:91], a[216:219], v[204:207], v[88:91]
    v_add_f32_e64 v118, v118, v138
    v_add_f32 v119, v119, v139
    s_waitcnt vmcnt(6)
    v_mfma_f32_16x16x32_bf16 v[72:75], a[108:111], v[208:211], v[72:75]
    buffer_load_dwordx4 v[188:191], v1, s[4:7], s59 offen offset:2048 sc1
    v_mfma_f32_16x16x32_bf16 v[76:79], a[136:139], v[208:211], v[76:79]
    v_add_f32 v120, v120, v140
    v_add_f32 v121, v121, v141
    v_mfma_f32_16x16x32_bf16 v[80:83], a[164:167], v[208:211], v[80:83]
    v_add_f32 v122, v122, v142
    v_add_f32 v123, v123, v143
    v_mfma_f32_16x16x32_bf16 v[84:87], a[192:195], v[208:211], v[84:87]
    v_add_f32 v124, v124, v144
    v_add_f32 v125, v125, v145
    v_mfma_f32_16x16x32_bf16 v[88:91], a[220:223], v[208:211], v[88:91]
    v_add_f32_e64 v126, v126, v146
    v_add_f32 v127, v127, v147
    s_waitcnt vmcnt(6)
    v_mfma_f32_16x16x32_bf16 v[72:75], a[112:115], v[212:215], v[72:75]
    buffer_load_dwordx4 v[192:195], v1, s[4:7], s59 offen offset:3072 sc1
    v_mfma_f32_16x16x32_bf16 v[76:79], a[140:143], v[212:215], v[76:79]
    v_add_f32 v128, v128, v148
    v_add_f32 v129, v129, v149
    v_mfma_f32_16x16x32_bf16 v[80:83], a[168:171], v[212:215], v[80:83]
    v_add_f32 v130, v130, v150
    v_add_f32 v131, v131, v151
    v_mfma_f32_16x16x32_bf16 v[84:87], a[196:199], v[212:215], v[84:87]
    v_cvt_pk_bf16_f32 v172, v112, v113
    v_cvt_pk_bf16_f32 v173, v114, v115
    v_mfma_f32_16x16x32_bf16 v[88:91], a[224:227], v[212:215], v[88:91]
    v_cvt_pk_bf16_f32 v174, v116, v117
    v_cvt_pk_bf16_f32 v175, v118, v119
    s_waitcnt vmcnt(6)
    v_mfma_f32_16x16x32_bf16 v[72:75], a[116:119], v[216:219], v[72:75]
    s_add_u32 s59, s59, 4096
    buffer_load_dwordx4 v[196:199], v1, s[4:7], s59 offen offset:0 sc1
    v_mfma_f32_16x16x32_bf16 v[76:79], a[144:147], v[216:219], v[76:79]
    v_cvt_pk_bf16_f32 v176, v120, v121
    v_cvt_pk_bf16_f32 v177, v122, v123
    v_mfma_f32_16x16x32_bf16 v[80:83], a[172:175], v[216:219], v[80:83]
    s_cmp_eq_u32 s43, 0
    s_cbranch_scc1 L_safe_130
    buffer_store_dwordx4 v[172:175], v1, s[8:11], s64 offen offset:0
L_join_131:
    v_mfma_f32_16x16x32_bf16 v[84:87], a[200:203], v[216:219], v[84:87]
    v_cvt_pk_bf16_f32 v178, v124, v125
    v_cvt_pk_bf16_f32 v179, v126, v127
    v_mfma_f32_16x16x32_bf16 v[88:91], a[228:231], v[216:219], v[88:91]
    v_cvt_pk_bf16_f32 v180, v128, v129
    v_cvt_pk_bf16_f32 v181, v130, v131
    s_waitcnt vmcnt(7)
    v_mfma_f32_16x16x32_bf16 v[72:75], a[120:123], v[220:223], v[72:75]
    buffer_load_dwordx4 v[200:203], v1, s[4:7], s59 offen offset:1024 sc1
    v_mfma_f32_16x16x32_bf16 v[76:79], a[148:151], v[220:223], v[76:79]
    s_cmp_eq_u32 s43, 0
    s_cbranch_scc1 L_safe_132
    buffer_store_dwordx4 v[176:179], v1, s[8:11], s64 offen offset:1024
L_join_133:
    v_mfma_f32_16x16x32_bf16 v[80:83], a[176:179], v[220:223], v[80:83]
    v_mfma_f32_16x16x32_bf16 v[84:87], a[204:207], v[220:223], v[84:87]
    s_cmp_eq_u32 s43, 0
    s_cbranch_scc1 L_safe_134
    buffer_store_dwordx2 v[180:181], v9, s[8:11], s64 offen offset:2048
L_join_135:
    v_mfma_f32_16x16x32_bf16 v[88:91], a[232:235], v[220:223], v[88:91]
    s_waitcnt vmcnt(9)
    v_mfma_f32_16x16x32_bf16 v[72:75], a[124:127], v[224:227], v[72:75]
    buffer_load_dwordx4 v[204:207], v25, s[4:7], s59 offen offset:2048 sc1
    v_mfma_f32_16x16x32_bf16 v[76:79], a[152:155], v[224:227], v[76:79]
    v_mfma_f32_16x16x32_bf16 v[80:83], a[180:183], v[224:227], v[80:83]
    v_mfma_f32_16x16x32_bf16 v[84:87], a[208:211], v[224:227], v[84:87]
    v_mfma_f32_16x16x32_bf16 v[88:91], a[236:239], v[224:227], v[88:91]
    s_waitcnt vmcnt(9)
    v_mfma_f32_16x16x32_bf16 v[92:95], a[100:103], v[228:231], 0
    s_add_u32 s60, s60, s57
    buffer_load_dwordx4 v[208:211], v1, s[4:7], s60 offen offset:0 sc1
    v_mfma_f32_16x16x32_bf16 v[96:99], a[128:131], v[228:231], 0
    v_mfma_f32_16x16x32_bf16 v[100:103], a[156:159], v[228:231], 0
    v_mfma_f32_16x16x32_bf16 v[104:107], a[184:187], v[228:231], 0
    ds_write_b128 v52, v[72:75] offset:0
    v_mfma_f32_16x16x32_bf16 v[108:111], a[212:215], v[228:231], 0
    s_waitcnt vmcnt(9)
    v_mfma_f32_16x16x32_bf16 v[92:95], a[104:107], v[184:187], v[92:95]
    buffer_load_dwordx4 v[212:215], v1, s[4:7], s60 offen offset:1024 sc1
    v_mfma_f32_16x16x32_bf16 v[96:99], a[132:135], v[184:187], v[96:99]
    ds_write_b128 v52, v[76:79] offset:1024
    v_mfma_f32_16x16x32_bf16 v[100:103], a[160:163], v[184:187], v[100:103]
    v_mfma_f32_16x16x32_bf16 v[104:107], a[188:191], v[184:187], v[104:107]
    ds_write_b128 v52, v[80:83] offset:2048
    v_mfma_f32_16x16x32_bf16 v[108:111], a[216:219], v[184:187], v[108:111]
    s_waitcnt vmcnt(9)
    v_mfma_f32_16x16x32_bf16 v[92:95], a[108:111], v[188:191], v[92:95]
    buffer_load_dwordx4 v[216:219], v1, s[4:7], s60 offen offset:2048 sc1
    v_mfma_f32_16x16x32_bf16 v[96:99], a[136:139], v[188:191], v[96:99]
    ds_write_b128 v52, v[84:87] offset:3072
    v_mfma_f32_16x16x32_bf16 v[100:103], a[164:167], v[188:191], v[100:103]
    v_mfma_f32_16x16x32_bf16 v[104:107], a[192:195], v[188:191], v[104:107]
    ds_write_b128 v52, v[88:91] offset:4096
    v_mfma_f32_16x16x32_bf16 v[108:111], a[220:223], v[188:191], v[108:111]
    s_waitcnt vmcnt(9)
    v_mfma_f32_16x16x32_bf16 v[92:95], a[112:115], v[192:195], v[92:95]
    buffer_load_dwordx4 v[220:223], v1, s[4:7], s60 offen offset:3072 sc1
    v_mfma_f32_16x16x32_bf16 v[96:99], a[140:143], v[192:195], v[96:99]
    v_mfma_f32_16x16x32_bf16 v[100:103], a[168:171], v[192:195], v[100:103]
    v_mfma_f32_16x16x32_bf16 v[104:107], a[196:199], v[192:195], v[104:107]
    v_mfma_f32_16x16x32_bf16 v[108:111], a[224:227], v[192:195], v[108:111]
    s_waitcnt vmcnt(9)
    v_mfma_f32_16x16x32_bf16 v[92:95], a[116:119], v[196:199], v[92:95]
    s_add_u32 s60, s60, 4096
    buffer_load_dwordx4 v[224:227], v1, s[4:7], s60 offen offset:0 sc1
    v_mfma_f32_16x16x32_bf16 v[96:99], a[144:147], v[196:199], v[96:99]
    s_waitcnt vmcnt(6)
    s_cmp_eq_u32 s43, 0
    s_cbranch_scc1 L_safe_136
    buffer_store_dword v0, v14, s[4:7], s53 offen offset:0
L_join_137:
    v_mfma_f32_16x16x32_bf16 v[100:103], a[172:175], v[196:199], v[100:103]
    s_branch L_over_454
L_chain0_1_3:
    s_branch L_chainret0
L_over_454:
    v_mfma_f32_16x16x32_bf16 v[104:107], a[200:203], v[196:199], v[104:107]
    v_mfma_f32_16x16x32_bf16 v[108:111], a[228:231], v[196:199], v[108:111]
    v_mfma_f32_16x16x32_bf16 v[92:95], a[120:123], v[200:203], v[92:95]
    buffer_load_dwordx4 v[228:231], v1, s[4:7], s60 offen offset:1024 sc1
    v_mfma_f32_16x16x32_bf16 v[96:99], a[148:151], v[200:203], v[96:99]
    v_mfma_f32_16x16x32_bf16 v[100:103], a[176:179], v[200:203], v[100:103]
    v_mfma_f32_16x16x32_bf16 v[104:107], a[204:207], v[200:203], v[104:107]
    v_mfma_f32_16x16x32_bf16 v[108:111], a[232:235], v[200:203], v[108:111]
    s_waitcnt vmcnt(7)
    v_mfma_f32_16x16x32_bf16 v[92:95], a[124:127], v[204:207], v[92:95]
    buffer_load_dwordx4 v[184:187], v25, s[4:7], s60 offen offset:2048 sc1
    v_mfma_f32_16x16x32_bf16 v[96:99], a[152:155], v[204:207], v[96:99]
    v_mfma_f32_16x16x32_bf16 v[100:103], a[180:183], v[204:207], v[100:103]
    v_mfma_f32_16x16x32_bf16 v[104:107], a[208:211], v[204:207], v[104:107]
    v_mfma_f32_16x16x32_bf16 v[108:111], a[236:239], v[204:207], v[108:111]
    s_waitcnt vmcnt(7)
    v_mfma_f32_16x16x32_bf16 v[72:75], a[100:103], v[208:211], 0
    s_add_u32 s61, s61, s57
    buffer_load_dwordx4 v[188:191], v1, s[4:7], s61 offen offset:0 sc1
    v_mfma_f32_16x16x32_bf16 v[76:79], a[128:131], v[208:211], 0
    v_mfma_f32_16x16x32_bf16 v[80:83], a[156:159], v[208:211], 0
    v_mfma_f32_16x16x32_bf16 v[84:87], a[184:187], v[208:211], 0
    ds_write_b128 v53, v[92:95] offset:0
    v_mfma_f32_16x16x32_bf16 v[88:91], a[212:215], v[208:211], 0
    s_waitcnt vmcnt(7)
    v_mfma_f32_16x16x32_bf16 v[72:75], a[104:107], v[212:215], v[72:75]
    buffer_load_dwordx4 v[192:195], v1, s[4:7], s61 offen offset:1024 sc1
    v_mfma_f32_16x16x32_bf16 v[76:79], a[132:135], v[212:215], v[76:79]
    ds_write_b128 v53, v[96:99] offset:1024
    v_mfma_f32_16x16x32_bf16 v[80:83], a[160:163], v[212:215], v[80:83]
    v_mfma_f32_16x16x32_bf16 v[84:87], a[188:191], v[212:215], v[84:87]
    ds_write_b128 v53, v[100:103] offset:2048
    v_mfma_f32_16x16x32_bf16 v[88:91], a[216:219], v[212:215], v[88:91]
    s_waitcnt vmcnt(7)
    v_mfma_f32_16x16x32_bf16 v[72:75], a[108:111], v[216:219], v[72:75]
    buffer_load_dwordx4 v[196:199], v1, s[4:7], s61 offen offset:2048 sc1
    v_mfma_f32_16x16x32_bf16 v[76:79], a[136:139], v[216:219], v[76:79]
    ds_write_b128 v53, v[104:107] offset:3072
    v_mfma_f32_16x16x32_bf16 v[80:83], a[164:167], v[216:219], v[80:83]
    buffer_load_dword v27, v14, s[4:7], s65 offen sc1
    v_mfma_f32_16x16x32_bf16 v[84:87], a[192:195], v[216:219], v[84:87]
    ds_write_b128 v53, v[108:111] offset:4096
    v_mfma_f32_16x16x32_bf16 v[88:91], a[220:223], v[216:219], v[88:91]
    s_waitcnt vmcnt(8)
    v_mfma_f32_16x16x32_bf16 v[72:75], a[112:115], v[220:223], v[72:75]
    buffer_load_dwordx4 v[200:203], v1, s[4:7], s61 offen offset:3072 sc1
    v_mfma_f32_16x16x32_bf16 v[76:79], a[140:143], v[220:223], v[76:79]
    v_mfma_f32_16x16x32_bf16 v[80:83], a[168:171], v[220:223], v[80:83]
    v_mfma_f32_16x16x32_bf16 v[84:87], a[196:199], v[220:223], v[84:87]
    v_mfma_f32_16x16x32_bf16 v[88:91], a[224:227], v[220:223], v[88:91]
    s_waitcnt lgkmcnt(0)
    s_barrier
    s_waitcnt vmcnt(8)
    v_mfma_f32_16x16x32_bf16 v[72:75], a[116:119], v[224:227], v[72:75]
    s_add_u32 s61, s61, 4096
    buffer_load_dwordx4 v[204:207], v1, s[4:7], s61 offen offset:0 sc1
    v_mfma_f32_16x16x32_bf16 v[76:79], a[144:147], v[224:227], v[76:79]
    ds_read_b128 v[112:115], v55 offset:0
    v_mfma_f32_16x16x32_bf16 v[80:83], a[172:175], v[224:227], v[80:83]
    ds_read_b128 v[116:119], v55 offset:1024
    v_mfma_f32_16x16x32_bf16 v[84:87], a[200:203], v[224:227], v[84:87]
    ds_read_b128 v[120:123], v55 offset:2048
    v_mfma_f32_16x16x32_bf16 v[88:91], a[228:231], v[224:227], v[88:91]
    ds_read_b128 v[124:127], v55 offset:3072
    s_waitcnt vmcnt(7)
    v_mfma_f32_16x16x32_bf16 v[72:75], a[120:123], v[228:231], v[72:75]
    buffer_load_dwordx4 v[208:211], v1, s[4:7], s61 offen offset:1024 sc1
    v_mfma_f32_16x16x32_bf16 v[76:79], a[148:151], v[228:231], v[76:79]
    ds_read_b128 v[128:131], v55 offset:4096
    v_mfma_f32_16x16x32_bf16 v[80:83], a[176:179], v[228:231], v[80:83]
    ds_read_b128 v[132:135], v55 offset:5120
    v_mfma_f32_16x16x32_bf16 v[84:87], a[204:207], v[228:231], v[84:87]
    ds_read_b128 v[136:139], v55 offset:6144
    v_mfma_f32_16x16x32_bf16 v[88:91], a[232:235], v[228:231], v[88:91]
    ds_read_b128 v[140:143], v55 offset:7168
    s_waitcnt vmcnt(7)
    v_mfma_f32_16x16x32_bf16 v[72:75], a[124:127], v[184:187], v[72:75]
    buffer_load_dwordx4 v[212:215], v25, s[4:7], s61 offen offset:2048 sc1
    v_mfma_f32_16x16x32_bf16 v[76:79], a[152:155], v[184:187], v[76:79]
    ds_read_b128 v[144:147], v55 offset:8192
    v_mfma_f32_16x16x32_bf16 v[80:83], a[180:183], v[184:187], v[80:83]
    ds_read_b128 v[148:151], v55 offset:9216
    v_mfma_f32_16x16x32_bf16 v[84:87], a[208:211], v[184:187], v[84:87]
    v_mfma_f32_16x16x32_bf16 v[88:91], a[236:239], v[184:187], v[88:91]
    s_waitcnt vmcnt(7)
    v_mfma_f32_16x16x32_bf16 v[32:35], a[100:103], v[188:191], v[32:35]
    v_mfma_f32_16x16x32_bf16 v[36:39], a[128:131], v[188:191], v[36:39]
    s_waitcnt lgkmcnt(3)
    v_add_f32 v112, v112, v132
    v_add_f32_e64 v113, v113, v133
    v_mfma_f32_16x16x32_bf16 v[40:43], a[156:159], v[188:191], v[40:43]
    s_waitcnt vmcnt(4)
    v_sub_u32 v27, v27, v15
    v_cmp_ne_u32 vcc, 6, v27
    s_nop 0
    s_and_b32 vcc_hi, vcc_lo, 1
    s_cbranch_scc0 L_pxok_138
L_poll_139:
    buffer_load_dword v26, v14, s[4:7], s65 offen offset:0 sc1
    s_waitcnt vmcnt(0)
    v_sub_u32 v26, v26, v15
    v_cmp_ne_u32_e64 vcc, 6, v26
    s_nop 0
    s_and_b32 vcc_hi, vcc_lo, 1
    s_cbranch_scc0 L_polled_140
    s_sub_u32 s44, s44, 1
    s_cbranch_scc0 L_poll_139
    s_mov_b32 s44, 0
L_polled_140:
L_pxok_138:
    buffer_load_dwordx4 v[172:175], v1, s[8:11], s34 offen offset:0 sc1
    buffer_load_dwordx4 v[176:179], v1, s[8:11], s34 offen offset:1024 sc1
    buffer_load_dwordx2 v[180:181], v9, s[8:11], s34 offen offset:2048 sc1
    v_add_u32_e64 v0, 7, v15
    v_mfma_f32_16x16x32_bf16 v[44:47], a[184:187], v[188:191], v[44:47]
    ds_write_b128 v54, v[72:75] offset:0
    v_mfma_f32_16x16x32_bf16 v[48:51], a[212:215], v[188:191], v[48:51]
    v_add_f32 v114, v114, v134
    v_add_f32 v115, v115, v135
    v_mfma_f32_16x16x32_bf16 v[32:35], a[104:107], v[192:195], v[32:35]
    s_waitcnt lgkmcnt(3)
    v_add_f32 v116, v116, v136
    v_add_f32_e64 v117, v117, v137
    v_mfma_f32_16x16x32_bf16 v[36:39], a[132:135], v[192:195], v[36:39]
    ds_write_b128 v54, v[76:79] offset:1024
    v_mfma_f32_16x16x32_bf16 v[40:43], a[160:163], v[192:195], v[40:43]
    v_add_f32 v118, v118, v138
    v_add_f32 v119, v119, v139
    v_mfma_f32_16x16x32_bf16 v[44:47], a[188:191], v[192:195], v[44:47]
    ds_write_b128 v54, v[80:83] offset:2048
    v_mfma_f32_16x16x32_bf16 v[48:51], a[216:219], v[192:195], v[48:51]
    s_waitcnt lgkmcnt(4)
    v_add_f32 v120, v120, v140
    v_add_f32_e64 v121, v121, v141
    v_mfma_f32_16x16x32_bf16 v[32:35], a[108:111], v[196:199], v[32:35]
    v_add_f32 v122, v122, v142
    v_add_f32 v123, v123, v143
    v_mfma_f32_16x16x32_bf16 v[36:39], a[136:139], v[196:199], v[36:39]
    ds_write_b128 v54, v[84:87] offset:3072
    v_mfma_f32_16x16x32_bf16 v[40:43], a[164:167], v[196:199], v[40:43]
    s_waitcnt lgkmcnt(4)
    v_add_f32 v124, v124, v144
    v_add_f32_e64 v125, v125, v145
    v_mfma_f32_16x16x32_bf16 v[44:47], a[192:195], v[196:199], v[44:47]
    ds_write_b128 v54, v[88:91] offset:4096
    v_mfma_f32_16x16x32_bf16 v[48:51], a[220:223], v[196:199], v[48:51]
    v_add_f32_e64 v126, v126, v146
    v_add_f32 v127, v127, v147
    s_waitcnt vmcnt(6)
    v_mfma_f32_16x16x32_bf16 v[32:35], a[112:115], v[200:203], v[32:35]
    v_add_f32 v128, v128, v148
    v_add_f32 v129, v129, v149
    v_mfma_f32_16x16x32_bf16 v[36:39], a[140:143], v[200:203], v[36:39]
    v_add_f32 v130, v130, v150
    v_add_f32 v131, v131, v151
    v_mfma_f32_16x16x32_bf16 v[40:43], a[168:171], v[200:203], v[40:43]
    v_mfma_f32_16x16x32_bf16 v[44:47], a[196:199], v[200:203], v[44:47]
    v_mfma_f32_16x16x32_bf16 v[48:51], a[224:227], v[200:203], v[48:51]
    s_waitcnt lgkmcnt(0)
    s_barrier
    s_waitcnt vmcnt(5)
    v_mfma_f32_16x16x32_bf16 v[32:35], a[116:119], v[204:207], v[32:35]
    ds_read_b128 v[152:155], v55 offset:10240
    v_mfma_f32_16x16x32_bf16 v[36:39], a[144:147], v[204:207], v[36:39]
    ds_read_b128 v[156:159], v55 offset:11264
    v_mfma_f32_16x16x32_bf16 v[40:43], a[172:175], v[204:207], v[40:43]
    ds_read_b128 v[160:163], v55 offset:12288
    v_mfma_f32_16x16x32_bf16 v[44:47], a[200:203], v[204:207], v[44:47]
    ds_read_b128 v[164:167], v55 offset:13312
    v_mfma_f32_16x16x32_bf16 v[48:51], a[228:231], v[204:207], v[48:51]
    ds_read_b128 v[168:171], v55 offset:14336
    s_waitcnt vmcnt(4)
    v_mfma_f32_16x16x32_bf16 v[32:35], a[120:123], v[208:211], v[32:35]
    v_mfma_f32_16x16x32_bf16 v[36:39], a[148:151], v[208:211], v[36:39]
    v_mfma_f32_16x16x32_bf16 v[40:43], a[176:179], v[208:211], v[40:43]
    v_mfma_f32_16x16x32_bf16 v[44:47], a[204:207], v[208:211], v[44:47]
    s_waitcnt lgkmcnt(3)
    v_add_f32 v112, v112, v152
    v_add_f32_e64 v113, v113, v153
    v_mfma_f32_16x16x32_bf16 v[48:51], a[232:235], v[208:211], v[48:51]
    v_add_f32_e64 v114, v114, v154
    v_add_f32 v115, v115, v155
    s_waitcnt vmcnt(3)
    v_mfma_f32_16x16x32_bf16 v[32:35], a[124:127], v[212:215], v[32:35]
    s_waitcnt lgkmcnt(2)
    v_add_f32 v116, v116, v156
    v_add_f32_e64 v117, v117, v157
    v_mfma_f32_16x16x32_bf16 v[36:39], a[152:155], v[212:215], v[36:39]
    v_add_f32 v118, v118, v158
    v_add_f32 v119, v119, v159
    v_mfma_f32_16x16x32_bf16 v[40:43], a[180:183], v[212:215], v[40:43]
    s_waitcnt lgkmcnt(1)
    v_add_f32 v120, v120, v160
    v_add_f32_e64 v121, v121, v161
    v_mfma_f32_16x16x32_bf16 v[44:47], a[208:211], v[212:215], v[44:47]
    v_add_f32 v122, v122, v162
    v_add_f32 v123, v123, v163
    v_mfma_f32_16x16x32_bf16 v[48:51], a[236:239], v[212:215], v[48:51]
    s_waitcnt lgkmcnt(0)
    v_add_f32 v124, v124, v164
    v_add_f32 v125, v125, v165
    s_waitcnt vmcnt(0)
    v_mfma_f32_16x16x32_bf16 v[32:35], a[242:245], v[172:175], v[32:35]
    v_add_f32 v126, v126, v166
    v_add_f32 v127, v127, v167
    v_mfma_f32_16x16x32_bf16 v[36:39], a[240:243], v[172:175], v[36:39]
    v_add_f32 v128, v128, v168
    v_add_f32 v129, v129, v169
    v_mfma_f32_16x16x32_bf16 v[40:43], a[242:245], v[176:179], v[40:43]
    buffer_load_dword v28, v12, s[4:7], s46 offen offset:2048 sc1
    v_mfma_f32_16x16x32_bf16 v[44:47], a[240:243], v[176:179], v[44:47]
    v_add_f32 v130, v130, v170
    v_add_f32 v131, v131, v171
    v_mfma_f32_16x16x32_bf16 v[48:51], a[240:243], v[178:181], v[48:51]
    v_pk_add_f32 v[32:33], v[32:33], v[112:113]
    v_pk_add_f32 v[34:35], v[34:35], v[114:115]
    v_pk_add_f32 v[36:37], v[36:37], v[116:117]
    v_pk_add_f32 v[38:39], v[38:39], v[118:119]
    v_pk_add_f32 v[40:41], v[40:41], v[120:121]
    v_pk_add_f32 v[42:43], v[42:43], v[122:123]
    v_pk_add_f32 v[44:45], v[44:45], v[124:125]
    v_pk_add_f32 v[46:47], v[46:47], v[126:127]
    v_pk_add_f32 v[48:49], v[48:49], v[128:129]
    v_pk_add_f32 v[50:51], v[50:51], v[130:131]
L_layer1:
L_ph5:
    s_cmp_eq_u32 s43, 0
    s_cbranch_scc1 L_safe_141
    v_cvt_pk_bf16_f32 v56, v32, v33
    v_cvt_pk_bf16_f32 v58, v36, v37
    v_cvt_pk_bf16_f32 v57, v34, v35
    v_cvt_pk_bf16_f32 v59, v38, v39
    v_permlane16_swap_b32 v56, v58
    v_cvt_pk_bf16_f32 v60, v40, v41
    v_cvt_pk_bf16_f32 v62, v44, v45
    v_cvt_pk_bf16_f32 v61, v42, v43
    v_cvt_pk_bf16_f32 v63, v46, v47
    v_permlane16_swap_b32 v57, v59
    buffer_store_dwordx4 v[56:59], v3, s[8:11], s34 offen offset:0
    v_permlane16_swap_b32 v60, v62
    v_cvt_pk_bf16_f32 v64, v48, v49
    v_cvt_pk_bf16_f32 v66, v48, v49
    v_cvt_pk_bf16_f32 v65, v50, v51
    v_cvt_pk_bf16_f32 v67, v50, v51
    v_permlane16_swap_b32 v61, v63
    buffer_store_dwordx4 v[60:63], v3, s[8:11], s34 offen offset:1024
    v_permlane16_swap_b32 v64, v66
    v_permlane16_swap_b32 v65, v67
    buffer_store_dwordx4 v[64:67], v4, s[8:11], s34 offen offset:2048
    v_pk_add_f32 v[68:69], v[32:33], v[34:35]
    v_pk_mul_f32 v[70:71], v[32:33], v[32:33]
    v_pk_fma_f32 v[70:71], v[34:35], v[34:35], v[70:71]
    v_pk_add_f32 v[68:69], v[68:69], v[36:37]
    v_pk_fma_f32 v[70:71], v[36:37], v[36:37], v[70:71]
    v_pk_add_f32 v[68:69], v[68:69], v[38:39]
    v_pk_fma_f32 v[70:71], v[38:39], v[38:39], v[70:71]
    v_pk_add_f32 v[68:69], v[68:69], v[40:41]
    v_pk_fma_f32 v[70:71], v[40:41], v[40:41], v[70:71]
    v_pk_add_f32 v[68:69], v[68:69], v[42:43]
    v_pk_fma_f32 v[70:71], v[42:43], v[42:43], v[70:71]
    v_pk_add_f32 v[68:69], v[68:69], v[44:45]
    v_pk_fma_f32 v[70:71], v[44:45], v[44:45], v[70:71]
    v_pk_add_f32 v[68:69], v[68:69], v[46:47]
    v_pk_fma_f32 v[70:71], v[46:47], v[46:47], v[70:71]
    v_pk_add_f32 v[68:69], v[68:69], v[48:49]
    v_pk_fma_f32 v[70:71], v[48:49], v[48:49], v[70:71]
    v_pk_add_f32 v[68:69], v[68:69], v[50:51]
    v_pk_fma_f32 v[70:71], v[50:51], v[50:51], v[70:71]
    v_add_f32 v68, v68, v69
    v_add_f32 v69, v70, v71
    s_nop 1
    v_permlane16_swap_b32 v68, v69
    v_add_f32 v68, v68, v69
    v_mov_b32 v69, v68
    s_nop 1
    v_permlane32_swap_b32 v68, v69
    v_add_f32 v68, v68, v69
    v_mov_b32 v69, v68
    s_nop 1
    v_permlane16_swap_b32 v68, v69
    buffer_store_dwordx2 v[68:69], v8, s[4:7], s35 offen offset:0
    ds_read_b128 v[120:123], v236 offset:0
    ds_read_b128 v[124:127], v236 offset:1024
    ds_read_b128 v[128:131], v236 offset:2048
    ds_read_b128 v[132:135], v236 offset:3072
    s_waitcnt vmcnt(4)
    v_sub_u32 v28, v28, v15
    v_subrev_u32_e64 v28, 7, v28
    v_cmp_lt_u32 vcc, 1, v28
    s_nop 0
    s_and_b32 vcc_hi, vcc_lo, 4294901760
    s_cbranch_scc0 L_xearly_143
    s_waitcnt vmcnt(1)
    buffer_store_dword v0, v14, s[4:7], s49 offen offset:0
L_poll_145:
    buffer_load_dword v26, v12, s[4:7], s46 offen offset:2048 sc1
    s_waitcnt vmcnt(0)
    v_sub_u32 v26, v26, v15
    v_subrev_u32_e64 v26, 7, v26
    v_cmp_lt_u32 vcc, 1, v26
    s_nop 0
    s_and_b32 vcc_hi, vcc_lo, 4294901760
    s_cbranch_scc0 L_polled_146
    s_sub_u32 s44, s44, 1
    s_cbranch_scc0 L_poll_145
    s_mov_b32 s44, 0
L_polled_146:
    buffer_load_dwordx4 v[144:147], v2, s[8:11], s31 offen offset:0 sc1
    buffer_load_dwordx4 v[148:151], v2, s[8:11], s31 offen offset:512 sc1
    buffer_load_dwordx4 v[152:155], v2, s[8:11], s31 offen offset:1024 sc1
    buffer_load_dwordx4 v[156:159], v2, s[8:11], s31 offen offset:1536 sc1
    buffer_load_dwordx4 v[160:163], v2, s[8:11], s31 offen offset:2048 sc1
    s_branch L_xjoin_144
L_xearly_143:
    buffer_load_dwordx4 v[144:147], v2, s[8:11], s31 offen offset:0 sc1
    buffer_load_dwordx4 v[148:151], v2, s[8:11], s31 offen offset:512 sc1
    buffer_load_dwordx4 v[152:155], v2, s[8:11], s31 offen offset:1024 sc1
    buffer_load_dwordx4 v[156:159], v2, s[8:11], s31 offen offset:1536 sc1
    buffer_load_dwordx4 v[160:163], v2, s[8:11], s31 offen offset:2048 sc1
    s_waitcnt vmcnt(6)
    buffer_store_dword v0, v14, s[4:7], s49 offen offset:0
L_xjoin_144:
L_join_142:
    s_waitcnt vmcnt(4) lgkmcnt(2)
    v_mfma_f32_32x32x16_bf16 v[88:103], v[120:123], v[144:147], 0
    ds_read_b128 v[136:139], v236 offset:4096
    v_add_u32 v0, 1, v0
    s_cmp_eq_u32 s43, 0
    s_cbranch_scc1 L_safe_147
    buffer_store_dword v0, v14, s[4:7], s49 offen offset:0
L_join_148:
    v_mfma_f32_32x32x16_bf16 v[104:119], v[124:127], v[144:147], 0
    ds_read_b128 v[140:143], v236 offset:5120
    buffer_load_dwordx4 v[164:167], v2, s[8:11], s31 offen offset:2560 sc1
    buffer_load_dwordx4 v[168:171], v2, s[8:11], s31 offen offset:3072 sc1
    s_waitcnt vmcnt(6) lgkmcnt(2)
    v_mfma_f32_32x32x16_bf16 v[88:103], v[128:131], v[148:151], v[88:103]
    ds_read_b128 v[120:123], v236 offset:6144
    v_mfma_f32_32x32x16_bf16 v[104:119], v[132:135], v[148:151], v[104:119]
    ds_read_b128 v[124:127], v236 offset:7168
    buffer_load_dwordx4 v[172:175], v2, s[8:11], s31 offen offset:3584 sc1
    s_add_u32 s31, s31, 4096
    buffer_load_dwordx4 v[176:179], v2, s[8:11], s31 offen offset:0 sc1
    s_waitcnt vmcnt(7) lgkmcnt(2)
    v_mfma_f32_32x32x16_bf16 v[88:103], v[136:139], v[152:155], v[88:103]
    ds_read_b128 v[128:131], v236 offset:8192
    s_mul_i32 s56, s36, 3072
    s_sub_u32 s57, 21504, s56
    s_mul_i32 s58, s38, 27648
    s_add_u32 s63, s58, s45
    s_add_u32 s58, s63, 1458176
    v_mfma_f32_32x32x16_bf16 v[104:119], v[140:143], v[152:155], v[104:119]
    ds_read_b128 v[132:135], v236 offset:9216
    buffer_load_dwordx4 v[180:183], v2, s[8:11], s31 offen offset:512 sc1
    buffer_load_dwordx4 v[184:187], v2, s[8:11], s31 offen offset:1024 sc1
    s_cmp_eq_u32 s37, 7
    s_cselect_b32 s61, 0x10000000, s58
    s_sub_u32 s59, s53, s46
    s_lshl_b32 s59, s59, 6
    s_mul_i32 s60, s37, 131072
    s_add_u32 s59, s59, s60
    s_barrier
    s_waitcnt vmcnt(8) lgkmcnt(2)
    v_mfma_f32_32x32x16_bf16 v[88:103], v[120:123], v[156:159], v[88:103]
    ds_read_b128 v[136:139], v236 offset:10240
    s_lshr_b32 s28, s36, 1
    s_mul_i32 s28, s28, 61440
    s_add_u32 s28, s28, 2523136
    s_lshl_b32 s29, s36, 10
    s_add_u32 m0, s29, 102400
    s_nop 0
    buffer_load_dwordx4 v11, s[4:7], s28 offen offset:0 sc1 lds
    s_add_u32 s59, s59, 10551296
    s_sub_u32 s60, s59, 131072
    v_mov_b32 v31, 0x3f80
    v_mfma_f32_32x32x16_bf16 v[104:119], v[124:127], v[156:159], v[104:119]
    ds_read_b128 v[140:143], v236 offset:11264
    buffer_load_dwordx4 v[188:191], v2, s[8:11], s31 offen offset:1536 sc1
    buffer_load_dwordx4 v[144:147], v2, s[8:11], s31 offen offset:2048 sc1
    s_cmp_eq_u32 s37, 0
    s_cselect_b32 s62, 2147483648, 0
    s_cselect_b32 s60, s6, s60
    s_add_u32 s63, s63, 372736
    v_mul_u32_u24 v255, 1696, v23
    v_add_u32 v255, v255, v1
    s_waitcnt vmcnt(10) lgkmcnt(2)
    v_mfma_f32_32x32x16_bf16 v[88:103], v[128:131], v[160:163], v[88:103]
    ds_read_b128 v[120:123], v236 offset:12288
    s_add_u32 s28, s28, 122880
    s_add_u32 m0, s29, 106496
    s_nop 0
    buffer_load_dwordx4 v11, s[4:7], s28 offen offset:0 sc1 lds
    s_and_b32 s21, s38, 15
    s_mul_i32 s21, s21, 143360
    v_mfma_f32_32x32x16_bf16 v[104:119], v[132:135], v[160:163], v[104:119]
    ds_read_b128 v[124:127], v236 offset:13312
    buffer_load_dwordx4 v[148:151], v2, s[8:11], s31 offen offset:2560 sc1
    buffer_load_dwordx4 v[152:155], v2, s[8:11], s31 offen offset:3072 sc1
    s_lshl_b32 s22, s36, 12
    s_add_u32 s21, s21, s22
    s_waitcnt vmcnt(11) lgkmcnt(2)
    v_mfma_f32_32x32x16_bf16 v[88:103], v[136:139], v[164:167], v[88:103]
    ds_read_b128 v[128:131], v236 offset:14336
    buffer_load_dword v28, v12, s[4:7], s46 offen offset:2048 sc1
    s_add_u32 s21, s21, 5226496
    s_mul_i32 s18, s36, 221184
    v_mfma_f32_32x32x16_bf16 v[104:119], v[140:143], v[164:167], v[104:119]
    ds_read_b128 v[132:135], v236 offset:15360
    buffer_load_dwordx4 v[156:159], v2, s[8:11], s31 offen offset:3584 sc1
    s_add_u32 s18, s18, s45
    s_add_u32 s18, s18, 372736
    s_waitcnt vmcnt(12) lgkmcnt(2)
    v_mfma_f32_32x32x16_bf16 v[88:103], v[120:123], v[168:171], v[88:103]
    ds_read_b128 v[136:139], v236 offset:16384
    s_lshl_b32 s19, s39, 2
    s_add_u32 s12, s36, 1
    v_mfma_f32_32x32x16_bf16 v[104:119], v[124:127], v[168:171], v[104:119]
    ds_read_b128 v[140:143], v236 offset:17408
    s_add_u32 s31, s31, 4096
    buffer_load_dwordx4 v[160:163], v2, s[8:11], s31 offen offset:0 sc1
    s_and_b32 s12, s12, 3
    s_add_u32 s12, s12, s19
    s_waitcnt vmcnt(12) lgkmcnt(2)
    v_mfma_f32_32x32x16_bf16 v[88:103], v[128:131], v[172:175], v[88:103]
    ds_read_b128 v[120:123], v236 offset:18432
    s_add_u32 s28, s28, 122880
    s_add_u32 m0, s29, 110592
    s_nop 0
    buffer_load_dwordx4 v11, s[4:7], s28 offen offset:0 sc1 lds
    s_mul_i32 s12, s12, 640
    s_add_u32 s12, s12, s18
    v_mfma_f32_32x32x16_bf16 v[104:119], v[132:135], v[172:175], v[104:119]
    ds_read_b128 v[124:127], v236 offset:19456
    s_add_u32 s13, s36, 2
    s_and_b32 s13, s13, 3
    s_waitcnt vmcnt(12) lgkmcnt(2)
    v_mfma_f32_32x32x16_bf16 v[88:103], v[136:139], v[176:179], v[88:103]
    ds_read_b128 v[128:131], v236 offset:20480
    s_add_u32 s13, s13, s19
    s_mul_i32 s13, s13, 640
    v_mfma_f32_32x32x16_bf16 v[104:119], v[140:143], v[176:179], v[104:119]
    ds_read_b128 v[132:135], v236 offset:21504
    s_add_u32 s13, s13, s18
    s_add_u32 s14, s36, 3
    s_waitcnt vmcnt(11) lgkmcnt(2)
    v_mfma_f32_32x32x16_bf16 v[88:103], v[120:123], v[180:183], v[88:103]
    ds_read_b128 v[136:139], v236 offset:22528
    s_and_b32 s14, s14, 3
    s_add_u32 s14, s14, s19
    v_mfma_f32_32x32x16_bf16 v[104:119], v[124:127], v[180:183], v[104:119]
    ds_read_b128 v[140:143], v236 offset:23552
    s_mul_i32 s14, s14, 640
    s_add_u32 s14, s14, s18
    s_waitcnt vmcnt(10) lgkmcnt(2)
    v_mfma_f32_32x32x16_bf16 v[88:103], v[128:131], v[184:187], v[88:103]
    ds_read_b128 v[120:123], v236 offset:24576
    buffer_load_dword v238, v12, s[4:7], s46 offen offset:2048 sc1
    s_add_u32 s15, s36, 4
    s_and_b32 s15, s15, 3
    v_mfma_f32_32x32x16_bf16 v[104:119], v[132:135], v[184:187], v[104:119]
    ds_read_b128 v[124:127], v236 offset:25600
    s_add_u32 s15, s15, s19
    s_mul_i32 s15, s15, 640
    s_waitcnt vmcnt(9) lgkmcnt(2)
    v_mfma_f32_32x32x16_bf16 v[88:103], v[136:139], v[188:191], v[88:103]
    ds_read_b128 v[128:131], v236 offset:26624
    s_add_u32 s28, s28, 122880
    s_add_u32 m0, s29, 114688
    s_nop 0
    buffer_load_dwordx4 v11, s[4:7], s28 offen offset:0 sc1 lds
    s_waitcnt vmcnt(5)
    v_sub_u32 v28, v28, v15
    v_subrev_u32_e64 v28, 7, v28
    v_cmp_lt_u32 vcc, 1, v28
    s_nop 0
    s_and_b32 vcc_hi, vcc_lo, 65535
    s_cbranch_scc0 L_stok_149
L_poll_150:
    buffer_load_dword v28, v12, s[4:7], s46 offen offset:2048 sc1
    s_waitcnt vmcnt(0)
    v_sub_u32 v28, v28, v15
    v_subrev_u32 v28, 7, v28
    v_cmp_lt_u32 vcc, 1, v28
    s_nop 0
    s_and_b32 vcc_hi, vcc_lo, 65535
    s_cbranch_scc0 L_polled_151
    s_sub_u32 s44, s44, 1
    s_cbranch_scc0 L_poll_150
    s_mov_b32 s44, 0
L_polled_151:
L_stok_149:
    s_add_u32 s15, s15, s18
    s_lshr_b32 s19, s39, 1
    v_mfma_f32_32x32x16_bf16 v[104:119], v[140:143], v[188:191], v[104:119]
    ds_read_b128 v[132:135], v236 offset:27648
    s_add_u32 s30, s30, 8192
    buffer_load_dwordx4 v[164:167], v2, s[8:11], s30 offen offset:0 sc1
    buffer_load_dwordx4 v[168:171], v2, s[8:11], s31 offen offset:512 sc1
    s_sub_u32 s16, 10, s19
    s_add_u32 s18, s39, 1
    s_waitcnt lgkmcnt(2)
    v_mfma_f32_32x32x16_bf16 v[88:103], v[120:123], v[144:147], v[88:103]
    ds_read_b128 v[136:139], v236 offset:28672
    s_bfe_u32 s18, s18, 0x10001
    s_lshl_b32 s18, s18, 9
    v_mfma_f32_32x32x16_bf16 v[104:119], v[124:127], v[144:147], v[104:119]
    ds_read_b128 v[140:143], v236 offset:29696
    buffer_load_dwordx4 v[172:175], v2, s[8:11], s30 offen offset:512 sc1
    buffer_load_dwordx4 v[176:179], v2, s[8:11], s31 offen offset:1024 sc1
    s_lshl_b32 s19, s36, 7
    s_add_u32 s18, s18, s19
    s_waitcnt lgkmcnt(2)
    v_mfma_f32_32x32x16_bf16 v[88:103], v[128:131], v[148:151], v[88:103]
    ds_read_b128 v[120:123], v236 offset:30720
    s_add_u32 s17, s18, s46
    v_mfma_f32_32x32x16_bf16 v[104:119], v[132:135], v[148:151], v[104:119]
    ds_read_b128 v[124:127], v236 offset:31744
    buffer_load_dwordx4 v[180:183], v2, s[8:11], s30 offen offset:1024 sc1
    buffer_load_dwordx4 v[184:187], v2, s[8:11], s31 offen offset:1536 sc1
    s_waitcnt lgkmcnt(2)
    v_mfma_f32_32x32x16_bf16 v[88:103], v[136:139], v[152:155], v[88:103]
    ds_read_b128 v[128:131], v236 offset:32768
    v_mfma_f32_32x32x16_bf16 v[104:119], v[140:143], v[152:155], v[104:119]
    ds_read_b128 v[132:135], v236 offset:33792
    buffer_load_dwordx4 v[188:191], v2, s[8:11], s30 offen offset:1536 sc1
    buffer_load_dwordx4 v[144:147], v2, s[8:11], s31 offen offset:2048 sc1
    s_waitcnt vmcnt(12) lgkmcnt(2)
    v_mfma_f32_32x32x16_bf16 v[88:103], v[120:123], v[156:159], v[88:103]
    s_add_u32 s28, s28, 122880
    s_add_u32 m0, s29, 118784
    s_nop 0
    buffer_load_dwordx4 v11, s[4:7], s28 offen offset:0 sc1 lds
    v_mfma_f32_32x32x16_bf16 v[104:119], v[124:127], v[156:159], v[104:119]
    buffer_load_dwordx4 v[148:151], v2, s[8:11], s30 offen offset:2048 sc1
    s_waitcnt vmcnt(13) lgkmcnt(0)
    v_mfma_f32_32x32x16_bf16 v[88:103], v[128:131], v[160:163], v[88:103]
    ds_read_b128 v[136:139], v236 offset:34816
    v_mfma_f32_32x32x16_bf16 v[104:119], v[132:135], v[160:163], v[104:119]
    ds_read_b128 v[140:143], v236 offset:35840
    buffer_load_dwordx4 v[152:155], v2, s[8:11], s31 offen offset:2560 sc1
    s_waitcnt vmcnt(10)
    v_mfma_f32_32x32x16_bf16 v[56:71], v[128:131], v[164:167], 0
    v_mfma_f32_32x32x16_bf16 v[72:87], v[132:135], v[164:167], 0
    buffer_load_dwordx4 v[156:159], v2, s[8:11], s30 offen offset:2560 sc1
    s_waitcnt vmcnt(10) lgkmcnt(0)
    v_mfma_f32_32x32x16_bf16 v[88:103], v[136:139], v[168:171], v[88:103]
    ds_read_b128 v[120:123], v236 offset:36864
    s_add_u32 s28, s28, 122880
    s_add_u32 m0, s29, 122880
    s_nop 0
    buffer_load_dwordx4 v11, s[4:7], s28 offen offset:0 sc1 lds
    v_mfma_f32_32x32x16_bf16 v[104:119], v[140:143], v[168:171], v[104:119]
    ds_read_b128 v[124:127], v236 offset:37888
    buffer_load_dwordx4 v[160:163], v2, s[8:11], s31 offen offset:3072 sc1
    s_waitcnt vmcnt(11)
    v_mfma_f32_32x32x16_bf16 v[56:71], v[136:139], v[172:175], v[56:71]
    v_mfma_f32_32x32x16_bf16 v[72:87], v[140:143], v[172:175], v[72:87]
    buffer_load_dwordx4 v[164:167], v2, s[8:11], s30 offen offset:3072 sc1
    s_waitcnt vmcnt(11) lgkmcnt(0)
    v_mfma_f32_32x32x16_bf16 v[88:103], v[120:123], v[176:179], v[88:103]
    ds_read_b128 v[128:131], v236 offset:38912
    v_mfma_f32_32x32x16_bf16 v[104:119], v[124:127], v[176:179], v[104:119]
    ds_read_b128 v[132:135], v236 offset:39936
    buffer_load_dwordx4 v[168:171], v2, s[8:11], s31 offen offset:3584 sc1
    s_waitcnt vmcnt(11)
    v_mfma_f32_32x32x16_bf16 v[56:71], v[120:123], v[180:183], v[56:71]
    v_mfma_f32_32x32x16_bf16 v[72:87], v[124:127], v[180:183], v[72:87]
    buffer_load_dwordx4 v[172:175], v2, s[8:11], s30 offen offset:3584 sc1
    s_waitcnt vmcnt(11) lgkmcnt(0)
    v_mfma_f32_32x32x16_bf16 v[88:103], v[128:131], v[184:187], v[88:103]
    ds_read_b128 v[136:139], v236 offset:40960
    s_add_u32 s28, s28, 122880
    s_add_u32 m0, s29, 126976
    s_nop 0
    buffer_load_dwordx4 v11, s[4:7], s28 offen offset:0 sc1 lds
    v_sub_u32_e64 v238, v238, v15
    v_cmp_ne_u32 vcc, 8, v238
    s_nop 0
    s_and_b32 vcc_hi, vcc_lo, 4294967295
    s_cbranch_scc0 L_stok_152
L_poll_153:
    buffer_load_dword v238, v12, s[4:7], s46 offen offset:2048 sc1
    s_waitcnt vmcnt(0)
    v_sub_u32 v238, v238, v15
    v_cmp_ne_u32_e64 vcc, 8, v238
    s_nop 0
    s_and_b32 vcc_hi, vcc_lo, 4294967295
    s_cbranch_scc0 L_polled_154
    s_sub_u32 s44, s44, 1
    s_cbranch_scc0 L_poll_153
    s_mov_b32 s44, 0
L_polled_154:
L_stok_152:
    v_mfma_f32_32x32x16_bf16 v[104:119], v[132:135], v[184:187], v[104:119]
    ds_read_b128 v[140:143], v236 offset:41984
    s_add_u32 s31, s31, 4096
    buffer_load_dwordx4 v[176:179], v2, s[8:11], s31 offen offset:0 sc1
    s_waitcnt vmcnt(12)
    v_mfma_f32_32x32x16_bf16 v[56:71], v[128:131], v[188:191], v[56:71]
    s_lshl_b32 s67, s36, 12
    s_add_u32 m0, s67, 149504
    s_nop 0
    buffer_load_dwordx4 v1, s[4:7], s33 offen offset:0 sc1 lds
    buffer_load_dwordx4 v1, s[4:7], s33 offen offset:1024 sc1 lds
    v_mfma_f32_32x32x16_bf16 v[72:87], v[132:135], v[188:191], v[72:87]
    s_add_u32 s30, s30, 4096
    buffer_load_dwordx4 v[180:183], v2, s[8:11], s30 offen offset:0 sc1
    s_waitcnt vmcnt(14) lgkmcnt(0)
    v_mfma_f32_32x32x16_bf16 v[88:103], v[136:139], v[144:147], v[88:103]
    ds_read_b128 v[120:123], v236 offset:43008
    s_lshl_b32 s67, s36, 12
    s_add_u32 m0, s67, 147456
    s_nop 0
    buffer_load_dwordx4 v1, s[4:7], s32 offen offset:0 sc1 lds
    buffer_load_dwordx4 v1, s[4:7], s32 offen offset:1024 sc1 lds
    v_mfma_f32_32x32x16_bf16 v[104:119], v[140:143], v[144:147], v[104:119]
    ds_read_b128 v[124:127], v236 offset:44032
    buffer_load_dwordx4 v[184:187], v2, s[8:11], s31 offen offset:512 sc1
    s_waitcnt vmcnt(15)
    v_mfma_f32_32x32x16_bf16 v[56:71], v[136:139], v[148:151], v[56:71]
    v_mfma_f32_32x32x16_bf16 v[72:87], v[140:143], v[148:151], v[72:87]
    buffer_load_dwordx4 v[188:191], v2, s[8:11], s30 offen offset:512 sc1
    s_waitcnt vmcnt(15) lgkmcnt(0)
    v_mfma_f32_32x32x16_bf16 v[88:103], v[120:123], v[152:155], v[88:103]
    ds_read_b128 v[128:131], v236 offset:45056
    s_add_u32 s28, s28, 122880
    s_add_u32 m0, s29, 131072
    s_nop 0
    buffer_load_dwordx4 v11, s[4:7], s28 offen offset:0 sc1 lds
    v_mfma_f32_32x32x16_bf16 v[104:119], v[124:127], v[152:155], v[104:119]
    ds_read_b128 v[132:135], v236 offset:46080
    buffer_load_dwordx4 v[144:147], v2, s[8:11], s31 offen offset:1024 sc1
    s_waitcnt vmcnt(16)
    v_mfma_f32_32x32x16_bf16 v[56:71], v[120:123], v[156:159], v[56:71]
    s_branch L_over_455
L_chain6_0_0:
    s_branch L_chain6_0_1
L_over_455:
    v_mfma_f32_32x32x16_bf16 v[72:87], v[124:127], v[156:159], v[72:87]
    buffer_load_dwordx4 v[148:151], v2, s[8:11], s30 offen offset:1024 sc1
    s_waitcnt vmcnt(15) lgkmcnt(0)
    v_mfma_f32_32x32x16_bf16 v[88:103], v[128:131], v[160:163], v[88:103]
    ds_read_b128 v[136:139], v236 offset:47104
    v_mfma_f32_32x32x16_bf16 v[104:119], v[132:135], v[160:163], v[104:119]
    ds_read_b128 v[140:143], v236 offset:48128
    buffer_load_dwordx4 v[152:155], v2, s[8:11], s31 offen offset:1536 sc1
    s_waitcnt vmcnt(15)
    v_mfma_f32_32x32x16_bf16 v[56:71], v[128:131], v[164:167], v[56:71]
    v_mfma_f32_32x32x16_bf16 v[72:87], v[132:135], v[164:167], v[72:87]
    buffer_load_dwordx4 v[156:159], v2, s[8:11], s30 offen offset:1536 sc1
    s_barrier
    s_waitcnt vmcnt(15) lgkmcnt(0)
    v_mfma_f32_32x32x16_bf16 v[88:103], v[136:139], v[168:171], v[88:103]
    ds_read_b128 v[120:123], v237 offset:0
    v_mfma_f32_32x32x16_bf16 v[104:119], v[140:143], v[168:171], v[104:119]
    ds_read_b128 v[124:127], v237 offset:1024
    buffer_load_dwordx4 v[160:163], v2, s[8:11], s31 offen offset:2048 sc1
    s_waitcnt vmcnt(15)
    v_mfma_f32_32x32x16_bf16 v[56:71], v[136:139], v[172:175], v[56:71]
    v_mfma_f32_32x32x16_bf16 v[72:87], v[140:143], v[172:175], v[72:87]
    buffer_load_dwordx4 v[164:167], v2, s[8:11], s30 offen offset:2048 sc1
    s_waitcnt vmcnt(14) lgkmcnt(0)
    v_mfma_f32_32x32x16_bf16 v[88:103], v[120:123], v[176:179], v[88:103]
    ds_read_b128 v[128:131], v237 offset:2048
    v_mfma_f32_32x32x16_bf16 v[104:119], v[124:127], v[176:179], v[104:119]
    ds_read_b128 v[132:135], v237 offset:3072
    buffer_load_dwordx4 v[168:171], v2, s[8:11], s31 offen offset:2560 sc1
    s_waitcnt vmcnt(12)
    v_mfma_f32_32x32x16_bf16 v[56:71], v[120:123], v[180:183], v[56:71]
    v_mfma_f32_32x32x16_bf16 v[72:87], v[124:127], v[180:183], v[72:87]
    buffer_load_dwordx4 v[172:175], v2, s[8:11], s30 offen offset:2560 sc1
    s_waitcnt vmcnt(10) lgkmcnt(0)
    v_mfma_f32_32x32x16_bf16 v[88:103], v[128:131], v[184:187], v[88:103]
    ds_read_b128 v[136:139], v237 offset:4096
    v_mfma_f32_32x32x16_bf16 v[104:119], v[132:135], v[184:187], v[104:119]
    ds_read_b128 v[140:143], v237 offset:5120
    buffer_load_dwordx4 v[176:179], v2, s[8:11], s31 offen offset:3072 sc1
    s_waitcnt vmcnt(10)
    v_mfma_f32_32x32x16_bf16 v[56:71], v[128:131], v[188:191], v[56:71]
    v_mfma_f32_32x32x16_bf16 v[72:87], v[132:135], v[188:191], v[72:87]
    buffer_load_dwordx4 v[180:183], v2, s[8:11], s30 offen offset:3072 sc1
    s_waitcnt vmcnt(9) lgkmcnt(0)
    v_mfma_f32_32x32x16_bf16 v[88:103], v[136:139], v[144:147], v[88:103]
    ds_read_b128 v[120:123], v237 offset:6144
    ds_read_b64 v[200:201], v10 offset:63488
    ds_read_b64 v[202:203], v10 offset:63616
    v_mfma_f32_32x32x16_bf16 v[104:119], v[140:143], v[144:147], v[104:119]
    ds_read_b128 v[124:127], v237 offset:7168
    buffer_load_dwordx4 v[184:187], v2, s[8:11], s31 offen offset:3584 sc1
    ds_read_b64 v[204:205], v10 offset:63744
    ds_read_b64 v[206:207], v10 offset:63872
    ds_read_b64 v[192:193], v10 offset:61440
    s_waitcnt vmcnt(9)
    v_mfma_f32_32x32x16_bf16 v[56:71], v[136:139], v[148:151], v[56:71]
    ds_read_b64 v[194:195], v10 offset:61568
    ds_read_b64 v[196:197], v10 offset:61696
    ds_read_b64 v[198:199], v10 offset:61824
    v_mfma_f32_32x32x16_bf16 v[72:87], v[140:143], v[148:151], v[72:87]
    buffer_load_dwordx4 v[188:191], v2, s[8:11], s30 offen offset:3584 sc1
    s_waitcnt vmcnt(9) lgkmcnt(6)
    v_mfma_f32_32x32x16_bf16 v[88:103], v[120:123], v[152:155], v[88:103]
    ds_read_b128 v[128:131], v237 offset:8192
    v_mfma_f32_32x32x16_bf16 v[104:119], v[124:127], v[152:155], v[104:119]
    ds_read_b128 v[132:135], v237 offset:9216
    s_add_u32 s31, s31, 4096
    buffer_load_dwordx4 v[144:147], v2, s[8:11], s31 offen offset:0 sc1
    s_waitcnt lgkmcnt(2)
    v_add_f32 v200, v200, v204
    v_add_f32 v201, v201, v205
    s_waitcnt vmcnt(9)
    v_mfma_f32_32x32x16_bf16 v[56:71], v[120:123], v[156:159], v[56:71]
    v_add_f32 v202, v202, v206
    v_add_f32 v203, v203, v207
    v_add_f32_e64 v200, v200, v202
    v_mfma_f32_32x32x16_bf16 v[72:87], v[124:127], v[156:159], v[72:87]
    s_add_u32 s30, s30, 4096
    buffer_load_dwordx4 v[148:151], v2, s[8:11], s30 offen offset:0 sc1
    v_add_f32_e64 v201, v201, v203
    s_nop 1
    v_permlane32_swap_b32 v200, v201
    v_add_f32 v200, v200, v201
    s_waitcnt vmcnt(9) lgkmcnt(0)
    v_mfma_f32_32x32x16_bf16 v[88:103], v[128:131], v[160:163], v[88:103]
    ds_read_b128 v[136:139], v237 offset:10240
    s_lshl_b32 s68, s38, 2
    s_add_u32 s68, s68, s36
    s_mul_i32 s68, s68, 6912
    s_add_u32 s68, s68, s45
    s_add_u32 s68, s68, 360448
    v_add_u32 v30, 10, v21
    v_lshrrev_b32_e64 v30, 6, v30
    v_lshl_add_u32 v30, v30, 28, v1
    v_lshlrev_b32_e64 v30, 3, v30
    buffer_load_dword a252, v30, s[4:7], s68 offen offset:0 sc1
    v_mov_b32_e64 v201, v200
    s_nop 1
    v_permlane32_swap_b32 v200, v201
    v_mul_f32 v228, 0xbacccccd, v200
    v_mfma_f32_32x32x16_bf16 v[104:119], v[132:135], v[160:163], v[104:119]
    ds_read_b128 v[140:143], v237 offset:11264
    buffer_load_dwordx4 v[152:155], v2, s[8:11], s31 offen offset:512 sc1
    v_mul_f32 v201, 0x3acccccd, v201
    v_fma_f32 v201, -v228, v228, v201
    v_max_f32 v201, 0, v201
    s_waitcnt vmcnt(10)
    v_mfma_f32_32x32x16_bf16 v[56:71], v[128:131], v[164:167], v[56:71]
    v_add_f32 v201, 0x3727c5ac, v201
    v_rsq_f32_e64 v229, v201
    v_cvt_pk_bf16_f32 v234, v228, v228
    v_mfma_f32_32x32x16_bf16 v[72:87], v[132:135], v[164:167], v[72:87]
    buffer_load_dwordx4 v[156:159], v2, s[8:11], s30 offen offset:512 sc1
    v_lshlrev_b32 v235, 16, v234
    v_sub_f32 v235, v228, v235
    v_cvt_pk_bf16_f32 v235, v235, 0
    s_waitcnt vmcnt(10) lgkmcnt(0)
    v_mfma_f32_32x32x16_bf16 v[88:103], v[136:139], v[168:171], v[88:103]
    ds_read_b128 v[120:123], v237 offset:12288
    v_mul_f32 v230, 0x3ea52b5c, v229
    v_cndmask_b32 v231, v230, 0, s[50:51]
    v_add_f32 v192, v192, v196
    v_mfma_f32_32x32x16_bf16 v[104:119], v[140:143], v[168:171], v[104:119]
    ds_read_b128 v[124:127], v237 offset:13312
    buffer_load_dwordx4 v[160:163], v2, s[8:11], s31 offen offset:1024 sc1
    v_add_f32 v193, v193, v197
    v_add_f32 v194, v194, v198
    v_add_f32 v195, v195, v199
    s_waitcnt vmcnt(10)
    v_mfma_f32_32x32x16_bf16 v[56:71], v[136:139], v[172:175], v[56:71]
    v_add_f32 v192, v192, v194
    v_add_f32 v193, v193, v195
    s_nop 1
    v_permlane32_swap_b32 v192, v193
    v_mfma_f32_32x32x16_bf16 v[72:87], v[140:143], v[172:175], v[72:87]
    buffer_load_dwordx4 v[164:167], v2, s[8:11], s30 offen offset:1024 sc1
    v_add_f32_e64 v192, v192, v193
    v_mov_b32 v193, v192
    s_nop 1
    v_permlane32_swap_b32 v192, v193
    s_waitcnt vmcnt(10) lgkmcnt(0)
    v_mfma_f32_32x32x16_bf16 v[88:103], v[120:123], v[176:179], v[88:103]
    ds_read_b128 v[128:131], v237 offset:14336
    v_mul_f32 v224, 0xbacccccd, v192
    v_mul_f32 v193, 0x3acccccd, v193
    v_fma_f32 v193, -v224, v224, v193
    v_mfma_f32_32x32x16_bf16 v[104:119], v[124:127], v[176:179], v[104:119]
    ds_read_b128 v[132:135], v237 offset:15360
    buffer_load_dwordx4 v[168:171], v2, s[8:11], s31 offen offset:1536 sc1
    v_max_f32_e64 v193, 0, v193
    v_add_f32 v193, 0x3727c5ac, v193
    v_rsq_f32 v225, v193
    s_waitcnt vmcnt(10)
    v_mfma_f32_32x32x16_bf16 v[56:71], v[120:123], v[180:183], v[56:71]
    v_cvt_pk_bf16_f32 v232, v224, v224
    v_lshlrev_b32 v233, 16, v232
    v_sub_f32 v233, v224, v233
    v_mfma_f32_32x32x16_bf16 v[72:87], v[124:127], v[180:183], v[72:87]
    buffer_load_dwordx4 v[172:175], v2, s[8:11], s30 offen offset:1536 sc1
    v_cvt_pk_bf16_f32 v233, v233, 0
    v_mul_f32 v226, 0x3ea52b5c, v225
    v_cndmask_b32 v227, v226, 0, s[50:51]
    s_waitcnt vmcnt(10) lgkmcnt(0)
    v_mfma_f32_32x32x16_bf16 v[88:103], v[128:131], v[184:187], v[88:103]
    ds_read_b128 v[136:139], v237 offset:16384
    v_and_b32 v28, 31, v21
    v_lshrrev_b32 v29, 2, v23
    v_sub_u32 v28, v28, v29
    v_mov_b32 v29, 0xff800000
    v_cmp_gt_i32 s[24:25], 0, v28
    v_mfma_f32_32x32x16_bf16 v[104:119], v[132:135], v[184:187], v[104:119]
    ds_read_b128 v[140:143], v237 offset:17408
    buffer_load_dwordx4 v[176:179], v2, s[8:11], s31 offen offset:2048 sc1
    v_cndmask_b32 v192, 0, v29, s[24:25]
    v_xor_b32_e64 v208, v192, v29
    v_cmp_gt_i32 s[24:25], 1, v28
    s_waitcnt vmcnt(10)
    v_mfma_f32_32x32x16_bf16 v[56:71], v[128:131], v[188:191], v[56:71]
    v_cndmask_b32 v193, 0, v29, s[24:25]
    v_xor_b32 v209, v193, v29
    v_cmp_gt_i32 s[24:25], 2, v28
    v_mfma_f32_32x32x16_bf16 v[72:87], v[132:135], v[188:191], v[72:87]
    buffer_load_dwordx4 v[180:183], v2, s[8:11], s30 offen offset:2048 sc1
    v_cndmask_b32 v194, 0, v29, s[24:25]
    v_xor_b32_e64 v210, v194, v29
    v_cmp_gt_i32 s[24:25], 3, v28
    s_waitcnt vmcnt(10) lgkmcnt(0)
    v_mfma_f32_32x32x16_bf16 v[88:103], v[136:139], v[144:147], v[88:103]
    ds_read_b128 v[120:123], v237 offset:18432
    v_cndmask_b32 v195, 0, v29, s[24:25]
    v_xor_b32 v211, v195, v29
    v_cmp_gt_i32 s[24:25], 8, v28
    v_mfma_f32_32x32x16_bf16 v[104:119], v[140:143], v[144:147], v[104:119]
    ds_read_b128 v[124:127], v237 offset:19456
    buffer_load_dwordx4 v[184:187], v2, s[8:11], s31 offen offset:2560 sc1
    v_cndmask_b32 v196, 0, v29, s[24:25]
    v_xor_b32_e64 v212, v196, v29
    v_cmp_gt_i32 s[24:25], 9, v28
    s_waitcnt vmcnt(10)
    v_mfma_f32_32x32x16_bf16 v[56:71], v[136:139], v[148:151], v[56:71]
    v_cndmask_b32 v197, 0, v29, s[24:25]
    v_xor_b32 v213, v197, v29
    v_cmp_gt_i32 s[24:25], 10, v28
    v_mfma_f32_32x32x16_bf16 v[72:87], v[140:143], v[148:151], v[72:87]
    buffer_load_dwordx4 v[188:191], v2, s[8:11], s30 offen offset:2560 sc1
    v_cndmask_b32 v198, 0, v29, s[24:25]
    v_xor_b32_e64 v214, v198, v29
    v_cmp_gt_i32 s[24:25], 11, v28
    s_waitcnt vmcnt(9) lgkmcnt(0)
    v_mfma_f32_32x32x16_bf16 v[88:103], v[120:123], v[152:155], v[88:103]
    ds_read_b128 v[128:131], v237 offset:20480
    v_cndmask_b32 v199, 0, v29, s[24:25]
    v_xor_b32 v215, v199, v29
    v_cmp_gt_i32 s[24:25], 16, v28
    v_mfma_f32_32x32x16_bf16 v[104:119], v[124:127], v[152:155], v[104:119]
    ds_read_b128 v[132:135], v237 offset:21504
    buffer_load_dwordx4 v[144:147], v2, s[8:11], s31 offen offset:3072 sc1
    v_cndmask_b32 v200, 0, v29, s[24:25]
    v_xor_b32_e64 v216, v200, v29
    v_cmp_gt_i32 s[24:25], 17, v28
    s_waitcnt vmcnt(9)
    v_mfma_f32_32x32x16_bf16 v[56:71], v[120:123], v[156:159], v[56:71]
    v_cndmask_b32 v201, 0, v29, s[24:25]
    v_xor_b32 v217, v201, v29
    v_cmp_gt_i32 s[24:25], 18, v28
    v_mfma_f32_32x32x16_bf16 v[72:87], v[124:127], v[156:159], v[72:87]
    buffer_load_dwordx4 v[148:151], v2, s[8:11], s30 offen offset:3072 sc1
    v_cndmask_b32 v202, 0, v29, s[24:25]
    v_xor_b32_e64 v218, v202, v29
    v_cmp_gt_i32 s[24:25], 19, v28
    s_waitcnt vmcnt(9) lgkmcnt(0)
    v_mfma_f32_32x32x16_bf16 v[88:103], v[128:131], v[160:163], v[88:103]
    ds_read_b128 v[136:139], v237 offset:22528
    v_cndmask_b32 v203, 0, v29, s[24:25]
    v_xor_b32 v219, v203, v29
    v_cmp_gt_i32 s[24:25], 24, v28
    v_mfma_f32_32x32x16_bf16 v[104:119], v[132:135], v[160:163], v[104:119]
    ds_read_b128 v[140:143], v237 offset:23552
    buffer_load_dwordx4 v[152:155], v2, s[8:11], s31 offen offset:3584 sc1
    v_cndmask_b32 v204, 0, v29, s[24:25]
    v_xor_b32_e64 v220, v204, v29
    v_cmp_gt_i32 s[24:25], 25, v28
    s_waitcnt vmcnt(9)
    v_mfma_f32_32x32x16_bf16 v[56:71], v[128:131], v[164:167], v[56:71]
    v_cndmask_b32 v205, 0, v29, s[24:25]
    v_xor_b32 v221, v205, v29
    v_cmp_gt_i32 s[24:25], 26, v28
    v_mfma_f32_32x32x16_bf16 v[72:87], v[132:135], v[164:167], v[72:87]
    buffer_load_dwordx4 v[156:159], v2, s[8:11], s30 offen offset:3584 sc1
    v_cndmask_b32 v206, 0, v29, s[24:25]
    v_xor_b32_e64 v222, v206, v29
    v_cmp_gt_i32 s[24:25], 27, v28
    s_barrier
    s_waitcnt vmcnt(9) lgkmcnt(0)
    v_mfma_f32_32x32x16_bf16 v[88:103], v[136:139], v[168:171], v[88:103]
    ds_read_b128 v[120:123], v237 offset:24576
    v_cndmask_b32 v207, 0, v29, s[24:25]
    v_xor_b32_e64 v223, v207, v29
    v_mfma_f32_32x32x16_bf16 v[104:119], v[140:143], v[168:171], v[104:119]
    ds_read_b128 v[124:127], v237 offset:25600
    s_sub_u32 s30, s30, 16384
    buffer_load_dwordx4 v[160:163], v2, s[8:11], s30 offen offset:0 sc1
    s_waitcnt vmcnt(9)
    v_mfma_f32_32x32x16_bf16 v[56:71], v[136:139], v[172:175], v[56:71]
    v_mfma_f32_32x32x16_bf16 v[72:87], v[140:143], v[172:175], v[72:87]
    buffer_load_dwordx4 v[164:167], v2, s[8:11], s30 offen offset:512 sc1
    s_waitcnt vmcnt(9) lgkmcnt(0)
    v_mfma_f32_32x32x16_bf16 v[88:103], v[120:123], v[176:179], v[88:103]
    ds_read_b128 v[128:131], v237 offset:26624
    v_mfma_f32_32x32x16_bf16 v[104:119], v[124:127], v[176:179], v[104:119]
    ds_read_b128 v[132:135], v237 offset:27648
    buffer_load_dwordx4 v[168:171], v2, s[8:11], s30 offen offset:1024 sc1
    s_waitcnt vmcnt(9)
    v_mfma_f32_32x32x16_bf16 v[56:71], v[120:123], v[180:183], v[56:71]
    v_mfma_f32_32x32x16_bf16 v[72:87], v[124:127], v[180:183], v[72:87]
    buffer_load_dwordx4 v[172:175], v2, s[8:11], s30 offen offset:1536 sc1
    s_waitcnt vmcnt(9) lgkmcnt(0)
    v_mfma_f32_32x32x16_bf16 v[88:103], v[128:131], v[184:187], v[88:103]
    ds_read_b128 v[136:139], v237 offset:28672
    v_mfma_f32_32x32x16_bf16 v[104:119], v[132:135], v[184:187], v[104:119]
    ds_read_b128 v[140:143], v237 offset:29696
    buffer_load_dwordx4 v[176:179], v2, s[8:11], s30 offen offset:2048 sc1
    s_waitcnt vmcnt(9)
    v_mfma_f32_32x32x16_bf16 v[56:71], v[128:131], v[188:191], v[56:71]
    v_mfma_f32_32x32x16_bf16 v[72:87], v[132:135], v[188:191], v[72:87]
    buffer_load_dwordx4 v[180:183], v2, s[8:11], s30 offen offset:2560 sc1
    s_waitcnt vmcnt(9) lgkmcnt(0)
    v_mfma_f32_32x32x16_bf16 v[88:103], v[136:139], v[144:147], v[88:103]
    ds_read_b128 v[120:123], v237 offset:30720
    v_mfma_f32_32x32x16_bf16 v[104:119], v[140:143], v[144:147], v[104:119]
    ds_read_b128 v[124:127], v237 offset:31744
    buffer_load_dwordx4 v[184:187], v2, s[8:11], s30 offen offset:3072 sc1
    s_waitcnt vmcnt(9)
    v_mfma_f32_32x32x16_bf16 v[56:71], v[136:139], v[148:151], v[56:71]
    v_mfma_f32_32x32x16_bf16 v[72:87], v[140:143], v[148:151], v[72:87]
    buffer_load_dwordx4 v[188:191], v2, s[8:11], s30 offen offset:3584 sc1
    s_waitcnt vmcnt(9) lgkmcnt(0)
    v_mfma_f32_32x32x16_bf16 v[88:103], v[120:123], v[152:155], v[88:103]
    ds_read_b128 v[128:131], v236 offset:0
    v_mfma_f32_32x32x16_bf16 v[104:119], v[124:127], v[152:155], v[104:119]
    ds_read_b128 v[132:135], v236 offset:1024
    s_add_u32 s30, s30, 4096
    buffer_load_dwordx4 v[144:147], v2, s[8:11], s30 offen offset:0 sc1
    v_mfma_f32_32x32x8bf16_1k v[88:103], a[248:249], v[234:235], v[88:103]
    v_mfma_f32_32x32x8bf16_1k v[104:119], a[250:251], v[234:235], v[104:119]
    s_waitcnt vmcnt(9)
    v_mfma_f32_32x32x16_bf16 v[56:71], v[120:123], v[156:159], v[56:71]
    ds_read_b128 v[136:139], v236 offset:2048
    v_mfma_f32_32x32x16_bf16 v[72:87], v[124:127], v[156:159], v[72:87]
    ds_read_b128 v[140:143], v236 offset:3072
    buffer_load_dwordx4 v[148:151], v2, s[8:11], s30 offen offset:512 sc1
    v_add_u32 v26, s57, v16
    v_add_u32_e64 v27, s57, v17
    v_add_u32 v28, s57, v18
    s_waitcnt vmcnt(9) lgkmcnt(2)
    v_mfma_f32_32x32x16_bf16 v[56:71], v[128:131], v[160:163], v[56:71]
    ds_read_b128 v[120:123], v236 offset:4096
    v_mul_f32 v104, v104, v229
    v_mul_f32 v105, v105, v229
    v_mul_f32 v106, v106, v229
    v_mul_f32 v107, v107, v229
    v_mul_f32 v108, v108, v229
    v_mul_f32 v109, v109, v229
    v_mfma_f32_32x32x16_bf16 v[72:87], v[132:135], v[160:163], v[72:87]
    ds_read_b128 v[124:127], v236 offset:5120
    buffer_load_dwordx4 v[152:155], v2, s[8:11], s30 offen offset:1024 sc1
    v_mul_f32 v110, v110, v229
    v_mul_f32 v111, v111, v229
    v_mul_f32 v112, v112, v229
    v_mul_f32 v113, v113, v229
    v_mul_f32_e64 v114, v114, v229
    v_mul_f32 v115, v115, v229
    s_waitcnt vmcnt(9) lgkmcnt(2)
    v_mfma_f32_32x32x16_bf16 v[56:71], v[136:139], v[164:167], v[56:71]
    ds_read_b128 v[128:131], v236 offset:6144
    v_mul_f32 v116, v116, v229
    v_mul_f32 v117, v117, v229
    v_mul_f32 v118, v118, v229
    v_mul_f32 v119, v119, v229
    v_cvt_pk_bf16_f32 v104, v104, v105
    v_cvt_pk_bf16_f32 v105, v106, v107
    v_mfma_f32_32x32x16_bf16 v[72:87], v[140:143], v[164:167], v[72:87]
    ds_read_b128 v[132:135], v236 offset:7168
    buffer_load_dwordx4 v[156:159], v2, s[8:11], s30 offen offset:1536 sc1
    v_cvt_pk_bf16_f32 v106, v108, v109
    v_cvt_pk_bf16_f32 v107, v110, v111
    v_cvt_pk_bf16_f32 v108, v112, v113
    v_cvt_pk_bf16_f32 v109, v114, v115
    v_cvt_pk_bf16_f32 v110, v116, v117
    v_cvt_pk_bf16_f32 v111, v118, v119
    s_waitcnt vmcnt(9) lgkmcnt(2)
    v_mfma_f32_32x32x16_bf16 v[56:71], v[120:123], v[168:171], v[56:71]
    ds_read_b128 v[136:139], v236 offset:8192
    v_cndmask_b32 v110, v110, v31, s[50:51]
    v_cndmask_b32 v111, v111, 0, s[50:51]
    v_mul_f32 v112, v96, v229
    v_mul_f32 v113, v97, v229
    v_mul_f32 v114, v98, v229
    v_mfma_f32_32x32x16_bf16 v[72:87], v[124:127], v[168:171], v[72:87]
    ds_read_b128 v[140:143], v236 offset:9216
    buffer_load_dwordx4 v[160:163], v2, s[8:11], s30 offen offset:2048 sc1
    v_mul_f32 v115, v99, v229
    v_mul_f32 v116, v100, v229
    v_mul_f32 v117, v101, v229
    v_mul_f32 v118, v102, v229
    v_mul_f32 v119, v103, v229
    s_waitcnt vmcnt(9) lgkmcnt(2)
    v_mfma_f32_32x32x16_bf16 v[56:71], v[128:131], v[172:175], v[56:71]
    ds_read_b128 v[120:123], v236 offset:10240
    v_cvt_pk_bf16_f32 v112, v112, v113
    v_cvt_pk_bf16_f32 v113, v114, v115
    v_cvt_pk_bf16_f32 v114, v116, v117
    v_cvt_pk_bf16_f32 v115, v118, v119
    ds_write_b128 v26, v[104:107] offset:24576
    v_mfma_f32_32x32x16_bf16 v[72:87], v[132:135], v[172:175], v[72:87]
    ds_read_b128 v[124:127], v236 offset:11264
    buffer_load_dwordx4 v[164:167], v2, s[8:11], s30 offen offset:2560 sc1
    v_mul_f32 v96, v96, v231
    v_mul_f32 v97, v97, v231
    v_mul_f32 v98, v98, v231
    v_mul_f32 v99, v99, v231
    ds_write_b128 v28, v[108:111] offset:24576
    v_mul_f32 v88, v88, v230
    s_waitcnt vmcnt(9) lgkmcnt(4)
    v_mfma_f32_32x32x16_bf16 v[56:71], v[136:139], v[176:179], v[56:71]
    ds_read_b128 v[128:131], v236 offset:12288
    v_mul_f32 v89, v89, v230
    v_mul_f32 v90, v90, v230
    v_mul_f32 v91, v91, v230
    v_mul_f32 v92, v92, v230
    v_mul_f32 v93, v93, v230
    v_mul_f32 v94, v94, v230
    v_mfma_f32_32x32x16_bf16 v[72:87], v[140:143], v[176:179], v[72:87]
    ds_read_b128 v[132:135], v236 offset:13312
    buffer_load_dwordx4 v[168:171], v2, s[8:11], s30 offen offset:3072 sc1
    v_mul_f32_e64 v95, v95, v230
    ds_write_b128 v27, v[112:115] offset:24576
    v_cvt_pk_bf16_f32 v248, v88, v89
    v_cvt_pk_bf16_f32 v249, v90, v91
    v_cvt_pk_bf16_f32 v250, v92, v93
    v_cvt_pk_bf16_f32 v251, v94, v95
    s_waitcnt vmcnt(9) lgkmcnt(4)
    v_mfma_f32_32x32x16_bf16 v[56:71], v[120:123], v[180:183], v[56:71]
    ds_read_b128 v[136:139], v236 offset:14336
    v_cvt_pk_bf16_f32 v252, v96, v97
    v_cvt_pk_bf16_f32 v253, v98, v99
    v_mfma_f32_32x32x16_bf16 v[72:87], v[124:127], v[180:183], v[72:87]
    ds_read_b128 v[140:143], v236 offset:15360
    buffer_load_dwordx4 v[172:175], v2, s[8:11], s30 offen offset:3584 sc1
    buffer_store_dwordx4 v[104:107], v26, s[4:7], s61 offen offset:0 sc1
    s_waitcnt vmcnt(10) lgkmcnt(3)
    v_mfma_f32_32x32x16_bf16 v[56:71], v[128:131], v[184:187], v[56:71]
    ds_read_b128 v[120:123], v236 offset:16384
    buffer_store_dwordx4 v[108:111], v28, s[4:7], s61 offen offset:0 sc1
    v_mfma_f32_32x32x16_bf16 v[72:87], v[132:135], v[184:187], v[72:87]
    ds_read_b128 v[124:127], v236 offset:17408
    buffer_store_dwordx4 v[112:115], v27, s[4:7], s61 offen offset:0 sc1
    s_waitcnt vmcnt(11) lgkmcnt(2)
    v_mfma_f32_32x32x16_bf16 v[56:71], v[136:139], v[188:191], v[56:71]
    ds_read_b128 v[128:131], v236 offset:18432
    v_mfma_f32_32x32x16_bf16 v[72:87], v[140:143], v[188:191], v[72:87]
    ds_read_b128 v[132:135], v236 offset:19456
    s_waitcnt vmcnt(10) lgkmcnt(2)
    v_mfma_f32_32x32x16_bf16 v[56:71], v[120:123], v[144:147], v[56:71]
    ds_read_b128 v[136:139], v236 offset:20480
    v_mfma_f32_32x32x16_bf16 v[72:87], v[124:127], v[144:147], v[72:87]
    ds_read_b128 v[140:143], v236 offset:21504
    s_waitcnt vmcnt(9) lgkmcnt(2)
    v_mfma_f32_32x32x16_bf16 v[56:71], v[128:131], v[148:151], v[56:71]
    ds_read_b128 v[120:123], v236 offset:22528
    v_mfma_f32_32x32x16_bf16 v[72:87], v[132:135], v[148:151], v[72:87]
    ds_read_b128 v[124:127], v236 offset:23552
    s_waitcnt vmcnt(8) lgkmcnt(2)
    v_mfma_f32_32x32x16_bf16 v[56:71], v[136:139], v[152:155], v[56:71]
    ds_read_b128 v[128:131], v236 offset:24576
    v_mfma_f32_32x32x16_bf16 v[72:87], v[140:143], v[152:155], v[72:87]
    ds_read_b128 v[132:135], v236 offset:25600
    s_waitcnt vmcnt(7) lgkmcnt(2)
    v_mfma_f32_32x32x16_bf16 v[56:71], v[120:123], v[156:159], v[56:71]
    ds_read_b128 v[136:139], v236 offset:26624
    v_mfma_f32_32x32x16_bf16 v[72:87], v[124:127], v[156:159], v[72:87]
    ds_read_b128 v[140:143], v236 offset:27648
    s_waitcnt vmcnt(6) lgkmcnt(2)
    v_mfma_f32_32x32x16_bf16 v[56:71], v[128:131], v[160:163], v[56:71]
    ds_read_b128 v[120:123], v236 offset:28672
    v_mfma_f32_32x32x16_bf16 v[72:87], v[132:135], v[160:163], v[72:87]
    ds_read_b128 v[124:127], v236 offset:29696
    s_waitcnt vmcnt(5) lgkmcnt(2)
    v_mfma_f32_32x32x16_bf16 v[56:71], v[136:139], v[164:167], v[56:71]
    ds_read_b128 v[128:131], v236 offset:30720
    v_mfma_f32_32x32x16_bf16 v[72:87], v[140:143], v[164:167], v[72:87]
    ds_read_b128 v[132:135], v236 offset:31744
    s_waitcnt vmcnt(4) lgkmcnt(2)
    v_mfma_f32_32x32x16_bf16 v[56:71], v[120:123], v[168:171], v[56:71]
    v_mfma_f32_32x32x16_bf16 v[72:87], v[124:127], v[168:171], v[72:87]
    s_waitcnt vmcnt(3) lgkmcnt(0)
    v_mfma_f32_32x32x16_bf16 v[56:71], v[128:131], v[172:175], v[56:71]
    v_mfma_f32_32x32x16_bf16 v[72:87], v[132:135], v[172:175], v[72:87]
    v_mfma_f32_32x32x8bf16_1k v[56:71], a[248:249], v[232:233], v[56:71]
    v_mfma_f32_32x32x8bf16_1k v[72:87], a[250:251], v[232:233], v[72:87]
L_ph6:
    s_cmp_eq_u32 s36, 1
    s_cbranch_scc1 L_att1_156
    s_cmp_eq_u32 s36, 2
    s_cbranch_scc1 L_att2_157
    s_cmp_eq_u32 s36, 3
    s_cbranch_scc1 L_att3_158
L_att0_155:
    ds_read_b128 v[136:139], v16 offset:46080
    ds_read_b64 v[140:141], v18 offset:46080
    ds_read_b64_tr_b16 v[152:153], v19 offset:46080
    ds_read_b64_tr_b16 v[154:155], v20 offset:46080
    ds_read_b64_tr_b16 v[156:157], v19 offset:46336
    ds_read_b64_tr_b16 v[158:159], v20 offset:46336
    v_add_u32 v26, s56, v16
    v_add_u32 v27, s56, v17
    v_add_u32 v28, s56, v18
    v_pk_mul_f32 v[72:73], v[72:73], v[224:225] op_sel:[0,1] op_sel_hi:[1,1]
    v_pk_mul_f32 v[74:75], v[74:75], v[224:225] op_sel:[0,1] op_sel_hi:[1,1]
    v_pk_mul_f32 v[76:77], v[76:77], v[224:225] op_sel:[0,1] op_sel_hi:[1,1]
    v_pk_mul_f32 v[78:79], v[78:79], v[224:225] op_sel:[0,1] op_sel_hi:[1,1]
    v_pk_mul_f32 v[80:81], v[80:81], v[224:225] op_sel:[0,1] op_sel_hi:[1,1]
    v_pk_mul_f32 v[82:83], v[82:83], v[224:225] op_sel:[0,1] op_sel_hi:[1,1]
    v_pk_mul_f32 v[84:85], v[84:85], v[224:225] op_sel:[0,1] op_sel_hi:[1,1]
    v_pk_mul_f32 v[86:87], v[86:87], v[224:225] op_sel:[0,1] op_sel_hi:[1,1]
    v_cvt_pk_bf16_f32 v72, v72, v73
    v_cvt_pk_bf16_f32 v73, v74, v75
    v_cvt_pk_bf16_f32 v74, v76, v77
    v_cvt_pk_bf16_f32 v75, v78, v79
    v_cvt_pk_bf16_f32 v76, v80, v81
    v_cvt_pk_bf16_f32 v77, v82, v83
    v_cvt_pk_bf16_f32 v78, v84, v85
    v_cvt_pk_bf16_f32 v79, v86, v87
    v_cndmask_b32 v78, v78, v31, s[50:51]
    v_cndmask_b32 v79, v79, 0, s[50:51]
    buffer_store_dwordx4 v[72:75], v26, s[4:7], s61 offen offset:0 sc1
    v_pk_mul_f32 v[80:81], v[64:65], v[224:225] op_sel:[0,1] op_sel_hi:[1,1]
    v_pk_mul_f32 v[82:83], v[66:67], v[224:225] op_sel:[0,1] op_sel_hi:[1,1]
    v_pk_mul_f32 v[84:85], v[68:69], v[224:225] op_sel:[0,1] op_sel_hi:[1,1]
    v_pk_mul_f32 v[86:87], v[70:71], v[224:225] op_sel:[0,1] op_sel_hi:[1,1]
    buffer_store_dwordx4 v[76:79], v28, s[4:7], s61 offen offset:0 sc1
    v_cvt_pk_bf16_f32 v80, v80, v81
    v_cvt_pk_bf16_f32 v81, v82, v83
    v_cvt_pk_bf16_f32 v82, v84, v85
    v_cvt_pk_bf16_f32 v83, v86, v87
    ds_write_b128 v26, v[72:75] offset:24576
    buffer_store_dwordx4 v[80:83], v27, s[4:7], s61 offen offset:0 sc1
    v_pk_mul_f32 v[64:65], v[64:65], v[226:227] op_sel:[0,1] op_sel_hi:[1,1]
    v_pk_mul_f32 v[66:67], v[66:67], v[226:227] op_sel:[0,1] op_sel_hi:[1,1]
    ds_write_b128 v28, v[76:79] offset:24576
    v_pk_mul_f32 v[56:57], v[56:57], v[226:227] op_sel:[0,0] op_sel_hi:[1,0]
    v_pk_mul_f32 v[58:59], v[58:59], v[226:227] op_sel:[0,0] op_sel_hi:[1,0]
    v_pk_mul_f32 v[60:61], v[60:61], v[226:227] op_sel:[0,0] op_sel_hi:[1,0]
    v_pk_mul_f32 v[62:63], v[62:63], v[226:227] op_sel:[0,0] op_sel_hi:[1,0]
    ds_write_b128 v27, v[80:83] offset:24576
    s_waitcnt vmcnt(3)
    buffer_store_dword v15, v24, s[4:7], s59 offen offset:0 sc1
    s_waitcnt lgkmcnt(7)
    v_mfma_f32_32x32x16_bf16 v[88:103], v[136:139], v[248:251], v[192:207]
    v_mfma_f32_32x32x8bf16_1k v[88:103], v[140:141], v[252:253], v[88:103]
    s_waitcnt lgkmcnt(0)
    s_barrier
    ds_read_b128 v[144:147], v16 offset:43008
    ds_read_b64 v[148:149], v18 offset:43008
    v_cvt_pk_bf16_f32 v240, v56, v57
    v_cvt_pk_bf16_f32 v241, v58, v59
    v_cvt_pk_bf16_f32 v242, v60, v61
    v_cvt_pk_bf16_f32 v243, v62, v63
    v_cvt_pk_bf16_f32 v244, v64, v65
    v_cvt_pk_bf16_f32 v245, v66, v67
    s_add_u32 s61, s58, -4079616
    v_add_u32 v31, s62, v1
    s_mov_b32 s56, s63
    v_add_u32 v0, 9, v15
    v_exp_f32 v88, v88
    v_exp_f32 v89, v89
    v_exp_f32 v90, v90
    v_exp_f32 v91, v91
    s_waitcnt lgkmcnt(0)
    v_mfma_f32_32x32x16_bf16 v[104:119], v[144:147], v[248:251], 0
    ds_read_b128 v[136:139], v16 offset:39936
    ds_read_b64 v[140:141], v18 offset:39936
    v_exp_f32 v92, v92
    v_exp_f32 v93, v93
    v_exp_f32 v94, v94
    v_exp_f32 v95, v95
    v_mfma_f32_32x32x8bf16_1k v[104:119], v[148:149], v[252:253], v[104:119]
    ds_read_b64_tr_b16 v[160:161], v19 offset:43008
    ds_read_b64_tr_b16 v[162:163], v20 offset:43008
    ds_read_b64_tr_b16 v[164:165], v19 offset:43264
    ds_read_b64_tr_b16 v[166:167], v20 offset:43264
    v_cvt_pk_bf16_f32 v120, v88, v89
    v_cvt_pk_bf16_f32 v121, v90, v91
    v_cvt_pk_bf16_f32 v122, v92, v93
    v_cvt_pk_bf16_f32 v123, v94, v95
    v_exp_f32 v96, v96
    v_exp_f32 v97, v97
    v_exp_f32 v98, v98
    v_exp_f32 v99, v99
    v_mfma_f32_32x32x16_bf16 v[72:87], v[152:155], v[120:123], 0
    s_waitcnt lgkmcnt(2)
    v_exp_f32 v100, v100
    v_exp_f32 v101, v101
    v_exp_f32 v102, v102
    v_exp_f32_e64 v103, v103
    v_cvt_pk_bf16_f32 v124, v96, v97
    v_cvt_pk_bf16_f32 v125, v98, v99
    v_cvt_pk_bf16_f32 v126, v100, v101
    v_cvt_pk_bf16_f32 v127, v102, v103
    s_lshl_b32 s68, s38, 2
    s_add_u32 s68, s68, s36
    s_mul_i32 s68, s68, 2560
    s_mul_i32 s69, s38, 17408
    s_add_u32 s68, s68, s69
    s_add_u32 s68, s68, s45
    s_add_u32 s68, s68, 372736
    v_add_u32 v168, 44, v21
    v_lshrrev_b32 v168, 6, v168
    v_lshl_add_u32 v168, v168, 28, v1
    v_lshlrev_b32_e64 v168, 3, v168
    buffer_load_dword a252, v168, s[4:7], s68 offen offset:0 sc1
    v_mfma_f32_32x32x16_bf16 v[88:103], v[136:139], v[248:251], 0
    ds_read_b128 v[144:147], v16 offset:36864
    ds_read_b64 v[148:149], v18 offset:36864
    v_exp_f32 v104, v104
    v_exp_f32 v105, v105
    v_exp_f32 v106, v106
    v_exp_f32 v107, v107
    v_mfma_f32_32x32x8bf16_1k v[88:103], v[140:141], v[252:253], v[88:103]
    ds_read_b64_tr_b16 v[152:153], v19 offset:39936
    ds_read_b64_tr_b16 v[154:155], v20 offset:39936
    v_exp_f32 v108, v108
    v_exp_f32 v109, v109
    v_exp_f32 v110, v110
    v_exp_f32 v111, v111
    v_mfma_f32_32x32x16_bf16 v[72:87], v[156:159], v[124:127], v[72:87]
    ds_read_b64_tr_b16 v[156:157], v19 offset:40192
    ds_read_b64_tr_b16 v[158:159], v20 offset:40192
    v_cvt_pk_bf16_f32 v128, v104, v105
    v_cvt_pk_bf16_f32 v129, v106, v107
    v_cvt_pk_bf16_f32 v130, v108, v109
    v_cvt_pk_bf16_f32 v131, v110, v111
    v_exp_f32 v112, v112
    v_exp_f32 v113, v113
    v_exp_f32 v114, v114
    v_exp_f32 v115, v115
    v_mfma_f32_32x32x16_bf16 v[72:87], v[160:163], v[128:131], v[72:87]
    s_branch L_over_456
L_chain6_1_0:
    s_branch L_chain6_1_1
L_over_456:
    s_waitcnt lgkmcnt(2)
    v_exp_f32 v116, v116
    v_exp_f32 v117, v117
    v_exp_f32 v118, v118
    v_exp_f32_e64 v119, v119
    v_cvt_pk_bf16_f32 v132, v112, v113
    v_cvt_pk_bf16_f32 v133, v114, v115
    v_cvt_pk_bf16_f32 v134, v116, v117
    v_cvt_pk_bf16_f32 v135, v118, v119
    buffer_load_dword v224, v14, s[4:7], s60 offen offset:0 sc1
    s_lshl_b32 s68, s38, 2
    s_add_u32 s68, s68, s36
    s_mul_i32 s68, s68, 2560
    s_mul_i32 s69, s37, 327680
    s_add_u32 s68, s68, s69
    v_add_u32 v169, 44, v21
    v_lshrrev_b32_e64 v169, 6, v169
    v_lshl_add_u32 v169, v169, 28, v1
    v_lshlrev_b32_e64 v169, 3, v169
    buffer_load_dword a252, v169, s[8:11], s68 offen offset:0 sc1
    v_mfma_f32_32x32x16_bf16 v[104:119], v[144:147], v[248:251], 0
    ds_read_b128 v[136:139], v16 offset:33792
    ds_read_b64 v[140:141], v18 offset:33792
    v_exp_f32 v88, v88
    v_exp_f32 v89, v89
    v_exp_f32 v90, v90
    v_exp_f32 v91, v91
    v_mfma_f32_32x32x8bf16_1k v[104:119], v[148:149], v[252:253], v[104:119]
    ds_read_b64_tr_b16 v[160:161], v19 offset:36864
    ds_read_b64_tr_b16 v[162:163], v20 offset:36864
    v_exp_f32 v92, v92
    v_exp_f32 v93, v93
    v_exp_f32 v94, v94
    v_exp_f32 v95, v95
    v_mfma_f32_32x32x16_bf16 v[72:87], v[164:167], v[132:135], v[72:87]
    ds_read_b64_tr_b16 v[164:165], v19 offset:37120
    ds_read_b64_tr_b16 v[166:167], v20 offset:37120
    v_cvt_pk_bf16_f32 v120, v88, v89
    v_cvt_pk_bf16_f32 v121, v90, v91
    v_cvt_pk_bf16_f32 v122, v92, v93
    v_cvt_pk_bf16_f32 v123, v94, v95
    v_exp_f32 v96, v96
    v_exp_f32 v97, v97
    v_exp_f32 v98, v98
    v_exp_f32 v99, v99
    v_mfma_f32_32x32x16_bf16 v[72:87], v[152:155], v[120:123], v[72:87]
    s_waitcnt lgkmcnt(2)
    s_add_u32 m0, s22, 1024
    s_add_u32 s21, s21, 65536
    buffer_load_dwordx4 v1, s[4:7], s21 offen offset:0 sc1 lds
    v_exp_f32 v100, v100
    v_exp_f32 v101, v101
    v_exp_f32 v102, v102
    v_exp_f32_e64 v103, v103
    v_cvt_pk_bf16_f32 v124, v96, v97
    v_cvt_pk_bf16_f32 v125, v98, v99
    v_cvt_pk_bf16_f32 v126, v100, v101
    v_cvt_pk_bf16_f32 v127, v102, v103
    s_waitcnt vmcnt(5)
    buffer_store_dword v15, v24, s[4:7], s59 offen offset:128 sc1
    v_mfma_f32_32x32x16_bf16 v[88:103], v[136:139], v[248:251], 0
    ds_read_b128 v[144:147], v16 offset:30720
    ds_read_b64 v[148:149], v18 offset:30720
    v_exp_f32 v104, v104
    v_exp_f32 v105, v105
    v_exp_f32 v106, v106
    v_exp_f32_e64 v107, v107
    v_mfma_f32_32x32x8bf16_1k v[88:103], v[140:141], v[252:253], v[88:103]
    ds_read_b64_tr_b16 v[152:153], v19 offset:33792
    ds_read_b64_tr_b16 v[154:155], v20 offset:33792
    v_exp_f32 v108, v108
    v_exp_f32 v109, v109
    v_exp_f32 v110, v110
    v_exp_f32 v111, v111
    v_mfma_f32_32x32x16_bf16 v[72:87], v[156:159], v[124:127], v[72:87]
    ds_read_b64_tr_b16 v[156:157], v19 offset:34048
    ds_read_b64_tr_b16 v[158:159], v20 offset:34048
    v_cvt_pk_bf16_f32 v128, v104, v105
    v_cvt_pk_bf16_f32 v129, v106, v107
    v_cvt_pk_bf16_f32 v130, v108, v109
    v_cvt_pk_bf16_f32 v131, v110, v111
    v_exp_f32 v112, v112
    v_exp_f32 v113, v113
    v_exp_f32 v114, v114
    v_exp_f32 v115, v115
    v_mfma_f32_32x32x16_bf16 v[72:87], v[160:163], v[128:131], v[72:87]
    s_waitcnt lgkmcnt(2)
    buffer_load_dwordx4 v1, s[4:7], s21 offen offset:1024 sc1 lds
    v_exp_f32 v116, v116
    v_exp_f32 v117, v117
    v_exp_f32 v118, v118
    v_exp_f32_e64 v119, v119
    v_cvt_pk_bf16_f32 v132, v112, v113
    v_cvt_pk_bf16_f32 v133, v114, v115
    v_cvt_pk_bf16_f32 v134, v116, v117
    v_cvt_pk_bf16_f32 v135, v118, v119
    s_cmp_eq_u32 s37, 0
    s_cbranch_scc1 L_halook_160
    s_waitcnt vmcnt(4)
    v_cmp_ne_u32 vcc, v224, v15
    s_nop 0
    s_and_b32 vcc_hi, vcc_lo, 1
    s_cbranch_scc0 L_halook_160
L_poll_162:
    buffer_load_dword v26, v14, s[4:7], s60 offen offset:0 sc1
    s_waitcnt vmcnt(0)
    v_cmp_ne_u32_e64 vcc, v26, v15
    s_nop 0
    s_and_b32 vcc_hi, vcc_lo, 1
    s_cbranch_scc0 L_polled_163
    s_sub_u32 s44, s44, 1
    s_cbranch_scc0 L_poll_162
    s_mov_b32 s44, 0
L_polled_163:
L_halook_160:
    s_mov_b32 m0, 136192
    s_add_u32 s63, s61, 21504
    buffer_load_dwordx4 v31, s[4:7], s63 offen offset:0 sc1 lds
    buffer_load_dwordx4 v31, s[4:7], s63 offen offset:1024 sc1 lds
    buffer_load_dwordx4 v31, s[4:7], s63 offen offset:2048 sc1 lds
    v_mfma_f32_32x32x16_bf16 v[104:119], v[144:147], v[248:251], 0
    ds_read_b128 v[136:139], v16 offset:27648
    ds_read_b64 v[140:141], v18 offset:27648
    v_exp_f32 v88, v88
    v_exp_f32 v89, v89
    v_exp_f32 v90, v90
    v_exp_f32 v91, v91
    v_mfma_f32_32x32x8bf16_1k v[104:119], v[148:149], v[252:253], v[104:119]
    ds_read_b64_tr_b16 v[160:161], v19 offset:30720
    ds_read_b64_tr_b16 v[162:163], v20 offset:30720
    v_exp_f32 v92, v92
    v_exp_f32 v93, v93
    v_exp_f32 v94, v94
    v_exp_f32 v95, v95
    v_mfma_f32_32x32x16_bf16 v[72:87], v[164:167], v[132:135], v[72:87]
    ds_read_b64_tr_b16 v[164:165], v19 offset:30976
    ds_read_b64_tr_b16 v[166:167], v20 offset:30976
    v_cvt_pk_bf16_f32 v120, v88, v89
    v_cvt_pk_bf16_f32 v121, v90, v91
    v_cvt_pk_bf16_f32 v122, v92, v93
    v_cvt_pk_bf16_f32 v123, v94, v95
    v_exp_f32 v96, v96
    v_exp_f32 v97, v97
    v_exp_f32 v98, v98
    v_exp_f32 v99, v99
    v_mfma_f32_32x32x16_bf16 v[72:87], v[152:155], v[120:123], v[72:87]
    s_waitcnt lgkmcnt(2)
    s_add_u32 m0, s22, 1024
    s_nop 0
    buffer_load_dwordx4 v1, s[4:7], s21 offen offset:2048 sc1 lds
    v_exp_f32 v100, v100
    v_exp_f32 v101, v101
    v_exp_f32 v102, v102
    v_exp_f32 v103, v103
    v_cvt_pk_bf16_f32 v124, v96, v97
    v_cvt_pk_bf16_f32 v125, v98, v99
    v_cvt_pk_bf16_f32 v126, v100, v101
    v_cvt_pk_bf16_f32 v127, v102, v103
    v_mfma_f32_32x32x16_bf16 v[88:103], v[136:139], v[248:251], 0
    ds_read_b128 v[144:147], v16 offset:24576
    ds_read_b64 v[148:149], v18 offset:24576
    v_exp_f32 v104, v104
    v_exp_f32 v105, v105
    v_exp_f32 v106, v106
    v_exp_f32 v107, v107
    v_mfma_f32_32x32x8bf16_1k v[88:103], v[140:141], v[252:253], v[88:103]
    ds_read_b64_tr_b16 v[152:153], v19 offset:27648
    ds_read_b64_tr_b16 v[154:155], v20 offset:27648
    v_exp_f32 v108, v108
    v_exp_f32 v109, v109
    v_exp_f32 v110, v110
    v_exp_f32 v111, v111
    v_mfma_f32_32x32x16_bf16 v[72:87], v[156:159], v[124:127], v[72:87]
    ds_read_b64_tr_b16 v[156:157], v19 offset:27904
    ds_read_b64_tr_b16 v[158:159], v20 offset:27904
    v_cvt_pk_bf16_f32 v128, v104, v105
    v_cvt_pk_bf16_f32 v129, v106, v107
    v_cvt_pk_bf16_f32 v130, v108, v109
    v_cvt_pk_bf16_f32 v131, v110, v111
    v_exp_f32 v112, v112
    v_exp_f32 v113, v113
    v_exp_f32 v114, v114
    v_exp_f32 v115, v115
    v_mfma_f32_32x32x16_bf16 v[72:87], v[160:163], v[128:131], v[72:87]
    s_waitcnt lgkmcnt(2)
    buffer_load_dwordx4 v1, s[4:7], s21 offen offset:3072 sc1 lds
    v_exp_f32 v116, v116
    v_exp_f32 v117, v117
    v_exp_f32 v118, v118
    v_exp_f32_e64 v119, v119
    v_cvt_pk_bf16_f32 v132, v112, v113
    v_cvt_pk_bf16_f32 v133, v114, v115
    v_cvt_pk_bf16_f32 v134, v116, v117
    v_cvt_pk_bf16_f32 v135, v118, v119
    v_mfma_f32_32x32x16_bf16 v[104:119], v[144:147], v[248:251], 0
    s_add_u32 m0, s22, 17408
    s_add_u32 s21, s21, 16384
    buffer_load_dwordx4 v1, s[4:7], s21 offen offset:0 sc1 lds
    v_exp_f32 v88, v88
    v_exp_f32 v89, v89
    v_exp_f32 v90, v90
    v_exp_f32 v91, v91
    v_mfma_f32_32x32x8bf16_1k v[104:119], v[148:149], v[252:253], v[104:119]
    ds_read_b64_tr_b16 v[160:161], v19 offset:24576
    ds_read_b64_tr_b16 v[162:163], v20 offset:24576
    v_exp_f32 v92, v92
    v_exp_f32 v93, v93
    v_exp_f32 v94, v94
    v_exp_f32 v95, v95
    v_mfma_f32_32x32x16_bf16 v[72:87], v[164:167], v[132:135], v[72:87]
    ds_read_b64_tr_b16 v[164:165], v19 offset:24832
    ds_read_b64_tr_b16 v[166:167], v20 offset:24832
    v_cvt_pk_bf16_f32 v120, v88, v89
    v_cvt_pk_bf16_f32 v121, v90, v91
    v_cvt_pk_bf16_f32 v122, v92, v93
    v_cvt_pk_bf16_f32 v123, v94, v95
    v_exp_f32 v96, v96
    v_exp_f32 v97, v97
    v_exp_f32 v98, v98
    v_exp_f32 v99, v99
    v_mfma_f32_32x32x16_bf16 v[72:87], v[152:155], v[120:123], v[72:87]
    s_waitcnt lgkmcnt(2)
    v_exp_f32 v100, v100
    v_exp_f32 v101, v101
    v_exp_f32 v102, v102
    v_exp_f32_e64 v103, v103
    v_cvt_pk_bf16_f32 v124, v96, v97
    v_cvt_pk_bf16_f32 v125, v98, v99
    v_cvt_pk_bf16_f32 v126, v100, v101
    v_cvt_pk_bf16_f32 v127, v102, v103
    buffer_load_dword v228, v14, s[4:7], s60 offen offset:128 sc1
    v_mfma_f32_32x32x16_bf16 v[88:103], v[144:147], v[240:243], v[192:207]
    buffer_load_dwordx4 v1, s[4:7], s21 offen offset:1024 sc1 lds
    v_exp_f32 v104, v104
    v_exp_f32 v105, v105
    v_exp_f32 v106, v106
    v_exp_f32 v107, v107
    v_mfma_f32_32x32x8bf16_1k v[88:103], v[148:149], v[244:245], v[88:103]
    v_exp_f32 v108, v108
    v_exp_f32 v109, v109
    v_exp_f32 v110, v110
    v_exp_f32 v111, v111
    v_mfma_f32_32x32x16_bf16 v[72:87], v[156:159], v[124:127], v[72:87]
    v_cvt_pk_bf16_f32 v128, v104, v105
    v_cvt_pk_bf16_f32 v129, v106, v107
    v_cvt_pk_bf16_f32 v130, v108, v109
    v_cvt_pk_bf16_f32 v131, v110, v111
    v_exp_f32 v112, v112
    v_exp_f32 v113, v113
    v_exp_f32 v114, v114
    v_exp_f32 v115, v115
    v_mfma_f32_32x32x16_bf16 v[72:87], v[160:163], v[128:131], v[72:87]
    s_waitcnt lgkmcnt(0)
    v_exp_f32 v116, v116
    v_exp_f32 v117, v117
    v_exp_f32 v118, v118
    v_exp_f32_e64 v119, v119
    v_cvt_pk_bf16_f32 v132, v112, v113
    v_cvt_pk_bf16_f32 v133, v114, v115
    v_cvt_pk_bf16_f32 v134, v116, v117
    v_cvt_pk_bf16_f32 v135, v118, v119
    s_waitcnt vmcnt(5)
    s_barrier
    ds_read_b128 v[136:139], v16 offset:21504
    ds_read_b64 v[140:141], v18 offset:21504
    s_waitcnt lgkmcnt(0)
    v_mfma_f32_32x32x16_bf16 v[104:119], v[136:139], v[248:251], v[208:223]
    buffer_load_dwordx4 v1, s[4:7], s21 offen offset:2048 sc1 lds
    v_exp_f32 v88, v88
    v_exp_f32 v89, v89
    v_exp_f32 v90, v90
    v_exp_f32_e64 v91, v91
    v_mfma_f32_32x32x8bf16_1k v[104:119], v[140:141], v[252:253], v[104:119]
    ds_read_b64_tr_b16 v[152:153], v19 offset:21504
    ds_read_b64_tr_b16 v[154:155], v20 offset:21504
    v_exp_f32 v92, v92
    v_exp_f32 v93, v93
    v_exp_f32 v94, v94
    v_exp_f32 v95, v95
    v_mfma_f32_32x32x16_bf16 v[72:87], v[164:167], v[132:135], v[72:87]
    ds_read_b64_tr_b16 v[156:157], v19 offset:21760
    ds_read_b64_tr_b16 v[158:159], v20 offset:21760
    v_cvt_pk_bf16_f32 v120, v88, v89
    v_cvt_pk_bf16_f32 v121, v90, v91
    v_cvt_pk_bf16_f32 v122, v92, v93
    v_cvt_pk_bf16_f32 v123, v94, v95
    v_exp_f32 v96, v96
    v_exp_f32 v97, v97
    v_exp_f32 v98, v98
    v_exp_f32 v99, v99
    v_mfma_f32_32x32x16_bf16 v[56:71], v[160:163], v[120:123], 0
    s_waitcnt lgkmcnt(2)
    v_exp_f32 v100, v100
    v_exp_f32 v101, v101
    v_exp_f32 v102, v102
    v_exp_f32_e64 v103, v103
    v_cvt_pk_bf16_f32 v124, v96, v97
    v_cvt_pk_bf16_f32 v125, v98, v99
    v_cvt_pk_bf16_f32 v126, v100, v101
    v_cvt_pk_bf16_f32 v127, v102, v103
    v_mfma_f32_32x32x16_bf16 v[88:103], v[136:139], v[240:243], 0
    ds_read_b128 v[144:147], v16 offset:18432
    ds_read_b64 v[148:149], v18 offset:18432
    v_exp_f32 v104, v104
    v_exp_f32 v105, v105
    v_exp_f32 v106, v106
    v_exp_f32 v107, v107
    v_mfma_f32_32x32x8bf16_1k v[88:103], v[140:141], v[244:245], v[88:103]
    buffer_load_dwordx4 v1, s[4:7], s21 offen offset:3072 sc1 lds
    v_exp_f32 v108, v108
    v_exp_f32 v109, v109
    v_exp_f32 v110, v110
    v_exp_f32 v111, v111
    v_mfma_f32_32x32x16_bf16 v[56:71], v[164:167], v[124:127], v[56:71]
    v_cvt_pk_bf16_f32 v128, v104, v105
    v_cvt_pk_bf16_f32 v129, v106, v107
    v_cvt_pk_bf16_f32 v130, v108, v109
    v_cvt_pk_bf16_f32 v131, v110, v111
    v_exp_f32 v112, v112
    v_exp_f32 v113, v113
    v_exp_f32 v114, v114
    v_exp_f32 v115, v115
    v_mfma_f32_32x32x16_bf16 v[72:87], v[152:155], v[128:131], v[72:87]
    s_waitcnt lgkmcnt(0)
    v_exp_f32 v116, v116
    v_exp_f32 v117, v117
    v_exp_f32 v118, v118
    v_exp_f32_e64 v119, v119
    v_cvt_pk_bf16_f32 v132, v112, v113
    v_cvt_pk_bf16_f32 v133, v114, v115
    v_cvt_pk_bf16_f32 v134, v116, v117
    v_cvt_pk_bf16_f32 v135, v118, v119
    s_cmp_eq_u32 s37, 0
    s_cbranch_scc1 L_halook_164
    s_waitcnt vmcnt(3)
    v_cmp_ne_u32 vcc, v228, v15
    s_nop 0
    s_and_b32 vcc_hi, vcc_lo, 1
    s_cbranch_scc0 L_halook_164
L_poll_166:
    buffer_load_dword v26, v14, s[4:7], s60 offen offset:128 sc1
    s_waitcnt vmcnt(0)
    v_cmp_ne_u32_e64 vcc, v26, v15
    s_nop 0
    s_and_b32 vcc_hi, vcc_lo, 1
    s_cbranch_scc0 L_polled_167
    s_sub_u32 s44, s44, 1
    s_cbranch_scc0 L_poll_166
    s_mov_b32 s44, 0
L_polled_167:
L_halook_164:
    s_mov_b32 m0, 114688
    s_add_u32 s63, s61, 0
    buffer_load_dwordx4 v31, s[4:7], s63 offen offset:0 sc1 lds
    buffer_load_dwordx4 v31, s[4:7], s63 offen offset:1024 sc1 lds
    buffer_load_dwordx4 v31, s[4:7], s63 offen offset:2048 sc1 lds
    v_mfma_f32_32x32x16_bf16 v[104:119], v[144:147], v[240:243], 0
    ds_read_b128 v[136:139], v16 offset:15360
    ds_read_b64 v[140:141], v18 offset:15360
    v_exp_f32 v88, v88
    v_exp_f32 v89, v89
    v_exp_f32 v90, v90
    v_exp_f32_e64 v91, v91
    v_mfma_f32_32x32x8bf16_1k v[104:119], v[148:149], v[244:245], v[104:119]
    ds_read_b64_tr_b16 v[160:161], v19 offset:18432
    ds_read_b64_tr_b16 v[162:163], v20 offset:18432
    v_exp_f32 v92, v92
    v_exp_f32 v93, v93
    v_exp_f32 v94, v94
    v_exp_f32 v95, v95
    v_mfma_f32_32x32x16_bf16 v[72:87], v[156:159], v[132:135], v[72:87]
    ds_read_b64_tr_b16 v[164:165], v19 offset:18688
    ds_read_b64_tr_b16 v[166:167], v20 offset:18688
    v_cvt_pk_bf16_f32 v120, v88, v89
    v_cvt_pk_bf16_f32 v121, v90, v91
    v_cvt_pk_bf16_f32 v122, v92, v93
    v_cvt_pk_bf16_f32 v123, v94, v95
    v_exp_f32 v96, v96
    v_exp_f32 v97, v97
    v_exp_f32 v98, v98
    v_exp_f32 v99, v99
    v_mfma_f32_32x32x16_bf16 v[56:71], v[152:155], v[120:123], v[56:71]
    s_waitcnt lgkmcnt(2)
    s_add_u32 m0, s22, 33792
    s_add_u32 s21, s21, 16384
    buffer_load_dwordx4 v1, s[4:7], s21 offen offset:0 sc1 lds
    v_exp_f32 v100, v100
    v_exp_f32 v101, v101
    v_exp_f32 v102, v102
    v_exp_f32_e64 v103, v103
    v_cvt_pk_bf16_f32 v124, v96, v97
    v_cvt_pk_bf16_f32 v125, v98, v99
    v_cvt_pk_bf16_f32 v126, v100, v101
    v_cvt_pk_bf16_f32 v127, v102, v103
    v_rcp_f32_e64 v86, v84
    s_add_u32 s54, s56, 8960
    v_pk_mul_f32 v[72:73], v[72:73], v[86:87] op_sel_hi:[1,0]
    v_pk_mul_f32 v[74:75], v[74:75], v[86:87] op_sel_hi:[1,0]
    v_pk_mul_f32 v[76:77], v[76:77], v[86:87] op_sel_hi:[1,0]
    v_pk_mul_f32 v[78:79], v[78:79], v[86:87] op_sel_hi:[1,0]
    v_pk_mul_f32 v[80:81], v[80:81], v[86:87] op_sel_hi:[1,0]
    v_pk_mul_f32 v[82:83], v[82:83], v[86:87] op_sel_hi:[1,0]
    v_cvt_pk_bf16_f32 v172, v72, v73
    v_cvt_pk_bf16_f32 v173, v74, v75
    v_cvt_pk_bf16_f32 v174, v76, v77
    v_cvt_pk_bf16_f32 v175, v78, v79
    v_cvt_pk_bf16_f32 v176, v80, v81
    v_cvt_pk_bf16_f32 v177, v82, v83
    s_cmp_eq_u32 s43, 0
    s_cbranch_scc1 L_safe_168
    buffer_store_dwordx4 v[172:175], v5, s[4:7], s54 offen offset:0
    buffer_store_dwordx2 v[176:177], v6, s[4:7], s54 offen offset:512
L_join_169:
    v_add_u32 v27, 3766484992, v84
    v_cmp_lt_u32 vcc, 1073741824, v27
    s_nop 0
    s_or_b32 s23, vcc_lo, vcc_hi
    s_mov_b32 s26, s23
    v_mfma_f32_32x32x16_bf16 v[88:103], v[136:139], v[240:243], 0
    ds_read_b128 v[144:147], v16 offset:12288
    ds_read_b64 v[148:149], v18 offset:12288
    v_exp_f32 v104, v104
    v_exp_f32 v105, v105
    v_exp_f32 v106, v106
    v_exp_f32 v107, v107
    v_mfma_f32_32x32x8bf16_1k v[88:103], v[140:141], v[244:245], v[88:103]
    ds_read_b64_tr_b16 v[152:153], v19 offset:15360
    ds_read_b64_tr_b16 v[154:155], v20 offset:15360
    v_exp_f32 v108, v108
    v_exp_f32 v109, v109
    v_exp_f32 v110, v110
    v_exp_f32 v111, v111
    v_mfma_f32_32x32x16_bf16 v[56:71], v[156:159], v[124:127], v[56:71]
    ds_read_b64_tr_b16 v[156:157], v19 offset:15616
    ds_read_b64_tr_b16 v[158:159], v20 offset:15616
    v_cvt_pk_bf16_f32 v128, v104, v105
    v_cvt_pk_bf16_f32 v129, v106, v107
    v_cvt_pk_bf16_f32 v130, v108, v109
    v_cvt_pk_bf16_f32 v131, v110, v111
    v_exp_f32 v112, v112
    v_exp_f32 v113, v113
    v_exp_f32 v114, v114
    v_exp_f32 v115, v115
    v_mfma_f32_32x32x16_bf16 v[56:71], v[160:163], v[128:131], v[56:71]
    s_waitcnt lgkmcnt(2)
    buffer_load_dwordx4 v1, s[4:7], s21 offen offset:1024 sc1 lds
    v_exp_f32 v116, v116
    v_exp_f32 v117, v117
    v_exp_f32 v118, v118
    v_exp_f32_e64 v119, v119
    v_cvt_pk_bf16_f32 v132, v112, v113
    v_cvt_pk_bf16_f32 v133, v114, v115
    v_cvt_pk_bf16_f32 v134, v116, v117
    v_cvt_pk_bf16_f32 v135, v118, v119
    v_mfma_f32_32x32x16_bf16 v[104:119], v[144:147], v[240:243], 0
    buffer_load_dwordx4 v1, s[4:7], s21 offen offset:2048 sc1 lds
    v_exp_f32 v88, v88
    v_exp_f32 v89, v89
    v_exp_f32 v90, v90
    v_exp_f32 v91, v91
    v_mfma_f32_32x32x8bf16_1k v[104:119], v[148:149], v[244:245], v[104:119]
    ds_read_b64_tr_b16 v[160:161], v19 offset:12288
    ds_read_b64_tr_b16 v[162:163], v20 offset:12288
    v_exp_f32 v92, v92
    v_exp_f32 v93, v93
    v_exp_f32 v94, v94
    v_exp_f32 v95, v95
    v_mfma_f32_32x32x16_bf16 v[56:71], v[164:167], v[132:135], v[56:71]
    ds_read_b64_tr_b16 v[164:165], v19 offset:12544
    ds_read_b64_tr_b16 v[166:167], v20 offset:12544
    v_cvt_pk_bf16_f32 v120, v88, v89
    v_cvt_pk_bf16_f32 v121, v90, v91
    v_cvt_pk_bf16_f32 v122, v92, v93
    v_cvt_pk_bf16_f32 v123, v94, v95
    v_exp_f32 v96, v96
    v_exp_f32 v97, v97
    v_exp_f32 v98, v98
    v_exp_f32 v99, v99
    v_mfma_f32_32x32x16_bf16 v[56:71], v[152:155], v[120:123], v[56:71]
    s_waitcnt lgkmcnt(2)
    v_exp_f32 v100, v100
    v_exp_f32 v101, v101
    v_exp_f32 v102, v102
    v_exp_f32_e64 v103, v103
    v_cvt_pk_bf16_f32 v124, v96, v97
    v_cvt_pk_bf16_f32 v125, v98, v99
    v_cvt_pk_bf16_f32 v126, v100, v101
    v_cvt_pk_bf16_f32 v127, v102, v103
    s_waitcnt vmcnt(5)
    s_barrier
    s_cmp_lg_u32 s23, 0
    s_cbranch_scc1 L_nohi_170
    s_waitcnt vmcnt(2)
    s_cmp_eq_u32 s43, 0
    s_cbranch_scc1 L_safe_171
    buffer_store_dword v0, v14, s[4:7], s41 offen offset:0
L_join_172:
L_nohi_170:
    ds_read_b128 v[136:139], v16 offset:9216
    ds_read_b64 v[140:141], v18 offset:9216
    s_waitcnt lgkmcnt(0)
    v_mfma_f32_32x32x16_bf16 v[88:103], v[136:139], v[240:243], 0
    ds_read_b128 v[144:147], v16 offset:6144
    ds_read_b64 v[148:149], v18 offset:6144
    v_exp_f32 v104, v104
    v_exp_f32 v105, v105
    v_exp_f32 v106, v106
    v_exp_f32 v107, v107
    v_mfma_f32_32x32x8bf16_1k v[88:103], v[140:141], v[244:245], v[88:103]
    ds_read_b64_tr_b16 v[152:153], v19 offset:9216
    ds_read_b64_tr_b16 v[154:155], v20 offset:9216
    v_exp_f32 v108, v108
    v_exp_f32 v109, v109
    v_exp_f32 v110, v110
    v_exp_f32 v111, v111
    v_mfma_f32_32x32x16_bf16 v[56:71], v[156:159], v[124:127], v[56:71]
    ds_read_b64_tr_b16 v[156:157], v19 offset:9472
    ds_read_b64_tr_b16 v[158:159], v20 offset:9472
    v_cvt_pk_bf16_f32 v128, v104, v105
    v_cvt_pk_bf16_f32 v129, v106, v107
    v_cvt_pk_bf16_f32 v130, v108, v109
    v_cvt_pk_bf16_f32 v131, v110, v111
    v_exp_f32 v112, v112
    v_exp_f32 v113, v113
    v_exp_f32 v114, v114
    v_exp_f32 v115, v115
    v_mfma_f32_32x32x16_bf16 v[56:71], v[160:163], v[128:131], v[56:71]
    s_waitcnt lgkmcnt(2)
    buffer_load_dwordx4 v1, s[4:7], s21 offen offset:3072 sc1 lds
    v_exp_f32 v116, v116
    v_exp_f32 v117, v117
    v_exp_f32 v118, v118
    v_exp_f32_e64 v119, v119
    v_cvt_pk_bf16_f32 v132, v112, v113
    v_cvt_pk_bf16_f32 v133, v114, v115
    v_cvt_pk_bf16_f32 v134, v116, v117
    v_cvt_pk_bf16_f32 v135, v118, v119
    v_mfma_f32_32x32x16_bf16 v[104:119], v[144:147], v[240:243], 0
    ds_read_b128 v[136:139], v16 offset:3072
    ds_read_b64 v[140:141], v18 offset:3072
    v_exp_f32 v88, v88
    v_exp_f32 v89, v89
    v_exp_f32 v90, v90
    v_exp_f32 v91, v91
    v_mfma_f32_32x32x8bf16_1k v[104:119], v[148:149], v[244:245], v[104:119]
    ds_read_b64_tr_b16 v[160:161], v19 offset:6144
    ds_read_b64_tr_b16 v[162:163], v20 offset:6144
    v_exp_f32 v92, v92
    v_exp_f32 v93, v93
    v_exp_f32 v94, v94
    v_exp_f32 v95, v95
    v_mfma_f32_32x32x16_bf16 v[56:71], v[164:167], v[132:135], v[56:71]
    ds_read_b64_tr_b16 v[164:165], v19 offset:6400
    ds_read_b64_tr_b16 v[166:167], v20 offset:6400
    v_cvt_pk_bf16_f32 v120, v88, v89
    v_cvt_pk_bf16_f32 v121, v90, v91
    v_cvt_pk_bf16_f32 v122, v92, v93
    v_cvt_pk_bf16_f32 v123, v94, v95
    v_exp_f32 v96, v96
    v_exp_f32 v97, v97
    v_exp_f32 v98, v98
    v_exp_f32 v99, v99
    v_mfma_f32_32x32x16_bf16 v[56:71], v[152:155], v[120:123], v[56:71]
    s_waitcnt lgkmcnt(2)
    v_exp_f32 v100, v100
    v_exp_f32 v101, v101
    v_exp_f32 v102, v102
    v_exp_f32_e64 v103, v103
    v_cvt_pk_bf16_f32 v124, v96, v97
    v_cvt_pk_bf16_f32 v125, v98, v99
    v_cvt_pk_bf16_f32 v126, v100, v101
    v_cvt_pk_bf16_f32 v127, v102, v103
    v_mfma_f32_32x32x16_bf16 v[88:103], v[136:139], v[240:243], 0
    ds_read_b128 v[144:147], v16 offset:0
    ds_read_b64 v[148:149], v18 offset:0
    v_exp_f32 v104, v104
    v_exp_f32 v105, v105
    v_exp_f32 v106, v106
    v_exp_f32 v107, v107
    v_mfma_f32_32x32x8bf16_1k v[88:103], v[140:141], v[244:245], v[88:103]
    ds_read_b64_tr_b16 v[152:153], v19 offset:3072
    ds_read_b64_tr_b16 v[154:155], v20 offset:3072
    v_exp_f32 v108, v108
    v_exp_f32 v109, v109
    v_exp_f32 v110, v110
    v_exp_f32 v111, v111
    v_mfma_f32_32x32x16_bf16 v[56:71], v[156:159], v[124:127], v[56:71]
    ds_read_b64_tr_b16 v[156:157], v19 offset:3328
    ds_read_b64_tr_b16 v[158:159], v20 offset:3328
    v_cvt_pk_bf16_f32 v128, v104, v105
    v_cvt_pk_bf16_f32 v129, v106, v107
    v_cvt_pk_bf16_f32 v130, v108, v109
    v_cvt_pk_bf16_f32 v131, v110, v111
    v_exp_f32 v112, v112
    v_exp_f32 v113, v113
    v_exp_f32 v114, v114
    v_exp_f32 v115, v115
    v_mfma_f32_32x32x16_bf16 v[56:71], v[160:163], v[128:131], v[56:71]
    s_waitcnt lgkmcnt(2)
    v_exp_f32 v116, v116
    v_exp_f32 v117, v117
    v_exp_f32 v118, v118
    v_exp_f32_e64 v119, v119
    v_cvt_pk_bf16_f32 v132, v112, v113
    v_cvt_pk_bf16_f32 v133, v114, v115
    v_cvt_pk_bf16_f32 v134, v116, v117
    v_cvt_pk_bf16_f32 v135, v118, v119
    v_mfma_f32_32x32x16_bf16 v[104:119], v[144:147], v[240:243], v[208:223]
    v_exp_f32 v88, v88
    v_exp_f32 v89, v89
    v_exp_f32 v90, v90
    v_exp_f32 v91, v91
    v_mfma_f32_32x32x8bf16_1k v[104:119], v[148:149], v[244:245], v[104:119]
    ds_read_b64_tr_b16 v[160:161], v19 offset:0
    ds_read_b64_tr_b16 v[162:163], v20 offset:0
    v_exp_f32 v92, v92
    v_exp_f32 v93, v93
    v_exp_f32 v94, v94
    v_exp_f32 v95, v95
    v_mfma_f32_32x32x16_bf16 v[56:71], v[164:167], v[132:135], v[56:71]
    ds_read_b64_tr_b16 v[164:165], v19 offset:256
    ds_read_b64_tr_b16 v[166:167], v20 offset:256
    v_cvt_pk_bf16_f32 v120, v88, v89
    v_cvt_pk_bf16_f32 v121, v90, v91
    v_cvt_pk_bf16_f32 v122, v92, v93
    v_cvt_pk_bf16_f32 v123, v94, v95
    v_exp_f32 v96, v96
    v_exp_f32 v97, v97
    v_exp_f32 v98, v98
    v_exp_f32 v99, v99
    v_mfma_f32_32x32x16_bf16 v[56:71], v[152:155], v[120:123], v[56:71]
    s_waitcnt lgkmcnt(2)
    v_exp_f32 v100, v100
    v_exp_f32 v101, v101
    v_exp_f32 v102, v102
    v_exp_f32_e64 v103, v103
    v_cvt_pk_bf16_f32 v124, v96, v97
    v_cvt_pk_bf16_f32 v125, v98, v99
    v_cvt_pk_bf16_f32 v126, v100, v101
    v_cvt_pk_bf16_f32 v127, v102, v103
    v_exp_f32 v104, v104
    v_exp_f32 v105, v105
    v_exp_f32 v106, v106
    v_exp_f32 v107, v107
    v_exp_f32 v108, v108
    v_exp_f32 v109, v109
    v_exp_f32 v110, v110
    v_exp_f32 v111, v111
    v_mfma_f32_32x32x16_bf16 v[56:71], v[156:159], v[124:127], v[56:71]
    v_cvt_pk_bf16_f32 v128, v104, v105
    v_cvt_pk_bf16_f32 v129, v106, v107
    v_cvt_pk_bf16_f32 v130, v108, v109
    v_cvt_pk_bf16_f32 v131, v110, v111
    v_exp_f32 v112, v112
    v_exp_f32 v113, v113
    v_exp_f32 v114, v114
    v_exp_f32 v115, v115
    v_mfma_f32_32x32x16_bf16 v[56:71], v[160:163], v[128:131], v[56:71]
    s_waitcnt lgkmcnt(0)
    v_exp_f32 v116, v116
    v_exp_f32 v117, v117
    v_exp_f32 v118, v118
    v_exp_f32_e64 v119, v119
    v_cvt_pk_bf16_f32 v132, v112, v113
    v_cvt_pk_bf16_f32 v133, v114, v115
    v_cvt_pk_bf16_f32 v134, v116, v117
    v_cvt_pk_bf16_f32 v135, v118, v119
    s_nop 1
    v_mfma_f32_32x32x16_bf16 v[56:71], v[164:167], v[132:135], v[56:71]
    s_nop 11
    v_rcp_f32 v70, v68
    s_add_u32 s54, s56, 0
    v_pk_mul_f32 v[56:57], v[56:57], v[70:71] op_sel_hi:[1,0]
    v_pk_mul_f32 v[58:59], v[58:59], v[70:71] op_sel_hi:[1,0]
    v_pk_mul_f32 v[60:61], v[60:61], v[70:71] op_sel_hi:[1,0]
    v_pk_mul_f32 v[62:63], v[62:63], v[70:71] op_sel_hi:[1,0]
    v_pk_mul_f32 v[64:65], v[64:65], v[70:71] op_sel_hi:[1,0]
    v_pk_mul_f32 v[66:67], v[66:67], v[70:71] op_sel_hi:[1,0]
    v_cvt_pk_bf16_f32 v172, v56, v57
    s_branch L_over_457
L_chain6_2_0:
    s_branch L_chain6_2_1
L_over_457:
    v_cvt_pk_bf16_f32 v173, v58, v59
    v_cvt_pk_bf16_f32 v174, v60, v61
    v_cvt_pk_bf16_f32 v175, v62, v63
    v_cvt_pk_bf16_f32 v176, v64, v65
    v_cvt_pk_bf16_f32 v177, v66, v67
    s_cmp_eq_u32 s43, 0
    s_cbranch_scc1 L_safe_175
    buffer_store_dwordx4 v[172:175], v5, s[4:7], s54 offen offset:0
    buffer_store_dwordx2 v[176:177], v6, s[4:7], s54 offen offset:512
L_join_176:
    v_add_u32 v27, 3766484992, v68
    v_cmp_lt_u32_e64 vcc, 1073741824, v27
    s_nop 0
    s_or_b32 s23, s23, vcc_lo
    s_or_b32 s23, s23, vcc_hi
    s_cmp_lg_u32 s23, 0
    s_cbranch_scc1 L_fallback_173
L_fbdone_174:
    s_branch L_attdone_159
L_chain6_3_0:
    s_branch L_chain6_3_1
    s_nop 0
L_att1_156:
    ds_read_b128 v[136:139], v16 offset:43008
    ds_read_b64 v[140:141], v18 offset:43008
    ds_read_b64_tr_b16 v[152:153], v19 offset:43008
    ds_read_b64_tr_b16 v[154:155], v20 offset:43008
    ds_read_b64_tr_b16 v[156:157], v19 offset:43264
    ds_read_b64_tr_b16 v[158:159], v20 offset:43264
    v_add_u32 v26, s56, v16
    v_add_u32 v27, s56, v17
    v_add_u32 v28, s56, v18
    s_nop 0
    v_pk_mul_f32 v[72:73], v[72:73], v[224:225] op_sel:[0,1] op_sel_hi:[1,1]
    v_pk_mul_f32 v[74:75], v[74:75], v[224:225] op_sel:[0,1] op_sel_hi:[1,1]
    v_pk_mul_f32 v[76:77], v[76:77], v[224:225] op_sel:[0,1] op_sel_hi:[1,1]
    v_pk_mul_f32 v[78:79], v[78:79], v[224:225] op_sel:[0,1] op_sel_hi:[1,1]
    v_pk_mul_f32 v[80:81], v[80:81], v[224:225] op_sel:[0,1] op_sel_hi:[1,1]
    v_pk_mul_f32 v[82:83], v[82:83], v[224:225] op_sel:[0,1] op_sel_hi:[1,1]
    v_pk_mul_f32 v[84:85], v[84:85], v[224:225] op_sel:[0,1] op_sel_hi:[1,1]
    v_pk_mul_f32 v[86:87], v[86:87], v[224:225] op_sel:[0,1] op_sel_hi:[1,1]
    v_cvt_pk_bf16_f32 v72, v72, v73
    v_cvt_pk_bf16_f32 v73, v74, v75
    v_cvt_pk_bf16_f32 v74, v76, v77
    v_cvt_pk_bf16_f32 v75, v78, v79
    v_cvt_pk_bf16_f32 v76, v80, v81
    v_cvt_pk_bf16_f32 v77, v82, v83
    v_cvt_pk_bf16_f32 v78, v84, v85
    v_cvt_pk_bf16_f32 v79, v86, v87
    v_cndmask_b32 v78, v78, v31, s[50:51]
    v_cndmask_b32 v79, v79, 0, s[50:51]
    buffer_store_dwordx4 v[72:75], v26, s[4:7], s61 offen offset:0 sc1
    v_pk_mul_f32 v[80:81], v[64:65], v[224:225] op_sel:[0,1] op_sel_hi:[1,1]
    v_pk_mul_f32 v[82:83], v[66:67], v[224:225] op_sel:[0,1] op_sel_hi:[1,1]
    v_pk_mul_f32 v[84:85], v[68:69], v[224:225] op_sel:[0,1] op_sel_hi:[1,1]
    v_pk_mul_f32 v[86:87], v[70:71], v[224:225] op_sel:[0,1] op_sel_hi:[1,1]
    buffer_store_dwordx4 v[76:79], v28, s[4:7], s61 offen offset:0 sc1
    v_cvt_pk_bf16_f32 v80, v80, v81
    v_cvt_pk_bf16_f32 v81, v82, v83
    v_cvt_pk_bf16_f32 v82, v84, v85
    v_cvt_pk_bf16_f32 v83, v86, v87
    ds_write_b128 v26, v[72:75] offset:24576
    buffer_store_dwordx4 v[80:83], v27, s[4:7], s61 offen offset:0 sc1
    v_pk_mul_f32 v[64:65], v[64:65], v[226:227] op_sel:[0,1] op_sel_hi:[1,1]
    v_pk_mul_f32 v[66:67], v[66:67], v[226:227] op_sel:[0,1] op_sel_hi:[1,1]
    ds_write_b128 v28, v[76:79] offset:24576
    v_pk_mul_f32 v[56:57], v[56:57], v[226:227] op_sel:[0,0] op_sel_hi:[1,0]
    v_pk_mul_f32 v[58:59], v[58:59], v[226:227] op_sel:[0,0] op_sel_hi:[1,0]
    v_pk_mul_f32 v[60:61], v[60:61], v[226:227] op_sel:[0,0] op_sel_hi:[1,0]
    v_pk_mul_f32 v[62:63], v[62:63], v[226:227] op_sel:[0,0] op_sel_hi:[1,0]
    ds_write_b128 v27, v[80:83] offset:24576
    s_waitcnt vmcnt(3)
    buffer_store_dword v15, v24, s[4:7], s59 offen offset:0 sc1
    s_waitcnt lgkmcnt(7)
    v_mfma_f32_32x32x16_bf16 v[88:103], v[136:139], v[248:251], v[192:207]
    v_mfma_f32_32x32x8bf16_1k v[88:103], v[140:141], v[252:253], v[88:103]
    s_waitcnt lgkmcnt(0)
    s_barrier
    ds_read_b128 v[144:147], v16 offset:39936
    ds_read_b64 v[148:149], v18 offset:39936
    v_cvt_pk_bf16_f32 v240, v56, v57
    v_cvt_pk_bf16_f32 v241, v58, v59
    v_cvt_pk_bf16_f32 v242, v60, v61
    v_cvt_pk_bf16_f32 v243, v62, v63
    v_cvt_pk_bf16_f32 v244, v64, v65
    v_cvt_pk_bf16_f32 v245, v66, v67
    s_add_u32 s61, s58, -4079616
    v_add_u32 v31, s62, v1
    s_mov_b32 s56, s63
    v_add_u32 v0, 9, v15
    v_exp_f32 v88, v88
    v_exp_f32 v89, v89
    v_exp_f32 v90, v90
    v_exp_f32 v91, v91
    s_waitcnt lgkmcnt(0)
    v_mfma_f32_32x32x16_bf16 v[104:119], v[144:147], v[248:251], 0
    ds_read_b128 v[136:139], v16 offset:36864
    ds_read_b64 v[140:141], v18 offset:36864
    v_exp_f32 v92, v92
    v_exp_f32 v93, v93
    v_exp_f32 v94, v94
    v_exp_f32 v95, v95
    v_mfma_f32_32x32x8bf16_1k v[104:119], v[148:149], v[252:253], v[104:119]
    ds_read_b64_tr_b16 v[160:161], v19 offset:39936
    ds_read_b64_tr_b16 v[162:163], v20 offset:39936
    ds_read_b64_tr_b16 v[164:165], v19 offset:40192
    ds_read_b64_tr_b16 v[166:167], v20 offset:40192
    v_cvt_pk_bf16_f32 v120, v88, v89
    v_cvt_pk_bf16_f32 v121, v90, v91
    v_cvt_pk_bf16_f32 v122, v92, v93
    v_cvt_pk_bf16_f32 v123, v94, v95
    v_exp_f32 v96, v96
    v_exp_f32 v97, v97
    v_exp_f32 v98, v98
    v_exp_f32 v99, v99
    v_mfma_f32_32x32x16_bf16 v[72:87], v[152:155], v[120:123], 0
    s_waitcnt lgkmcnt(2)
    v_exp_f32 v100, v100
    v_exp_f32 v101, v101
    v_exp_f32 v102, v102
    v_exp_f32_e64 v103, v103
    v_cvt_pk_bf16_f32 v124, v96, v97
    v_cvt_pk_bf16_f32 v125, v98, v99
    v_cvt_pk_bf16_f32 v126, v100, v101
    v_cvt_pk_bf16_f32 v127, v102, v103
    s_lshl_b32 s68, s38, 2
    s_add_u32 s68, s68, s36
    s_mul_i32 s68, s68, 2560
    s_mul_i32 s69, s38, 17408
    s_add_u32 s68, s68, s69
    s_add_u32 s68, s68, s45
    s_add_u32 s68, s68, 372736
    v_add_u32 v168, 44, v21
    v_lshrrev_b32 v168, 6, v168
    v_lshl_add_u32 v168, v168, 28, v1
    v_lshlrev_b32_e64 v168, 3, v168
    buffer_load_dword a252, v168, s[4:7], s68 offen offset:0 sc1
    v_mfma_f32_32x32x16_bf16 v[88:103], v[136:139], v[248:251], 0
    ds_read_b128 v[144:147], v16 offset:33792
    ds_read_b64 v[148:149], v18 offset:33792
    v_exp_f32 v104, v104
    v_exp_f32 v105, v105
    v_exp_f32 v106, v106
    v_exp_f32 v107, v107
    v_mfma_f32_32x32x8bf16_1k v[88:103], v[140:141], v[252:253], v[88:103]
    ds_read_b64_tr_b16 v[152:153], v19 offset:36864
    ds_read_b64_tr_b16 v[154:155], v20 offset:36864
    v_exp_f32 v108, v108
    v_exp_f32 v109, v109
    v_exp_f32 v110, v110
    v_exp_f32 v111, v111
    v_mfma_f32_32x32x16_bf16 v[72:87], v[156:159], v[124:127], v[72:87]
    ds_read_b64_tr_b16 v[156:157], v19 offset:37120
    ds_read_b64_tr_b16 v[158:159], v20 offset:37120
    v_cvt_pk_bf16_f32 v128, v104, v105
    v_cvt_pk_bf16_f32 v129, v106, v107
    v_cvt_pk_bf16_f32 v130, v108, v109
    v_cvt_pk_bf16_f32 v131, v110, v111
    v_exp_f32 v112, v112
    v_exp_f32 v113, v113
    v_exp_f32 v114, v114
    v_exp_f32 v115, v115
    v_mfma_f32_32x32x16_bf16 v[72:87], v[160:163], v[128:131], v[72:87]
    s_waitcnt lgkmcnt(2)
    v_exp_f32 v116, v116
    v_exp_f32 v117, v117
    v_exp_f32 v118, v118
    v_exp_f32_e64 v119, v119
    v_cvt_pk_bf16_f32 v132, v112, v113
    v_cvt_pk_bf16_f32 v133, v114, v115
    v_cvt_pk_bf16_f32 v134, v116, v117
    v_cvt_pk_bf16_f32 v135, v118, v119
    buffer_load_dword v224, v14, s[4:7], s60 offen offset:0 sc1
    s_lshl_b32 s68, s38, 2
    s_add_u32 s68, s68, s36
    s_mul_i32 s68, s68, 2560
    s_mul_i32 s69, s37, 327680
    s_add_u32 s68, s68, s69
    v_add_u32 v169, 44, v21
    v_lshrrev_b32_e64 v169, 6, v169
    v_lshl_add_u32 v169, v169, 28, v1
    v_lshlrev_b32_e64 v169, 3, v169
    buffer_load_dword a252, v169, s[8:11], s68 offen offset:0 sc1
    v_mfma_f32_32x32x16_bf16 v[104:119], v[144:147], v[248:251], 0
    ds_read_b128 v[136:139], v16 offset:30720
    ds_read_b64 v[140:141], v18 offset:30720
    v_exp_f32 v88, v88
    v_exp_f32 v89, v89
    v_exp_f32 v90, v90
    v_exp_f32 v91, v91
    v_mfma_f32_32x32x8bf16_1k v[104:119], v[148:149], v[252:253], v[104:119]
    ds_read_b64_tr_b16 v[160:161], v19 offset:33792
    ds_read_b64_tr_b16 v[162:163], v20 offset:33792
    v_exp_f32 v92, v92
    v_exp_f32 v93, v93
    v_exp_f32 v94, v94
    v_exp_f32 v95, v95
    v_mfma_f32_32x32x16_bf16 v[72:87], v[164:167], v[132:135], v[72:87]
    ds_read_b64_tr_b16 v[164:165], v19 offset:34048
    ds_read_b64_tr_b16 v[166:167], v20 offset:34048
    v_cvt_pk_bf16_f32 v120, v88, v89
    v_cvt_pk_bf16_f32 v121, v90, v91
    v_cvt_pk_bf16_f32 v122, v92, v93
    v_cvt_pk_bf16_f32 v123, v94, v95
    v_exp_f32 v96, v96
    v_exp_f32 v97, v97
    v_exp_f32 v98, v98
    v_exp_f32 v99, v99
    v_mfma_f32_32x32x16_bf16 v[72:87], v[152:155], v[120:123], v[72:87]
    s_waitcnt lgkmcnt(2)
    s_add_u32 m0, s22, 1024
    s_add_u32 s21, s21, 65536
    buffer_load_dwordx4 v1, s[4:7], s21 offen offset:0 sc1 lds
    v_exp_f32 v100, v100
    v_exp_f32 v101, v101
    v_exp_f32 v102, v102
    v_exp_f32_e64 v103, v103
    v_cvt_pk_bf16_f32 v124, v96, v97
    v_cvt_pk_bf16_f32 v125, v98, v99
    v_cvt_pk_bf16_f32 v126, v100, v101
    v_cvt_pk_bf16_f32 v127, v102, v103
    s_waitcnt vmcnt(5)
    buffer_store_dword v15, v24, s[4:7], s59 offen offset:128 sc1
    v_mfma_f32_32x32x16_bf16 v[88:103], v[136:139], v[248:251], 0
    ds_read_b128 v[144:147], v16 offset:27648
    ds_read_b64 v[148:149], v18 offset:27648
    v_exp_f32 v104, v104
    v_exp_f32 v105, v105
    v_exp_f32 v106, v106
    v_exp_f32_e64 v107, v107
    v_mfma_f32_32x32x8bf16_1k v[88:103], v[140:141], v[252:253], v[88:103]
    ds_read_b64_tr_b16 v[152:153], v19 offset:30720
    ds_read_b64_tr_b16 v[154:155], v20 offset:30720
    v_exp_f32 v108, v108
    v_exp_f32 v109, v109
    v_exp_f32 v110, v110
    v_exp_f32 v111, v111
    v_mfma_f32_32x32x16_bf16 v[72:87], v[156:159], v[124:127], v[72:87]
    ds_read_b64_tr_b16 v[156:157], v19 offset:30976
    ds_read_b64_tr_b16 v[158:159], v20 offset:30976
    v_cvt_pk_bf16_f32 v128, v104, v105
    v_cvt_pk_bf16_f32 v129, v106, v107
    v_cvt_pk_bf16_f32 v130, v108, v109
    v_cvt_pk_bf16_f32 v131, v110, v111
    v_exp_f32 v112, v112
    v_exp_f32 v113, v113
    v_exp_f32 v114, v114
    v_exp_f32 v115, v115
    v_mfma_f32_32x32x16_bf16 v[72:87], v[160:163], v[128:131], v[72:87]
    s_waitcnt lgkmcnt(2)
    buffer_load_dwordx4 v1, s[4:7], s21 offen offset:1024 sc1 lds
    v_exp_f32 v116, v116
    v_exp_f32 v117, v117
    v_exp_f32 v118, v118
    v_exp_f32_e64 v119, v119
    v_cvt_pk_bf16_f32 v132, v112, v113
    v_cvt_pk_bf16_f32 v133, v114, v115
    v_cvt_pk_bf16_f32 v134, v116, v117
    v_cvt_pk_bf16_f32 v135, v118, v119
    s_cmp_eq_u32 s37, 0
    s_cbranch_scc1 L_halook_177
    s_waitcnt vmcnt(4)
    v_cmp_ne_u32 vcc, v224, v15
    s_nop 0
    s_and_b32 vcc_hi, vcc_lo, 1
    s_cbranch_scc0 L_halook_177
L_poll_179:
    buffer_load_dword v26, v14, s[4:7], s60 offen offset:0 sc1
    s_waitcnt vmcnt(0)
    v_cmp_ne_u32_e64 vcc, v26, v15
    s_nop 0
    s_and_b32 vcc_hi, vcc_lo, 1
    s_cbranch_scc0 L_polled_180
    s_sub_u32 s44, s44, 1
    s_cbranch_scc0 L_poll_179
    s_mov_b32 s44, 0
L_polled_180:
L_halook_177:
    s_mov_b32 m0, 133120
    s_add_u32 s63, s61, 18432
    buffer_load_dwordx4 v31, s[4:7], s63 offen offset:0 sc1 lds
    buffer_load_dwordx4 v31, s[4:7], s63 offen offset:1024 sc1 lds
    buffer_load_dwordx4 v31, s[4:7], s63 offen offset:2048 sc1 lds
    v_mfma_f32_32x32x16_bf16 v[104:119], v[144:147], v[248:251], 0
    s_add_u32 m0, s22, 1024
    s_nop 0
    buffer_load_dwordx4 v1, s[4:7], s21 offen offset:2048 sc1 lds
    v_exp_f32 v88, v88
    v_exp_f32 v89, v89
    v_exp_f32 v90, v90
    v_exp_f32_e64 v91, v91
    v_mfma_f32_32x32x8bf16_1k v[104:119], v[148:149], v[252:253], v[104:119]
    ds_read_b64_tr_b16 v[160:161], v19 offset:27648
    ds_read_b64_tr_b16 v[162:163], v20 offset:27648
    v_exp_f32 v92, v92
    v_exp_f32 v93, v93
    v_exp_f32 v94, v94
    v_exp_f32 v95, v95
    v_mfma_f32_32x32x16_bf16 v[72:87], v[164:167], v[132:135], v[72:87]
    ds_read_b64_tr_b16 v[164:165], v19 offset:27904
    ds_read_b64_tr_b16 v[166:167], v20 offset:27904
    v_cvt_pk_bf16_f32 v120, v88, v89
    v_cvt_pk_bf16_f32 v121, v90, v91
    v_cvt_pk_bf16_f32 v122, v92, v93
    v_cvt_pk_bf16_f32 v123, v94, v95
    v_exp_f32 v96, v96
    v_exp_f32 v97, v97
    v_exp_f32 v98, v98
    v_exp_f32 v99, v99
    v_mfma_f32_32x32x16_bf16 v[72:87], v[152:155], v[120:123], v[72:87]
    s_waitcnt lgkmcnt(2)
    v_exp_f32 v100, v100
    v_exp_f32 v101, v101
    v_exp_f32 v102, v102
    v_exp_f32_e64 v103, v103
    v_cvt_pk_bf16_f32 v124, v96, v97
    v_cvt_pk_bf16_f32 v125, v98, v99
    v_cvt_pk_bf16_f32 v126, v100, v101
    v_cvt_pk_bf16_f32 v127, v102, v103
    v_mfma_f32_32x32x16_bf16 v[88:103], v[144:147], v[240:243], v[192:207]
    ds_read_b128 v[136:139], v16 offset:24576
    ds_read_b64 v[140:141], v18 offset:24576
    v_exp_f32 v104, v104
    v_exp_f32 v105, v105
    v_exp_f32 v106, v106
    v_exp_f32 v107, v107
    v_mfma_f32_32x32x8bf16_1k v[88:103], v[148:149], v[244:245], v[88:103]
    buffer_load_dwordx4 v1, s[4:7], s21 offen offset:3072 sc1 lds
    v_exp_f32 v108, v108
    v_exp_f32 v109, v109
    v_exp_f32 v110, v110
    v_exp_f32 v111, v111
    v_mfma_f32_32x32x16_bf16 v[72:87], v[156:159], v[124:127], v[72:87]
    v_cvt_pk_bf16_f32 v128, v104, v105
    v_cvt_pk_bf16_f32 v129, v106, v107
    v_cvt_pk_bf16_f32 v130, v108, v109
    v_cvt_pk_bf16_f32 v131, v110, v111
    v_exp_f32 v112, v112
    v_exp_f32 v113, v113
    v_exp_f32 v114, v114
    v_exp_f32 v115, v115
    v_mfma_f32_32x32x16_bf16 v[72:87], v[160:163], v[128:131], v[72:87]
    s_waitcnt lgkmcnt(0)
    v_exp_f32 v116, v116
    v_exp_f32 v117, v117
    v_exp_f32 v118, v118
    v_exp_f32_e64 v119, v119
    v_cvt_pk_bf16_f32 v132, v112, v113
    v_cvt_pk_bf16_f32 v133, v114, v115
    v_cvt_pk_bf16_f32 v134, v116, v117
    v_cvt_pk_bf16_f32 v135, v118, v119
    v_mfma_f32_32x32x16_bf16 v[104:119], v[136:139], v[248:251], 0
    s_add_u32 m0, s22, 17408
    s_add_u32 s21, s21, 16384
    buffer_load_dwordx4 v1, s[4:7], s21 offen offset:0 sc1 lds
    v_exp_f32 v88, v88
    v_exp_f32 v89, v89
    v_exp_f32 v90, v90
    v_exp_f32 v91, v91
    v_mfma_f32_32x32x8bf16_1k v[104:119], v[140:141], v[252:253], v[104:119]
    ds_read_b64_tr_b16 v[152:153], v19 offset:24576
    ds_read_b64_tr_b16 v[154:155], v20 offset:24576
    v_exp_f32 v92, v92
    v_exp_f32 v93, v93
    v_exp_f32 v94, v94
    v_exp_f32 v95, v95
    v_mfma_f32_32x32x16_bf16 v[72:87], v[164:167], v[132:135], v[72:87]
    ds_read_b64_tr_b16 v[156:157], v19 offset:24832
    ds_read_b64_tr_b16 v[158:159], v20 offset:24832
    v_cvt_pk_bf16_f32 v120, v88, v89
    v_cvt_pk_bf16_f32 v121, v90, v91
    v_cvt_pk_bf16_f32 v122, v92, v93
    v_cvt_pk_bf16_f32 v123, v94, v95
    v_exp_f32 v96, v96
    v_exp_f32 v97, v97
    v_exp_f32 v98, v98
    v_exp_f32 v99, v99
    v_mfma_f32_32x32x16_bf16 v[56:71], v[160:163], v[120:123], 0
    s_waitcnt lgkmcnt(2)
    v_exp_f32 v100, v100
    v_exp_f32 v101, v101
    v_exp_f32 v102, v102
    v_exp_f32_e64 v103, v103
    v_cvt_pk_bf16_f32 v124, v96, v97
    v_cvt_pk_bf16_f32 v125, v98, v99
    v_cvt_pk_bf16_f32 v126, v100, v101
    v_cvt_pk_bf16_f32 v127, v102, v103
    buffer_load_dword v228, v14, s[4:7], s60 offen offset:128 sc1
    v_mfma_f32_32x32x16_bf16 v[88:103], v[136:139], v[240:243], 0
    buffer_load_dwordx4 v1, s[4:7], s21 offen offset:1024 sc1 lds
    v_exp_f32 v104, v104
    v_exp_f32 v105, v105
    v_exp_f32 v106, v106
    v_exp_f32 v107, v107
    v_mfma_f32_32x32x8bf16_1k v[88:103], v[140:141], v[244:245], v[88:103]
    v_exp_f32 v108, v108
    v_exp_f32 v109, v109
    v_exp_f32 v110, v110
    v_exp_f32 v111, v111
    v_mfma_f32_32x32x16_bf16 v[56:71], v[164:167], v[124:127], v[56:71]
    v_cvt_pk_bf16_f32 v128, v104, v105
    v_cvt_pk_bf16_f32 v129, v106, v107
    v_cvt_pk_bf16_f32 v130, v108, v109
    v_cvt_pk_bf16_f32 v131, v110, v111
    v_exp_f32 v112, v112
    v_exp_f32 v113, v113
    v_exp_f32 v114, v114
    v_exp_f32 v115, v115
    v_mfma_f32_32x32x16_bf16 v[72:87], v[152:155], v[128:131], v[72:87]
    s_waitcnt lgkmcnt(0)
    v_exp_f32 v116, v116
    v_exp_f32 v117, v117
    v_exp_f32 v118, v118
    v_exp_f32_e64 v119, v119
    v_cvt_pk_bf16_f32 v132, v112, v113
    v_cvt_pk_bf16_f32 v133, v114, v115
    v_cvt_pk_bf16_f32 v134, v116, v117
    v_cvt_pk_bf16_f32 v135, v118, v119
    s_waitcnt vmcnt(5)
    s_barrier
    ds_read_b128 v[144:147], v16 offset:21504
    ds_read_b64 v[148:149], v18 offset:21504
    s_waitcnt lgkmcnt(0)
    v_mfma_f32_32x32x16_bf16 v[104:119], v[144:147], v[248:251], 0
    ds_read_b128 v[136:139], v16 offset:18432
    ds_read_b64 v[140:141], v18 offset:18432
    v_exp_f32 v88, v88
    v_exp_f32 v89, v89
    v_exp_f32 v90, v90
    v_exp_f32_e64 v91, v91
    v_mfma_f32_32x32x8bf16_1k v[104:119], v[148:149], v[252:253], v[104:119]
    ds_read_b64_tr_b16 v[160:161], v19 offset:21504
    ds_read_b64_tr_b16 v[162:163], v20 offset:21504
    v_exp_f32 v92, v92
    v_exp_f32 v93, v93
    v_exp_f32 v94, v94
    v_exp_f32 v95, v95
    v_mfma_f32_32x32x16_bf16 v[72:87], v[156:159], v[132:135], v[72:87]
    ds_read_b64_tr_b16 v[164:165], v19 offset:21760
    ds_read_b64_tr_b16 v[166:167], v20 offset:21760
    v_cvt_pk_bf16_f32 v120, v88, v89
    v_cvt_pk_bf16_f32 v121, v90, v91
    v_cvt_pk_bf16_f32 v122, v92, v93
    v_cvt_pk_bf16_f32 v123, v94, v95
    v_exp_f32 v96, v96
    v_exp_f32 v97, v97
    v_exp_f32 v98, v98
    v_exp_f32 v99, v99
    v_mfma_f32_32x32x16_bf16 v[56:71], v[152:155], v[120:123], v[56:71]
    s_waitcnt lgkmcnt(2)
    buffer_load_dwordx4 v1, s[4:7], s21 offen offset:2048 sc1 lds
    v_exp_f32 v100, v100
    v_exp_f32 v101, v101
    v_exp_f32 v102, v102
    v_exp_f32_e64 v103, v103
    v_cvt_pk_bf16_f32 v124, v96, v97
    v_cvt_pk_bf16_f32 v125, v98, v99
    v_cvt_pk_bf16_f32 v126, v100, v101
    v_cvt_pk_bf16_f32 v127, v102, v103
    v_mfma_f32_32x32x16_bf16 v[88:103], v[136:139], v[248:251], v[208:223]
    ds_read_b128 v[144:147], v16 offset:21504
    ds_read_b64 v[148:149], v18 offset:21504
    v_exp_f32 v104, v104
    v_exp_f32 v105, v105
    v_exp_f32 v106, v106
    v_exp_f32 v107, v107
    v_mfma_f32_32x32x8bf16_1k v[88:103], v[140:141], v[252:253], v[88:103]
    ds_read_b64_tr_b16 v[152:153], v19 offset:18432
    ds_read_b64_tr_b16 v[154:155], v20 offset:18432
    v_exp_f32 v108, v108
    v_exp_f32 v109, v109
    v_exp_f32 v110, v110
    v_exp_f32 v111, v111
    v_mfma_f32_32x32x16_bf16 v[56:71], v[156:159], v[124:127], v[56:71]
    ds_read_b64_tr_b16 v[156:157], v19 offset:18688
    ds_read_b64_tr_b16 v[158:159], v20 offset:18688
    v_cvt_pk_bf16_f32 v128, v104, v105
    v_cvt_pk_bf16_f32 v129, v106, v107
    v_cvt_pk_bf16_f32 v130, v108, v109
    v_cvt_pk_bf16_f32 v131, v110, v111
    v_exp_f32 v112, v112
    v_exp_f32 v113, v113
    v_exp_f32 v114, v114
    v_exp_f32 v115, v115
    v_mfma_f32_32x32x16_bf16 v[72:87], v[160:163], v[128:131], v[72:87]
    s_waitcnt lgkmcnt(2)
    buffer_load_dwordx4 v1, s[4:7], s21 offen offset:3072 sc1 lds
    v_exp_f32 v116, v116
    v_exp_f32 v117, v117
    v_exp_f32 v118, v118
    v_exp_f32_e64 v119, v119
    v_cvt_pk_bf16_f32 v132, v112, v113
    v_cvt_pk_bf16_f32 v133, v114, v115
    v_cvt_pk_bf16_f32 v134, v116, v117
    v_cvt_pk_bf16_f32 v135, v118, v119
    s_cmp_eq_u32 s37, 0
    s_cbranch_scc1 L_halook_181
    s_waitcnt vmcnt(3)
    v_cmp_ne_u32 vcc, v228, v15
    s_nop 0
    s_and_b32 vcc_hi, vcc_lo, 1
    s_cbranch_scc0 L_halook_181
L_poll_183:
    buffer_load_dword v26, v14, s[4:7], s60 offen offset:128 sc1
    s_waitcnt vmcnt(0)
    v_cmp_ne_u32_e64 vcc, v26, v15
    s_nop 0
    s_and_b32 vcc_hi, vcc_lo, 1
    s_cbranch_scc0 L_polled_184
    s_sub_u32 s44, s44, 1
    s_cbranch_scc0 L_poll_183
    s_mov_b32 s44, 0
L_polled_184:
L_halook_181:
    s_mov_b32 m0, 117760
    s_add_u32 s63, s61, 3072
    buffer_load_dwordx4 v31, s[4:7], s63 offen offset:0 sc1 lds
    buffer_load_dwordx4 v31, s[4:7], s63 offen offset:1024 sc1 lds
    buffer_load_dwordx4 v31, s[4:7], s63 offen offset:2048 sc1 lds
    v_mfma_f32_32x32x16_bf16 v[104:119], v[144:147], v[240:243], 0
    ds_read_b128 v[136:139], v16 offset:18432
    ds_read_b64 v[140:141], v18 offset:18432
    v_exp_f32 v88, v88
    v_exp_f32 v89, v89
    v_exp_f32 v90, v90
    v_exp_f32 v91, v91
    v_mfma_f32_32x32x8bf16_1k v[104:119], v[148:149], v[244:245], v[104:119]
    ds_read_b64_tr_b16 v[160:161], v19 offset:21504
    ds_read_b64_tr_b16 v[162:163], v20 offset:21504
    v_exp_f32 v92, v92
    v_exp_f32 v93, v93
    v_exp_f32 v94, v94
    v_exp_f32 v95, v95
    v_mfma_f32_32x32x16_bf16 v[72:87], v[164:167], v[132:135], v[72:87]
    ds_read_b64_tr_b16 v[164:165], v19 offset:21760
    ds_read_b64_tr_b16 v[166:167], v20 offset:21760
    v_cvt_pk_bf16_f32 v120, v88, v89
    v_cvt_pk_bf16_f32 v121, v90, v91
    v_cvt_pk_bf16_f32 v122, v92, v93
    v_cvt_pk_bf16_f32 v123, v94, v95
    v_exp_f32 v96, v96
    v_exp_f32 v97, v97
    v_exp_f32 v98, v98
    v_exp_f32 v99, v99
    v_mfma_f32_32x32x16_bf16 v[72:87], v[152:155], v[120:123], v[72:87]
    s_waitcnt lgkmcnt(2)
    s_add_u32 m0, s22, 33792
    s_add_u32 s21, s21, 16384
    buffer_load_dwordx4 v1, s[4:7], s21 offen offset:0 sc1 lds
    v_exp_f32 v100, v100
    v_exp_f32 v101, v101
    v_exp_f32 v102, v102
    v_exp_f32_e64 v103, v103
    v_cvt_pk_bf16_f32 v124, v96, v97
    v_cvt_pk_bf16_f32 v125, v98, v99
    v_cvt_pk_bf16_f32 v126, v100, v101
    v_cvt_pk_bf16_f32 v127, v102, v103
    v_mfma_f32_32x32x16_bf16 v[88:103], v[136:139], v[240:243], 0
    ds_read_b128 v[144:147], v16 offset:15360
    ds_read_b64 v[148:149], v18 offset:15360
    v_exp_f32 v104, v104
    v_exp_f32 v105, v105
    v_exp_f32 v106, v106
    v_exp_f32 v107, v107
    v_mfma_f32_32x32x8bf16_1k v[88:103], v[140:141], v[244:245], v[88:103]
    ds_read_b64_tr_b16 v[152:153], v19 offset:18432
    ds_read_b64_tr_b16 v[154:155], v20 offset:18432
    v_exp_f32 v108, v108
    v_exp_f32 v109, v109
    v_exp_f32 v110, v110
    v_exp_f32 v111, v111
    v_mfma_f32_32x32x16_bf16 v[72:87], v[156:159], v[124:127], v[72:87]
    ds_read_b64_tr_b16 v[156:157], v19 offset:18688
    ds_read_b64_tr_b16 v[158:159], v20 offset:18688
    v_cvt_pk_bf16_f32 v128, v104, v105
    v_cvt_pk_bf16_f32 v129, v106, v107
    v_cvt_pk_bf16_f32 v130, v108, v109
    v_cvt_pk_bf16_f32 v131, v110, v111
    v_exp_f32 v112, v112
    v_exp_f32 v113, v113
    v_exp_f32 v114, v114
    v_exp_f32 v115, v115
    v_mfma_f32_32x32x16_bf16 v[56:71], v[160:163], v[128:131], v[56:71]
    s_waitcnt lgkmcnt(2)
    buffer_load_dwordx4 v1, s[4:7], s21 offen offset:1024 sc1 lds
    v_exp_f32 v116, v116
    v_exp_f32 v117, v117
    v_exp_f32 v118, v118
    v_exp_f32_e64 v119, v119
    v_cvt_pk_bf16_f32 v132, v112, v113
    v_cvt_pk_bf16_f32 v133, v114, v115
    v_cvt_pk_bf16_f32 v134, v116, v117
    v_cvt_pk_bf16_f32 v135, v118, v119
    v_rcp_f32_e64 v86, v84
    s_add_u32 s54, s56, 7680
    v_pk_mul_f32 v[72:73], v[72:73], v[86:87] op_sel_hi:[1,0]
    v_pk_mul_f32 v[74:75], v[74:75], v[86:87] op_sel_hi:[1,0]
    v_pk_mul_f32 v[76:77], v[76:77], v[86:87] op_sel_hi:[1,0]
    v_pk_mul_f32 v[78:79], v[78:79], v[86:87] op_sel_hi:[1,0]
    v_pk_mul_f32 v[80:81], v[80:81], v[86:87] op_sel_hi:[1,0]
    v_pk_mul_f32 v[82:83], v[82:83], v[86:87] op_sel_hi:[1,0]
    v_cvt_pk_bf16_f32 v172, v72, v73
    v_cvt_pk_bf16_f32 v173, v74, v75
    v_cvt_pk_bf16_f32 v174, v76, v77
    v_cvt_pk_bf16_f32 v175, v78, v79
    v_cvt_pk_bf16_f32 v176, v80, v81
    v_cvt_pk_bf16_f32 v177, v82, v83
    s_cmp_eq_u32 s43, 0
    s_cbranch_scc1 L_safe_185
    buffer_store_dwordx4 v[172:175], v5, s[4:7], s54 offen offset:0
    buffer_store_dwordx2 v[176:177], v6, s[4:7], s54 offen offset:512
L_join_186:
    v_add_u32 v27, 3766484992, v84
    v_cmp_lt_u32 vcc, 1073741824, v27
    s_nop 0
    s_or_b32 s23, vcc_lo, vcc_hi
    s_mov_b32 s26, s23
    v_mfma_f32_32x32x16_bf16 v[104:119], v[144:147], v[240:243], 0
    ds_read_b128 v[136:139], v16 offset:12288
    ds_read_b64 v[140:141], v18 offset:12288
    v_exp_f32 v88, v88
    v_exp_f32 v89, v89
    v_exp_f32 v90, v90
    v_exp_f32 v91, v91
    v_mfma_f32_32x32x8bf16_1k v[104:119], v[148:149], v[244:245], v[104:119]
    ds_read_b64_tr_b16 v[160:161], v19 offset:15360
    ds_read_b64_tr_b16 v[162:163], v20 offset:15360
    v_exp_f32 v92, v92
    v_exp_f32 v93, v93
    v_exp_f32 v94, v94
    v_exp_f32 v95, v95
    v_mfma_f32_32x32x16_bf16 v[56:71], v[164:167], v[132:135], v[56:71]
    ds_read_b64_tr_b16 v[164:165], v19 offset:15616
    ds_read_b64_tr_b16 v[166:167], v20 offset:15616
    v_cvt_pk_bf16_f32 v120, v88, v89
    v_cvt_pk_bf16_f32 v121, v90, v91
    v_cvt_pk_bf16_f32 v122, v92, v93
    v_cvt_pk_bf16_f32 v123, v94, v95
    v_exp_f32 v96, v96
    v_exp_f32 v97, v97
    v_exp_f32 v98, v98
    v_exp_f32 v99, v99
    v_mfma_f32_32x32x16_bf16 v[56:71], v[152:155], v[120:123], v[56:71]
    s_waitcnt lgkmcnt(2)
    buffer_load_dwordx4 v1, s[4:7], s21 offen offset:2048 sc1 lds
    v_exp_f32 v100, v100
    v_exp_f32 v101, v101
    v_exp_f32 v102, v102
    v_exp_f32_e64 v103, v103
    v_cvt_pk_bf16_f32 v124, v96, v97
    v_cvt_pk_bf16_f32 v125, v98, v99
    v_cvt_pk_bf16_f32 v126, v100, v101
    v_cvt_pk_bf16_f32 v127, v102, v103
    s_waitcnt vmcnt(5)
    s_barrier
    v_mfma_f32_32x32x16_bf16 v[88:103], v[136:139], v[240:243], 0
    s_branch L_over_458
L_chain6_0_1:
    s_branch L_chain6_0_2
L_over_458:
    ds_read_b128 v[144:147], v16 offset:9216
    ds_read_b64 v[148:149], v18 offset:9216
    v_exp_f32 v104, v104
    v_exp_f32 v105, v105
    v_exp_f32 v106, v106
    v_exp_f32 v107, v107
    v_mfma_f32_32x32x8bf16_1k v[88:103], v[140:141], v[244:245], v[88:103]
    ds_read_b64_tr_b16 v[152:153], v19 offset:12288
    ds_read_b64_tr_b16 v[154:155], v20 offset:12288
    v_exp_f32 v108, v108
    v_exp_f32 v109, v109
    v_exp_f32 v110, v110
    v_exp_f32 v111, v111
    v_mfma_f32_32x32x16_bf16 v[56:71], v[156:159], v[124:127], v[56:71]
    ds_read_b64_tr_b16 v[156:157], v19 offset:12544
    ds_read_b64_tr_b16 v[158:159], v20 offset:12544
    v_cvt_pk_bf16_f32 v128, v104, v105
    v_cvt_pk_bf16_f32 v129, v106, v107
    v_cvt_pk_bf16_f32 v130, v108, v109
    v_cvt_pk_bf16_f32 v131, v110, v111
    v_exp_f32 v112, v112
    v_exp_f32 v113, v113
    v_exp_f32 v114, v114
    v_exp_f32 v115, v115
    v_mfma_f32_32x32x16_bf16 v[56:71], v[160:163], v[128:131], v[56:71]
    s_waitcnt lgkmcnt(2)
    buffer_load_dwordx4 v1, s[4:7], s21 offen offset:3072 sc1 lds
    v_exp_f32 v116, v116
    v_exp_f32 v117, v117
    v_exp_f32 v118, v118
    v_exp_f32_e64 v119, v119
    v_cvt_pk_bf16_f32 v132, v112, v113
    v_cvt_pk_bf16_f32 v133, v114, v115
    v_cvt_pk_bf16_f32 v134, v116, v117
    v_cvt_pk_bf16_f32 v135, v118, v119
    s_cmp_lg_u32 s23, 0
    s_cbranch_scc1 L_nohi_187
    s_waitcnt vmcnt(2)
    s_cmp_eq_u32 s43, 0
    s_cbranch_scc1 L_safe_188
    buffer_store_dword v0, v14, s[4:7], s41 offen offset:0
L_join_189:
L_nohi_187:
    v_mfma_f32_32x32x16_bf16 v[104:119], v[144:147], v[240:243], 0
    ds_read_b128 v[136:139], v16 offset:6144
    ds_read_b64 v[140:141], v18 offset:6144
    v_exp_f32 v88, v88
    v_exp_f32 v89, v89
    v_exp_f32 v90, v90
    v_exp_f32_e64 v91, v91
    v_mfma_f32_32x32x8bf16_1k v[104:119], v[148:149], v[244:245], v[104:119]
    ds_read_b64_tr_b16 v[160:161], v19 offset:9216
    ds_read_b64_tr_b16 v[162:163], v20 offset:9216
    v_exp_f32 v92, v92
    v_exp_f32 v93, v93
    v_exp_f32 v94, v94
    v_exp_f32 v95, v95
    v_mfma_f32_32x32x16_bf16 v[56:71], v[164:167], v[132:135], v[56:71]
    ds_read_b64_tr_b16 v[164:165], v19 offset:9472
    ds_read_b64_tr_b16 v[166:167], v20 offset:9472
    v_cvt_pk_bf16_f32 v120, v88, v89
    v_cvt_pk_bf16_f32 v121, v90, v91
    v_cvt_pk_bf16_f32 v122, v92, v93
    v_cvt_pk_bf16_f32 v123, v94, v95
    v_exp_f32 v96, v96
    v_exp_f32 v97, v97
    v_exp_f32 v98, v98
    v_exp_f32 v99, v99
    v_mfma_f32_32x32x16_bf16 v[56:71], v[152:155], v[120:123], v[56:71]
    s_waitcnt lgkmcnt(2)
    v_exp_f32 v100, v100
    v_exp_f32 v101, v101
    v_exp_f32 v102, v102
    v_exp_f32_e64 v103, v103
    v_cvt_pk_bf16_f32 v124, v96, v97
    v_cvt_pk_bf16_f32 v125, v98, v99
    v_cvt_pk_bf16_f32 v126, v100, v101
    v_cvt_pk_bf16_f32 v127, v102, v103
    v_mfma_f32_32x32x16_bf16 v[88:103], v[136:139], v[240:243], 0
    ds_read_b128 v[144:147], v16 offset:3072
    ds_read_b64 v[148:149], v18 offset:3072
    v_exp_f32 v104, v104
    v_exp_f32 v105, v105
    v_exp_f32 v106, v106
    v_exp_f32 v107, v107
    v_mfma_f32_32x32x8bf16_1k v[88:103], v[140:141], v[244:245], v[88:103]
    ds_read_b64_tr_b16 v[152:153], v19 offset:6144
    ds_read_b64_tr_b16 v[154:155], v20 offset:6144
    v_exp_f32 v108, v108
    v_exp_f32 v109, v109
    v_exp_f32 v110, v110
    v_exp_f32 v111, v111
    v_mfma_f32_32x32x16_bf16 v[56:71], v[156:159], v[124:127], v[56:71]
    ds_read_b64_tr_b16 v[156:157], v19 offset:6400
    ds_read_b64_tr_b16 v[158:159], v20 offset:6400
    v_cvt_pk_bf16_f32 v128, v104, v105
    v_cvt_pk_bf16_f32 v129, v106, v107
    v_cvt_pk_bf16_f32 v130, v108, v109
    v_cvt_pk_bf16_f32 v131, v110, v111
    v_exp_f32 v112, v112
    v_exp_f32 v113, v113
    v_exp_f32 v114, v114
    v_exp_f32 v115, v115
    v_mfma_f32_32x32x16_bf16 v[56:71], v[160:163], v[128:131], v[56:71]
    s_waitcnt lgkmcnt(2)
    v_exp_f32 v116, v116
    v_exp_f32 v117, v117
    v_exp_f32 v118, v118
    v_exp_f32_e64 v119, v119
    v_cvt_pk_bf16_f32 v132, v112, v113
    v_cvt_pk_bf16_f32 v133, v114, v115
    v_cvt_pk_bf16_f32 v134, v116, v117
    v_cvt_pk_bf16_f32 v135, v118, v119
    v_mfma_f32_32x32x16_bf16 v[104:119], v[144:147], v[240:243], v[208:223]
    v_exp_f32 v88, v88
    v_exp_f32 v89, v89
    v_exp_f32 v90, v90
    v_exp_f32 v91, v91
    v_mfma_f32_32x32x8bf16_1k v[104:119], v[148:149], v[244:245], v[104:119]
    ds_read_b64_tr_b16 v[160:161], v19 offset:3072
    ds_read_b64_tr_b16 v[162:163], v20 offset:3072
    v_exp_f32 v92, v92
    v_exp_f32 v93, v93
    v_exp_f32 v94, v94
    v_exp_f32 v95, v95
    v_mfma_f32_32x32x16_bf16 v[56:71], v[164:167], v[132:135], v[56:71]
    ds_read_b64_tr_b16 v[164:165], v19 offset:3328
    ds_read_b64_tr_b16 v[166:167], v20 offset:3328
    v_cvt_pk_bf16_f32 v120, v88, v89
    v_cvt_pk_bf16_f32 v121, v90, v91
    v_cvt_pk_bf16_f32 v122, v92, v93
    v_cvt_pk_bf16_f32 v123, v94, v95
    v_exp_f32 v96, v96
    v_exp_f32 v97, v97
    v_exp_f32 v98, v98
    v_exp_f32 v99, v99
    v_mfma_f32_32x32x16_bf16 v[56:71], v[152:155], v[120:123], v[56:71]
    s_waitcnt lgkmcnt(2)
    v_exp_f32 v100, v100
    v_exp_f32 v101, v101
    v_exp_f32 v102, v102
    v_exp_f32_e64 v103, v103
    v_cvt_pk_bf16_f32 v124, v96, v97
    v_cvt_pk_bf16_f32 v125, v98, v99
    v_cvt_pk_bf16_f32 v126, v100, v101
    v_cvt_pk_bf16_f32 v127, v102, v103
    v_exp_f32 v104, v104
    v_exp_f32 v105, v105
    v_exp_f32 v106, v106
    v_exp_f32 v107, v107
    v_exp_f32 v108, v108
    v_exp_f32 v109, v109
    v_exp_f32 v110, v110
    v_exp_f32 v111, v111
    v_mfma_f32_32x32x16_bf16 v[56:71], v[156:159], v[124:127], v[56:71]
    v_cvt_pk_bf16_f32 v128, v104, v105
    v_cvt_pk_bf16_f32 v129, v106, v107
    v_cvt_pk_bf16_f32 v130, v108, v109
    v_cvt_pk_bf16_f32 v131, v110, v111
    v_exp_f32 v112, v112
    v_exp_f32 v113, v113
    v_exp_f32 v114, v114
    v_exp_f32 v115, v115
    v_mfma_f32_32x32x16_bf16 v[56:71], v[160:163], v[128:131], v[56:71]
    s_waitcnt lgkmcnt(0)
    v_exp_f32 v116, v116
    v_exp_f32 v117, v117
    v_exp_f32 v118, v118
    v_exp_f32_e64 v119, v119
    v_cvt_pk_bf16_f32 v132, v112, v113
    v_cvt_pk_bf16_f32 v133, v114, v115
    v_cvt_pk_bf16_f32 v134, v116, v117
    v_cvt_pk_bf16_f32 v135, v118, v119
    s_nop 1
    v_mfma_f32_32x32x16_bf16 v[56:71], v[164:167], v[132:135], v[56:71]
    s_nop 11
    v_rcp_f32_e64 v70, v68
    s_add_u32 s54, s56, 1280
    v_pk_mul_f32 v[56:57], v[56:57], v[70:71] op_sel_hi:[1,0]
    v_pk_mul_f32 v[58:59], v[58:59], v[70:71] op_sel_hi:[1,0]
    v_pk_mul_f32 v[60:61], v[60:61], v[70:71] op_sel_hi:[1,0]
    v_pk_mul_f32 v[62:63], v[62:63], v[70:71] op_sel_hi:[1,0]
    v_pk_mul_f32 v[64:65], v[64:65], v[70:71] op_sel_hi:[1,0]
    v_pk_mul_f32 v[66:67], v[66:67], v[70:71] op_sel_hi:[1,0]
    v_cvt_pk_bf16_f32 v172, v56, v57
    v_cvt_pk_bf16_f32 v173, v58, v59
    v_cvt_pk_bf16_f32 v174, v60, v61
    v_cvt_pk_bf16_f32 v175, v62, v63
    v_cvt_pk_bf16_f32 v176, v64, v65
    v_cvt_pk_bf16_f32 v177, v66, v67
    s_cmp_eq_u32 s43, 0
    s_cbranch_scc1 L_safe_192
    buffer_store_dwordx4 v[172:175], v5, s[4:7], s54 offen offset:0
    buffer_store_dwordx2 v[176:177], v6, s[4:7], s54 offen offset:512
L_join_193:
    v_add_u32 v27, 3766484992, v68
    v_cmp_lt_u32_e64 vcc, 1073741824, v27
    s_nop 0
    s_or_b32 s23, s23, vcc_lo
    s_or_b32 s23, s23, vcc_hi
    s_cmp_lg_u32 s23, 0
    s_cbranch_scc1 L_fallback_190
L_fbdone_191:
    s_branch L_attdone_159
L_chain6_1_1:
    s_branch L_chain6_1_2
    s_nop 0
L_att2_157:
    ds_read_b128 v[136:139], v16 offset:39936
    ds_read_b64 v[140:141], v18 offset:39936
    ds_read_b64_tr_b16 v[152:153], v19 offset:39936
    ds_read_b64_tr_b16 v[154:155], v20 offset:39936
    ds_read_b64_tr_b16 v[156:157], v19 offset:40192
    ds_read_b64_tr_b16 v[158:159], v20 offset:40192
    v_add_u32 v26, s56, v16
    v_add_u32 v27, s56, v17
    v_add_u32_e64 v28, s56, v18
    v_pk_mul_f32 v[72:73], v[72:73], v[224:225] op_sel:[0,1] op_sel_hi:[1,1]
    v_pk_mul_f32 v[74:75], v[74:75], v[224:225] op_sel:[0,1] op_sel_hi:[1,1]
    v_pk_mul_f32 v[76:77], v[76:77], v[224:225] op_sel:[0,1] op_sel_hi:[1,1]
    v_pk_mul_f32 v[78:79], v[78:79], v[224:225] op_sel:[0,1] op_sel_hi:[1,1]
    v_pk_mul_f32 v[80:81], v[80:81], v[224:225] op_sel:[0,1] op_sel_hi:[1,1]
    v_pk_mul_f32 v[82:83], v[82:83], v[224:225] op_sel:[0,1] op_sel_hi:[1,1]
    v_pk_mul_f32 v[84:85], v[84:85], v[224:225] op_sel:[0,1] op_sel_hi:[1,1]
    v_pk_mul_f32 v[86:87], v[86:87], v[224:225] op_sel:[0,1] op_sel_hi:[1,1]
    v_cvt_pk_bf16_f32 v72, v72, v73
    v_cvt_pk_bf16_f32 v73, v74, v75
    v_cvt_pk_bf16_f32 v74, v76, v77
    v_cvt_pk_bf16_f32 v75, v78, v79
    v_cvt_pk_bf16_f32 v76, v80, v81
    v_cvt_pk_bf16_f32 v77, v82, v83
    v_cvt_pk_bf16_f32 v78, v84, v85
    v_cvt_pk_bf16_f32 v79, v86, v87
    v_cndmask_b32 v78, v78, v31, s[50:51]
    v_cndmask_b32 v79, v79, 0, s[50:51]
    buffer_store_dwordx4 v[72:75], v26, s[4:7], s61 offen offset:0 sc1
    v_pk_mul_f32 v[80:81], v[64:65], v[224:225] op_sel:[0,1] op_sel_hi:[1,1]
    v_pk_mul_f32 v[82:83], v[66:67], v[224:225] op_sel:[0,1] op_sel_hi:[1,1]
    v_pk_mul_f32 v[84:85], v[68:69], v[224:225] op_sel:[0,1] op_sel_hi:[1,1]
    v_pk_mul_f32 v[86:87], v[70:71], v[224:225] op_sel:[0,1] op_sel_hi:[1,1]
    buffer_store_dwordx4 v[76:79], v28, s[4:7], s61 offen offset:0 sc1
    v_cvt_pk_bf16_f32 v80, v80, v81
    v_cvt_pk_bf16_f32 v81, v82, v83
    v_cvt_pk_bf16_f32 v82, v84, v85
    v_cvt_pk_bf16_f32 v83, v86, v87
    ds_write_b128 v26, v[72:75] offset:24576
    buffer_store_dwordx4 v[80:83], v27, s[4:7], s61 offen offset:0 sc1
    v_pk_mul_f32 v[64:65], v[64:65], v[226:227] op_sel:[0,1] op_sel_hi:[1,1]
    v_pk_mul_f32 v[66:67], v[66:67], v[226:227] op_sel:[0,1] op_sel_hi:[1,1]
    ds_write_b128 v28, v[76:79] offset:24576
    v_pk_mul_f32 v[56:57], v[56:57], v[226:227] op_sel:[0,0] op_sel_hi:[1,0]
    v_pk_mul_f32 v[58:59], v[58:59], v[226:227] op_sel:[0,0] op_sel_hi:[1,0]
    v_pk_mul_f32 v[60:61], v[60:61], v[226:227] op_sel:[0,0] op_sel_hi:[1,0]
    v_pk_mul_f32 v[62:63], v[62:63], v[226:227] op_sel:[0,0] op_sel_hi:[1,0]
    ds_write_b128 v27, v[80:83] offset:24576
    s_waitcnt vmcnt(3)
    buffer_store_dword v15, v24, s[4:7], s59 offen offset:0 sc1
    s_waitcnt lgkmcnt(7)
    v_mfma_f32_32x32x16_bf16 v[88:103], v[136:139], v[248:251], v[192:207]
    v_mfma_f32_32x32x8bf16_1k v[88:103], v[140:141], v[252:253], v[88:103]
    s_waitcnt lgkmcnt(0)
    s_barrier
    ds_read_b128 v[144:147], v16 offset:36864
    ds_read_b64 v[148:149], v18 offset:36864
    v_cvt_pk_bf16_f32 v240, v56, v57
    v_cvt_pk_bf16_f32 v241, v58, v59
    v_cvt_pk_bf16_f32 v242, v60, v61
    v_cvt_pk_bf16_f32 v243, v62, v63
    v_cvt_pk_bf16_f32 v244, v64, v65
    v_cvt_pk_bf16_f32 v245, v66, v67
    s_add_u32 s61, s58, -4079616
    v_add_u32 v31, s62, v1
    s_mov_b32 s56, s63
    v_add_u32 v0, 9, v15
    v_exp_f32 v88, v88
    v_exp_f32 v89, v89
    v_exp_f32 v90, v90
    v_exp_f32 v91, v91
    s_waitcnt lgkmcnt(0)
    v_mfma_f32_32x32x16_bf16 v[104:119], v[144:147], v[248:251], 0
    ds_read_b128 v[136:139], v16 offset:33792
    ds_read_b64 v[140:141], v18 offset:33792
    v_exp_f32 v92, v92
    v_exp_f32 v93, v93
    v_exp_f32 v94, v94
    v_exp_f32 v95, v95
    v_mfma_f32_32x32x8bf16_1k v[104:119], v[148:149], v[252:253], v[104:119]
    ds_read_b64_tr_b16 v[160:161], v19 offset:36864
    ds_read_b64_tr_b16 v[162:163], v20 offset:36864
    ds_read_b64_tr_b16 v[164:165], v19 offset:37120
    ds_read_b64_tr_b16 v[166:167], v20 offset:37120
    v_cvt_pk_bf16_f32 v120, v88, v89
    v_cvt_pk_bf16_f32 v121, v90, v91
    v_cvt_pk_bf16_f32 v122, v92, v93
    v_cvt_pk_bf16_f32 v123, v94, v95
    v_exp_f32 v96, v96
    v_exp_f32 v97, v97
    v_exp_f32 v98, v98
    v_exp_f32 v99, v99
    v_mfma_f32_32x32x16_bf16 v[72:87], v[152:155], v[120:123], 0
    s_waitcnt lgkmcnt(2)
    v_exp_f32 v100, v100
    v_exp_f32 v101, v101
    v_exp_f32 v102, v102
    v_exp_f32_e64 v103, v103
    v_cvt_pk_bf16_f32 v124, v96, v97
    v_cvt_pk_bf16_f32 v125, v98, v99
    v_cvt_pk_bf16_f32 v126, v100, v101
    v_cvt_pk_bf16_f32 v127, v102, v103
    s_lshl_b32 s68, s38, 2
    s_add_u32 s68, s68, s36
    s_mul_i32 s68, s68, 2560
    s_mul_i32 s69, s38, 17408
    s_add_u32 s68, s68, s69
    s_add_u32 s68, s68, s45
    s_add_u32 s68, s68, 372736
    v_add_u32 v168, 44, v21
    v_lshrrev_b32 v168, 6, v168
    v_lshl_add_u32 v168, v168, 28, v1
    v_lshlrev_b32_e64 v168, 3, v168
    buffer_load_dword a252, v168, s[4:7], s68 offen offset:0 sc1
    v_mfma_f32_32x32x16_bf16 v[88:103], v[136:139], v[248:251], 0
    ds_read_b128 v[144:147], v16 offset:30720
    ds_read_b64 v[148:149], v18 offset:30720
    v_exp_f32 v104, v104
    v_exp_f32 v105, v105
    v_exp_f32 v106, v106
    v_exp_f32 v107, v107
    v_mfma_f32_32x32x8bf16_1k v[88:103], v[140:141], v[252:253], v[88:103]
    ds_read_b64_tr_b16 v[152:153], v19 offset:33792
    ds_read_b64_tr_b16 v[154:155], v20 offset:33792
    v_exp_f32 v108, v108
    v_exp_f32 v109, v109
    v_exp_f32 v110, v110
    v_exp_f32 v111, v111
    v_mfma_f32_32x32x16_bf16 v[72:87], v[156:159], v[124:127], v[72:87]
    ds_read_b64_tr_b16 v[156:157], v19 offset:34048
    ds_read_b64_tr_b16 v[158:159], v20 offset:34048
    v_cvt_pk_bf16_f32 v128, v104, v105
    v_cvt_pk_bf16_f32 v129, v106, v107
    v_cvt_pk_bf16_f32 v130, v108, v109
    v_cvt_pk_bf16_f32 v131, v110, v111
    v_exp_f32 v112, v112
    v_exp_f32 v113, v113
    v_exp_f32 v114, v114
    v_exp_f32 v115, v115
    v_mfma_f32_32x32x16_bf16 v[72:87], v[160:163], v[128:131], v[72:87]
    s_waitcnt lgkmcnt(2)
    v_exp_f32 v116, v116
    v_exp_f32 v117, v117
    v_exp_f32 v118, v118
    v_exp_f32_e64 v119, v119
    v_cvt_pk_bf16_f32 v132, v112, v113
    v_cvt_pk_bf16_f32 v133, v114, v115
    v_cvt_pk_bf16_f32 v134, v116, v117
    v_cvt_pk_bf16_f32 v135, v118, v119
    buffer_load_dword v224, v14, s[4:7], s60 offen offset:0 sc1
    s_lshl_b32 s68, s38, 2
    s_add_u32 s68, s68, s36
    s_mul_i32 s68, s68, 2560
    s_mul_i32 s69, s37, 327680
    s_add_u32 s68, s68, s69
    v_add_u32 v169, 44, v21
    v_lshrrev_b32_e64 v169, 6, v169
    v_lshl_add_u32 v169, v169, 28, v1
    v_lshlrev_b32_e64 v169, 3, v169
    buffer_load_dword a252, v169, s[8:11], s68 offen offset:0 sc1
    v_mfma_f32_32x32x16_bf16 v[104:119], v[144:147], v[248:251], 0
    s_add_u32 m0, s22, 1024
    s_add_u32 s21, s21, 65536
    buffer_load_dwordx4 v1, s[4:7], s21 offen offset:0 sc1 lds
    v_exp_f32 v88, v88
    v_exp_f32 v89, v89
    v_exp_f32 v90, v90
    v_exp_f32 v91, v91
    v_mfma_f32_32x32x8bf16_1k v[104:119], v[148:149], v[252:253], v[104:119]
    ds_read_b64_tr_b16 v[160:161], v19 offset:30720
    ds_read_b64_tr_b16 v[162:163], v20 offset:30720
    v_exp_f32 v92, v92
    v_exp_f32 v93, v93
    v_exp_f32 v94, v94
    v_exp_f32 v95, v95
    v_mfma_f32_32x32x16_bf16 v[72:87], v[164:167], v[132:135], v[72:87]
    ds_read_b64_tr_b16 v[164:165], v19 offset:30976
    ds_read_b64_tr_b16 v[166:167], v20 offset:30976
    v_cvt_pk_bf16_f32 v120, v88, v89
    v_cvt_pk_bf16_f32 v121, v90, v91
    v_cvt_pk_bf16_f32 v122, v92, v93
    v_cvt_pk_bf16_f32 v123, v94, v95
    v_exp_f32 v96, v96
    v_exp_f32 v97, v97
    v_exp_f32 v98, v98
    v_exp_f32 v99, v99
    v_mfma_f32_32x32x16_bf16 v[72:87], v[152:155], v[120:123], v[72:87]
    s_waitcnt lgkmcnt(2)
    v_exp_f32 v100, v100
    v_exp_f32 v101, v101
    v_exp_f32 v102, v102
    v_exp_f32_e64 v103, v103
    v_cvt_pk_bf16_f32 v124, v96, v97
    v_cvt_pk_bf16_f32 v125, v98, v99
    v_cvt_pk_bf16_f32 v126, v100, v101
    v_cvt_pk_bf16_f32 v127, v102, v103
    s_waitcnt vmcnt(5)
    buffer_store_dword v15, v24, s[4:7], s59 offen offset:128 sc1
    v_mfma_f32_32x32x16_bf16 v[88:103], v[144:147], v[240:243], v[192:207]
    ds_read_b128 v[136:139], v16 offset:27648
    ds_read_b64 v[140:141], v18 offset:27648
    v_exp_f32 v104, v104
    v_exp_f32 v105, v105
    v_exp_f32 v106, v106
    v_exp_f32_e64 v107, v107
    v_mfma_f32_32x32x8bf16_1k v[88:103], v[148:149], v[244:245], v[88:103]
    buffer_load_dwordx4 v1, s[4:7], s21 offen offset:1024 sc1 lds
    v_exp_f32 v108, v108
    v_exp_f32 v109, v109
    v_exp_f32 v110, v110
    v_exp_f32 v111, v111
    v_mfma_f32_32x32x16_bf16 v[72:87], v[156:159], v[124:127], v[72:87]
    v_cvt_pk_bf16_f32 v128, v104, v105
    v_cvt_pk_bf16_f32 v129, v106, v107
    v_cvt_pk_bf16_f32 v130, v108, v109
    v_cvt_pk_bf16_f32 v131, v110, v111
    v_exp_f32 v112, v112
    v_exp_f32 v113, v113
    v_exp_f32 v114, v114
    v_exp_f32 v115, v115
    v_mfma_f32_32x32x16_bf16 v[72:87], v[160:163], v[128:131], v[72:87]
    s_waitcnt lgkmcnt(0)
    v_exp_f32 v116, v116
    v_exp_f32 v117, v117
    v_exp_f32 v118, v118
    v_exp_f32_e64 v119, v119
    v_cvt_pk_bf16_f32 v132, v112, v113
    v_cvt_pk_bf16_f32 v133, v114, v115
    v_cvt_pk_bf16_f32 v134, v116, v117
    v_cvt_pk_bf16_f32 v135, v118, v119
    s_cmp_eq_u32 s37, 0
    s_cbranch_scc1 L_halook_194
    s_waitcnt vmcnt(4)
    v_cmp_ne_u32 vcc, v224, v15
    s_nop 0
    s_and_b32 vcc_hi, vcc_lo, 1
    s_cbranch_scc0 L_halook_194
L_poll_196:
    buffer_load_dword v26, v14, s[4:7], s60 offen offset:0 sc1
    s_waitcnt vmcnt(0)
    v_cmp_ne_u32_e64 vcc, v26, v15
    s_nop 0
    s_and_b32 vcc_hi, vcc_lo, 1
    s_cbranch_scc0 L_polled_197
    s_sub_u32 s44, s44, 1
    s_cbranch_scc0 L_poll_196
    s_mov_b32 s44, 0
L_polled_197:
L_halook_194:
    s_mov_b32 m0, 130048
    s_add_u32 s63, s61, 15360
    buffer_load_dwordx4 v31, s[4:7], s63 offen offset:0 sc1 lds
    buffer_load_dwordx4 v31, s[4:7], s63 offen offset:1024 sc1 lds
    buffer_load_dwordx4 v31, s[4:7], s63 offen offset:2048 sc1 lds
    v_mfma_f32_32x32x16_bf16 v[104:119], v[136:139], v[248:251], 0
    s_add_u32 m0, s22, 1024
    s_nop 0
    buffer_load_dwordx4 v1, s[4:7], s21 offen offset:2048 sc1 lds
    v_exp_f32 v88, v88
    v_exp_f32 v89, v89
    v_exp_f32 v90, v90
    v_exp_f32_e64 v91, v91
    v_mfma_f32_32x32x8bf16_1k v[104:119], v[140:141], v[252:253], v[104:119]
    ds_read_b64_tr_b16 v[152:153], v19 offset:27648
    ds_read_b64_tr_b16 v[154:155], v20 offset:27648
    v_exp_f32 v92, v92
    v_exp_f32 v93, v93
    v_exp_f32 v94, v94
    v_exp_f32 v95, v95
    v_mfma_f32_32x32x16_bf16 v[72:87], v[164:167], v[132:135], v[72:87]
    ds_read_b64_tr_b16 v[156:157], v19 offset:27904
    ds_read_b64_tr_b16 v[158:159], v20 offset:27904
    v_cvt_pk_bf16_f32 v120, v88, v89
    v_cvt_pk_bf16_f32 v121, v90, v91
    v_cvt_pk_bf16_f32 v122, v92, v93
    v_cvt_pk_bf16_f32 v123, v94, v95
    v_exp_f32 v96, v96
    v_exp_f32 v97, v97
    v_exp_f32 v98, v98
    v_exp_f32 v99, v99
    v_mfma_f32_32x32x16_bf16 v[56:71], v[160:163], v[120:123], 0
    s_waitcnt lgkmcnt(2)
    v_exp_f32 v100, v100
    v_exp_f32 v101, v101
    v_exp_f32 v102, v102
    v_exp_f32_e64 v103, v103
    v_cvt_pk_bf16_f32 v124, v96, v97
    v_cvt_pk_bf16_f32 v125, v98, v99
    v_cvt_pk_bf16_f32 v126, v100, v101
    v_cvt_pk_bf16_f32 v127, v102, v103
    v_mfma_f32_32x32x16_bf16 v[88:103], v[136:139], v[240:243], 0
    ds_read_b128 v[144:147], v16 offset:24576
    ds_read_b64 v[148:149], v18 offset:24576
    v_exp_f32 v104, v104
    v_exp_f32 v105, v105
    v_exp_f32 v106, v106
    v_exp_f32 v107, v107
    v_mfma_f32_32x32x8bf16_1k v[88:103], v[140:141], v[244:245], v[88:103]
    buffer_load_dwordx4 v1, s[4:7], s21 offen offset:3072 sc1 lds
    v_exp_f32 v108, v108
    v_exp_f32 v109, v109
    v_exp_f32 v110, v110
    v_exp_f32 v111, v111
    v_mfma_f32_32x32x16_bf16 v[56:71], v[164:167], v[124:127], v[56:71]
    v_cvt_pk_bf16_f32 v128, v104, v105
    v_cvt_pk_bf16_f32 v129, v106, v107
    v_cvt_pk_bf16_f32 v130, v108, v109
    v_cvt_pk_bf16_f32 v131, v110, v111
    v_exp_f32 v112, v112
    v_exp_f32 v113, v113
    v_exp_f32 v114, v114
    v_exp_f32 v115, v115
    v_mfma_f32_32x32x16_bf16 v[72:87], v[152:155], v[128:131], v[72:87]
    s_waitcnt lgkmcnt(0)
    v_exp_f32 v116, v116
    v_exp_f32 v117, v117
    v_exp_f32 v118, v118
    v_exp_f32_e64 v119, v119
    v_cvt_pk_bf16_f32 v132, v112, v113
    v_cvt_pk_bf16_f32 v133, v114, v115
    v_cvt_pk_bf16_f32 v134, v116, v117
    v_cvt_pk_bf16_f32 v135, v118, v119
    v_mfma_f32_32x32x16_bf16 v[104:119], v[144:147], v[248:251], 0
    s_add_u32 m0, s22, 17408
    s_add_u32 s21, s21, 16384
    buffer_load_dwordx4 v1, s[4:7], s21 offen offset:0 sc1 lds
    v_exp_f32 v88, v88
    v_exp_f32 v89, v89
    v_exp_f32 v90, v90
    v_exp_f32 v91, v91
    v_mfma_f32_32x32x8bf16_1k v[104:119], v[148:149], v[252:253], v[104:119]
    ds_read_b64_tr_b16 v[160:161], v19 offset:24576
    ds_read_b64_tr_b16 v[162:163], v20 offset:24576
    v_exp_f32 v92, v92
    v_exp_f32 v93, v93
    v_exp_f32 v94, v94
    v_exp_f32 v95, v95
    v_mfma_f32_32x32x16_bf16 v[72:87], v[156:159], v[132:135], v[72:87]
    ds_read_b64_tr_b16 v[164:165], v19 offset:24832
    ds_read_b64_tr_b16 v[166:167], v20 offset:24832
    v_cvt_pk_bf16_f32 v120, v88, v89
    v_cvt_pk_bf16_f32 v121, v90, v91
    v_cvt_pk_bf16_f32 v122, v92, v93
    v_cvt_pk_bf16_f32 v123, v94, v95
    v_exp_f32 v96, v96
    v_exp_f32 v97, v97
    v_exp_f32 v98, v98
    v_exp_f32 v99, v99
    v_mfma_f32_32x32x16_bf16 v[56:71], v[152:155], v[120:123], v[56:71]
    s_waitcnt lgkmcnt(2)
    v_exp_f32 v100, v100
    v_exp_f32 v101, v101
    v_exp_f32 v102, v102
    v_exp_f32_e64 v103, v103
    v_cvt_pk_bf16_f32 v124, v96, v97
    v_cvt_pk_bf16_f32 v125, v98, v99
    v_cvt_pk_bf16_f32 v126, v100, v101
    v_cvt_pk_bf16_f32 v127, v102, v103
    buffer_load_dword v228, v14, s[4:7], s60 offen offset:128 sc1
    v_mfma_f32_32x32x16_bf16 v[88:103], v[144:147], v[240:243], 0
    buffer_load_dwordx4 v1, s[4:7], s21 offen offset:1024 sc1 lds
    v_exp_f32 v104, v104
    v_exp_f32 v105, v105
    v_exp_f32 v106, v106
    v_exp_f32 v107, v107
    v_mfma_f32_32x32x8bf16_1k v[88:103], v[148:149], v[244:245], v[88:103]
    v_exp_f32 v108, v108
    v_exp_f32 v109, v109
    v_exp_f32 v110, v110
    v_exp_f32 v111, v111
    v_mfma_f32_32x32x16_bf16 v[56:71], v[156:159], v[124:127], v[56:71]
    v_cvt_pk_bf16_f32 v128, v104, v105
    v_cvt_pk_bf16_f32 v129, v106, v107
    v_cvt_pk_bf16_f32 v130, v108, v109
    v_cvt_pk_bf16_f32 v131, v110, v111
    v_exp_f32 v112, v112
    v_exp_f32 v113, v113
    v_exp_f32 v114, v114
    v_exp_f32 v115, v115
    v_mfma_f32_32x32x16_bf16 v[72:87], v[160:163], v[128:131], v[72:87]
    s_waitcnt lgkmcnt(0)
    v_exp_f32 v116, v116
    v_exp_f32 v117, v117
    v_exp_f32 v118, v118
    v_exp_f32_e64 v119, v119
    v_cvt_pk_bf16_f32 v132, v112, v113
    v_cvt_pk_bf16_f32 v133, v114, v115
    v_cvt_pk_bf16_f32 v134, v116, v117
    v_cvt_pk_bf16_f32 v135, v118, v119
    s_waitcnt vmcnt(5)
    s_barrier
    ds_read_b128 v[136:139], v16 offset:21504
    ds_read_b64 v[140:141], v18 offset:21504
    s_waitcnt lgkmcnt(0)
    v_mfma_f32_32x32x16_bf16 v[104:119], v[136:139], v[248:251], 0
    ds_read_b128 v[144:147], v16 offset:18432
    ds_read_b64 v[148:149], v18 offset:18432
    v_exp_f32 v88, v88
    v_exp_f32 v89, v89
    v_exp_f32 v90, v90
    v_exp_f32_e64 v91, v91
    v_mfma_f32_32x32x8bf16_1k v[104:119], v[140:141], v[252:253], v[104:119]
    ds_read_b64_tr_b16 v[152:153], v19 offset:21504
    ds_read_b64_tr_b16 v[154:155], v20 offset:21504
    v_exp_f32 v92, v92
    v_exp_f32 v93, v93
    v_exp_f32 v94, v94
    v_exp_f32 v95, v95
    v_mfma_f32_32x32x16_bf16 v[72:87], v[164:167], v[132:135], v[72:87]
    ds_read_b64_tr_b16 v[156:157], v19 offset:21760
    ds_read_b64_tr_b16 v[158:159], v20 offset:21760
    v_cvt_pk_bf16_f32 v120, v88, v89
    v_cvt_pk_bf16_f32 v121, v90, v91
    v_cvt_pk_bf16_f32 v122, v92, v93
    v_cvt_pk_bf16_f32 v123, v94, v95
    v_exp_f32 v96, v96
    v_exp_f32 v97, v97
    v_exp_f32 v98, v98
    v_exp_f32 v99, v99
    v_mfma_f32_32x32x16_bf16 v[56:71], v[160:163], v[120:123], v[56:71]
    s_waitcnt lgkmcnt(2)
    buffer_load_dwordx4 v1, s[4:7], s21 offen offset:2048 sc1 lds
    v_exp_f32 v100, v100
    v_exp_f32 v101, v101
    v_exp_f32 v102, v102
    v_exp_f32_e64 v103, v103
    v_cvt_pk_bf16_f32 v124, v96, v97
    v_cvt_pk_bf16_f32 v125, v98, v99
    v_cvt_pk_bf16_f32 v126, v100, v101
    v_cvt_pk_bf16_f32 v127, v102, v103
    v_mfma_f32_32x32x16_bf16 v[88:103], v[144:147], v[248:251], 0
    ds_read_b128 v[136:139], v16 offset:15360
    ds_read_b64 v[140:141], v18 offset:15360
    v_exp_f32 v104, v104
    v_exp_f32 v105, v105
    v_exp_f32 v106, v106
    v_exp_f32 v107, v107
    v_mfma_f32_32x32x8bf16_1k v[88:103], v[148:149], v[252:253], v[88:103]
    ds_read_b64_tr_b16 v[160:161], v19 offset:18432
    ds_read_b64_tr_b16 v[162:163], v20 offset:18432
    v_exp_f32 v108, v108
    v_exp_f32 v109, v109
    v_exp_f32 v110, v110
    v_exp_f32 v111, v111
    v_mfma_f32_32x32x16_bf16 v[56:71], v[164:167], v[124:127], v[56:71]
    ds_read_b64_tr_b16 v[164:165], v19 offset:18688
    ds_read_b64_tr_b16 v[166:167], v20 offset:18688
    v_cvt_pk_bf16_f32 v128, v104, v105
    v_cvt_pk_bf16_f32 v129, v106, v107
    v_cvt_pk_bf16_f32 v130, v108, v109
    v_cvt_pk_bf16_f32 v131, v110, v111
    v_exp_f32 v112, v112
    v_exp_f32 v113, v113
    v_exp_f32 v114, v114
    v_exp_f32 v115, v115
    v_mfma_f32_32x32x16_bf16 v[72:87], v[152:155], v[128:131], v[72:87]
    s_waitcnt lgkmcnt(2)
    buffer_load_dwordx4 v1, s[4:7], s21 offen offset:3072 sc1 lds
    v_exp_f32 v116, v116
    v_exp_f32 v117, v117
    v_exp_f32 v118, v118
    v_exp_f32_e64 v119, v119
    v_cvt_pk_bf16_f32 v132, v112, v113
    v_cvt_pk_bf16_f32 v133, v114, v115
    s_branch L_over_459
L_chain6_2_1:
    s_branch L_chain6_2_2
L_over_459:
    v_cvt_pk_bf16_f32 v134, v116, v117
    v_cvt_pk_bf16_f32 v135, v118, v119
    s_cmp_eq_u32 s37, 0
    s_cbranch_scc1 L_halook_198
    s_waitcnt vmcnt(3)
    v_cmp_ne_u32 vcc, v228, v15
    s_nop 0
    s_and_b32 vcc_hi, vcc_lo, 1
    s_cbranch_scc0 L_halook_198
L_poll_200:
    buffer_load_dword v26, v14, s[4:7], s60 offen offset:128 sc1
    s_waitcnt vmcnt(0)
    v_cmp_ne_u32_e64 vcc, v26, v15
    s_nop 0
    s_and_b32 vcc_hi, vcc_lo, 1
    s_cbranch_scc0 L_polled_201
    s_sub_u32 s44, s44, 1
    s_cbranch_scc0 L_poll_200
    s_mov_b32 s44, 0
L_polled_201:
L_halook_198:
    s_mov_b32 m0, 120832
    s_add_u32 s63, s61, 6144
    buffer_load_dwordx4 v31, s[4:7], s63 offen offset:0 sc1 lds
    buffer_load_dwordx4 v31, s[4:7], s63 offen offset:1024 sc1 lds
    buffer_load_dwordx4 v31, s[4:7], s63 offen offset:2048 sc1 lds
    v_mfma_f32_32x32x16_bf16 v[104:119], v[136:139], v[248:251], v[208:223]
    ds_read_b128 v[144:147], v16 offset:21504
    ds_read_b64 v[148:149], v18 offset:21504
    v_exp_f32 v88, v88
    v_exp_f32 v89, v89
    v_exp_f32 v90, v90
    v_exp_f32 v91, v91
    v_mfma_f32_32x32x8bf16_1k v[104:119], v[140:141], v[252:253], v[104:119]
    ds_read_b64_tr_b16 v[152:153], v19 offset:15360
    ds_read_b64_tr_b16 v[154:155], v20 offset:15360
    v_exp_f32 v92, v92
    v_exp_f32 v93, v93
    v_exp_f32 v94, v94
    v_exp_f32 v95, v95
    v_mfma_f32_32x32x16_bf16 v[72:87], v[156:159], v[132:135], v[72:87]
    ds_read_b64_tr_b16 v[156:157], v19 offset:15616
    ds_read_b64_tr_b16 v[158:159], v20 offset:15616
    v_cvt_pk_bf16_f32 v120, v88, v89
    v_cvt_pk_bf16_f32 v121, v90, v91
    v_cvt_pk_bf16_f32 v122, v92, v93
    v_cvt_pk_bf16_f32 v123, v94, v95
    v_exp_f32 v96, v96
    v_exp_f32 v97, v97
    v_exp_f32 v98, v98
    v_exp_f32 v99, v99
    v_mfma_f32_32x32x16_bf16 v[72:87], v[160:163], v[120:123], v[72:87]
    s_waitcnt lgkmcnt(2)
    s_add_u32 m0, s22, 33792
    s_add_u32 s21, s21, 16384
    buffer_load_dwordx4 v1, s[4:7], s21 offen offset:0 sc1 lds
    v_exp_f32 v100, v100
    v_exp_f32 v101, v101
    v_exp_f32 v102, v102
    v_exp_f32_e64 v103, v103
    v_cvt_pk_bf16_f32 v124, v96, v97
    v_cvt_pk_bf16_f32 v125, v98, v99
    v_cvt_pk_bf16_f32 v126, v100, v101
    v_cvt_pk_bf16_f32 v127, v102, v103
    v_mfma_f32_32x32x16_bf16 v[88:103], v[144:147], v[240:243], 0
    ds_read_b128 v[136:139], v16 offset:18432
    ds_read_b64 v[140:141], v18 offset:18432
    v_exp_f32 v104, v104
    v_exp_f32 v105, v105
    v_exp_f32 v106, v106
    v_exp_f32 v107, v107
    v_mfma_f32_32x32x8bf16_1k v[88:103], v[148:149], v[244:245], v[88:103]
    ds_read_b64_tr_b16 v[160:161], v19 offset:21504
    ds_read_b64_tr_b16 v[162:163], v20 offset:21504
    v_exp_f32 v108, v108
    v_exp_f32 v109, v109
    v_exp_f32 v110, v110
    v_exp_f32 v111, v111
    v_mfma_f32_32x32x16_bf16 v[72:87], v[164:167], v[124:127], v[72:87]
    ds_read_b64_tr_b16 v[164:165], v19 offset:21760
    ds_read_b64_tr_b16 v[166:167], v20 offset:21760
    v_cvt_pk_bf16_f32 v128, v104, v105
    v_cvt_pk_bf16_f32 v129, v106, v107
    v_cvt_pk_bf16_f32 v130, v108, v109
    v_cvt_pk_bf16_f32 v131, v110, v111
    v_exp_f32 v112, v112
    v_exp_f32 v113, v113
    v_exp_f32 v114, v114
    v_exp_f32 v115, v115
    v_mfma_f32_32x32x16_bf16 v[72:87], v[152:155], v[128:131], v[72:87]
    s_waitcnt lgkmcnt(2)
    buffer_load_dwordx4 v1, s[4:7], s21 offen offset:1024 sc1 lds
    v_exp_f32 v116, v116
    v_exp_f32 v117, v117
    v_exp_f32 v118, v118
    v_exp_f32_e64 v119, v119
    v_cvt_pk_bf16_f32 v132, v112, v113
    v_cvt_pk_bf16_f32 v133, v114, v115
    v_cvt_pk_bf16_f32 v134, v116, v117
    v_cvt_pk_bf16_f32 v135, v118, v119
    v_mfma_f32_32x32x16_bf16 v[104:119], v[136:139], v[240:243], 0
    ds_read_b128 v[144:147], v16 offset:15360
    ds_read_b64 v[148:149], v18 offset:15360
    v_exp_f32 v88, v88
    v_exp_f32 v89, v89
    v_exp_f32 v90, v90
    v_exp_f32 v91, v91
    v_mfma_f32_32x32x8bf16_1k v[104:119], v[140:141], v[244:245], v[104:119]
    ds_read_b64_tr_b16 v[152:153], v19 offset:18432
    ds_read_b64_tr_b16 v[154:155], v20 offset:18432
    v_exp_f32 v92, v92
    v_exp_f32 v93, v93
    v_exp_f32 v94, v94
    v_exp_f32 v95, v95
    v_mfma_f32_32x32x16_bf16 v[72:87], v[156:159], v[132:135], v[72:87]
    ds_read_b64_tr_b16 v[156:157], v19 offset:18688
    ds_read_b64_tr_b16 v[158:159], v20 offset:18688
    v_cvt_pk_bf16_f32 v120, v88, v89
    v_cvt_pk_bf16_f32 v121, v90, v91
    v_cvt_pk_bf16_f32 v122, v92, v93
    v_cvt_pk_bf16_f32 v123, v94, v95
    v_exp_f32 v96, v96
    v_exp_f32 v97, v97
    v_exp_f32 v98, v98
    v_exp_f32 v99, v99
    v_mfma_f32_32x32x16_bf16 v[56:71], v[160:163], v[120:123], v[56:71]
    s_waitcnt lgkmcnt(2)
    buffer_load_dwordx4 v1, s[4:7], s21 offen offset:2048 sc1 lds
    v_exp_f32 v100, v100
    v_exp_f32 v101, v101
    v_exp_f32 v102, v102
    v_exp_f32_e64 v103, v103
    v_cvt_pk_bf16_f32 v124, v96, v97
    v_cvt_pk_bf16_f32 v125, v98, v99
    v_cvt_pk_bf16_f32 v126, v100, v101
    v_cvt_pk_bf16_f32 v127, v102, v103
    s_waitcnt vmcnt(3)
    s_barrier
    v_rcp_f32_e64 v86, v84
    s_add_u32 s54, s56, 6400
    v_pk_mul_f32 v[72:73], v[72:73], v[86:87] op_sel_hi:[1,0]
    v_pk_mul_f32 v[74:75], v[74:75], v[86:87] op_sel_hi:[1,0]
    v_pk_mul_f32 v[76:77], v[76:77], v[86:87] op_sel_hi:[1,0]
    v_pk_mul_f32 v[78:79], v[78:79], v[86:87] op_sel_hi:[1,0]
    v_pk_mul_f32 v[80:81], v[80:81], v[86:87] op_sel_hi:[1,0]
    v_pk_mul_f32 v[82:83], v[82:83], v[86:87] op_sel_hi:[1,0]
    v_cvt_pk_bf16_f32 v172, v72, v73
    v_cvt_pk_bf16_f32 v173, v74, v75
    v_cvt_pk_bf16_f32 v174, v76, v77
    v_cvt_pk_bf16_f32 v175, v78, v79
    v_cvt_pk_bf16_f32 v176, v80, v81
    v_cvt_pk_bf16_f32 v177, v82, v83
    s_cmp_eq_u32 s43, 0
    s_cbranch_scc1 L_safe_202
    buffer_store_dwordx4 v[172:175], v5, s[4:7], s54 offen offset:0
    buffer_store_dwordx2 v[176:177], v6, s[4:7], s54 offen offset:512
L_join_203:
    v_add_u32 v27, 3766484992, v84
    v_cmp_lt_u32 vcc, 1073741824, v27
    s_nop 0
    s_or_b32 s23, vcc_lo, vcc_hi
    s_mov_b32 s26, s23
    v_mfma_f32_32x32x16_bf16 v[88:103], v[144:147], v[240:243], 0
    ds_read_b128 v[136:139], v16 offset:12288
    ds_read_b64 v[140:141], v18 offset:12288
    v_exp_f32 v104, v104
    v_exp_f32 v105, v105
    v_exp_f32 v106, v106
    v_exp_f32 v107, v107
    v_mfma_f32_32x32x8bf16_1k v[88:103], v[148:149], v[244:245], v[88:103]
    ds_read_b64_tr_b16 v[160:161], v19 offset:15360
    ds_read_b64_tr_b16 v[162:163], v20 offset:15360
    v_exp_f32 v108, v108
    v_exp_f32 v109, v109
    v_exp_f32 v110, v110
    v_exp_f32 v111, v111
    v_mfma_f32_32x32x16_bf16 v[56:71], v[164:167], v[124:127], v[56:71]
    ds_read_b64_tr_b16 v[164:165], v19 offset:15616
    ds_read_b64_tr_b16 v[166:167], v20 offset:15616
    v_cvt_pk_bf16_f32 v128, v104, v105
    v_cvt_pk_bf16_f32 v129, v106, v107
    v_cvt_pk_bf16_f32 v130, v108, v109
    v_cvt_pk_bf16_f32 v131, v110, v111
    v_exp_f32 v112, v112
    v_exp_f32 v113, v113
    v_exp_f32 v114, v114
    v_exp_f32 v115, v115
    v_mfma_f32_32x32x16_bf16 v[56:71], v[152:155], v[128:131], v[56:71]
    s_waitcnt lgkmcnt(2)
    buffer_load_dwordx4 v1, s[4:7], s21 offen offset:3072 sc1 lds
    v_exp_f32 v116, v116
    v_exp_f32 v117, v117
    v_exp_f32 v118, v118
    v_exp_f32_e64 v119, v119
    v_cvt_pk_bf16_f32 v132, v112, v113
    v_cvt_pk_bf16_f32 v133, v114, v115
    v_cvt_pk_bf16_f32 v134, v116, v117
    v_cvt_pk_bf16_f32 v135, v118, v119
    v_mfma_f32_32x32x16_bf16 v[104:119], v[136:139], v[240:243], 0
    ds_read_b128 v[144:147], v16 offset:9216
    ds_read_b64 v[148:149], v18 offset:9216
    v_exp_f32 v88, v88
    v_exp_f32 v89, v89
    v_exp_f32 v90, v90
    v_exp_f32 v91, v91
    v_mfma_f32_32x32x8bf16_1k v[104:119], v[140:141], v[244:245], v[104:119]
    ds_read_b64_tr_b16 v[152:153], v19 offset:12288
    ds_read_b64_tr_b16 v[154:155], v20 offset:12288
    v_exp_f32 v92, v92
    v_exp_f32 v93, v93
    v_exp_f32 v94, v94
    v_exp_f32 v95, v95
    v_mfma_f32_32x32x16_bf16 v[56:71], v[156:159], v[132:135], v[56:71]
    ds_read_b64_tr_b16 v[156:157], v19 offset:12544
    ds_read_b64_tr_b16 v[158:159], v20 offset:12544
    v_cvt_pk_bf16_f32 v120, v88, v89
    v_cvt_pk_bf16_f32 v121, v90, v91
    v_cvt_pk_bf16_f32 v122, v92, v93
    v_cvt_pk_bf16_f32 v123, v94, v95
    v_exp_f32 v96, v96
    v_exp_f32 v97, v97
    v_exp_f32 v98, v98
    v_exp_f32 v99, v99
    v_mfma_f32_32x32x16_bf16 v[56:71], v[160:163], v[120:123], v[56:71]
    s_waitcnt lgkmcnt(2)
    v_exp_f32 v100, v100
    v_exp_f32 v101, v101
    v_exp_f32 v102, v102
    v_exp_f32_e64 v103, v103
    v_cvt_pk_bf16_f32 v124, v96, v97
    v_cvt_pk_bf16_f32 v125, v98, v99
    v_cvt_pk_bf16_f32 v126, v100, v101
    v_cvt_pk_bf16_f32 v127, v102, v103
    s_cmp_lg_u32 s23, 0
    s_cbranch_scc1 L_nohi_204
    s_waitcnt vmcnt(1)
    s_cmp_eq_u32 s43, 0
    s_cbranch_scc1 L_safe_205
    buffer_store_dword v0, v14, s[4:7], s41 offen offset:0
L_join_206:
L_nohi_204:
    v_mfma_f32_32x32x16_bf16 v[88:103], v[144:147], v[240:243], 0
    ds_read_b128 v[136:139], v16 offset:6144
    ds_read_b64 v[140:141], v18 offset:6144
    v_exp_f32 v104, v104
    v_exp_f32 v105, v105
    v_exp_f32 v106, v106
    v_exp_f32_e64 v107, v107
    v_mfma_f32_32x32x8bf16_1k v[88:103], v[148:149], v[244:245], v[88:103]
    ds_read_b64_tr_b16 v[160:161], v19 offset:9216
    ds_read_b64_tr_b16 v[162:163], v20 offset:9216
    v_exp_f32 v108, v108
    v_exp_f32 v109, v109
    v_exp_f32 v110, v110
    v_exp_f32 v111, v111
    v_mfma_f32_32x32x16_bf16 v[56:71], v[164:167], v[124:127], v[56:71]
    ds_read_b64_tr_b16 v[164:165], v19 offset:9472
    ds_read_b64_tr_b16 v[166:167], v20 offset:9472
    v_cvt_pk_bf16_f32 v128, v104, v105
    v_cvt_pk_bf16_f32 v129, v106, v107
    v_cvt_pk_bf16_f32 v130, v108, v109
    v_cvt_pk_bf16_f32 v131, v110, v111
    v_exp_f32 v112, v112
    v_exp_f32 v113, v113
    v_exp_f32 v114, v114
    v_exp_f32 v115, v115
    v_mfma_f32_32x32x16_bf16 v[56:71], v[152:155], v[128:131], v[56:71]
    s_waitcnt lgkmcnt(2)
    v_exp_f32 v116, v116
    v_exp_f32 v117, v117
    v_exp_f32 v118, v118
    v_exp_f32_e64 v119, v119
    v_cvt_pk_bf16_f32 v132, v112, v113
    v_cvt_pk_bf16_f32 v133, v114, v115
    v_cvt_pk_bf16_f32 v134, v116, v117
    v_cvt_pk_bf16_f32 v135, v118, v119
    v_mfma_f32_32x32x16_bf16 v[104:119], v[136:139], v[240:243], v[208:223]
    v_exp_f32 v88, v88
    v_exp_f32 v89, v89
    v_exp_f32 v90, v90
    v_exp_f32 v91, v91
    v_mfma_f32_32x32x8bf16_1k v[104:119], v[140:141], v[244:245], v[104:119]
    ds_read_b64_tr_b16 v[152:153], v19 offset:6144
    ds_read_b64_tr_b16 v[154:155], v20 offset:6144
    v_exp_f32 v92, v92
    v_exp_f32 v93, v93
    v_exp_f32 v94, v94
    v_exp_f32 v95, v95
    v_mfma_f32_32x32x16_bf16 v[56:71], v[156:159], v[132:135], v[56:71]
    ds_read_b64_tr_b16 v[156:157], v19 offset:6400
    ds_read_b64_tr_b16 v[158:159], v20 offset:6400
    v_cvt_pk_bf16_f32 v120, v88, v89
    v_cvt_pk_bf16_f32 v121, v90, v91
    v_cvt_pk_bf16_f32 v122, v92, v93
    v_cvt_pk_bf16_f32 v123, v94, v95
    v_exp_f32 v96, v96
    v_exp_f32 v97, v97
    v_exp_f32 v98, v98
    v_exp_f32 v99, v99
    v_mfma_f32_32x32x16_bf16 v[56:71], v[160:163], v[120:123], v[56:71]
    s_waitcnt lgkmcnt(2)
    v_exp_f32 v100, v100
    v_exp_f32 v101, v101
    v_exp_f32 v102, v102
    v_exp_f32_e64 v103, v103
    v_cvt_pk_bf16_f32 v124, v96, v97
    v_cvt_pk_bf16_f32 v125, v98, v99
    v_cvt_pk_bf16_f32 v126, v100, v101
    v_cvt_pk_bf16_f32 v127, v102, v103
    v_exp_f32 v104, v104
    v_exp_f32 v105, v105
    v_exp_f32 v106, v106
    v_exp_f32 v107, v107
    v_exp_f32 v108, v108
    v_exp_f32 v109, v109
    v_exp_f32 v110, v110
    v_exp_f32 v111, v111
    v_mfma_f32_32x32x16_bf16 v[56:71], v[164:167], v[124:127], v[56:71]
    v_cvt_pk_bf16_f32 v128, v104, v105
    v_cvt_pk_bf16_f32 v129, v106, v107
    v_cvt_pk_bf16_f32 v130, v108, v109
    v_cvt_pk_bf16_f32 v131, v110, v111
    v_exp_f32 v112, v112
    v_exp_f32 v113, v113
    v_exp_f32 v114, v114
    v_exp_f32 v115, v115
    v_mfma_f32_32x32x16_bf16 v[56:71], v[152:155], v[128:131], v[56:71]
    s_waitcnt lgkmcnt(0)
    v_exp_f32 v116, v116
    v_exp_f32 v117, v117
    v_exp_f32 v118, v118
    v_exp_f32_e64 v119, v119
    v_cvt_pk_bf16_f32 v132, v112, v113
    v_cvt_pk_bf16_f32 v133, v114, v115
    v_cvt_pk_bf16_f32 v134, v116, v117
    v_cvt_pk_bf16_f32 v135, v118, v119
    s_nop 1
    v_mfma_f32_32x32x16_bf16 v[56:71], v[156:159], v[132:135], v[56:71]
    s_nop 11
    v_rcp_f32_e64 v70, v68
    s_add_u32 s54, s56, 2560
    v_pk_mul_f32 v[56:57], v[56:57], v[70:71] op_sel_hi:[1,0]
    v_pk_mul_f32 v[58:59], v[58:59], v[70:71] op_sel_hi:[1,0]
    v_pk_mul_f32 v[60:61], v[60:61], v[70:71] op_sel_hi:[1,0]
    v_pk_mul_f32 v[62:63], v[62:63], v[70:71] op_sel_hi:[1,0]
    v_pk_mul_f32 v[64:65], v[64:65], v[70:71] op_sel_hi:[1,0]
    v_pk_mul_f32 v[66:67], v[66:67], v[70:71] op_sel_hi:[1,0]
    v_cvt_pk_bf16_f32 v172, v56, v57
    v_cvt_pk_bf16_f32 v173, v58, v59
    v_cvt_pk_bf16_f32 v174, v60, v61
    v_cvt_pk_bf16_f32 v175, v62, v63
    v_cvt_pk_bf16_f32 v176, v64, v65
    v_cvt_pk_bf16_f32 v177, v66, v67
    s_cmp_eq_u32 s43, 0
    s_cbranch_scc1 L_safe_209
    buffer_store_dwordx4 v[172:175], v5, s[4:7], s54 offen offset:0
    buffer_store_dwordx2 v[176:177], v6, s[4:7], s54 offen offset:512
L_join_210:
    v_add_u32 v27, 3766484992, v68
    v_cmp_lt_u32_e64 vcc, 1073741824, v27
    s_nop 0
    s_or_b32 s23, s23, vcc_lo
    s_or_b32 s23, s23, vcc_hi
    s_cmp_lg_u32 s23, 0
    s_cbranch_scc1 L_fallback_207
L_fbdone_208:
    s_branch L_attdone_159
L_chain6_3_1:
    s_branch L_chain6_3_2
    s_nop 0
L_att3_158:
    ds_read_b128 v[136:139], v16 offset:36864
    ds_read_b64 v[140:141], v18 offset:36864
    ds_read_b64_tr_b16 v[152:153], v19 offset:36864
    ds_read_b64_tr_b16 v[154:155], v20 offset:36864
    ds_read_b64_tr_b16 v[156:157], v19 offset:37120
    ds_read_b64_tr_b16 v[158:159], v20 offset:37120
    v_add_u32 v26, s56, v16
    v_add_u32 v27, s56, v17
    v_add_u32_e64 v28, s56, v18
    v_pk_mul_f32 v[72:73], v[72:73], v[224:225] op_sel:[0,1] op_sel_hi:[1,1]
    v_pk_mul_f32 v[74:75], v[74:75], v[224:225] op_sel:[0,1] op_sel_hi:[1,1]
    v_pk_mul_f32 v[76:77], v[76:77], v[224:225] op_sel:[0,1] op_sel_hi:[1,1]
    v_pk_mul_f32 v[78:79], v[78:79], v[224:225] op_sel:[0,1] op_sel_hi:[1,1]
    v_pk_mul_f32 v[80:81], v[80:81], v[224:225] op_sel:[0,1] op_sel_hi:[1,1]
    v_pk_mul_f32 v[82:83], v[82:83], v[224:225] op_sel:[0,1] op_sel_hi:[1,1]
    v_pk_mul_f32 v[84:85], v[84:85], v[224:225] op_sel:[0,1] op_sel_hi:[1,1]
    v_pk_mul_f32 v[86:87], v[86:87], v[224:225] op_sel:[0,1] op_sel_hi:[1,1]
    v_cvt_pk_bf16_f32 v72, v72, v73
    v_cvt_pk_bf16_f32 v73, v74, v75
    v_cvt_pk_bf16_f32 v74, v76, v77
    v_cvt_pk_bf16_f32 v75, v78, v79
    v_cvt_pk_bf16_f32 v76, v80, v81
    v_cvt_pk_bf16_f32 v77, v82, v83
    v_cvt_pk_bf16_f32 v78, v84, v85
    v_cvt_pk_bf16_f32 v79, v86, v87
    v_cndmask_b32 v78, v78, v31, s[50:51]
    v_cndmask_b32 v79, v79, 0, s[50:51]
    buffer_store_dwordx4 v[72:75], v26, s[4:7], s61 offen offset:0 sc1
    v_pk_mul_f32 v[80:81], v[64:65], v[224:225] op_sel:[0,1] op_sel_hi:[1,1]
    v_pk_mul_f32 v[82:83], v[66:67], v[224:225] op_sel:[0,1] op_sel_hi:[1,1]
    v_pk_mul_f32 v[84:85], v[68:69], v[224:225] op_sel:[0,1] op_sel_hi:[1,1]
    v_pk_mul_f32 v[86:87], v[70:71], v[224:225] op_sel:[0,1] op_sel_hi:[1,1]
    buffer_store_dwordx4 v[76:79], v28, s[4:7], s61 offen offset:0 sc1
    v_cvt_pk_bf16_f32 v80, v80, v81
    v_cvt_pk_bf16_f32 v81, v82, v83
    v_cvt_pk_bf16_f32 v82, v84, v85
    v_cvt_pk_bf16_f32 v83, v86, v87
    ds_write_b128 v26, v[72:75] offset:24576
    buffer_store_dwordx4 v[80:83], v27, s[4:7], s61 offen offset:0 sc1
    v_pk_mul_f32 v[64:65], v[64:65], v[226:227] op_sel:[0,1] op_sel_hi:[1,1]
    v_pk_mul_f32 v[66:67], v[66:67], v[226:227] op_sel:[0,1] op_sel_hi:[1,1]
    ds_write_b128 v28, v[76:79] offset:24576
    v_pk_mul_f32 v[56:57], v[56:57], v[226:227] op_sel:[0,0] op_sel_hi:[1,0]
    v_pk_mul_f32 v[58:59], v[58:59], v[226:227] op_sel:[0,0] op_sel_hi:[1,0]
    v_pk_mul_f32 v[60:61], v[60:61], v[226:227] op_sel:[0,0] op_sel_hi:[1,0]
    v_pk_mul_f32 v[62:63], v[62:63], v[226:227] op_sel:[0,0] op_sel_hi:[1,0]
    ds_write_b128 v27, v[80:83] offset:24576
    s_waitcnt vmcnt(3)
    buffer_store_dword v15, v24, s[4:7], s59 offen offset:0 sc1
    s_waitcnt lgkmcnt(7)
    v_mfma_f32_32x32x16_bf16 v[88:103], v[136:139], v[248:251], v[192:207]
    v_mfma_f32_32x32x8bf16_1k v[88:103], v[140:141], v[252:253], v[88:103]
    s_waitcnt lgkmcnt(0)
    s_barrier
    ds_read_b128 v[144:147], v16 offset:33792
    ds_read_b64 v[148:149], v18 offset:33792
    v_cvt_pk_bf16_f32 v240, v56, v57
    v_cvt_pk_bf16_f32 v241, v58, v59
    v_cvt_pk_bf16_f32 v242, v60, v61
    v_cvt_pk_bf16_f32 v243, v62, v63
    v_cvt_pk_bf16_f32 v244, v64, v65
    v_cvt_pk_bf16_f32 v245, v66, v67
    s_add_u32 s61, s58, -4079616
    v_add_u32 v31, s62, v1
    s_mov_b32 s56, s63
    v_add_u32 v0, 9, v15
    v_exp_f32 v88, v88
    v_exp_f32 v89, v89
    v_exp_f32 v90, v90
    v_exp_f32 v91, v91
    s_waitcnt lgkmcnt(0)
    v_mfma_f32_32x32x16_bf16 v[104:119], v[144:147], v[248:251], 0
    v_exp_f32 v92, v92
    v_exp_f32 v93, v93
    v_exp_f32 v94, v94
    v_exp_f32 v95, v95
    v_mfma_f32_32x32x8bf16_1k v[104:119], v[148:149], v[252:253], v[104:119]
    ds_read_b64_tr_b16 v[160:161], v19 offset:33792
    ds_read_b64_tr_b16 v[162:163], v20 offset:33792
    ds_read_b64_tr_b16 v[164:165], v19 offset:34048
    ds_read_b64_tr_b16 v[166:167], v20 offset:34048
    v_cvt_pk_bf16_f32 v120, v88, v89
    v_cvt_pk_bf16_f32 v121, v90, v91
    v_cvt_pk_bf16_f32 v122, v92, v93
    v_cvt_pk_bf16_f32 v123, v94, v95
    v_exp_f32 v96, v96
    v_exp_f32 v97, v97
    v_exp_f32 v98, v98
    v_exp_f32 v99, v99
    v_mfma_f32_32x32x16_bf16 v[72:87], v[152:155], v[120:123], 0
    s_waitcnt lgkmcnt(2)
    v_exp_f32 v100, v100
    v_exp_f32 v101, v101
    v_exp_f32 v102, v102
    v_exp_f32_e64 v103, v103
    v_cvt_pk_bf16_f32 v124, v96, v97
    v_cvt_pk_bf16_f32 v125, v98, v99
    v_cvt_pk_bf16_f32 v126, v100, v101
    v_cvt_pk_bf16_f32 v127, v102, v103
    s_lshl_b32 s68, s38, 2
    s_add_u32 s68, s68, s36
    s_mul_i32 s68, s68, 2560
    s_mul_i32 s69, s38, 17408
    s_add_u32 s68, s68, s69
    s_add_u32 s68, s68, s45
    s_add_u32 s68, s68, 372736
    v_add_u32 v168, 44, v21
    v_lshrrev_b32 v168, 6, v168
    v_lshl_add_u32 v168, v168, 28, v1
    v_lshlrev_b32_e64 v168, 3, v168
    buffer_load_dword a252, v168, s[4:7], s68 offen offset:0 sc1
    v_mfma_f32_32x32x16_bf16 v[88:103], v[144:147], v[240:243], v[192:207]
    ds_read_b128 v[136:139], v16 offset:30720
    ds_read_b64 v[140:141], v18 offset:30720
    v_exp_f32 v104, v104
    v_exp_f32 v105, v105
    v_exp_f32 v106, v106
    v_exp_f32 v107, v107
    v_mfma_f32_32x32x8bf16_1k v[88:103], v[148:149], v[244:245], v[88:103]
    v_exp_f32 v108, v108
    v_exp_f32 v109, v109
    v_exp_f32 v110, v110
    v_exp_f32 v111, v111
    v_mfma_f32_32x32x16_bf16 v[72:87], v[156:159], v[124:127], v[72:87]
    v_cvt_pk_bf16_f32 v128, v104, v105
    v_cvt_pk_bf16_f32 v129, v106, v107
    v_cvt_pk_bf16_f32 v130, v108, v109
    v_cvt_pk_bf16_f32 v131, v110, v111
    v_exp_f32 v112, v112
    v_exp_f32 v113, v113
    v_exp_f32 v114, v114
    v_exp_f32 v115, v115
    v_mfma_f32_32x32x16_bf16 v[72:87], v[160:163], v[128:131], v[72:87]
    s_waitcnt lgkmcnt(0)
    v_exp_f32 v116, v116
    v_exp_f32 v117, v117
    v_exp_f32 v118, v118
    v_exp_f32_e64 v119, v119
    v_cvt_pk_bf16_f32 v132, v112, v113
    v_cvt_pk_bf16_f32 v133, v114, v115
    v_cvt_pk_bf16_f32 v134, v116, v117
    v_cvt_pk_bf16_f32 v135, v118, v119
    buffer_load_dword v224, v14, s[4:7], s60 offen offset:0 sc1
    s_lshl_b32 s68, s38, 2
    s_add_u32 s68, s68, s36
    s_mul_i32 s68, s68, 2560
    s_mul_i32 s69, s37, 327680
    s_add_u32 s68, s68, s69
    v_add_u32 v169, 44, v21
    v_lshrrev_b32_e64 v169, 6, v169
    v_lshl_add_u32 v169, v169, 28, v1
    v_lshlrev_b32_e64 v169, 3, v169
    buffer_load_dword a252, v169, s[8:11], s68 offen offset:0 sc1
    v_mfma_f32_32x32x16_bf16 v[104:119], v[136:139], v[248:251], 0
    s_add_u32 m0, s22, 1024
    s_add_u32 s21, s21, 65536
    buffer_load_dwordx4 v1, s[4:7], s21 offen offset:0 sc1 lds
    v_exp_f32 v88, v88
    v_exp_f32 v89, v89
    v_exp_f32 v90, v90
    v_exp_f32 v91, v91
    v_mfma_f32_32x32x8bf16_1k v[104:119], v[140:141], v[252:253], v[104:119]
    ds_read_b64_tr_b16 v[152:153], v19 offset:30720
    ds_read_b64_tr_b16 v[154:155], v20 offset:30720
    v_exp_f32 v92, v92
    v_exp_f32 v93, v93
    v_exp_f32 v94, v94
    v_exp_f32 v95, v95
    v_mfma_f32_32x32x16_bf16 v[72:87], v[164:167], v[132:135], v[72:87]
    ds_read_b64_tr_b16 v[156:157], v19 offset:30976
    ds_read_b64_tr_b16 v[158:159], v20 offset:30976
    v_cvt_pk_bf16_f32 v120, v88, v89
    v_cvt_pk_bf16_f32 v121, v90, v91
    v_cvt_pk_bf16_f32 v122, v92, v93
    v_cvt_pk_bf16_f32 v123, v94, v95
    v_exp_f32 v96, v96
    v_exp_f32 v97, v97
    v_exp_f32 v98, v98
    v_exp_f32 v99, v99
    v_mfma_f32_32x32x16_bf16 v[56:71], v[160:163], v[120:123], 0
    s_waitcnt lgkmcnt(2)
    v_exp_f32 v100, v100
    v_exp_f32 v101, v101
    v_exp_f32 v102, v102
    v_exp_f32_e64 v103, v103
    v_cvt_pk_bf16_f32 v124, v96, v97
    v_cvt_pk_bf16_f32 v125, v98, v99
    v_cvt_pk_bf16_f32 v126, v100, v101
    v_cvt_pk_bf16_f32 v127, v102, v103
    s_waitcnt vmcnt(5)
    buffer_store_dword v15, v24, s[4:7], s59 offen offset:128 sc1
    v_mfma_f32_32x32x16_bf16 v[88:103], v[136:139], v[240:243], 0
    ds_read_b128 v[144:147], v16 offset:27648
    ds_read_b64 v[148:149], v18 offset:27648
    v_exp_f32 v104, v104
    v_exp_f32 v105, v105
    v_exp_f32 v106, v106
    v_exp_f32_e64 v107, v107
    v_mfma_f32_32x32x8bf16_1k v[88:103], v[140:141], v[244:245], v[88:103]
    buffer_load_dwordx4 v1, s[4:7], s21 offen offset:1024 sc1 lds
    v_exp_f32 v108, v108
    v_exp_f32 v109, v109
    v_exp_f32 v110, v110
    v_exp_f32 v111, v111
    v_mfma_f32_32x32x16_bf16 v[56:71], v[164:167], v[124:127], v[56:71]
    v_cvt_pk_bf16_f32 v128, v104, v105
    v_cvt_pk_bf16_f32 v129, v106, v107
    v_cvt_pk_bf16_f32 v130, v108, v109
    v_cvt_pk_bf16_f32 v131, v110, v111
    v_exp_f32 v112, v112
    v_exp_f32 v113, v113
    v_exp_f32 v114, v114
    v_exp_f32 v115, v115
    v_mfma_f32_32x32x16_bf16 v[72:87], v[152:155], v[128:131], v[72:87]
    s_waitcnt lgkmcnt(0)
    v_exp_f32 v116, v116
    v_exp_f32 v117, v117
    v_exp_f32 v118, v118
    v_exp_f32_e64 v119, v119
    v_cvt_pk_bf16_f32 v132, v112, v113
    v_cvt_pk_bf16_f32 v133, v114, v115
    v_cvt_pk_bf16_f32 v134, v116, v117
    v_cvt_pk_bf16_f32 v135, v118, v119
    s_cmp_eq_u32 s37, 0
    s_cbranch_scc1 L_halook_211
    s_waitcnt vmcnt(4)
    v_cmp_ne_u32 vcc, v224, v15
    s_nop 0
    s_and_b32 vcc_hi, vcc_lo, 1
    s_cbranch_scc0 L_halook_211
L_poll_213:
    buffer_load_dword v26, v14, s[4:7], s60 offen offset:0 sc1
    s_waitcnt vmcnt(0)
    v_cmp_ne_u32_e64 vcc, v26, v15
    s_nop 0
    s_and_b32 vcc_hi, vcc_lo, 1
    s_cbranch_scc0 L_polled_214
    s_sub_u32 s44, s44, 1
    s_cbranch_scc0 L_poll_213
    s_mov_b32 s44, 0
L_polled_214:
L_halook_211:
    s_mov_b32 m0, 126976
    s_add_u32 s63, s61, 12288
    buffer_load_dwordx4 v31, s[4:7], s63 offen offset:0 sc1 lds
    buffer_load_dwordx4 v31, s[4:7], s63 offen offset:1024 sc1 lds
    buffer_load_dwordx4 v31, s[4:7], s63 offen offset:2048 sc1 lds
    v_mfma_f32_32x32x16_bf16 v[104:119], v[144:147], v[248:251], 0
    s_add_u32 m0, s22, 1024
    s_nop 0
    buffer_load_dwordx4 v1, s[4:7], s21 offen offset:2048 sc1 lds
    v_exp_f32 v88, v88
    v_exp_f32 v89, v89
    v_exp_f32 v90, v90
    v_exp_f32_e64 v91, v91
    v_mfma_f32_32x32x8bf16_1k v[104:119], v[148:149], v[252:253], v[104:119]
    ds_read_b64_tr_b16 v[160:161], v19 offset:27648
    ds_read_b64_tr_b16 v[162:163], v20 offset:27648
    v_exp_f32 v92, v92
    v_exp_f32 v93, v93
    v_exp_f32 v94, v94
    v_exp_f32 v95, v95
    v_mfma_f32_32x32x16_bf16 v[72:87], v[156:159], v[132:135], v[72:87]
    ds_read_b64_tr_b16 v[164:165], v19 offset:27904
    ds_read_b64_tr_b16 v[166:167], v20 offset:27904
    v_cvt_pk_bf16_f32 v120, v88, v89
    v_cvt_pk_bf16_f32 v121, v90, v91
    v_cvt_pk_bf16_f32 v122, v92, v93
    v_cvt_pk_bf16_f32 v123, v94, v95
    v_exp_f32 v96, v96
    v_exp_f32 v97, v97
    v_exp_f32 v98, v98
    v_exp_f32 v99, v99
    v_mfma_f32_32x32x16_bf16 v[56:71], v[152:155], v[120:123], v[56:71]
    s_waitcnt lgkmcnt(2)
    v_exp_f32 v100, v100
    v_exp_f32 v101, v101
    v_exp_f32 v102, v102
    v_exp_f32_e64 v103, v103
    v_cvt_pk_bf16_f32 v124, v96, v97
    v_cvt_pk_bf16_f32 v125, v98, v99
    v_cvt_pk_bf16_f32 v126, v100, v101
    v_cvt_pk_bf16_f32 v127, v102, v103
    v_mfma_f32_32x32x16_bf16 v[88:103], v[144:147], v[240:243], 0
    ds_read_b128 v[136:139], v16 offset:24576
    ds_read_b64 v[140:141], v18 offset:24576
    v_exp_f32 v104, v104
    v_exp_f32 v105, v105
    v_exp_f32 v106, v106
    v_exp_f32 v107, v107
    v_mfma_f32_32x32x8bf16_1k v[88:103], v[148:149], v[244:245], v[88:103]
    s_branch L_over_460
L_chain6_0_2:
    s_branch L_chain6_0_3
L_over_460:
    buffer_load_dwordx4 v1, s[4:7], s21 offen offset:3072 sc1 lds
    v_exp_f32 v108, v108
    v_exp_f32 v109, v109
    v_exp_f32 v110, v110
    v_exp_f32 v111, v111
    v_mfma_f32_32x32x16_bf16 v[56:71], v[156:159], v[124:127], v[56:71]
    v_cvt_pk_bf16_f32 v128, v104, v105
    v_cvt_pk_bf16_f32 v129, v106, v107
    v_cvt_pk_bf16_f32 v130, v108, v109
    v_cvt_pk_bf16_f32 v131, v110, v111
    v_exp_f32 v112, v112
    v_exp_f32 v113, v113
    v_exp_f32 v114, v114
    v_exp_f32 v115, v115
    v_mfma_f32_32x32x16_bf16 v[72:87], v[160:163], v[128:131], v[72:87]
    s_waitcnt lgkmcnt(0)
    v_exp_f32 v116, v116
    v_exp_f32 v117, v117
    v_exp_f32 v118, v118
    v_exp_f32_e64 v119, v119
    v_cvt_pk_bf16_f32 v132, v112, v113
    v_cvt_pk_bf16_f32 v133, v114, v115
    v_cvt_pk_bf16_f32 v134, v116, v117
    v_cvt_pk_bf16_f32 v135, v118, v119
    v_mfma_f32_32x32x16_bf16 v[104:119], v[136:139], v[248:251], 0
    s_add_u32 m0, s22, 17408
    s_add_u32 s21, s21, 16384
    buffer_load_dwordx4 v1, s[4:7], s21 offen offset:0 sc1 lds
    v_exp_f32 v88, v88
    v_exp_f32 v89, v89
    v_exp_f32 v90, v90
    v_exp_f32 v91, v91
    v_mfma_f32_32x32x8bf16_1k v[104:119], v[140:141], v[252:253], v[104:119]
    ds_read_b64_tr_b16 v[152:153], v19 offset:24576
    ds_read_b64_tr_b16 v[154:155], v20 offset:24576
    v_exp_f32 v92, v92
    v_exp_f32 v93, v93
    v_exp_f32 v94, v94
    v_exp_f32 v95, v95
    v_mfma_f32_32x32x16_bf16 v[72:87], v[164:167], v[132:135], v[72:87]
    ds_read_b64_tr_b16 v[156:157], v19 offset:24832
    ds_read_b64_tr_b16 v[158:159], v20 offset:24832
    v_cvt_pk_bf16_f32 v120, v88, v89
    v_cvt_pk_bf16_f32 v121, v90, v91
    v_cvt_pk_bf16_f32 v122, v92, v93
    v_cvt_pk_bf16_f32 v123, v94, v95
    v_exp_f32 v96, v96
    v_exp_f32 v97, v97
    v_exp_f32 v98, v98
    v_exp_f32 v99, v99
    v_mfma_f32_32x32x16_bf16 v[56:71], v[160:163], v[120:123], v[56:71]
    s_waitcnt lgkmcnt(2)
    v_exp_f32 v100, v100
    v_exp_f32 v101, v101
    v_exp_f32 v102, v102
    v_exp_f32_e64 v103, v103
    v_cvt_pk_bf16_f32 v124, v96, v97
    v_cvt_pk_bf16_f32 v125, v98, v99
    v_cvt_pk_bf16_f32 v126, v100, v101
    v_cvt_pk_bf16_f32 v127, v102, v103
    buffer_load_dword v228, v14, s[4:7], s60 offen offset:128 sc1
    v_mfma_f32_32x32x16_bf16 v[88:103], v[136:139], v[240:243], 0
    buffer_load_dwordx4 v1, s[4:7], s21 offen offset:1024 sc1 lds
    v_exp_f32 v104, v104
    v_exp_f32 v105, v105
    v_exp_f32 v106, v106
    v_exp_f32 v107, v107
    v_mfma_f32_32x32x8bf16_1k v[88:103], v[140:141], v[244:245], v[88:103]
    v_exp_f32 v108, v108
    v_exp_f32 v109, v109
    v_exp_f32 v110, v110
    v_exp_f32 v111, v111
    v_mfma_f32_32x32x16_bf16 v[56:71], v[164:167], v[124:127], v[56:71]
    v_cvt_pk_bf16_f32 v128, v104, v105
    v_cvt_pk_bf16_f32 v129, v106, v107
    v_cvt_pk_bf16_f32 v130, v108, v109
    v_cvt_pk_bf16_f32 v131, v110, v111
    v_exp_f32 v112, v112
    v_exp_f32 v113, v113
    v_exp_f32 v114, v114
    v_exp_f32 v115, v115
    v_mfma_f32_32x32x16_bf16 v[72:87], v[152:155], v[128:131], v[72:87]
    s_waitcnt lgkmcnt(0)
    v_exp_f32 v116, v116
    v_exp_f32 v117, v117
    v_exp_f32 v118, v118
    v_exp_f32_e64 v119, v119
    v_cvt_pk_bf16_f32 v132, v112, v113
    v_cvt_pk_bf16_f32 v133, v114, v115
    v_cvt_pk_bf16_f32 v134, v116, v117
    v_cvt_pk_bf16_f32 v135, v118, v119
    s_waitcnt vmcnt(5)
    s_barrier
    ds_read_b128 v[144:147], v16 offset:21504
    ds_read_b64 v[148:149], v18 offset:21504
    s_waitcnt lgkmcnt(0)
    v_mfma_f32_32x32x16_bf16 v[104:119], v[144:147], v[248:251], 0
    ds_read_b128 v[136:139], v16 offset:18432
    ds_read_b64 v[140:141], v18 offset:18432
    v_exp_f32 v88, v88
    v_exp_f32 v89, v89
    v_exp_f32 v90, v90
    v_exp_f32_e64 v91, v91
    v_mfma_f32_32x32x8bf16_1k v[104:119], v[148:149], v[252:253], v[104:119]
    ds_read_b64_tr_b16 v[160:161], v19 offset:21504
    ds_read_b64_tr_b16 v[162:163], v20 offset:21504
    v_exp_f32 v92, v92
    v_exp_f32 v93, v93
    v_exp_f32 v94, v94
    v_exp_f32 v95, v95
    v_mfma_f32_32x32x16_bf16 v[72:87], v[156:159], v[132:135], v[72:87]
    ds_read_b64_tr_b16 v[164:165], v19 offset:21760
    ds_read_b64_tr_b16 v[166:167], v20 offset:21760
    v_cvt_pk_bf16_f32 v120, v88, v89
    v_cvt_pk_bf16_f32 v121, v90, v91
    v_cvt_pk_bf16_f32 v122, v92, v93
    v_cvt_pk_bf16_f32 v123, v94, v95
    v_exp_f32 v96, v96
    v_exp_f32 v97, v97
    v_exp_f32 v98, v98
    v_exp_f32 v99, v99
    v_mfma_f32_32x32x16_bf16 v[56:71], v[152:155], v[120:123], v[56:71]
    s_waitcnt lgkmcnt(2)
    buffer_load_dwordx4 v1, s[4:7], s21 offen offset:2048 sc1 lds
    v_exp_f32 v100, v100
    v_exp_f32 v101, v101
    v_exp_f32 v102, v102
    v_exp_f32_e64 v103, v103
    v_cvt_pk_bf16_f32 v124, v96, v97
    v_cvt_pk_bf16_f32 v125, v98, v99
    v_cvt_pk_bf16_f32 v126, v100, v101
    v_cvt_pk_bf16_f32 v127, v102, v103
    v_mfma_f32_32x32x16_bf16 v[88:103], v[136:139], v[248:251], 0
    ds_read_b128 v[144:147], v16 offset:15360
    ds_read_b64 v[148:149], v18 offset:15360
    v_exp_f32 v104, v104
    v_exp_f32 v105, v105
    v_exp_f32 v106, v106
    v_exp_f32 v107, v107
    v_mfma_f32_32x32x8bf16_1k v[88:103], v[140:141], v[252:253], v[88:103]
    ds_read_b64_tr_b16 v[152:153], v19 offset:18432
    ds_read_b64_tr_b16 v[154:155], v20 offset:18432
    v_exp_f32 v108, v108
    v_exp_f32 v109, v109
    v_exp_f32 v110, v110
    v_exp_f32 v111, v111
    v_mfma_f32_32x32x16_bf16 v[56:71], v[156:159], v[124:127], v[56:71]
    ds_read_b64_tr_b16 v[156:157], v19 offset:18688
    ds_read_b64_tr_b16 v[158:159], v20 offset:18688
    v_cvt_pk_bf16_f32 v128, v104, v105
    v_cvt_pk_bf16_f32 v129, v106, v107
    v_cvt_pk_bf16_f32 v130, v108, v109
    v_cvt_pk_bf16_f32 v131, v110, v111
    v_exp_f32 v112, v112
    v_exp_f32 v113, v113
    v_exp_f32 v114, v114
    v_exp_f32 v115, v115
    v_mfma_f32_32x32x16_bf16 v[72:87], v[160:163], v[128:131], v[72:87]
    s_waitcnt lgkmcnt(2)
    buffer_load_dwordx4 v1, s[4:7], s21 offen offset:3072 sc1 lds
    v_exp_f32 v116, v116
    v_exp_f32 v117, v117
    v_exp_f32 v118, v118
    v_exp_f32_e64 v119, v119
    v_cvt_pk_bf16_f32 v132, v112, v113
    v_cvt_pk_bf16_f32 v133, v114, v115
    v_cvt_pk_bf16_f32 v134, v116, v117
    v_cvt_pk_bf16_f32 v135, v118, v119
    s_cmp_eq_u32 s37, 0
    s_cbranch_scc1 L_halook_215
    s_waitcnt vmcnt(3)
    v_cmp_ne_u32 vcc, v228, v15
    s_nop 0
    s_and_b32 vcc_hi, vcc_lo, 1
    s_cbranch_scc0 L_halook_215
L_poll_217:
    buffer_load_dword v26, v14, s[4:7], s60 offen offset:128 sc1
    s_waitcnt vmcnt(0)
    v_cmp_ne_u32_e64 vcc, v26, v15
    s_nop 0
    s_and_b32 vcc_hi, vcc_lo, 1
    s_cbranch_scc0 L_polled_218
    s_sub_u32 s44, s44, 1
    s_cbranch_scc0 L_poll_217
    s_mov_b32 s44, 0
L_polled_218:
L_halook_215:
    s_mov_b32 m0, 123904
    s_add_u32 s63, s61, 9216
    buffer_load_dwordx4 v31, s[4:7], s63 offen offset:0 sc1 lds
    buffer_load_dwordx4 v31, s[4:7], s63 offen offset:1024 sc1 lds
    buffer_load_dwordx4 v31, s[4:7], s63 offen offset:2048 sc1 lds
    v_mfma_f32_32x32x16_bf16 v[104:119], v[144:147], v[248:251], 0
    ds_read_b128 v[136:139], v16 offset:12288
    ds_read_b64 v[140:141], v18 offset:12288
    v_exp_f32 v88, v88
    v_exp_f32 v89, v89
    v_exp_f32 v90, v90
    v_exp_f32 v91, v91
    v_mfma_f32_32x32x8bf16_1k v[104:119], v[148:149], v[252:253], v[104:119]
    ds_read_b64_tr_b16 v[160:161], v19 offset:15360
    ds_read_b64_tr_b16 v[162:163], v20 offset:15360
    v_exp_f32 v92, v92
    v_exp_f32 v93, v93
    v_exp_f32 v94, v94
    v_exp_f32 v95, v95
    v_mfma_f32_32x32x16_bf16 v[72:87], v[164:167], v[132:135], v[72:87]
    ds_read_b64_tr_b16 v[164:165], v19 offset:15616
    ds_read_b64_tr_b16 v[166:167], v20 offset:15616
    v_cvt_pk_bf16_f32 v120, v88, v89
    v_cvt_pk_bf16_f32 v121, v90, v91
    v_cvt_pk_bf16_f32 v122, v92, v93
    v_cvt_pk_bf16_f32 v123, v94, v95
    v_exp_f32 v96, v96
    v_exp_f32 v97, v97
    v_exp_f32 v98, v98
    v_exp_f32 v99, v99
    v_mfma_f32_32x32x16_bf16 v[72:87], v[152:155], v[120:123], v[72:87]
    s_waitcnt lgkmcnt(2)
    s_add_u32 m0, s22, 33792
    s_add_u32 s21, s21, 16384
    buffer_load_dwordx4 v1, s[4:7], s21 offen offset:0 sc1 lds
    v_exp_f32 v100, v100
    v_exp_f32 v101, v101
    v_exp_f32 v102, v102
    v_exp_f32_e64 v103, v103
    v_cvt_pk_bf16_f32 v124, v96, v97
    v_cvt_pk_bf16_f32 v125, v98, v99
    v_cvt_pk_bf16_f32 v126, v100, v101
    v_cvt_pk_bf16_f32 v127, v102, v103
    v_mfma_f32_32x32x16_bf16 v[88:103], v[136:139], v[248:251], v[208:223]
    ds_read_b128 v[144:147], v16 offset:21504
    ds_read_b64 v[148:149], v18 offset:21504
    v_exp_f32 v104, v104
    v_exp_f32 v105, v105
    v_exp_f32 v106, v106
    v_exp_f32 v107, v107
    v_mfma_f32_32x32x8bf16_1k v[88:103], v[140:141], v[252:253], v[88:103]
    ds_read_b64_tr_b16 v[152:153], v19 offset:12288
    ds_read_b64_tr_b16 v[154:155], v20 offset:12288
    v_exp_f32 v108, v108
    v_exp_f32 v109, v109
    v_exp_f32 v110, v110
    v_exp_f32 v111, v111
    v_mfma_f32_32x32x16_bf16 v[72:87], v[156:159], v[124:127], v[72:87]
    ds_read_b64_tr_b16 v[156:157], v19 offset:12544
    ds_read_b64_tr_b16 v[158:159], v20 offset:12544
    v_cvt_pk_bf16_f32 v128, v104, v105
    v_cvt_pk_bf16_f32 v129, v106, v107
    v_cvt_pk_bf16_f32 v130, v108, v109
    v_cvt_pk_bf16_f32 v131, v110, v111
    v_exp_f32 v112, v112
    v_exp_f32 v113, v113
    v_exp_f32 v114, v114
    v_exp_f32 v115, v115
    v_mfma_f32_32x32x16_bf16 v[72:87], v[160:163], v[128:131], v[72:87]
    s_waitcnt lgkmcnt(2)
    buffer_load_dwordx4 v1, s[4:7], s21 offen offset:1024 sc1 lds
    v_exp_f32 v116, v116
    v_exp_f32 v117, v117
    v_exp_f32 v118, v118
    v_exp_f32_e64 v119, v119
    v_cvt_pk_bf16_f32 v132, v112, v113
    v_cvt_pk_bf16_f32 v133, v114, v115
    v_cvt_pk_bf16_f32 v134, v116, v117
    v_cvt_pk_bf16_f32 v135, v118, v119
    v_mfma_f32_32x32x16_bf16 v[104:119], v[144:147], v[240:243], 0
    ds_read_b128 v[136:139], v16 offset:18432
    ds_read_b64 v[140:141], v18 offset:18432
    v_exp_f32 v88, v88
    v_exp_f32 v89, v89
    v_exp_f32 v90, v90
    v_exp_f32 v91, v91
    v_mfma_f32_32x32x8bf16_1k v[104:119], v[148:149], v[244:245], v[104:119]
    ds_read_b64_tr_b16 v[160:161], v19 offset:21504
    ds_read_b64_tr_b16 v[162:163], v20 offset:21504
    v_exp_f32 v92, v92
    v_exp_f32 v93, v93
    v_exp_f32 v94, v94
    v_exp_f32 v95, v95
    v_mfma_f32_32x32x16_bf16 v[72:87], v[164:167], v[132:135], v[72:87]
    ds_read_b64_tr_b16 v[164:165], v19 offset:21760
    ds_read_b64_tr_b16 v[166:167], v20 offset:21760
    v_cvt_pk_bf16_f32 v120, v88, v89
    v_cvt_pk_bf16_f32 v121, v90, v91
    v_cvt_pk_bf16_f32 v122, v92, v93
    v_cvt_pk_bf16_f32 v123, v94, v95
    v_exp_f32 v96, v96
    v_exp_f32 v97, v97
    v_exp_f32 v98, v98
    v_exp_f32 v99, v99
    v_mfma_f32_32x32x16_bf16 v[72:87], v[152:155], v[120:123], v[72:87]
    s_waitcnt lgkmcnt(2)
    buffer_load_dwordx4 v1, s[4:7], s21 offen offset:2048 sc1 lds
    v_exp_f32 v100, v100
    v_exp_f32 v101, v101
    v_exp_f32 v102, v102
    v_exp_f32_e64 v103, v103
    v_cvt_pk_bf16_f32 v124, v96, v97
    v_cvt_pk_bf16_f32 v125, v98, v99
    v_cvt_pk_bf16_f32 v126, v100, v101
    v_cvt_pk_bf16_f32 v127, v102, v103
    s_waitcnt vmcnt(3)
    s_barrier
    v_mfma_f32_32x32x16_bf16 v[88:103], v[136:139], v[240:243], 0
    ds_read_b128 v[144:147], v16 offset:15360
    ds_read_b64 v[148:149], v18 offset:15360
    v_exp_f32 v104, v104
    v_exp_f32 v105, v105
    v_exp_f32 v106, v106
    v_exp_f32 v107, v107
    v_mfma_f32_32x32x8bf16_1k v[88:103], v[140:141], v[244:245], v[88:103]
    ds_read_b64_tr_b16 v[152:153], v19 offset:18432
    ds_read_b64_tr_b16 v[154:155], v20 offset:18432
    v_exp_f32 v108, v108
    v_exp_f32 v109, v109
    v_exp_f32 v110, v110
    v_exp_f32 v111, v111
    v_mfma_f32_32x32x16_bf16 v[72:87], v[156:159], v[124:127], v[72:87]
    ds_read_b64_tr_b16 v[156:157], v19 offset:18688
    ds_read_b64_tr_b16 v[158:159], v20 offset:18688
    v_cvt_pk_bf16_f32 v128, v104, v105
    v_cvt_pk_bf16_f32 v129, v106, v107
    v_cvt_pk_bf16_f32 v130, v108, v109
    v_cvt_pk_bf16_f32 v131, v110, v111
    v_exp_f32 v112, v112
    v_exp_f32 v113, v113
    v_exp_f32 v114, v114
    v_exp_f32 v115, v115
    v_mfma_f32_32x32x16_bf16 v[56:71], v[160:163], v[128:131], v[56:71]
    s_waitcnt lgkmcnt(2)
    buffer_load_dwordx4 v1, s[4:7], s21 offen offset:3072 sc1 lds
    v_exp_f32 v116, v116
    v_exp_f32 v117, v117
    v_exp_f32 v118, v118
    v_exp_f32_e64 v119, v119
    v_cvt_pk_bf16_f32 v132, v112, v113
    v_cvt_pk_bf16_f32 v133, v114, v115
    v_cvt_pk_bf16_f32 v134, v116, v117
    v_cvt_pk_bf16_f32 v135, v118, v119
    v_rcp_f32_e64 v86, v84
    s_add_u32 s54, s56, 5120
    v_pk_mul_f32 v[72:73], v[72:73], v[86:87] op_sel_hi:[1,0]
    v_pk_mul_f32 v[74:75], v[74:75], v[86:87] op_sel_hi:[1,0]
    v_pk_mul_f32 v[76:77], v[76:77], v[86:87] op_sel_hi:[1,0]
    v_pk_mul_f32 v[78:79], v[78:79], v[86:87] op_sel_hi:[1,0]
    v_pk_mul_f32 v[80:81], v[80:81], v[86:87] op_sel_hi:[1,0]
    v_pk_mul_f32 v[82:83], v[82:83], v[86:87] op_sel_hi:[1,0]
    v_cvt_pk_bf16_f32 v172, v72, v73
    v_cvt_pk_bf16_f32 v173, v74, v75
    v_cvt_pk_bf16_f32 v174, v76, v77
    v_cvt_pk_bf16_f32 v175, v78, v79
    v_cvt_pk_bf16_f32 v176, v80, v81
    v_cvt_pk_bf16_f32 v177, v82, v83
    s_cmp_eq_u32 s43, 0
    s_cbranch_scc1 L_safe_219
    buffer_store_dwordx4 v[172:175], v5, s[4:7], s54 offen offset:0
    buffer_store_dwordx2 v[176:177], v6, s[4:7], s54 offen offset:512
L_join_220:
    v_add_u32 v27, 3766484992, v84
    v_cmp_lt_u32 vcc, 1073741824, v27
    s_nop 0
    s_or_b32 s23, vcc_lo, vcc_hi
    s_mov_b32 s26, s23
    v_mfma_f32_32x32x16_bf16 v[104:119], v[144:147], v[240:243], 0
    ds_read_b128 v[136:139], v16 offset:12288
    ds_read_b64 v[140:141], v18 offset:12288
    v_exp_f32 v88, v88
    v_exp_f32 v89, v89
    v_exp_f32 v90, v90
    v_exp_f32 v91, v91
    v_mfma_f32_32x32x8bf16_1k v[104:119], v[148:149], v[244:245], v[104:119]
    ds_read_b64_tr_b16 v[160:161], v19 offset:15360
    ds_read_b64_tr_b16 v[162:163], v20 offset:15360
    v_exp_f32 v92, v92
    v_exp_f32 v93, v93
    v_exp_f32 v94, v94
    v_exp_f32 v95, v95
    v_mfma_f32_32x32x16_bf16 v[56:71], v[164:167], v[132:135], v[56:71]
    ds_read_b64_tr_b16 v[164:165], v19 offset:15616
    ds_read_b64_tr_b16 v[166:167], v20 offset:15616
    v_cvt_pk_bf16_f32 v120, v88, v89
    v_cvt_pk_bf16_f32 v121, v90, v91
    v_cvt_pk_bf16_f32 v122, v92, v93
    v_cvt_pk_bf16_f32 v123, v94, v95
    v_exp_f32 v96, v96
    v_exp_f32 v97, v97
    v_exp_f32 v98, v98
    v_exp_f32 v99, v99
    v_mfma_f32_32x32x16_bf16 v[56:71], v[152:155], v[120:123], v[56:71]
    s_waitcnt lgkmcnt(2)
    v_exp_f32 v100, v100
    v_exp_f32 v101, v101
    v_exp_f32 v102, v102
    v_exp_f32_e64 v103, v103
    v_cvt_pk_bf16_f32 v124, v96, v97
    v_cvt_pk_bf16_f32 v125, v98, v99
    v_cvt_pk_bf16_f32 v126, v100, v101
    v_cvt_pk_bf16_f32 v127, v102, v103
    v_mfma_f32_32x32x16_bf16 v[88:103], v[136:139], v[240:243], 0
    ds_read_b128 v[144:147], v16 offset:9216
    ds_read_b64 v[148:149], v18 offset:9216
    v_exp_f32 v104, v104
    v_exp_f32 v105, v105
    v_exp_f32 v106, v106
    v_exp_f32 v107, v107
    v_mfma_f32_32x32x8bf16_1k v[88:103], v[140:141], v[244:245], v[88:103]
    ds_read_b64_tr_b16 v[152:153], v19 offset:12288
    ds_read_b64_tr_b16 v[154:155], v20 offset:12288
    v_exp_f32 v108, v108
    v_exp_f32 v109, v109
    v_exp_f32 v110, v110
    v_exp_f32 v111, v111
    v_mfma_f32_32x32x16_bf16 v[56:71], v[156:159], v[124:127], v[56:71]
    ds_read_b64_tr_b16 v[156:157], v19 offset:12544
    ds_read_b64_tr_b16 v[158:159], v20 offset:12544
    v_cvt_pk_bf16_f32 v128, v104, v105
    v_cvt_pk_bf16_f32 v129, v106, v107
    v_cvt_pk_bf16_f32 v130, v108, v109
    v_cvt_pk_bf16_f32 v131, v110, v111
    v_exp_f32 v112, v112
    v_exp_f32 v113, v113
    v_exp_f32 v114, v114
    v_exp_f32 v115, v115
    v_mfma_f32_32x32x16_bf16 v[56:71], v[160:163], v[128:131], v[56:71]
    s_waitcnt lgkmcnt(2)
    v_exp_f32 v116, v116
    v_exp_f32 v117, v117
    v_exp_f32 v118, v118
    v_exp_f32_e64 v119, v119
    v_cvt_pk_bf16_f32 v132, v112, v113
    v_cvt_pk_bf16_f32 v133, v114, v115
    v_cvt_pk_bf16_f32 v134, v116, v117
    v_cvt_pk_bf16_f32 v135, v118, v119
    s_cmp_lg_u32 s23, 0
    s_cbranch_scc1 L_nohi_221
    s_waitcnt vmcnt(0)
    s_cmp_eq_u32 s43, 0
    s_cbranch_scc1 L_safe_222
    buffer_store_dword v0, v14, s[4:7], s41 offen offset:0
L_join_223:
L_nohi_221:
    v_mfma_f32_32x32x16_bf16 v[104:119], v[144:147], v[240:243], v[208:223]
    v_exp_f32 v88, v88
    v_exp_f32 v89, v89
    v_exp_f32 v90, v90
    v_exp_f32_e64 v91, v91
    v_mfma_f32_32x32x8bf16_1k v[104:119], v[148:149], v[244:245], v[104:119]
    ds_read_b64_tr_b16 v[160:161], v19 offset:9216
    ds_read_b64_tr_b16 v[162:163], v20 offset:9216
    v_exp_f32 v92, v92
    v_exp_f32 v93, v93
    v_exp_f32 v94, v94
    v_exp_f32 v95, v95
    v_mfma_f32_32x32x16_bf16 v[56:71], v[164:167], v[132:135], v[56:71]
    ds_read_b64_tr_b16 v[164:165], v19 offset:9472
    ds_read_b64_tr_b16 v[166:167], v20 offset:9472
    v_cvt_pk_bf16_f32 v120, v88, v89
    v_cvt_pk_bf16_f32 v121, v90, v91
    v_cvt_pk_bf16_f32 v122, v92, v93
    v_cvt_pk_bf16_f32 v123, v94, v95
    v_exp_f32 v96, v96
    v_exp_f32 v97, v97
    v_exp_f32 v98, v98
    v_exp_f32 v99, v99
    v_mfma_f32_32x32x16_bf16 v[56:71], v[152:155], v[120:123], v[56:71]
    s_waitcnt lgkmcnt(2)
    v_exp_f32 v100, v100
    v_exp_f32 v101, v101
    v_exp_f32 v102, v102
    v_exp_f32_e64 v103, v103
    v_cvt_pk_bf16_f32 v124, v96, v97
    v_cvt_pk_bf16_f32 v125, v98, v99
    v_cvt_pk_bf16_f32 v126, v100, v101
    v_cvt_pk_bf16_f32 v127, v102, v103
    v_exp_f32 v104, v104
    v_exp_f32 v105, v105
    v_exp_f32 v106, v106
    v_exp_f32 v107, v107
    v_exp_f32 v108, v108
    v_exp_f32 v109, v109
    v_exp_f32 v110, v110
    v_exp_f32 v111, v111
    v_mfma_f32_32x32x16_bf16 v[56:71], v[156:159], v[124:127], v[56:71]
    v_cvt_pk_bf16_f32 v128, v104, v105
    v_cvt_pk_bf16_f32 v129, v106, v107
    v_cvt_pk_bf16_f32 v130, v108, v109
    v_cvt_pk_bf16_f32 v131, v110, v111
    v_exp_f32 v112, v112
    v_exp_f32 v113, v113
    v_exp_f32 v114, v114
    v_exp_f32 v115, v115
    v_mfma_f32_32x32x16_bf16 v[56:71], v[160:163], v[128:131], v[56:71]
    s_waitcnt lgkmcnt(0)
    v_exp_f32 v116, v116
    v_exp_f32 v117, v117
    v_exp_f32 v118, v118
    v_exp_f32_e64 v119, v119
    v_cvt_pk_bf16_f32 v132, v112, v113
    v_cvt_pk_bf16_f32 v133, v114, v115
    v_cvt_pk_bf16_f32 v134, v116, v117
    v_cvt_pk_bf16_f32 v135, v118, v119
    s_nop 1
    v_mfma_f32_32x32x16_bf16 v[56:71], v[164:167], v[132:135], v[56:71]
    s_nop 11
    v_rcp_f32_e64 v70, v68
    s_add_u32 s54, s56, 3840
    v_pk_mul_f32 v[56:57], v[56:57], v[70:71] op_sel_hi:[1,0]
    v_pk_mul_f32 v[58:59], v[58:59], v[70:71] op_sel_hi:[1,0]
    v_pk_mul_f32 v[60:61], v[60:61], v[70:71] op_sel_hi:[1,0]
    v_pk_mul_f32 v[62:63], v[62:63], v[70:71] op_sel_hi:[1,0]
    v_pk_mul_f32 v[64:65], v[64:65], v[70:71] op_sel_hi:[1,0]
    v_pk_mul_f32 v[66:67], v[66:67], v[70:71] op_sel_hi:[1,0]
    v_cvt_pk_bf16_f32 v172, v56, v57
    v_cvt_pk_bf16_f32 v173, v58, v59
    v_cvt_pk_bf16_f32 v174, v60, v61
    v_cvt_pk_bf16_f32 v175, v62, v63
    v_cvt_pk_bf16_f32 v176, v64, v65
    v_cvt_pk_bf16_f32 v177, v66, v67
    s_cmp_eq_u32 s43, 0
    s_cbranch_scc1 L_safe_226
    buffer_store_dwordx4 v[172:175], v5, s[4:7], s54 offen offset:0
    buffer_store_dwordx2 v[176:177], v6, s[4:7], s54 offen offset:512
L_join_227:
    v_add_u32 v27, 3766484992, v68
    v_cmp_lt_u32 vcc, 1073741824, v27
    s_nop 0
    s_or_b32 s23, s23, vcc_lo
    s_or_b32 s23, s23, vcc_hi
    s_cmp_lg_u32 s23, 0
    s_cbranch_scc1 L_fallback_224
L_fbdone_225:
    s_branch L_over_461
L_chain6_1_2:
    s_branch L_chain6_1_3
L_over_461:
L_attdone_159:
    v_add_u32 v0, 10, v15
    s_waitcnt vmcnt(0)
    s_cmp_eq_u32 s43, 0
    s_cbranch_scc1 L_safe_228
    buffer_store_dword v0, v14, s[4:7], s41 offen offset:0
L_join_229:
L_ph7:
L_poll_230:
    buffer_load_dword v26, v13, s[4:7], s17 offen offset:1024 sc1
    s_waitcnt vmcnt(0)
    v_sub_u32 v26, v26, v15
    v_subrev_u32_e64 v26, s16, v26
    v_cmp_lt_u32 vcc, 1, v26
    s_nop 0
    s_and_b32 vcc_hi, vcc_lo, 65535
    s_cbranch_scc0 L_polled_231
    s_sub_u32 s44, s44, 1
    s_cbranch_scc0 L_poll_230
    s_mov_b32 s44, 0
L_polled_231:
    buffer_load_dwordx4 v[56:59], v255, s[4:7], s12 offen offset:0 sc1
    s_add_u32 s12, s12, 55296
    buffer_load_dwordx4 v[60:63], v255, s[4:7], s12 offen offset:0 sc1
    s_add_u32 s12, s12, 55296
    buffer_load_dwordx4 v[64:67], v255, s[4:7], s12 offen offset:0 sc1
    s_add_u32 s12, s12, 55296
    buffer_load_dwordx4 v[68:71], v255, s[4:7], s12 offen offset:0 sc1
    s_sub_u32 s12, s12, 165888
    buffer_load_dwordx2 v[72:73], v7, s[4:7], s12 offen offset:512 sc1
    s_add_u32 s12, s12, 27648
    buffer_load_dwordx2 v[74:75], v7, s[4:7], s12 offen offset:512 sc1
    buffer_load_dwordx4 v[76:79], v255, s[4:7], s13 offen offset:0 sc1
    s_waitcnt vmcnt(6)
    v_mfma_f32_16x16x32_bf16 v[136:139], a[0:3], v[56:59], 0
    s_add_u32 s13, s13, 55296
    buffer_load_dwordx4 v[80:83], v255, s[4:7], s13 offen offset:0 sc1
    v_mfma_f32_16x16x32_bf16 v[140:143], a[20:23], v[56:59], 0
    v_add_u32 v0, 10, v15
    v_add_u32 v236, 1024, v1
    v_add_u32 v237, 50176, v1
    v_mfma_f32_16x16x32_bf16 v[144:147], a[40:43], v[56:59], 0
    v_add_u32 v238, 99328, v1
    v_bfe_u32 v239, v21, 3, 1
    v_mul_u32_u24 v239, 480, v239
    v_mfma_f32_16x16x32_bf16 v[148:151], a[60:63], v[56:59], 0
    v_add_u32_e64 v239, v239, v13
    s_lshl_b32 s61, s39, 2
    s_add_u32 s61, s61, s36
    v_mfma_f32_16x16x32_bf16 v[152:155], a[80:83], v[56:59], 0
    s_waitcnt vmcnt(6)
    v_mfma_f32_16x16x32_bf16 v[136:139], a[4:7], v[60:63], v[136:139]
    s_add_u32 s13, s13, 55296
    buffer_load_dwordx4 v[84:87], v255, s[4:7], s13 offen offset:0 sc1
    v_mfma_f32_16x16x32_bf16 v[140:143], a[24:27], v[60:63], v[140:143]
    s_xor_b32 s60, s61, 4
    s_lshl_b32 s58, s47, 9
    s_add_u32 s58, s58, s45
    v_mfma_f32_16x16x32_bf16 v[144:147], a[44:47], v[60:63], v[144:147]
    s_add_u32 s58, s58, 360448
    s_add_u32 s59, s45, 327680
    s_lshl_b32 s54, s37, 4
    v_mfma_f32_16x16x32_bf16 v[148:151], a[64:67], v[60:63], v[148:151]
    s_add_u32 s54, s54, s60
    s_mul_i32 s54, s54, 20480
    s_lshl_b32 s56, s60, 10
    v_mfma_f32_16x16x32_bf16 v[152:155], a[84:87], v[60:63], v[152:155]
    s_waitcnt vmcnt(6)
    v_mfma_f32_16x16x32_bf16 v[136:139], a[8:11], v[64:67], v[136:139]
    s_add_u32 s13, s13, 55296
    buffer_load_dwordx4 v[88:91], v255, s[4:7], s13 offen offset:0 sc1
    v_mfma_f32_16x16x32_bf16 v[140:143], a[28:31], v[64:67], v[140:143]
    s_add_u32 s56, s56, s59
    s_mul_i32 s62, s60, 55296
    s_add_u32 s62, s62, s58
    v_mfma_f32_16x16x32_bf16 v[144:147], a[48:51], v[64:67], v[144:147]
    s_lshl_b32 s55, s37, 4
    s_add_u32 s55, s55, s61
    s_mul_i32 s55, s55, 20480
    v_mfma_f32_16x16x32_bf16 v[148:151], a[68:71], v[64:67], v[148:151]
    s_lshl_b32 s57, s61, 10
    s_add_u32 s57, s57, s59
    s_mul_i32 s63, s61, 55296
    v_mfma_f32_16x16x32_bf16 v[152:155], a[88:91], v[64:67], v[152:155]
    s_waitcnt vmcnt(6)
    v_mfma_f32_16x16x32_bf16 v[136:139], a[12:15], v[68:71], v[136:139]
    s_sub_u32 s13, s13, 165888
    buffer_load_dwordx2 v[92:93], v7, s[4:7], s13 offen offset:512 sc1
    s_add_u32 s13, s13, 27648
    buffer_load_dwordx2 v[94:95], v7, s[4:7], s13 offen offset:512 sc1
    v_mfma_f32_16x16x32_bf16 v[140:143], a[32:35], v[68:71], v[140:143]
    s_add_u32 s63, s63, s58
    s_and_b32 s59, s49, 4294966656
    s_xor_b32 s65, s59, 0x400
    v_mfma_f32_16x16x32_bf16 v[144:147], a[52:55], v[68:71], v[144:147]
    v_mfma_f32_16x16x32_bf16 v[148:151], a[72:75], v[68:71], v[148:151]
    v_mfma_f32_16x16x32_bf16 v[152:155], a[92:95], v[68:71], v[152:155]
    s_waitcnt vmcnt(6)
    v_mfma_f32_16x16x32_bf16 v[136:139], a[16:19], v[72:75], v[136:139]
    buffer_load_dwordx4 v[96:99], v255, s[4:7], s14 offen offset:0 sc1
    v_mfma_f32_16x16x32_bf16 v[140:143], a[36:39], v[72:75], v[140:143]
    v_mfma_f32_16x16x32_bf16 v[144:147], a[56:59], v[72:75], v[144:147]
    v_mfma_f32_16x16x32_bf16 v[148:151], a[76:79], v[72:75], v[148:151]
    v_mfma_f32_16x16x32_bf16 v[152:155], a[96:99], v[72:75], v[152:155]
    s_waitcnt vmcnt(6)
    v_mfma_f32_16x16x32_bf16 v[156:159], a[0:3], v[76:79], 0
    s_add_u32 s14, s14, 55296
    buffer_load_dwordx4 v[100:103], v255, s[4:7], s14 offen offset:0 sc1
    v_mfma_f32_16x16x32_bf16 v[160:163], a[20:23], v[76:79], 0
    s_barrier
    v_mfma_f32_16x16x32_bf16 v[164:167], a[40:43], v[76:79], 0
    ds_write_b128 v52, v[136:139] offset:0
    v_mfma_f32_16x16x32_bf16 v[168:171], a[60:63], v[76:79], 0
    v_mfma_f32_16x16x32_bf16 v[172:175], a[80:83], v[76:79], 0
    ds_write_b128 v52, v[140:143] offset:1024
    s_waitcnt vmcnt(6)
    v_mfma_f32_16x16x32_bf16 v[156:159], a[4:7], v[80:83], v[156:159]
    s_add_u32 s14, s14, 55296
    buffer_load_dwordx4 v[104:107], v255, s[4:7], s14 offen offset:0 sc1
    v_mfma_f32_16x16x32_bf16 v[160:163], a[24:27], v[80:83], v[160:163]
    v_mfma_f32_16x16x32_bf16 v[164:167], a[44:47], v[80:83], v[164:167]
    ds_write_b128 v52, v[144:147] offset:2048
    v_mfma_f32_16x16x32_bf16 v[168:171], a[64:67], v[80:83], v[168:171]
    v_mfma_f32_16x16x32_bf16 v[172:175], a[84:87], v[80:83], v[172:175]
    ds_write_b128 v52, v[148:151] offset:3072
    s_waitcnt vmcnt(6)
    v_mfma_f32_16x16x32_bf16 v[156:159], a[8:11], v[84:87], v[156:159]
    s_add_u32 s14, s14, 55296
    buffer_load_dwordx4 v[108:111], v255, s[4:7], s14 offen offset:0 sc1
    v_mfma_f32_16x16x32_bf16 v[160:163], a[28:31], v[84:87], v[160:163]
    s_branch L_over_462
L_chain6_2_2:
    s_branch L_chainret6
L_over_462:
    v_mfma_f32_16x16x32_bf16 v[164:167], a[48:51], v[84:87], v[164:167]
    ds_write_b128 v52, v[152:155] offset:4096
    v_mfma_f32_16x16x32_bf16 v[168:171], a[68:71], v[84:87], v[168:171]
    v_mfma_f32_16x16x32_bf16 v[172:175], a[88:91], v[84:87], v[172:175]
    s_waitcnt vmcnt(6)
    v_mfma_f32_16x16x32_bf16 v[156:159], a[12:15], v[88:91], v[156:159]
    s_sub_u32 s14, s14, 165888
    buffer_load_dwordx2 v[112:113], v7, s[4:7], s14 offen offset:512 sc1
    s_add_u32 s14, s14, 27648
    buffer_load_dwordx2 v[114:115], v7, s[4:7], s14 offen offset:512 sc1
    v_mfma_f32_16x16x32_bf16 v[160:163], a[32:35], v[88:91], v[160:163]
    v_mfma_f32_16x16x32_bf16 v[164:167], a[52:55], v[88:91], v[164:167]
    v_mfma_f32_16x16x32_bf16 v[168:171], a[72:75], v[88:91], v[168:171]
    v_mfma_f32_16x16x32_bf16 v[172:175], a[92:95], v[88:91], v[172:175]
    s_waitcnt vmcnt(6)
    v_mfma_f32_16x16x32_bf16 v[156:159], a[16:19], v[92:95], v[156:159]
    buffer_load_dwordx4 v[116:119], v255, s[4:7], s15 offen offset:0 sc1
    v_mfma_f32_16x16x32_bf16 v[160:163], a[36:39], v[92:95], v[160:163]
    v_mfma_f32_16x16x32_bf16 v[164:167], a[56:59], v[92:95], v[164:167]
    v_mfma_f32_16x16x32_bf16 v[168:171], a[76:79], v[92:95], v[168:171]
    v_mfma_f32_16x16x32_bf16 v[172:175], a[96:99], v[92:95], v[172:175]
    s_waitcnt vmcnt(6)
    v_mfma_f32_16x16x32_bf16 v[136:139], a[0:3], v[96:99], 0
    s_add_u32 s15, s15, 55296
    buffer_load_dwordx4 v[120:123], v255, s[4:7], s15 offen offset:0 sc1
    v_mfma_f32_16x16x32_bf16 v[140:143], a[20:23], v[96:99], 0
    v_mfma_f32_16x16x32_bf16 v[144:147], a[40:43], v[96:99], 0
    ds_write_b128 v53, v[156:159] offset:0
    v_mfma_f32_16x16x32_bf16 v[148:151], a[60:63], v[96:99], 0
    v_mfma_f32_16x16x32_bf16 v[152:155], a[80:83], v[96:99], 0
    ds_write_b128 v53, v[160:163] offset:1024
    s_waitcnt vmcnt(6)
    v_mfma_f32_16x16x32_bf16 v[136:139], a[4:7], v[100:103], v[136:139]
    s_add_u32 s15, s15, 55296
    buffer_load_dwordx4 v[124:127], v255, s[4:7], s15 offen offset:0 sc1
    v_mfma_f32_16x16x32_bf16 v[140:143], a[24:27], v[100:103], v[140:143]
    v_mfma_f32_16x16x32_bf16 v[144:147], a[44:47], v[100:103], v[144:147]
    ds_write_b128 v53, v[164:167] offset:2048
    v_mfma_f32_16x16x32_bf16 v[148:151], a[64:67], v[100:103], v[148:151]
    v_mfma_f32_16x16x32_bf16 v[152:155], a[84:87], v[100:103], v[152:155]
    ds_write_b128 v53, v[168:171] offset:3072
    s_waitcnt vmcnt(6)
    v_mfma_f32_16x16x32_bf16 v[136:139], a[8:11], v[104:107], v[136:139]
    s_add_u32 s15, s15, 55296
    buffer_load_dwordx4 v[128:131], v255, s[4:7], s15 offen offset:0 sc1
    v_mfma_f32_16x16x32_bf16 v[140:143], a[28:31], v[104:107], v[140:143]
    v_mfma_f32_16x16x32_bf16 v[144:147], a[48:51], v[104:107], v[144:147]
    ds_write_b128 v53, v[172:175] offset:4096
    v_mfma_f32_16x16x32_bf16 v[148:151], a[68:71], v[104:107], v[148:151]
    v_mfma_f32_16x16x32_bf16 v[152:155], a[88:91], v[104:107], v[152:155]
    s_waitcnt vmcnt(6)
    v_mfma_f32_16x16x32_bf16 v[136:139], a[12:15], v[108:111], v[136:139]
    s_sub_u32 s15, s15, 165888
    buffer_load_dwordx2 v[132:133], v7, s[4:7], s15 offen offset:512 sc1
    s_add_u32 s15, s15, 27648
    buffer_load_dwordx2 v[134:135], v7, s[4:7], s15 offen offset:512 sc1
    v_mfma_f32_16x16x32_bf16 v[140:143], a[32:35], v[108:111], v[140:143]
    s_waitcnt lgkmcnt(0)
    s_barrier
    v_mfma_f32_16x16x32_bf16 v[144:147], a[52:55], v[108:111], v[144:147]
    ds_read_b128 v[176:179], v55 offset:0
    v_mfma_f32_16x16x32_bf16 v[148:151], a[72:75], v[108:111], v[148:151]
    ds_read_b128 v[180:183], v55 offset:1024
    v_mfma_f32_16x16x32_bf16 v[152:155], a[92:95], v[108:111], v[152:155]
    ds_read_b128 v[184:187], v55 offset:2048
    s_waitcnt vmcnt(6)
    v_mfma_f32_16x16x32_bf16 v[136:139], a[16:19], v[112:115], v[136:139]
    ds_read_b128 v[188:191], v55 offset:3072
    v_mfma_f32_16x16x32_bf16 v[140:143], a[36:39], v[112:115], v[140:143]
    ds_read_b128 v[192:195], v55 offset:4096
    v_mfma_f32_16x16x32_bf16 v[144:147], a[56:59], v[112:115], v[144:147]
    ds_read_b128 v[196:199], v55 offset:5120
    v_mfma_f32_16x16x32_bf16 v[148:151], a[76:79], v[112:115], v[148:151]
    ds_read_b128 v[200:203], v55 offset:6144
    v_mfma_f32_16x16x32_bf16 v[152:155], a[96:99], v[112:115], v[152:155]
    ds_read_b128 v[204:207], v55 offset:7168
    s_waitcnt vmcnt(5)
    v_mfma_f32_16x16x32_bf16 v[32:35], a[0:3], v[116:119], v[32:35]
    ds_read_b128 v[208:211], v55 offset:8192
    v_mfma_f32_16x16x32_bf16 v[36:39], a[20:23], v[116:119], v[36:39]
    ds_read_b128 v[212:215], v55 offset:9216
    v_mfma_f32_16x16x32_bf16 v[40:43], a[40:43], v[116:119], v[40:43]
    ds_write_b128 v54, v[136:139] offset:0
    v_mfma_f32_16x16x32_bf16 v[44:47], a[60:63], v[116:119], v[44:47]
    s_waitcnt lgkmcnt(4)
    v_add_f32 v176, v176, v196
    v_add_f32 v177, v177, v197
    v_mfma_f32_16x16x32_bf16 v[48:51], a[80:83], v[116:119], v[48:51]
    ds_write_b128 v54, v[140:143] offset:1024
    s_waitcnt vmcnt(4)
    v_mfma_f32_16x16x32_bf16 v[32:35], a[4:7], v[120:123], v[32:35]
    v_add_f32 v178, v178, v198
    v_add_f32_e64 v179, v179, v199
    v_mfma_f32_16x16x32_bf16 v[36:39], a[24:27], v[120:123], v[36:39]
    s_waitcnt lgkmcnt(4)
    v_add_f32 v180, v180, v200
    v_add_f32_e64 v181, v181, v201
    v_mfma_f32_16x16x32_bf16 v[40:43], a[44:47], v[120:123], v[40:43]
    ds_write_b128 v54, v[144:147] offset:2048
    v_mfma_f32_16x16x32_bf16 v[44:47], a[64:67], v[120:123], v[44:47]
    v_add_f32 v182, v182, v202
    v_add_f32 v183, v183, v203
    v_mfma_f32_16x16x32_bf16 v[48:51], a[84:87], v[120:123], v[48:51]
    ds_write_b128 v54, v[148:151] offset:3072
    s_waitcnt vmcnt(3)
    v_mfma_f32_16x16x32_bf16 v[32:35], a[8:11], v[124:127], v[32:35]
    s_waitcnt lgkmcnt(5)
    v_add_f32 v184, v184, v204
    v_add_f32 v185, v185, v205
    v_mfma_f32_16x16x32_bf16 v[36:39], a[28:31], v[124:127], v[36:39]
    v_add_f32 v186, v186, v206
    v_add_f32 v187, v187, v207
    v_mfma_f32_16x16x32_bf16 v[40:43], a[48:51], v[124:127], v[40:43]
    ds_write_b128 v54, v[152:155] offset:4096
    v_mfma_f32_16x16x32_bf16 v[44:47], a[68:71], v[124:127], v[44:47]
    s_waitcnt lgkmcnt(5)
    v_add_f32 v188, v188, v208
    v_add_f32_e64 v189, v189, v209
    v_mfma_f32_16x16x32_bf16 v[48:51], a[88:91], v[124:127], v[48:51]
    v_add_f32_e64 v190, v190, v210
    v_add_f32 v191, v191, v211
    s_waitcnt vmcnt(2)
    v_mfma_f32_16x16x32_bf16 v[32:35], a[12:15], v[128:131], v[32:35]
    v_add_f32 v192, v192, v212
    v_add_f32 v193, v193, v213
    v_mfma_f32_16x16x32_bf16 v[36:39], a[32:35], v[128:131], v[36:39]
    s_waitcnt lgkmcnt(0)
    s_barrier
    v_mfma_f32_16x16x32_bf16 v[40:43], a[52:55], v[128:131], v[40:43]
    ds_read_b128 v[216:219], v55 offset:10240
    v_mfma_f32_16x16x32_bf16 v[44:47], a[72:75], v[128:131], v[44:47]
    ds_read_b128 v[220:223], v55 offset:11264
    v_mfma_f32_16x16x32_bf16 v[48:51], a[92:95], v[128:131], v[48:51]
    ds_read_b128 v[224:227], v55 offset:12288
    s_waitcnt vmcnt(0)
    v_mfma_f32_16x16x32_bf16 v[32:35], a[16:19], v[132:135], v[32:35]
    ds_read_b128 v[228:231], v55 offset:13312
    v_mfma_f32_16x16x32_bf16 v[36:39], a[36:39], v[132:135], v[36:39]
    ds_read_b128 v[232:235], v55 offset:14336
    v_mfma_f32_16x16x32_bf16 v[40:43], a[56:59], v[132:135], v[40:43]
    v_add_f32 v194, v194, v214
    v_add_f32_e64 v195, v195, v215
    v_mfma_f32_16x16x32_bf16 v[44:47], a[76:79], v[132:135], v[44:47]
    v_mfma_f32_16x16x32_bf16 v[48:51], a[96:99], v[132:135], v[48:51]
    s_waitcnt lgkmcnt(3)
    v_pk_add_f32 v[176:177], v[176:177], v[216:217]
    v_pk_add_f32 v[178:179], v[178:179], v[218:219]
    s_waitcnt lgkmcnt(2)
    v_pk_add_f32 v[180:181], v[180:181], v[220:221]
    v_pk_add_f32 v[182:183], v[182:183], v[222:223]
    s_waitcnt lgkmcnt(1)
    v_pk_add_f32 v[184:185], v[184:185], v[224:225]
    v_pk_add_f32 v[186:187], v[186:187], v[226:227]
    s_waitcnt lgkmcnt(0)
    v_pk_add_f32 v[188:189], v[188:189], v[228:229]
    v_pk_add_f32 v[190:191], v[190:191], v[230:231]
    v_pk_add_f32 v[192:193], v[192:193], v[232:233]
    v_pk_add_f32 v[194:195], v[194:195], v[234:235]
    v_pk_add_f32 v[32:33], v[32:33], v[176:177]
    v_pk_add_f32 v[34:35], v[34:35], v[178:179]
    v_pk_add_f32 v[36:37], v[36:37], v[180:181]
    v_pk_add_f32 v[38:39], v[38:39], v[182:183]
    v_pk_add_f32 v[40:41], v[40:41], v[184:185]
    v_pk_add_f32 v[42:43], v[42:43], v[186:187]
    v_pk_add_f32 v[44:45], v[44:45], v[188:189]
    v_pk_add_f32 v[46:47], v[46:47], v[190:191]
    v_pk_add_f32 v[48:49], v[48:49], v[192:193]
    v_pk_add_f32 v[50:51], v[50:51], v[194:195]
L_ph8:
    s_cmp_eq_u32 s43, 0
    s_cbranch_scc1 L_safe_232
    v_cvt_pk_bf16_f32 v56, v32, v33
    v_cvt_pk_bf16_f32 v58, v36, v37
    v_cvt_pk_bf16_f32 v57, v34, v35
    v_cvt_pk_bf16_f32 v59, v38, v39
    v_permlane16_swap_b32 v56, v58
    v_cvt_pk_bf16_f32 v60, v40, v41
    v_cvt_pk_bf16_f32 v62, v44, v45
    v_cvt_pk_bf16_f32 v61, v42, v43
    v_cvt_pk_bf16_f32 v63, v46, v47
    v_permlane16_swap_b32 v57, v59
    buffer_store_dwordx4 v[56:59], v3, s[8:11], s34 offen offset:0
    v_permlane16_swap_b32 v60, v62
    v_cvt_pk_bf16_f32 v64, v48, v49
    v_cvt_pk_bf16_f32 v66, v48, v49
    v_cvt_pk_bf16_f32 v65, v50, v51
    v_cvt_pk_bf16_f32 v67, v50, v51
    v_permlane16_swap_b32 v61, v63
    buffer_store_dwordx4 v[60:63], v3, s[8:11], s34 offen offset:1024
    v_permlane16_swap_b32 v64, v66
    v_permlane16_swap_b32 v65, v67
    buffer_store_dwordx4 v[64:67], v4, s[8:11], s34 offen offset:2048
    v_pk_add_f32 v[68:69], v[32:33], v[34:35]
    v_pk_mul_f32 v[70:71], v[32:33], v[32:33]
    v_pk_fma_f32 v[70:71], v[34:35], v[34:35], v[70:71]
    v_pk_add_f32 v[68:69], v[68:69], v[36:37]
    v_pk_fma_f32 v[70:71], v[36:37], v[36:37], v[70:71]
    v_pk_add_f32 v[68:69], v[68:69], v[38:39]
    v_pk_fma_f32 v[70:71], v[38:39], v[38:39], v[70:71]
    v_pk_add_f32 v[68:69], v[68:69], v[40:41]
    v_pk_fma_f32 v[70:71], v[40:41], v[40:41], v[70:71]
    v_pk_add_f32 v[68:69], v[68:69], v[42:43]
    v_pk_fma_f32 v[70:71], v[42:43], v[42:43], v[70:71]
    v_pk_add_f32 v[68:69], v[68:69], v[44:45]
    v_pk_fma_f32 v[70:71], v[44:45], v[44:45], v[70:71]
    v_pk_add_f32 v[68:69], v[68:69], v[46:47]
    v_pk_fma_f32 v[70:71], v[46:47], v[46:47], v[70:71]
    v_pk_add_f32 v[68:69], v[68:69], v[48:49]
    v_pk_fma_f32 v[70:71], v[48:49], v[48:49], v[70:71]
    v_pk_add_f32 v[68:69], v[68:69], v[50:51]
    v_pk_fma_f32 v[70:71], v[50:51], v[50:51], v[70:71]
    v_add_f32 v68, v68, v69
    v_add_f32 v69, v70, v71
    s_nop 1
    v_permlane16_swap_b32 v68, v69
    v_add_f32 v68, v68, v69
    v_mov_b32 v69, v68
    s_nop 1
    v_permlane32_swap_b32 v68, v69
    v_add_f32 v68, v68, v69
    v_mov_b32 v69, v68
    s_nop 1
    v_permlane16_swap_b32 v68, v69
    buffer_store_dwordx2 v[68:69], v8, s[4:7], s35 offen offset:0
    ds_read_b128 v[112:115], v236 offset:1024
    ds_read_b128 v[116:119], v236 offset:2048
    ds_read_b128 v[120:123], v236 offset:3072
    ds_read_b128 v[124:127], v236 offset:4096
    ds_read_b128 v[128:131], v236 offset:5120
    ds_read_b128 v[132:135], v236 offset:6144
    ds_read_b128 v[136:139], v236 offset:7168
    s_waitcnt vmcnt(1)
    buffer_store_dword v0, v14, s[4:7], s49 offen offset:0
L_join_233:
L_poll_234:
    buffer_load_dword v26, v239, s[4:7], s59 offen offset:0 sc1
    s_waitcnt vmcnt(0)
    v_sub_u32 v26, v26, v15
    v_subrev_u32 v26, 10, v26
    v_cmp_lt_u32 vcc, 1, v26
    s_nop 0
    s_and_b32 vcc_hi, vcc_lo, 65535
    s_cbranch_scc0 L_polled_235
    s_sub_u32 s44, s44, 1
    s_cbranch_scc0 L_poll_234
    s_mov_b32 s44, 0
L_polled_235:
    s_add_u32 s54, s54, 4096
    buffer_load_dwordx4 v[184:187], v1, s[8:11], s54 offen offset:3072 sc1
    s_add_u32 s55, s55, 4096
    buffer_load_dwordx4 v[188:191], v1, s[8:11], s55 offen offset:3072 sc1
    s_add_u32 s54, s54, 4096
    buffer_load_dwordx4 v[192:195], v1, s[8:11], s54 offen offset:0 sc1
    s_add_u32 s55, s55, 4096
    buffer_load_dwordx4 v[196:199], v1, s[8:11], s55 offen offset:0 sc1
    buffer_load_dwordx4 v[200:203], v1, s[8:11], s54 offen offset:1024 sc1
    buffer_load_dwordx4 v[204:207], v1, s[8:11], s55 offen offset:1024 sc1
    v_add_u32_e64 v0, 1, v0
    s_cmp_eq_u32 s43, 0
    s_cbranch_scc1 L_safe_236
    buffer_store_dword v0, v14, s[4:7], s49 offen offset:0
L_join_237:
    s_waitcnt vmcnt(5) lgkmcnt(0)
    v_mfma_f32_16x16x32_bf16 v[56:59], v[112:115], v[184:187], 0
    ds_read_b128 v[140:143], v236 offset:8192
    v_mfma_f32_16x16x32_bf16 v[84:87], v[112:115], v[188:191], 0
    ds_read_b128 v[144:147], v236 offset:9216
    v_mfma_f32_16x16x32_bf16 v[60:63], v[116:119], v[184:187], 0
    buffer_load_dwordx4 v[208:211], v1, s[8:11], s54 offen offset:2048 sc1
    v_mfma_f32_16x16x32_bf16 v[88:91], v[116:119], v[188:191], 0
    ds_read_b128 v[148:151], v236 offset:10240
    v_mfma_f32_16x16x32_bf16 v[64:67], v[120:123], v[184:187], 0
    ds_read_b128 v[152:155], v236 offset:11264
    v_mfma_f32_16x16x32_bf16 v[92:95], v[120:123], v[188:191], 0
    buffer_load_dwordx4 v[212:215], v1, s[8:11], s55 offen offset:2048 sc1
    v_mfma_f32_16x16x32_bf16 v[68:71], v[124:127], v[184:187], 0
    ds_read_b128 v[156:159], v236 offset:12288
    v_mfma_f32_16x16x32_bf16 v[96:99], v[124:127], v[188:191], 0
    ds_read_b128 v[160:163], v236 offset:13312
    v_mfma_f32_16x16x32_bf16 v[72:75], v[128:131], v[184:187], 0
    buffer_load_dwordx4 v[216:219], v1, s[8:11], s54 offen offset:3072 sc1
    v_mfma_f32_16x16x32_bf16 v[100:103], v[128:131], v[188:191], 0
    ds_read_b128 v[164:167], v236 offset:14336
    v_mfma_f32_16x16x32_bf16 v[76:79], v[132:135], v[184:187], 0
    buffer_load_dwordx4 v[220:223], v1, s[8:11], s55 offen offset:3072 sc1
    v_mfma_f32_16x16x32_bf16 v[104:107], v[132:135], v[188:191], 0
    v_mfma_f32_16x16x32_bf16 v[80:83], v[136:139], v[184:187], 0
    s_add_u32 s54, s54, 4096
    buffer_load_dwordx4 v[184:187], v1, s[8:11], s54 offen offset:0 sc1
    v_mfma_f32_16x16x32_bf16 v[108:111], v[136:139], v[188:191], 0
    s_add_u32 s55, s55, 4096
    buffer_load_dwordx4 v[188:191], v1, s[8:11], s55 offen offset:0 sc1
    s_barrier
    s_waitcnt vmcnt(9) lgkmcnt(0)
    v_mfma_f32_16x16x32_bf16 v[56:59], v[140:143], v[192:195], v[56:59]
    ds_read_b128 v[112:115], v236 offset:15360
    v_mfma_f32_16x16x32_bf16 v[84:87], v[140:143], v[196:199], v[84:87]
    ds_read_b128 v[116:119], v236 offset:16384
    v_mfma_f32_16x16x32_bf16 v[60:63], v[144:147], v[192:195], v[60:63]
    s_add_u32 m0, s22, 99328
    s_sub_u32 s21, s21, 81920
    buffer_load_dwordx4 v1, s[4:7], s21 offen offset:0 sc1 lds
    v_mfma_f32_16x16x32_bf16 v[88:91], v[144:147], v[196:199], v[88:91]
    ds_read_b128 v[120:123], v236 offset:17408
    v_mfma_f32_16x16x32_bf16 v[64:67], v[148:151], v[192:195], v[64:67]
    ds_read_b128 v[124:127], v236 offset:18432
    v_mfma_f32_16x16x32_bf16 v[92:95], v[148:151], v[196:199], v[92:95]
    buffer_load_dwordx4 v1, s[4:7], s21 offen offset:1024 sc1 lds
    v_mfma_f32_16x16x32_bf16 v[68:71], v[152:155], v[192:195], v[68:71]
    ds_read_b128 v[128:131], v236 offset:19456
    v_mfma_f32_16x16x32_bf16 v[96:99], v[152:155], v[196:199], v[96:99]
    ds_read_b128 v[132:135], v236 offset:20480
    v_mfma_f32_16x16x32_bf16 v[72:75], v[156:159], v[192:195], v[72:75]
    v_mfma_f32_16x16x32_bf16 v[100:103], v[156:159], v[196:199], v[100:103]
    ds_read_b128 v[136:139], v236 offset:21504
    v_mfma_f32_16x16x32_bf16 v[76:79], v[160:163], v[192:195], v[76:79]
    v_mfma_f32_16x16x32_bf16 v[104:107], v[160:163], v[196:199], v[104:107]
    v_mfma_f32_16x16x32_bf16 v[80:83], v[164:167], v[192:195], v[80:83]
    buffer_load_dwordx4 v[192:195], v1, s[8:11], s54 offen offset:1024 sc1
    v_mfma_f32_16x16x32_bf16 v[108:111], v[164:167], v[196:199], v[108:111]
    buffer_load_dwordx4 v[196:199], v1, s[8:11], s55 offen offset:1024 sc1
    s_waitcnt vmcnt(11) lgkmcnt(0)
    v_mfma_f32_16x16x32_bf16 v[56:59], v[112:115], v[200:203], v[56:59]
    ds_read_b128 v[140:143], v236 offset:22528
    v_mfma_f32_16x16x32_bf16 v[84:87], v[112:115], v[204:207], v[84:87]
    ds_read_b128 v[144:147], v236 offset:23552
    v_mfma_f32_16x16x32_bf16 v[60:63], v[116:119], v[200:203], v[60:63]
    buffer_load_dword v29, v239, s[4:7], s59 offen offset:0 sc1
    v_mfma_f32_16x16x32_bf16 v[88:91], v[116:119], v[204:207], v[88:91]
    ds_read_b128 v[148:151], v236 offset:24576
    v_mfma_f32_16x16x32_bf16 v[64:67], v[120:123], v[200:203], v[64:67]
    ds_read_b128 v[152:155], v236 offset:25600
    v_mfma_f32_16x16x32_bf16 v[92:95], v[120:123], v[204:207], v[92:95]
    buffer_load_dwordx4 v1, s[4:7], s21 offen offset:2048 sc1 lds
    v_mfma_f32_16x16x32_bf16 v[68:71], v[124:127], v[200:203], v[68:71]
    ds_read_b128 v[156:159], v236 offset:26624
    v_mfma_f32_16x16x32_bf16 v[96:99], v[124:127], v[204:207], v[96:99]
    ds_read_b128 v[160:163], v236 offset:27648
    v_mfma_f32_16x16x32_bf16 v[72:75], v[128:131], v[200:203], v[72:75]
    v_mfma_f32_16x16x32_bf16 v[100:103], v[128:131], v[204:207], v[100:103]
    ds_read_b128 v[164:167], v236 offset:28672
    v_mfma_f32_16x16x32_bf16 v[76:79], v[132:135], v[200:203], v[76:79]
    v_mfma_f32_16x16x32_bf16 v[104:107], v[132:135], v[204:207], v[104:107]
    v_mfma_f32_16x16x32_bf16 v[80:83], v[136:139], v[200:203], v[80:83]
    buffer_load_dwordx4 v[200:203], v1, s[8:11], s54 offen offset:2048 sc1
    v_mfma_f32_16x16x32_bf16 v[108:111], v[136:139], v[204:207], v[108:111]
    buffer_load_dwordx4 v[204:207], v1, s[8:11], s55 offen offset:2048 sc1
    s_waitcnt vmcnt(12) lgkmcnt(0)
    v_mfma_f32_16x16x32_bf16 v[56:59], v[140:143], v[208:211], v[56:59]
    ds_read_b128 v[112:115], v236 offset:29696
    v_mfma_f32_16x16x32_bf16 v[84:87], v[140:143], v[212:215], v[84:87]
    ds_read_b128 v[116:119], v236 offset:30720
    v_mfma_f32_16x16x32_bf16 v[60:63], v[144:147], v[208:211], v[60:63]
    buffer_load_dwordx4 v1, s[4:7], s21 offen offset:3072 sc1 lds
    v_mfma_f32_16x16x32_bf16 v[88:91], v[144:147], v[212:215], v[88:91]
    ds_read_b128 v[120:123], v236 offset:31744
    v_mfma_f32_16x16x32_bf16 v[64:67], v[148:151], v[208:211], v[64:67]
    ds_read_b128 v[124:127], v236 offset:32768
    v_mfma_f32_16x16x32_bf16 v[92:95], v[148:151], v[212:215], v[92:95]
    v_mfma_f32_16x16x32_bf16 v[68:71], v[152:155], v[208:211], v[68:71]
    ds_read_b128 v[128:131], v236 offset:33792
    v_mfma_f32_16x16x32_bf16 v[96:99], v[152:155], v[212:215], v[96:99]
    ds_read_b128 v[132:135], v236 offset:34816
    v_mfma_f32_16x16x32_bf16 v[72:75], v[156:159], v[208:211], v[72:75]
    v_mfma_f32_16x16x32_bf16 v[100:103], v[156:159], v[212:215], v[100:103]
    ds_read_b128 v[136:139], v236 offset:35840
    v_mfma_f32_16x16x32_bf16 v[76:79], v[160:163], v[208:211], v[76:79]
    v_mfma_f32_16x16x32_bf16 v[104:107], v[160:163], v[212:215], v[104:107]
    v_mfma_f32_16x16x32_bf16 v[80:83], v[164:167], v[208:211], v[80:83]
    buffer_load_dwordx4 v[208:211], v1, s[8:11], s54 offen offset:3072 sc1
    v_mfma_f32_16x16x32_bf16 v[108:111], v[164:167], v[212:215], v[108:111]
    buffer_load_dwordx4 v[212:215], v1, s[8:11], s55 offen offset:3072 sc1
    s_waitcnt vmcnt(13) lgkmcnt(0)
    v_mfma_f32_16x16x32_bf16 v[56:59], v[112:115], v[216:219], v[56:59]
    ds_read_b128 v[140:143], v236 offset:36864
    v_mfma_f32_16x16x32_bf16 v[84:87], v[112:115], v[220:223], v[84:87]
    ds_read_b128 v[144:147], v236 offset:37888
    v_mfma_f32_16x16x32_bf16 v[60:63], v[116:119], v[216:219], v[60:63]
    s_add_u32 m0, s22, 115712
    s_add_u32 s21, s21, 16384
    buffer_load_dwordx4 v1, s[4:7], s21 offen offset:0 sc1 lds
    v_mfma_f32_16x16x32_bf16 v[88:91], v[116:119], v[220:223], v[88:91]
    ds_read_b128 v[148:151], v236 offset:38912
    v_mfma_f32_16x16x32_bf16 v[64:67], v[120:123], v[216:219], v[64:67]
    ds_read_b128 v[152:155], v236 offset:39936
    v_mfma_f32_16x16x32_bf16 v[92:95], v[120:123], v[220:223], v[92:95]
    v_mfma_f32_16x16x32_bf16 v[68:71], v[124:127], v[216:219], v[68:71]
    ds_read_b128 v[156:159], v236 offset:40960
    v_mfma_f32_16x16x32_bf16 v[96:99], v[124:127], v[220:223], v[96:99]
    ds_read_b128 v[160:163], v236 offset:41984
    v_mfma_f32_16x16x32_bf16 v[72:75], v[128:131], v[216:219], v[72:75]
    v_mfma_f32_16x16x32_bf16 v[100:103], v[128:131], v[220:223], v[100:103]
    ds_read_b128 v[164:167], v236 offset:43008
    v_mfma_f32_16x16x32_bf16 v[76:79], v[132:135], v[216:219], v[76:79]
    v_mfma_f32_16x16x32_bf16 v[104:107], v[132:135], v[220:223], v[104:107]
    v_mfma_f32_16x16x32_bf16 v[80:83], v[136:139], v[216:219], v[80:83]
    s_add_u32 s54, s54, 4096
    buffer_load_dwordx4 v[216:219], v1, s[8:11], s54 offen offset:0 sc1
    v_mfma_f32_16x16x32_bf16 v[108:111], v[136:139], v[220:223], v[108:111]
    s_add_u32 s55, s55, 4096
    buffer_load_dwordx4 v[220:223], v1, s[8:11], s55 offen offset:0 sc1
    s_waitcnt vmcnt(14) lgkmcnt(0)
    v_mfma_f32_16x16x32_bf16 v[56:59], v[140:143], v[184:187], v[56:59]
    ds_read_b128 v[112:115], v236 offset:44032
    v_mfma_f32_16x16x32_bf16 v[84:87], v[140:143], v[188:191], v[84:87]
    ds_read_b128 v[116:119], v236 offset:45056
    v_mfma_f32_16x16x32_bf16 v[60:63], v[144:147], v[184:187], v[60:63]
    s_waitcnt vmcnt(9)
    v_sub_u32_e64 v29, v29, v15
    v_cmp_ne_u32 vcc, 11, v29
    s_nop 0
    s_and_b32 vcc_hi, vcc_lo, 65535
    s_cbranch_scc0 L_stok_238
L_poll_239:
    buffer_load_dword v29, v239, s[4:7], s59 offen offset:0 sc1
    s_waitcnt vmcnt(0)
    v_sub_u32_e64 v29, v29, v15
    v_cmp_ne_u32 vcc, 11, v29
    s_nop 0
    s_and_b32 vcc_hi, vcc_lo, 65535
    s_cbranch_scc0 L_polled_240
    s_sub_u32 s44, s44, 1
    s_cbranch_scc0 L_poll_239
    s_mov_b32 s44, 0
L_polled_240:
L_stok_238:
    buffer_load_dwordx2 v[176:177], v9, s[4:7], s56 offen offset:0 sc1
    buffer_load_dwordx2 v[178:179], v9, s[4:7], s56 offen offset:512 sc1
    buffer_load_dwordx2 v[180:181], v9, s[4:7], s57 offen offset:0 sc1
    buffer_load_dwordx2 v[182:183], v9, s[4:7], s57 offen offset:512 sc1
    v_add_u32_e64 v0, 12, v15
    v_mfma_f32_16x16x32_bf16 v[88:91], v[144:147], v[188:191], v[88:91]
    ds_read_b128 v[120:123], v236 offset:46080
    v_mfma_f32_16x16x32_bf16 v[64:67], v[148:151], v[184:187], v[64:67]
    ds_read_b128 v[124:127], v236 offset:47104
    v_mfma_f32_16x16x32_bf16 v[92:95], v[148:151], v[188:191], v[92:95]
    buffer_load_dwordx4 v1, s[4:7], s21 offen offset:1024 sc1 lds
    v_mfma_f32_16x16x32_bf16 v[68:71], v[152:155], v[184:187], v[68:71]
    ds_read_b128 v[128:131], v236 offset:48128
    v_mfma_f32_16x16x32_bf16 v[96:99], v[152:155], v[188:191], v[96:99]
    ds_read_b128 v[132:135], v237 offset:0
    v_mfma_f32_16x16x32_bf16 v[72:75], v[156:159], v[184:187], v[72:75]
    v_mfma_f32_16x16x32_bf16 v[100:103], v[156:159], v[188:191], v[100:103]
    ds_read_b128 v[136:139], v237 offset:1024
    v_mfma_f32_16x16x32_bf16 v[76:79], v[160:163], v[184:187], v[76:79]
    v_mfma_f32_16x16x32_bf16 v[104:107], v[160:163], v[188:191], v[104:107]
    v_mfma_f32_16x16x32_bf16 v[80:83], v[164:167], v[184:187], v[80:83]
    buffer_load_dwordx4 v[184:187], v1, s[8:11], s54 offen offset:1024 sc1
    v_mfma_f32_16x16x32_bf16 v[108:111], v[164:167], v[188:191], v[108:111]
    buffer_load_dwordx4 v[188:191], v1, s[8:11], s55 offen offset:1024 sc1
    s_waitcnt lgkmcnt(0)
    v_mfma_f32_16x16x32_bf16 v[56:59], v[112:115], v[192:195], v[56:59]
    ds_read_b128 v[140:143], v237 offset:2048
    v_mfma_f32_16x16x32_bf16 v[84:87], v[112:115], v[196:199], v[84:87]
    ds_read_b128 v[144:147], v237 offset:3072
    v_mfma_f32_16x16x32_bf16 v[60:63], v[116:119], v[192:195], v[60:63]
    buffer_load_dwordx4 v1, s[4:7], s21 offen offset:2048 sc1 lds
    v_mfma_f32_16x16x32_bf16 v[88:91], v[116:119], v[196:199], v[88:91]
    ds_read_b128 v[148:151], v237 offset:4096
    v_mfma_f32_16x16x32_bf16 v[64:67], v[120:123], v[192:195], v[64:67]
    ds_read_b128 v[152:155], v237 offset:5120
    v_mfma_f32_16x16x32_bf16 v[92:95], v[120:123], v[196:199], v[92:95]
    buffer_load_dwordx4 v1, s[4:7], s21 offen offset:3072 sc1 lds
    v_mfma_f32_16x16x32_bf16 v[68:71], v[124:127], v[192:195], v[68:71]
    ds_read_b128 v[156:159], v237 offset:6144
    v_mfma_f32_16x16x32_bf16 v[96:99], v[124:127], v[196:199], v[96:99]
    ds_read_b128 v[160:163], v237 offset:7168
    v_mfma_f32_16x16x32_bf16 v[72:75], v[128:131], v[192:195], v[72:75]
    v_mfma_f32_16x16x32_bf16 v[100:103], v[128:131], v[196:199], v[100:103]
    ds_read_b128 v[164:167], v237 offset:8192
    v_mfma_f32_16x16x32_bf16 v[76:79], v[132:135], v[192:195], v[76:79]
    v_mfma_f32_16x16x32_bf16 v[104:107], v[132:135], v[196:199], v[104:107]
    v_mfma_f32_16x16x32_bf16 v[80:83], v[136:139], v[192:195], v[80:83]
    buffer_load_dwordx4 v[192:195], v1, s[8:11], s54 offen offset:2048 sc1
    v_mfma_f32_16x16x32_bf16 v[108:111], v[136:139], v[196:199], v[108:111]
    buffer_load_dwordx4 v[196:199], v1, s[8:11], s55 offen offset:2048 sc1
    s_waitcnt vmcnt(17) lgkmcnt(0)
    v_mfma_f32_16x16x32_bf16 v[56:59], v[140:143], v[200:203], v[56:59]
    ds_read_b128 v[112:115], v237 offset:9216
    v_mfma_f32_16x16x32_bf16 v[84:87], v[140:143], v[204:207], v[84:87]
    ds_read_b128 v[116:119], v237 offset:10240
    v_mfma_f32_16x16x32_bf16 v[60:63], v[144:147], v[200:203], v[60:63]
    s_add_u32 m0, s22, 132096
    s_add_u32 s21, s21, 16384
    buffer_load_dwordx4 v1, s[4:7], s21 offen offset:0 sc1 lds
    v_mfma_f32_16x16x32_bf16 v[88:91], v[144:147], v[204:207], v[88:91]
    ds_read_b128 v[120:123], v237 offset:11264
    v_mfma_f32_16x16x32_bf16 v[64:67], v[148:151], v[200:203], v[64:67]
    ds_read_b128 v[124:127], v237 offset:12288
    v_mfma_f32_16x16x32_bf16 v[92:95], v[148:151], v[204:207], v[92:95]
    v_mfma_f32_16x16x32_bf16 v[68:71], v[152:155], v[200:203], v[68:71]
    ds_read_b128 v[128:131], v237 offset:13312
    v_mfma_f32_16x16x32_bf16 v[96:99], v[152:155], v[204:207], v[96:99]
    ds_read_b128 v[132:135], v237 offset:14336
    v_mfma_f32_16x16x32_bf16 v[72:75], v[156:159], v[200:203], v[72:75]
    v_mfma_f32_16x16x32_bf16 v[100:103], v[156:159], v[204:207], v[100:103]
    ds_read_b128 v[136:139], v237 offset:15360
    v_mfma_f32_16x16x32_bf16 v[76:79], v[160:163], v[200:203], v[76:79]
    v_mfma_f32_16x16x32_bf16 v[104:107], v[160:163], v[204:207], v[104:107]
    v_mfma_f32_16x16x32_bf16 v[80:83], v[164:167], v[200:203], v[80:83]
    buffer_load_dwordx4 v[200:203], v1, s[8:11], s54 offen offset:3072 sc1
    v_mfma_f32_16x16x32_bf16 v[108:111], v[164:167], v[204:207], v[108:111]
    buffer_load_dwordx4 v[204:207], v1, s[8:11], s55 offen offset:3072 sc1
    s_waitcnt vmcnt(17) lgkmcnt(0)
    v_mfma_f32_16x16x32_bf16 v[56:59], v[112:115], v[208:211], v[56:59]
    ds_read_b128 v[140:143], v237 offset:16384
    s_waitcnt vmcnt(10)
    v_mfma_f32_16x16x32_bf16 v[84:87], v[112:115], v[212:215], v[84:87]
    ds_read_b128 v[144:147], v237 offset:17408
    v_add_f32 v176, v176, v178
    v_add_f32 v177, v177, v179
    v_mfma_f32_16x16x32_bf16 v[60:63], v[116:119], v[208:211], v[60:63]
    buffer_load_dwordx4 v1, s[4:7], s21 offen offset:1024 sc1 lds
    v_mfma_f32_16x16x32_bf16 v[88:91], v[116:119], v[212:215], v[88:91]
    ds_read_b128 v[148:151], v237 offset:18432
    v_permlane16_swap_b32 v176, v177
    v_mfma_f32_16x16x32_bf16 v[64:67], v[120:123], v[208:211], v[64:67]
    ds_read_b128 v[152:155], v237 offset:19456
    v_add_f32 v176, v176, v177
    v_mfma_f32_16x16x32_bf16 v[92:95], v[120:123], v[212:215], v[92:95]
    v_mov_b32_e64 v177, v176
    s_nop 1
    v_permlane32_swap_b32 v176, v177
    v_mfma_f32_16x16x32_bf16 v[68:71], v[124:127], v[208:211], v[68:71]
    ds_read_b128 v[156:159], v237 offset:20480
    v_add_f32_e64 v176, v176, v177
    v_mfma_f32_16x16x32_bf16 v[96:99], v[124:127], v[212:215], v[96:99]
    ds_read_b128 v[160:163], v237 offset:21504
    v_mov_b32_e64 v177, v176
    v_mfma_f32_16x16x32_bf16 v[72:75], v[128:131], v[208:211], v[72:75]
    s_nop 0
    v_permlane16_swap_b32 v176, v177
    v_mul_f32 v168, 0xbacccccd, v176
    v_mfma_f32_16x16x32_bf16 v[100:103], v[128:131], v[212:215], v[100:103]
    ds_read_b128 v[164:167], v237 offset:22528
    v_mul_f32 v177, 0x3acccccd, v177
    v_mfma_f32_16x16x32_bf16 v[76:79], v[132:135], v[208:211], v[76:79]
    v_fma_f32 v177, -v168, v168, v177
    v_max_f32_e64 v177, 0, v177
    v_mfma_f32_16x16x32_bf16 v[104:107], v[132:135], v[212:215], v[104:107]
    v_add_f32 v177, 0x3727c5ac, v177
    v_rsq_f32_e64 v178, v177
    v_mfma_f32_16x16x32_bf16 v[80:83], v[136:139], v[208:211], v[80:83]
    s_sub_u32 s54, s54, 16384
    buffer_load_dwordx4 v[208:211], v1, s[8:11], s54 offen offset:0 sc1
    v_mfma_f32_16x16x32_bf16 v[108:111], v[136:139], v[212:215], v[108:111]
    s_sub_u32 s55, s55, 16384
    buffer_load_dwordx4 v[212:215], v1, s[8:11], s55 offen offset:0 sc1
    s_waitcnt lgkmcnt(0)
    v_mfma_f32_16x16x32_bf16 v[56:59], v[140:143], v[216:219], v[56:59]
    ds_read_b128 v[112:115], v237 offset:23552
    v_mul_f32 v169, 0xbfb8aa3b, v178
    v_mfma_f32_16x16x32_bf16 v[84:87], v[140:143], v[220:223], v[84:87]
    ds_read_b128 v[116:119], v237 offset:24576
    v_mul_f32 v170, v177, v178
    v_mfma_f32_16x16x32_bf16 v[60:63], v[144:147], v[216:219], v[60:63]
    buffer_load_dword v28, v239, s[4:7], s65 offen offset:0 sc1
    v_mfma_f32_16x16x32_bf16 v[88:91], v[144:147], v[220:223], v[88:91]
    ds_read_b128 v[120:123], v237 offset:25600
    v_add_f32 v180, v180, v182
    v_add_f32 v181, v181, v183
    v_mfma_f32_16x16x32_bf16 v[64:67], v[148:151], v[216:219], v[64:67]
    ds_read_b128 v[124:127], v237 offset:26624
    v_permlane16_swap_b32 v180, v181
    v_mfma_f32_16x16x32_bf16 v[92:95], v[148:151], v[220:223], v[92:95]
    buffer_load_dwordx4 v1, s[4:7], s21 offen offset:2048 sc1 lds
    v_mfma_f32_16x16x32_bf16 v[68:71], v[152:155], v[216:219], v[68:71]
    ds_read_b128 v[128:131], v237 offset:27648
    v_add_f32 v180, v180, v181
    v_mfma_f32_16x16x32_bf16 v[96:99], v[152:155], v[220:223], v[96:99]
    ds_read_b128 v[132:135], v237 offset:28672
    v_mov_b32_e64 v181, v180
    v_mfma_f32_16x16x32_bf16 v[72:75], v[156:159], v[216:219], v[72:75]
    s_branch L_over_463
L_chain6_3_2:
    s_branch L_chainret6
L_over_463:
    s_nop 0
    v_permlane32_swap_b32 v180, v181
    v_add_f32_e64 v180, v180, v181
    v_mfma_f32_16x16x32_bf16 v[100:103], v[156:159], v[220:223], v[100:103]
    ds_read_b128 v[136:139], v237 offset:29696
    v_mov_b32_e64 v181, v180
    v_mfma_f32_16x16x32_bf16 v[76:79], v[160:163], v[216:219], v[76:79]
    s_nop 0
    v_permlane16_swap_b32 v180, v181
    v_mul_f32 v172, 0xbacccccd, v180
    v_mfma_f32_16x16x32_bf16 v[104:107], v[160:163], v[220:223], v[104:107]
    v_mul_f32 v181, 0x3acccccd, v181
    v_fma_f32 v181, -v172, v172, v181
    v_mfma_f32_16x16x32_bf16 v[80:83], v[164:167], v[216:219], v[80:83]
    buffer_load_dwordx4 v[216:219], v1, s[8:11], s54 offen offset:1024 sc1
    v_mfma_f32_16x16x32_bf16 v[108:111], v[164:167], v[220:223], v[108:111]
    buffer_load_dwordx4 v[220:223], v1, s[8:11], s55 offen offset:1024 sc1
    s_waitcnt vmcnt(14) lgkmcnt(0)
    v_mfma_f32_16x16x32_bf16 v[56:59], v[112:115], v[184:187], v[56:59]
    ds_read_b128 v[140:143], v237 offset:30720
    v_max_f32 v181, 0, v181
    v_mfma_f32_16x16x32_bf16 v[84:87], v[112:115], v[188:191], v[84:87]
    ds_read_b128 v[144:147], v237 offset:31744
    v_add_f32 v181, 0x3727c5ac, v181
    v_mfma_f32_16x16x32_bf16 v[60:63], v[116:119], v[184:187], v[60:63]
    buffer_load_dwordx4 v1, s[4:7], s21 offen offset:3072 sc1 lds
    v_mfma_f32_16x16x32_bf16 v[88:91], v[116:119], v[188:191], v[88:91]
    ds_read_b128 v[148:151], v237 offset:32768
    v_rsq_f32_e64 v182, v181
    v_mfma_f32_16x16x32_bf16 v[64:67], v[120:123], v[184:187], v[64:67]
    ds_read_b128 v[152:155], v237 offset:33792
    v_mul_f32 v173, 0xbfb8aa3b, v182
    v_mfma_f32_16x16x32_bf16 v[92:95], v[120:123], v[188:191], v[92:95]
    v_mul_f32_e64 v174, v181, v182
    v_mfma_f32_16x16x32_bf16 v[68:71], v[124:127], v[184:187], v[68:71]
    ds_read_b128 v[156:159], v237 offset:34816
    v_mfma_f32_16x16x32_bf16 v[96:99], v[124:127], v[188:191], v[96:99]
    ds_read_b128 v[160:163], v237 offset:35840
    v_mfma_f32_16x16x32_bf16 v[72:75], v[128:131], v[184:187], v[72:75]
    v_mfma_f32_16x16x32_bf16 v[100:103], v[128:131], v[188:191], v[100:103]
    ds_read_b128 v[164:167], v237 offset:36864
    v_mfma_f32_16x16x32_bf16 v[76:79], v[132:135], v[184:187], v[76:79]
    v_mfma_f32_16x16x32_bf16 v[104:107], v[132:135], v[188:191], v[104:107]
    v_mfma_f32_16x16x32_bf16 v[80:83], v[136:139], v[184:187], v[80:83]
    buffer_load_dwordx4 v[184:187], v1, s[8:11], s54 offen offset:2048 sc1
    v_mfma_f32_16x16x32_bf16 v[108:111], v[136:139], v[188:191], v[108:111]
    buffer_load_dwordx4 v[188:191], v1, s[8:11], s55 offen offset:2048 sc1
    s_waitcnt vmcnt(13) lgkmcnt(0)
    v_mfma_f32_16x16x32_bf16 v[56:59], v[140:143], v[192:195], v[56:59]
    ds_read_b128 v[112:115], v237 offset:37888
    v_mfma_f32_16x16x32_bf16 v[84:87], v[140:143], v[196:199], v[84:87]
    ds_read_b128 v[116:119], v237 offset:38912
    v_mfma_f32_16x16x32_bf16 v[60:63], v[144:147], v[192:195], v[60:63]
    v_mfma_f32_16x16x32_bf16 v[88:91], v[144:147], v[196:199], v[88:91]
    ds_read_b128 v[120:123], v237 offset:39936
    v_mfma_f32_16x16x32_bf16 v[64:67], v[148:151], v[192:195], v[64:67]
    ds_read_b128 v[124:127], v237 offset:40960
    v_mfma_f32_16x16x32_bf16 v[92:95], v[148:151], v[196:199], v[92:95]
    v_mfma_f32_16x16x32_bf16 v[68:71], v[152:155], v[192:195], v[68:71]
    ds_read_b128 v[128:131], v237 offset:41984
    v_mfma_f32_16x16x32_bf16 v[96:99], v[152:155], v[196:199], v[96:99]
    ds_read_b128 v[132:135], v237 offset:43008
    v_mfma_f32_16x16x32_bf16 v[72:75], v[156:159], v[192:195], v[72:75]
    ds_read_b128 v[240:243], v22 offset:256
    v_mfma_f32_16x16x32_bf16 v[100:103], v[156:159], v[196:199], v[100:103]
    ds_read_b128 v[136:139], v237 offset:44032
    v_mfma_f32_16x16x32_bf16 v[76:79], v[160:163], v[192:195], v[76:79]
    v_mfma_f32_16x16x32_bf16 v[104:107], v[160:163], v[196:199], v[104:107]
    v_mfma_f32_16x16x32_bf16 v[80:83], v[164:167], v[192:195], v[80:83]
    buffer_load_dwordx4 v[192:195], v1, s[8:11], s54 offen offset:3072 sc1
    v_mfma_f32_16x16x32_bf16 v[108:111], v[164:167], v[196:199], v[108:111]
    buffer_load_dwordx4 v[196:199], v1, s[8:11], s55 offen offset:3072 sc1
    s_barrier
    s_waitcnt vmcnt(12) lgkmcnt(0)
    v_mfma_f32_16x16x32_bf16 v[56:59], v[112:115], v[200:203], v[56:59]
    ds_read_b128 v[140:143], v238 offset:0
    v_mfma_f32_16x16x32_bf16 v[84:87], v[112:115], v[204:207], v[84:87]
    ds_read_b128 v[144:147], v238 offset:1024
    v_mfma_f32_16x16x32_bf16 v[60:63], v[116:119], v[200:203], v[60:63]
    v_mfma_f32_16x16x32_bf16 v[88:91], v[116:119], v[204:207], v[88:91]
    ds_read_b128 v[148:151], v238 offset:2048
    v_mfma_f32_16x16x32_bf16 v[64:67], v[120:123], v[200:203], v[64:67]
    ds_read_b128 v[152:155], v238 offset:3072
    v_mfma_f32_16x16x32_bf16 v[92:95], v[120:123], v[204:207], v[92:95]
    v_fmac_f32 v56, v240, v168
    v_mfma_f32_16x16x32_bf16 v[68:71], v[124:127], v[200:203], v[68:71]
    ds_read_b128 v[156:159], v238 offset:4096
    v_fmac_f32_e64 v57, v241, v168
    v_mfma_f32_16x16x32_bf16 v[96:99], v[124:127], v[204:207], v[96:99]
    ds_read_b128 v[160:163], v238 offset:5120
    v_fmac_f32_e64 v58, v242, v168
    v_mfma_f32_16x16x32_bf16 v[72:75], v[128:131], v[200:203], v[72:75]
    v_fmac_f32_e64 v59, v243, v168
    ds_read_b128 v[244:247], v22 offset:320
    v_mfma_f32_16x16x32_bf16 v[100:103], v[128:131], v[204:207], v[100:103]
    ds_read_b128 v[164:167], v238 offset:6144
    v_fmac_f32_e64 v84, v240, v172
    v_mfma_f32_16x16x32_bf16 v[76:79], v[132:135], v[200:203], v[76:79]
    v_fmac_f32_e64 v85, v241, v172
    v_mfma_f32_16x16x32_bf16 v[104:107], v[132:135], v[204:207], v[104:107]
    v_fmac_f32_e64 v86, v242, v172
    v_mfma_f32_16x16x32_bf16 v[80:83], v[136:139], v[200:203], v[80:83]
    s_add_u32 s54, s54, 4096
    buffer_load_dwordx4 v[200:203], v1, s[8:11], s54 offen offset:0 sc1
    v_fmac_f32_e64 v87, v243, v172
    v_mfma_f32_16x16x32_bf16 v[108:111], v[136:139], v[204:207], v[108:111]
    s_add_u32 s55, s55, 4096
    buffer_load_dwordx4 v[204:207], v1, s[8:11], s55 offen offset:0 sc1
    s_waitcnt vmcnt(11) lgkmcnt(0)
    v_mfma_f32_16x16x32_bf16 v[56:59], v[140:143], v[208:211], v[56:59]
    ds_read_b128 v[112:115], v238 offset:7168
    v_mfma_f32_16x16x32_bf16 v[84:87], v[140:143], v[212:215], v[84:87]
    ds_read_b128 v[116:119], v238 offset:8192
    v_mfma_f32_16x16x32_bf16 v[60:63], v[144:147], v[208:211], v[60:63]
    v_mfma_f32_16x16x32_bf16 v[88:91], v[144:147], v[212:215], v[88:91]
    ds_read_b128 v[120:123], v238 offset:9216
    v_mfma_f32_16x16x32_bf16 v[64:67], v[148:151], v[208:211], v[64:67]
    ds_read_b128 v[124:127], v238 offset:10240
    v_mfma_f32_16x16x32_bf16 v[92:95], v[148:151], v[212:215], v[92:95]
    v_mfma_f32_16x16x32_bf16 v[68:71], v[152:155], v[208:211], v[68:71]
    ds_read_b128 v[128:131], v238 offset:11264
    v_mfma_f32_16x16x32_bf16 v[96:99], v[152:155], v[212:215], v[96:99]
    ds_read_b128 v[132:135], v238 offset:12288
    v_fmac_f32 v60, v244, v168
    v_mfma_f32_16x16x32_bf16 v[72:75], v[156:159], v[208:211], v[72:75]
    v_fmac_f32_e64 v61, v245, v168
    ds_read_b128 v[240:243], v22 offset:384
    v_mfma_f32_16x16x32_bf16 v[100:103], v[156:159], v[212:215], v[100:103]
    ds_read_b128 v[136:139], v238 offset:13312
    v_fmac_f32_e64 v62, v246, v168
    v_mfma_f32_16x16x32_bf16 v[76:79], v[160:163], v[208:211], v[76:79]
    v_fmac_f32_e64 v63, v247, v168
    v_mfma_f32_16x16x32_bf16 v[104:107], v[160:163], v[212:215], v[104:107]
    v_fmac_f32_e64 v88, v244, v172
    v_mfma_f32_16x16x32_bf16 v[80:83], v[164:167], v[208:211], v[80:83]
    buffer_load_dwordx4 v[208:211], v1, s[8:11], s54 offen offset:1024 sc1
    v_fmac_f32_e64 v89, v245, v172
    v_mfma_f32_16x16x32_bf16 v[108:111], v[164:167], v[212:215], v[108:111]
    buffer_load_dwordx4 v[212:215], v1, s[8:11], s55 offen offset:1024 sc1
    v_fmac_f32_e64 v90, v246, v172
    s_barrier
    s_waitcnt vmcnt(9) lgkmcnt(0)
    v_mfma_f32_16x16x32_bf16 v[56:59], v[112:115], v[216:219], v[56:59]
    ds_read_b128 v[140:143], v238 offset:14336
    v_fmac_f32_e64 v91, v247, v172
    v_mfma_f32_16x16x32_bf16 v[84:87], v[112:115], v[220:223], v[84:87]
    ds_read_b128 v[144:147], v238 offset:15360
    v_mfma_f32_16x16x32_bf16 v[60:63], v[116:119], v[216:219], v[60:63]
    v_sub_u32 v28, v28, v15
    v_subrev_u32 v28, 10, v28
    v_cmp_lt_u32 vcc, 6, v28
    s_nop 0
    s_and_b32 vcc_hi, vcc_lo, 65535
    s_cbranch_scc0 L_stok_241
L_poll_242:
    buffer_load_dword v28, v239, s[4:7], s65 offen offset:0 sc1
    s_waitcnt vmcnt(0)
    v_sub_u32 v28, v28, v15
    v_subrev_u32 v28, 10, v28
    v_cmp_lt_u32 vcc, 6, v28
    s_nop 0
    s_and_b32 vcc_hi, vcc_lo, 65535
    s_cbranch_scc0 L_polled_243
    s_sub_u32 s44, s44, 1
    s_cbranch_scc0 L_poll_242
    s_mov_b32 s44, 0
L_polled_243:
L_stok_241:
    v_mfma_f32_16x16x32_bf16 v[88:91], v[116:119], v[220:223], v[88:91]
    ds_read_b128 v[148:151], v238 offset:16384
    v_mfma_f32_16x16x32_bf16 v[64:67], v[120:123], v[216:219], v[64:67]
    ds_read_b128 v[152:155], v238 offset:17408
    v_mfma_f32_16x16x32_bf16 v[92:95], v[120:123], v[220:223], v[92:95]
    v_mfma_f32_16x16x32_bf16 v[68:71], v[124:127], v[216:219], v[68:71]
    ds_read_b128 v[156:159], v238 offset:18432
    v_mfma_f32_16x16x32_bf16 v[96:99], v[124:127], v[220:223], v[96:99]
    ds_read_b128 v[160:163], v238 offset:19456
    v_mfma_f32_16x16x32_bf16 v[72:75], v[128:131], v[216:219], v[72:75]
    ds_read_b128 v[244:247], v22 offset:448
    v_mfma_f32_16x16x32_bf16 v[100:103], v[128:131], v[220:223], v[100:103]
    ds_read_b128 v[164:167], v238 offset:20480
    v_fmac_f32_e64 v64, v240, v168
    v_mfma_f32_16x16x32_bf16 v[76:79], v[132:135], v[216:219], v[76:79]
    v_fmac_f32_e64 v65, v241, v168
    v_mfma_f32_16x16x32_bf16 v[104:107], v[132:135], v[220:223], v[104:107]
    v_fmac_f32_e64 v66, v242, v168
    v_mfma_f32_16x16x32_bf16 v[80:83], v[136:139], v[216:219], v[80:83]
    buffer_load_dwordx4 v[216:219], v1, s[8:11], s54 offen offset:2048 sc1
    v_fmac_f32_e64 v67, v243, v168
    v_mfma_f32_16x16x32_bf16 v[108:111], v[136:139], v[220:223], v[108:111]
    buffer_load_dwordx4 v[220:223], v1, s[8:11], s55 offen offset:2048 sc1
    v_fmac_f32 v92, v240, v172
    s_waitcnt vmcnt(8) lgkmcnt(0)
    v_mfma_f32_16x16x32_bf16 v[56:59], v[140:143], v[184:187], v[56:59]
    ds_read_b128 v[112:115], v238 offset:21504
    v_fmac_f32_e64 v93, v241, v172
    v_mfma_f32_16x16x32_bf16 v[84:87], v[140:143], v[188:191], v[84:87]
    ds_read_b128 v[116:119], v238 offset:22528
    v_fmac_f32_e64 v94, v242, v172
    v_mfma_f32_16x16x32_bf16 v[60:63], v[144:147], v[184:187], v[60:63]
    s_mul_i32 s66, s52, 27
    s_mul_i32 s65, s36, 7
    v_fmac_f32_e64 v95, v243, v172
    v_mfma_f32_16x16x32_bf16 v[88:91], v[144:147], v[188:191], v[88:91]
    ds_read_b128 v[120:123], v238 offset:23552
    v_mfma_f32_16x16x32_bf16 v[64:67], v[148:151], v[184:187], v[64:67]
    ds_read_b128 v[124:127], v238 offset:24576
    v_mfma_f32_16x16x32_bf16 v[92:95], v[148:151], v[188:191], v[92:95]
    s_add_u32 s66, s66, s65
    s_lshl_b32 s66, s66, 10
    v_mfma_f32_16x16x32_bf16 v[68:71], v[152:155], v[184:187], v[68:71]
    ds_read_b128 v[128:131], v238 offset:25600
    v_mfma_f32_16x16x32_bf16 v[96:99], v[152:155], v[188:191], v[96:99]
    ds_read_b128 v[132:135], v238 offset:26624
    v_mfma_f32_16x16x32_bf16 v[72:75], v[156:159], v[184:187], v[72:75]
    s_add_u32 s66, s66, s45
    s_add_u32 s66, s66, 360448
    ds_read_b128 v[240:243], v22 offset:512
    v_mfma_f32_16x16x32_bf16 v[100:103], v[156:159], v[188:191], v[100:103]
    ds_read_b128 v[136:139], v238 offset:27648
    v_mfma_f32_16x16x32_bf16 v[76:79], v[160:163], v[184:187], v[76:79]
    s_xor_b32 s65, s39, 1
    s_lshl_b32 s65, s65, 2
    v_mfma_f32_16x16x32_bf16 v[104:107], v[160:163], v[188:191], v[104:107]
    s_add_u32 s58, s36, 1
    s_and_b32 s58, s58, 3
    v_fmac_f32 v68, v244, v168
    v_mfma_f32_16x16x32_bf16 v[80:83], v[164:167], v[184:187], v[80:83]
    s_add_u32 s58, s58, s65
    s_mul_i32 s58, s58, 55296
    v_fmac_f32 v69, v245, v168
    v_mfma_f32_16x16x32_bf16 v[108:111], v[164:167], v[188:191], v[108:111]
    s_add_u32 s58, s58, s66
    s_add_u32 s59, s36, 2
    v_fmac_f32_e64 v70, v246, v168
    s_barrier
    s_waitcnt vmcnt(6) lgkmcnt(0)
    v_mfma_f32_16x16x32_bf16 v[56:59], v[112:115], v[192:195], v[56:59]
    ds_read_b128 v[140:143], v238 offset:28672
    v_fmac_f32_e64 v71, v247, v168
    v_mfma_f32_16x16x32_bf16 v[84:87], v[112:115], v[196:199], v[84:87]
    ds_read_b128 v[144:147], v238 offset:29696
    v_fmac_f32_e64 v96, v244, v172
    v_mfma_f32_16x16x32_bf16 v[60:63], v[116:119], v[192:195], v[60:63]
    s_and_b32 s59, s59, 3
    s_add_u32 s59, s59, s65
    v_fmac_f32_e64 v97, v245, v172
    v_mfma_f32_16x16x32_bf16 v[88:91], v[116:119], v[196:199], v[88:91]
    ds_read_b128 v[148:151], v238 offset:30720
    v_fmac_f32_e64 v98, v246, v172
    v_mfma_f32_16x16x32_bf16 v[64:67], v[120:123], v[192:195], v[64:67]
    ds_read_b128 v[152:155], v238 offset:31744
    v_fmac_f32_e64 v99, v247, v172
    v_mfma_f32_16x16x32_bf16 v[92:95], v[120:123], v[196:199], v[92:95]
    s_mul_i32 s59, s59, 55296
    s_add_u32 s59, s59, s66
    v_mfma_f32_16x16x32_bf16 v[68:71], v[124:127], v[192:195], v[68:71]
    ds_read_b128 v[156:159], v238 offset:32768
    v_mfma_f32_16x16x32_bf16 v[96:99], v[124:127], v[196:199], v[96:99]
    ds_read_b128 v[160:163], v238 offset:33792
    v_mfma_f32_16x16x32_bf16 v[72:75], v[128:131], v[192:195], v[72:75]
    s_add_u32 s60, s36, 3
    s_and_b32 s60, s60, 3
    ds_read_b128 v[244:247], v22 offset:576
    v_mfma_f32_16x16x32_bf16 v[100:103], v[128:131], v[196:199], v[100:103]
    ds_read_b128 v[164:167], v238 offset:34816
    v_mfma_f32_16x16x32_bf16 v[76:79], v[132:135], v[192:195], v[76:79]
    s_add_u32 s60, s60, s65
    s_mul_i32 s60, s60, 55296
    v_mfma_f32_16x16x32_bf16 v[104:107], v[132:135], v[196:199], v[104:107]
    s_add_u32 s60, s60, s66
    s_add_u32 s61, s36, 4
    v_mfma_f32_16x16x32_bf16 v[80:83], v[136:139], v[192:195], v[80:83]
    s_and_b32 s61, s61, 3
    s_add_u32 s61, s61, s65
    v_mfma_f32_16x16x32_bf16 v[108:111], v[136:139], v[196:199], v[108:111]
    s_mul_i32 s61, s61, 55296
    s_add_u32 s61, s61, s66
    v_fmac_f32 v72, v240, v168
    s_waitcnt vmcnt(4) lgkmcnt(0)
    v_mfma_f32_16x16x32_bf16 v[56:59], v[140:143], v[200:203], v[56:59]
    ds_read_b128 v[112:115], v238 offset:35840
    v_fmac_f32 v73, v241, v168
    v_mfma_f32_16x16x32_bf16 v[84:87], v[140:143], v[204:207], v[84:87]
    ds_read_b128 v[116:119], v238 offset:36864
    v_fmac_f32_e64 v74, v242, v168
    v_mfma_f32_16x16x32_bf16 v[60:63], v[144:147], v[200:203], v[60:63]
    s_mul_i32 s57, s52, 442368
    s_sub_u32 s57, s57, 225280
    v_fmac_f32_e64 v75, v243, v168
    v_mfma_f32_16x16x32_bf16 v[88:91], v[144:147], v[204:207], v[88:91]
    ds_read_b128 v[120:123], v238 offset:37888
    v_fmac_f32_e64 v100, v240, v172
    v_mfma_f32_16x16x32_bf16 v[64:67], v[148:151], v[200:203], v[64:67]
    ds_read_b128 v[124:127], v238 offset:38912
    v_fmac_f32_e64 v101, v241, v172
    v_mfma_f32_16x16x32_bf16 v[92:95], v[148:151], v[204:207], v[92:95]
    s_mul_i32 s64, s52, 163840
    s_sub_u32 s64, 81920, s64
    v_fmac_f32_e64 v102, v242, v172
    v_mfma_f32_16x16x32_bf16 v[68:71], v[152:155], v[200:203], v[68:71]
    ds_read_b128 v[128:131], v238 offset:39936
    v_fmac_f32_e64 v103, v243, v172
    v_mfma_f32_16x16x32_bf16 v[96:99], v[152:155], v[204:207], v[96:99]
    ds_read_b128 v[132:135], v238 offset:40960
    v_mfma_f32_16x16x32_bf16 v[72:75], v[156:159], v[200:203], v[72:75]
    s_add_u32 s64, s64, s34
    s_xor_b32 s65, s53, 128
    ds_read_b128 v[240:243], v22 offset:640
    v_mfma_f32_16x16x32_bf16 v[100:103], v[156:159], v[204:207], v[100:103]
    ds_read_b128 v[136:139], v238 offset:41984
    v_mfma_f32_16x16x32_bf16 v[76:79], v[160:163], v[200:203], v[76:79]
    s_and_b32 s66, s53, 4294967040
    s_and_b32 s56, s53, 4294967168
    v_mfma_f32_16x16x32_bf16 v[104:107], v[160:163], v[204:207], v[104:107]
    v_lshlrev_b32 v31, 2, v21
    v_mfma_f32_16x16x32_bf16 v[80:83], v[164:167], v[200:203], v[80:83]
    v_mfma_f32_16x16x32_bf16 v[108:111], v[164:167], v[204:207], v[108:111]
    s_waitcnt vmcnt(2) lgkmcnt(0)
    v_mfma_f32_16x16x32_bf16 v[56:59], v[112:115], v[208:211], v[56:59]
    ds_read_b128 v[140:143], v238 offset:43008
    v_mfma_f32_16x16x32_bf16 v[84:87], v[112:115], v[212:215], v[84:87]
    ds_read_b128 v[144:147], v238 offset:44032
    v_fmac_f32 v76, v244, v168
    v_mfma_f32_16x16x32_bf16 v[60:63], v[116:119], v[208:211], v[60:63]
    v_fmac_f32_e64 v77, v245, v168
    v_mfma_f32_16x16x32_bf16 v[88:91], v[116:119], v[212:215], v[88:91]
    ds_read_b128 v[148:151], v238 offset:45056
    v_fmac_f32_e64 v78, v246, v168
    v_mfma_f32_16x16x32_bf16 v[64:67], v[120:123], v[208:211], v[64:67]
    ds_read_b128 v[152:155], v238 offset:46080
    v_fmac_f32_e64 v79, v247, v168
    v_mfma_f32_16x16x32_bf16 v[92:95], v[120:123], v[212:215], v[92:95]
    v_fmac_f32_e64 v104, v244, v172
    v_mfma_f32_16x16x32_bf16 v[68:71], v[124:127], v[208:211], v[68:71]
    ds_read_b128 v[156:159], v238 offset:47104
    v_fmac_f32_e64 v105, v245, v172
    v_mfma_f32_16x16x32_bf16 v[96:99], v[124:127], v[212:215], v[96:99]
    ds_read_b128 v[160:163], v238 offset:48128
    v_fmac_f32_e64 v106, v246, v172
    v_mfma_f32_16x16x32_bf16 v[72:75], v[128:131], v[208:211], v[72:75]
    v_fmac_f32_e64 v107, v247, v172
    v_mfma_f32_16x16x32_bf16 v[100:103], v[128:131], v[212:215], v[100:103]
    ds_read_b128 v[164:167], v236 offset:0
    v_mfma_f32_16x16x32_bf16 v[76:79], v[132:135], v[208:211], v[76:79]
    v_mfma_f32_16x16x32_bf16 v[104:107], v[132:135], v[212:215], v[104:107]
    v_mfma_f32_16x16x32_bf16 v[80:83], v[136:139], v[208:211], v[80:83]
    v_mfma_f32_16x16x32_bf16 v[108:111], v[136:139], v[212:215], v[108:111]
    s_waitcnt vmcnt(0) lgkmcnt(0)
    v_mfma_f32_16x16x32_bf16 v[56:59], v[140:143], v[216:219], v[56:59]
    v_mfma_f32_16x16x32_bf16 v[84:87], v[140:143], v[220:223], v[84:87]
    v_mfma_f32_16x16x32_bf16 v[60:63], v[144:147], v[216:219], v[60:63]
    v_mfma_f32_16x16x32_bf16 v[88:91], v[144:147], v[220:223], v[88:91]
    s_nop 1
    v_fmac_f32_e64 v80, v240, v168
    v_mfma_f32_16x16x32_bf16 v[64:67], v[148:151], v[216:219], v[64:67]
    v_fmac_f32_e64 v81, v241, v168
    v_mfma_f32_16x16x32_bf16 v[92:95], v[148:151], v[220:223], v[92:95]
    v_fmac_f32_e64 v82, v242, v168
    v_mfma_f32_16x16x32_bf16 v[68:71], v[152:155], v[216:219], v[68:71]
    v_fmac_f32_e64 v83, v243, v168
    v_mfma_f32_16x16x32_bf16 v[96:99], v[152:155], v[220:223], v[96:99]
    v_fmac_f32_e64 v108, v240, v172
    v_mfma_f32_16x16x32_bf16 v[72:75], v[156:159], v[216:219], v[72:75]
    v_fmac_f32_e64 v109, v241, v172
    v_mfma_f32_16x16x32_bf16 v[100:103], v[156:159], v[220:223], v[100:103]
    v_fmac_f32_e64 v110, v242, v172
    v_mfma_f32_16x16x32_bf16 v[76:79], v[160:163], v[216:219], v[76:79]
    v_fmac_f32_e64 v111, v243, v172
    v_mfma_f32_16x16x32_bf16 v[104:107], v[160:163], v[220:223], v[104:107]
    v_mfma_f32_16x16x32_bf16 v[80:83], v[164:167], v[216:219], v[80:83]
    v_mfma_f32_16x16x32_bf16 v[108:111], v[164:167], v[220:223], v[108:111]
    s_waitcnt lgkmcnt(0)
    s_barrier
    s_cmp_eq_u32 s43, 0
    s_cbranch_scc1 L_safe_244
    s_and_b32 s67, s38, 3
    s_cmp_eq_u32 s67, 3
    s_cbranch_scc1 L_six_246
    v_pk_mul_f32 v[140:141], v[80:81], v[168:169] op_sel:[0,1] op_sel_hi:[1,1]
    v_pk_mul_f32 v[142:143], v[82:83], v[168:169] op_sel:[0,1] op_sel_hi:[1,1]
    v_exp_f32 v140, v140
    v_exp_f32 v141, v141
    v_exp_f32 v142, v142
    v_exp_f32_e64 v143, v143
    v_pk_fma_f32 v[140:141], v[140:141], v[170:171], v[170:171] op_sel_hi:[1,0,0]
    v_pk_fma_f32 v[142:143], v[142:143], v[170:171], v[170:171] op_sel_hi:[1,0,0]
    v_rcp_f32 v140, v140
    v_rcp_f32 v141, v141
    v_rcp_f32 v142, v142
    v_rcp_f32 v143, v143
    v_pk_mul_f32 v[80:81], v[80:81], v[140:141]
    v_pk_mul_f32 v[82:83], v[82:83], v[142:143]
    v_cvt_pk_bf16_f32 v156, v80, v81
    v_cvt_pk_bf16_f32 v158, v80, v81
    v_cvt_pk_bf16_f32 v157, v82, v83
    v_cvt_pk_bf16_f32 v159, v82, v83
    v_permlane16_swap_b32 v156, v158
    s_nop 0
    v_permlane16_swap_b32 v157, v159
    buffer_store_dwordx4 v[156:159], v4, s[4:7], s62 offen offset:3072
L_six_246:
    v_pk_mul_f32 v[148:149], v[56:57], v[168:169] op_sel:[0,1] op_sel_hi:[1,1]
    v_pk_mul_f32 v[150:151], v[58:59], v[168:169] op_sel:[0,1] op_sel_hi:[1,1]
    v_pk_mul_f32 v[152:153], v[60:61], v[168:169] op_sel:[0,1] op_sel_hi:[1,1]
    v_pk_mul_f32 v[154:155], v[62:63], v[168:169] op_sel:[0,1] op_sel_hi:[1,1]
    v_exp_f32 v148, v148
    v_exp_f32 v149, v149
    v_exp_f32 v150, v150
    v_exp_f32 v151, v151
    v_exp_f32 v152, v152
    v_exp_f32 v153, v153
    v_exp_f32 v154, v154
    v_exp_f32_e64 v155, v155
    v_pk_fma_f32 v[148:149], v[148:149], v[170:171], v[170:171] op_sel_hi:[1,0,0]
    v_pk_fma_f32 v[150:151], v[150:151], v[170:171], v[170:171] op_sel_hi:[1,0,0]
    v_pk_fma_f32 v[152:153], v[152:153], v[170:171], v[170:171] op_sel_hi:[1,0,0]
    v_pk_fma_f32 v[154:155], v[154:155], v[170:171], v[170:171] op_sel_hi:[1,0,0]
    v_rcp_f32 v148, v148
    v_rcp_f32 v149, v149
    v_rcp_f32 v150, v150
    v_rcp_f32 v151, v151
    v_rcp_f32 v152, v152
    v_rcp_f32 v153, v153
    v_rcp_f32 v154, v154
    v_rcp_f32 v155, v155
    v_pk_mul_f32 v[56:57], v[56:57], v[148:149]
    v_pk_mul_f32 v[58:59], v[58:59], v[150:151]
    v_pk_mul_f32 v[60:61], v[60:61], v[152:153]
    v_pk_mul_f32 v[62:63], v[62:63], v[154:155]
    v_cvt_pk_bf16_f32 v160, v56, v57
    v_cvt_pk_bf16_f32 v162, v60, v61
    v_cvt_pk_bf16_f32 v161, v58, v59
    v_cvt_pk_bf16_f32 v163, v62, v63
    v_permlane16_swap_b32 v160, v162
    s_nop 0
    v_permlane16_swap_b32 v161, v163
    buffer_store_dwordx4 v[160:163], v3, s[4:7], s62 offen offset:0
    v_pk_mul_f32 v[140:141], v[64:65], v[168:169] op_sel:[0,1] op_sel_hi:[1,1]
    v_pk_mul_f32 v[142:143], v[66:67], v[168:169] op_sel:[0,1] op_sel_hi:[1,1]
    v_pk_mul_f32 v[144:145], v[68:69], v[168:169] op_sel:[0,1] op_sel_hi:[1,1]
    v_pk_mul_f32 v[146:147], v[70:71], v[168:169] op_sel:[0,1] op_sel_hi:[1,1]
    v_exp_f32 v140, v140
    v_exp_f32 v141, v141
    v_exp_f32 v142, v142
    v_exp_f32 v143, v143
    v_exp_f32 v144, v144
    v_exp_f32 v145, v145
    v_exp_f32 v146, v146
    v_exp_f32_e64 v147, v147
    v_pk_fma_f32 v[140:141], v[140:141], v[170:171], v[170:171] op_sel_hi:[1,0,0]
    v_pk_fma_f32 v[142:143], v[142:143], v[170:171], v[170:171] op_sel_hi:[1,0,0]
    v_pk_fma_f32 v[144:145], v[144:145], v[170:171], v[170:171] op_sel_hi:[1,0,0]
    v_pk_fma_f32 v[146:147], v[146:147], v[170:171], v[170:171] op_sel_hi:[1,0,0]
    v_rcp_f32 v140, v140
    v_rcp_f32 v141, v141
    v_rcp_f32 v142, v142
    v_rcp_f32 v143, v143
    v_rcp_f32 v144, v144
    v_rcp_f32 v145, v145
    v_rcp_f32 v146, v146
    v_rcp_f32 v147, v147
    v_pk_mul_f32 v[64:65], v[64:65], v[140:141]
    v_pk_mul_f32 v[66:67], v[66:67], v[142:143]
    v_pk_mul_f32 v[68:69], v[68:69], v[144:145]
    v_pk_mul_f32 v[70:71], v[70:71], v[146:147]
    v_cvt_pk_bf16_f32 v156, v64, v65
    v_cvt_pk_bf16_f32 v158, v68, v69
    v_cvt_pk_bf16_f32 v157, v66, v67
    v_cvt_pk_bf16_f32 v159, v70, v71
    v_permlane16_swap_b32 v156, v158
    s_nop 0
    v_permlane16_swap_b32 v157, v159
    buffer_store_dwordx4 v[156:159], v3, s[4:7], s62 offen offset:1024
    v_pk_mul_f32 v[148:149], v[72:73], v[168:169] op_sel:[0,1] op_sel_hi:[1,1]
    v_pk_mul_f32 v[150:151], v[74:75], v[168:169] op_sel:[0,1] op_sel_hi:[1,1]
    v_pk_mul_f32 v[152:153], v[76:77], v[168:169] op_sel:[0,1] op_sel_hi:[1,1]
    v_pk_mul_f32 v[154:155], v[78:79], v[168:169] op_sel:[0,1] op_sel_hi:[1,1]
    v_exp_f32 v148, v148
    v_exp_f32 v149, v149
    v_exp_f32 v150, v150
    v_exp_f32 v151, v151
    v_exp_f32 v152, v152
    v_exp_f32 v153, v153
    v_exp_f32 v154, v154
    v_exp_f32_e64 v155, v155
    v_pk_fma_f32 v[148:149], v[148:149], v[170:171], v[170:171] op_sel_hi:[1,0,0]
    v_pk_fma_f32 v[150:151], v[150:151], v[170:171], v[170:171] op_sel_hi:[1,0,0]
    v_pk_fma_f32 v[152:153], v[152:153], v[170:171], v[170:171] op_sel_hi:[1,0,0]
    v_pk_fma_f32 v[154:155], v[154:155], v[170:171], v[170:171] op_sel_hi:[1,0,0]
    v_rcp_f32 v148, v148
    v_rcp_f32 v149, v149
    v_rcp_f32 v150, v150
    v_rcp_f32 v151, v151
    v_rcp_f32 v152, v152
    v_rcp_f32 v153, v153
    v_rcp_f32 v154, v154
    v_rcp_f32 v155, v155
    v_pk_mul_f32 v[72:73], v[72:73], v[148:149]
    v_pk_mul_f32 v[74:75], v[74:75], v[150:151]
    v_pk_mul_f32 v[76:77], v[76:77], v[152:153]
    v_pk_mul_f32 v[78:79], v[78:79], v[154:155]
    v_cvt_pk_bf16_f32 v160, v72, v73
    v_cvt_pk_bf16_f32 v162, v76, v77
    v_cvt_pk_bf16_f32 v161, v74, v75
    v_cvt_pk_bf16_f32 v163, v78, v79
    v_permlane16_swap_b32 v160, v162
    s_nop 0
    v_permlane16_swap_b32 v161, v163
    buffer_store_dwordx4 v[160:163], v3, s[4:7], s62 offen offset:2048
    s_and_b32 s67, s38, 3
    s_cmp_eq_u32 s67, 3
    s_cbranch_scc1 L_six_247
    v_pk_mul_f32 v[140:141], v[108:109], v[172:173] op_sel:[0,1] op_sel_hi:[1,1]
    v_pk_mul_f32 v[142:143], v[110:111], v[172:173] op_sel:[0,1] op_sel_hi:[1,1]
    v_exp_f32 v140, v140
    v_exp_f32 v141, v141
    v_exp_f32 v142, v142
    v_exp_f32 v143, v143
    v_pk_fma_f32 v[140:141], v[140:141], v[174:175], v[174:175] op_sel_hi:[1,0,0]
    v_pk_fma_f32 v[142:143], v[142:143], v[174:175], v[174:175] op_sel_hi:[1,0,0]
    v_rcp_f32 v140, v140
    v_rcp_f32 v141, v141
    v_rcp_f32 v142, v142
    v_rcp_f32 v143, v143
    v_pk_mul_f32 v[108:109], v[108:109], v[140:141]
    v_pk_mul_f32 v[110:111], v[110:111], v[142:143]
    v_cvt_pk_bf16_f32 v156, v108, v109
    v_cvt_pk_bf16_f32 v158, v108, v109
    v_cvt_pk_bf16_f32 v157, v110, v111
    v_cvt_pk_bf16_f32 v159, v110, v111
    v_permlane16_swap_b32 v156, v158
    s_nop 0
    v_permlane16_swap_b32 v157, v159
    buffer_store_dwordx4 v[156:159], v4, s[4:7], s63 offen offset:3072
L_six_247:
    v_pk_mul_f32 v[148:149], v[84:85], v[172:173] op_sel:[0,1] op_sel_hi:[1,1]
    v_pk_mul_f32 v[150:151], v[86:87], v[172:173] op_sel:[0,1] op_sel_hi:[1,1]
    v_pk_mul_f32 v[152:153], v[88:89], v[172:173] op_sel:[0,1] op_sel_hi:[1,1]
    v_pk_mul_f32 v[154:155], v[90:91], v[172:173] op_sel:[0,1] op_sel_hi:[1,1]
    v_exp_f32 v148, v148
    v_exp_f32 v149, v149
    v_exp_f32 v150, v150
    v_exp_f32 v151, v151
    v_exp_f32 v152, v152
    v_exp_f32 v153, v153
    v_exp_f32 v154, v154
    v_exp_f32_e64 v155, v155
    v_pk_fma_f32 v[148:149], v[148:149], v[174:175], v[174:175] op_sel_hi:[1,0,0]
    v_pk_fma_f32 v[150:151], v[150:151], v[174:175], v[174:175] op_sel_hi:[1,0,0]
    v_pk_fma_f32 v[152:153], v[152:153], v[174:175], v[174:175] op_sel_hi:[1,0,0]
    v_pk_fma_f32 v[154:155], v[154:155], v[174:175], v[174:175] op_sel_hi:[1,0,0]
    v_rcp_f32 v148, v148
    v_rcp_f32 v149, v149
    v_rcp_f32 v150, v150
    v_rcp_f32 v151, v151
    v_rcp_f32 v152, v152
    v_rcp_f32 v153, v153
    v_rcp_f32 v154, v154
    v_rcp_f32 v155, v155
    v_pk_mul_f32 v[84:85], v[84:85], v[148:149]
    v_pk_mul_f32 v[86:87], v[86:87], v[150:151]
    v_pk_mul_f32 v[88:89], v[88:89], v[152:153]
    v_pk_mul_f32 v[90:91], v[90:91], v[154:155]
    v_cvt_pk_bf16_f32 v160, v84, v85
    v_cvt_pk_bf16_f32 v162, v88, v89
    v_cvt_pk_bf16_f32 v161, v86, v87
    v_cvt_pk_bf16_f32 v163, v90, v91
    v_permlane16_swap_b32 v160, v162
    s_nop 0
    v_permlane16_swap_b32 v161, v163
    buffer_store_dwordx4 v[160:163], v3, s[4:7], s63 offen offset:0
    s_waitcnt vmcnt(1)
    buffer_store_dword v0, v14, s[4:7], s53 offen offset:0
    v_pk_mul_f32 v[140:141], v[92:93], v[172:173] op_sel:[0,1] op_sel_hi:[1,1]
    v_pk_mul_f32 v[142:143], v[94:95], v[172:173] op_sel:[0,1] op_sel_hi:[1,1]
    v_pk_mul_f32 v[144:145], v[96:97], v[172:173] op_sel:[0,1] op_sel_hi:[1,1]
    v_pk_mul_f32 v[146:147], v[98:99], v[172:173] op_sel:[0,1] op_sel_hi:[1,1]
    v_exp_f32 v140, v140
    v_exp_f32 v141, v141
    v_exp_f32 v142, v142
    v_exp_f32 v143, v143
    v_exp_f32 v144, v144
    v_exp_f32 v145, v145
    v_exp_f32 v146, v146
    v_exp_f32 v147, v147
    v_pk_fma_f32 v[140:141], v[140:141], v[174:175], v[174:175] op_sel_hi:[1,0,0]
    v_pk_fma_f32 v[142:143], v[142:143], v[174:175], v[174:175] op_sel_hi:[1,0,0]
    v_pk_fma_f32 v[144:145], v[144:145], v[174:175], v[174:175] op_sel_hi:[1,0,0]
    v_pk_fma_f32 v[146:147], v[146:147], v[174:175], v[174:175] op_sel_hi:[1,0,0]
    v_rcp_f32 v140, v140
    v_rcp_f32 v141, v141
    v_rcp_f32 v142, v142
    v_rcp_f32 v143, v143
    v_rcp_f32 v144, v144
    v_rcp_f32 v145, v145
    v_rcp_f32 v146, v146
    v_rcp_f32 v147, v147
    v_pk_mul_f32 v[92:93], v[92:93], v[140:141]
    v_pk_mul_f32 v[94:95], v[94:95], v[142:143]
    v_pk_mul_f32 v[96:97], v[96:97], v[144:145]
    v_pk_mul_f32 v[98:99], v[98:99], v[146:147]
    v_cvt_pk_bf16_f32 v156, v92, v93
    v_cvt_pk_bf16_f32 v158, v96, v97
    v_cvt_pk_bf16_f32 v157, v94, v95
    v_cvt_pk_bf16_f32 v159, v98, v99
    v_permlane16_swap_b32 v156, v158
    s_nop 0
    v_permlane16_swap_b32 v157, v159
    buffer_store_dwordx4 v[156:159], v3, s[4:7], s63 offen offset:1024
    buffer_load_dword v29, v24, s[4:7], s56 offen offset:0 sc1
    v_pk_mul_f32 v[148:149], v[100:101], v[172:173] op_sel:[0,1] op_sel_hi:[1,1]
    v_pk_mul_f32 v[150:151], v[102:103], v[172:173] op_sel:[0,1] op_sel_hi:[1,1]
    v_pk_mul_f32 v[152:153], v[104:105], v[172:173] op_sel:[0,1] op_sel_hi:[1,1]
    s_branch L_over_464
L_chain6_0_3:
    s_branch L_chainret6
L_over_464:
    v_pk_mul_f32 v[154:155], v[106:107], v[172:173] op_sel:[0,1] op_sel_hi:[1,1]
    v_exp_f32 v148, v148
    v_exp_f32 v149, v149
    v_exp_f32 v150, v150
    v_exp_f32 v151, v151
    v_exp_f32 v152, v152
    v_exp_f32 v153, v153
    v_exp_f32 v154, v154
    v_exp_f32_e64 v155, v155
    v_pk_fma_f32 v[148:149], v[148:149], v[174:175], v[174:175] op_sel_hi:[1,0,0]
    v_pk_fma_f32 v[150:151], v[150:151], v[174:175], v[174:175] op_sel_hi:[1,0,0]
    v_pk_fma_f32 v[152:153], v[152:153], v[174:175], v[174:175] op_sel_hi:[1,0,0]
    v_pk_fma_f32 v[154:155], v[154:155], v[174:175], v[174:175] op_sel_hi:[1,0,0]
    v_rcp_f32 v148, v148
    v_rcp_f32 v149, v149
    v_rcp_f32 v150, v150
    v_rcp_f32 v151, v151
    v_rcp_f32 v152, v152
    v_rcp_f32 v153, v153
    v_rcp_f32 v154, v154
    v_rcp_f32 v155, v155
    v_pk_mul_f32 v[100:101], v[100:101], v[148:149]
    v_pk_mul_f32 v[102:103], v[102:103], v[150:151]
    v_pk_mul_f32 v[104:105], v[104:105], v[152:153]
    v_pk_mul_f32 v[106:107], v[106:107], v[154:155]
    v_cvt_pk_bf16_f32 v160, v100, v101
    v_cvt_pk_bf16_f32 v162, v104, v105
    v_cvt_pk_bf16_f32 v161, v102, v103
    v_cvt_pk_bf16_f32 v163, v106, v107
    v_permlane16_swap_b32 v160, v162
    s_nop 0
    v_permlane16_swap_b32 v161, v163
    buffer_store_dwordx4 v[160:163], v3, s[4:7], s63 offen offset:2048
L_join_245:
    s_waitcnt vmcnt(1)
    v_sub_u32 v29, v29, v15
    v_subrev_u32 v29, 12, v29
    v_cmp_lt_u32 vcc, 1, v29
    s_nop 0
    s_and_b32 vcc_hi, vcc_lo, 4294967295
    s_cbranch_scc0 L_stok_248
L_poll_249:
    buffer_load_dword v29, v24, s[4:7], s56 offen offset:0 sc1
    s_waitcnt vmcnt(0)
    v_sub_u32 v29, v29, v15
    v_subrev_u32 v29, 12, v29
    v_cmp_lt_u32 vcc, 1, v29
    s_nop 0
    s_and_b32 vcc_hi, vcc_lo, 4294967295
    s_cbranch_scc0 L_polled_250
    s_sub_u32 s44, s44, 1
    s_cbranch_scc0 L_poll_249
    s_mov_b32 s44, 0
L_polled_250:
L_stok_248:
L_ph9:
    buffer_load_dwordx4 v[184:187], v1, s[4:7], s58 offen offset:0 sc1
    buffer_load_dwordx4 v[188:191], v1, s[4:7], s58 offen offset:1024 sc1
    buffer_load_dwordx4 v[192:195], v1, s[4:7], s58 offen offset:2048 sc1
    buffer_load_dwordx4 v[196:199], v1, s[4:7], s58 offen offset:3072 sc1
    s_add_u32 s58, s58, 4096
    buffer_load_dwordx4 v[200:203], v1, s[4:7], s58 offen offset:0 sc1
    buffer_load_dwordx4 v[204:207], v1, s[4:7], s58 offen offset:1024 sc1
    buffer_load_dwordx4 v[208:211], v25, s[4:7], s58 offen offset:2048 sc1
    buffer_load_dwordx4 v[212:215], v1, s[4:7], s59 offen offset:0 sc1
    s_waitcnt vmcnt(7)
    v_mfma_f32_16x16x32_bf16 v[72:75], a[100:103], v[184:187], 0
    buffer_load_dwordx4 v[216:219], v1, s[4:7], s59 offen offset:1024 sc1
    v_mfma_f32_16x16x32_bf16 v[76:79], a[128:131], v[184:187], 0
    v_add_u32 v0, 1, v0
    s_cmp_eq_u32 s43, 0
    s_cbranch_scc1 L_safe_251
    buffer_store_dword v0, v14, s[4:7], s53 offen offset:0
L_join_252:
    v_add_u32_e64 v0, 14, v15
    v_mfma_f32_16x16x32_bf16 v[80:83], a[156:159], v[184:187], 0
    v_lshrrev_b32 v238, 2, v21
    v_and_b32 v239, 3, v21
    v_mul_u32_u24 v237, 1280, v238
    v_mfma_f32_16x16x32_bf16 v[84:87], a[184:187], v[184:187], 0
    v_lshl_add_u32 v236, v239, 4, v237
    v_lshl_add_u32 v237, v239, 3, v237
    s_lshl_b32 s54, s36, 12
    v_mfma_f32_16x16x32_bf16 v[88:91], a[212:215], v[184:187], 0
    s_waitcnt vmcnt(8)
    v_mfma_f32_16x16x32_bf16 v[72:75], a[104:107], v[188:191], v[72:75]
    buffer_load_dwordx4 v[220:223], v1, s[4:7], s59 offen offset:2048 sc1
    v_mfma_f32_16x16x32_bf16 v[76:79], a[132:135], v[188:191], v[76:79]
    s_add_u32 s54, s54, 1024
    v_mul_u32_u24 v238, 176, v238
    v_add_u32_e64 v238, s54, v238
    v_mfma_f32_16x16x32_bf16 v[80:83], a[160:163], v[188:191], v[80:83]
    v_lshl_add_u32 v240, v239, 3, v238
    v_lshl_add_u32 v238, v239, 4, v238
    v_and_b32_e64 v239, 15, v21
    v_mfma_f32_16x16x32_bf16 v[84:87], a[188:191], v[188:191], v[84:87]
    v_mul_u32_u24 v239, 176, v239
    v_lshrrev_b32_e64 v241, 1, v22
    v_add3_u32 v239, v239, v241, s54
    v_mfma_f32_16x16x32_bf16 v[88:91], a[216:219], v[188:191], v[88:91]
    s_waitcnt vmcnt(8)
    v_mfma_f32_16x16x32_bf16 v[72:75], a[108:111], v[192:195], v[72:75]
    buffer_load_dwordx4 v[224:227], v1, s[4:7], s59 offen offset:3072 sc1
    v_mfma_f32_16x16x32_bf16 v[76:79], a[136:139], v[192:195], v[76:79]
    s_mul_i32 s55, s40, 2400
    s_sub_u32 s54, s34, s55
    s_sub_u32 s55, s64, s55
    v_mfma_f32_16x16x32_bf16 v[80:83], a[164:167], v[192:195], v[80:83]
    v_mfma_f32_16x16x32_bf16 v[84:87], a[192:195], v[192:195], v[84:87]
    v_mfma_f32_16x16x32_bf16 v[88:91], a[220:223], v[192:195], v[88:91]
    s_waitcnt vmcnt(8)
    v_mfma_f32_16x16x32_bf16 v[72:75], a[112:115], v[196:199], v[72:75]
    s_add_u32 s59, s59, 4096
    buffer_load_dwordx4 v[228:231], v1, s[4:7], s59 offen offset:0 sc1
    v_mfma_f32_16x16x32_bf16 v[76:79], a[140:143], v[196:199], v[76:79]
    v_mfma_f32_16x16x32_bf16 v[80:83], a[168:171], v[196:199], v[80:83]
    v_mfma_f32_16x16x32_bf16 v[84:87], a[196:199], v[196:199], v[84:87]
    v_mfma_f32_16x16x32_bf16 v[88:91], a[224:227], v[196:199], v[88:91]
    s_waitcnt vmcnt(8)
    v_mfma_f32_16x16x32_bf16 v[72:75], a[116:119], v[200:203], v[72:75]
    buffer_load_dwordx4 v[184:187], v1, s[4:7], s59 offen offset:1024 sc1
    v_mfma_f32_16x16x32_bf16 v[76:79], a[144:147], v[200:203], v[76:79]
    v_mfma_f32_16x16x32_bf16 v[80:83], a[172:175], v[200:203], v[80:83]
    v_mfma_f32_16x16x32_bf16 v[84:87], a[200:203], v[200:203], v[84:87]
    v_mfma_f32_16x16x32_bf16 v[88:91], a[228:231], v[200:203], v[88:91]
    s_waitcnt vmcnt(8)
    v_mfma_f32_16x16x32_bf16 v[72:75], a[120:123], v[204:207], v[72:75]
    buffer_load_dwordx4 v[188:191], v25, s[4:7], s59 offen offset:2048 sc1
    v_mfma_f32_16x16x32_bf16 v[76:79], a[148:151], v[204:207], v[76:79]
    v_mfma_f32_16x16x32_bf16 v[80:83], a[176:179], v[204:207], v[80:83]
    v_mfma_f32_16x16x32_bf16 v[84:87], a[204:207], v[204:207], v[84:87]
    v_mfma_f32_16x16x32_bf16 v[88:91], a[232:235], v[204:207], v[88:91]
    s_waitcnt vmcnt(8)
    v_mfma_f32_16x16x32_bf16 v[72:75], a[124:127], v[208:211], v[72:75]
    buffer_load_dwordx4 v[192:195], v1, s[4:7], s60 offen offset:0 sc1
    v_mfma_f32_16x16x32_bf16 v[76:79], a[152:155], v[208:211], v[76:79]
    v_mfma_f32_16x16x32_bf16 v[80:83], a[180:183], v[208:211], v[80:83]
    v_mfma_f32_16x16x32_bf16 v[84:87], a[208:211], v[208:211], v[84:87]
    v_mfma_f32_16x16x32_bf16 v[88:91], a[236:239], v[208:211], v[88:91]
    s_waitcnt vmcnt(8)
    v_mfma_f32_16x16x32_bf16 v[92:95], a[100:103], v[212:215], 0
    buffer_load_dwordx4 v[196:199], v1, s[4:7], s60 offen offset:1024 sc1
    v_mfma_f32_16x16x32_bf16 v[96:99], a[128:131], v[212:215], 0
    v_mfma_f32_16x16x32_bf16 v[100:103], a[156:159], v[212:215], 0
    ds_write_b128 v52, v[72:75] offset:0
    v_mfma_f32_16x16x32_bf16 v[104:107], a[184:187], v[212:215], 0
    v_mfma_f32_16x16x32_bf16 v[108:111], a[212:215], v[212:215], 0
    ds_write_b128 v52, v[76:79] offset:1024
    s_waitcnt vmcnt(8)
    v_mfma_f32_16x16x32_bf16 v[92:95], a[104:107], v[216:219], v[92:95]
    buffer_load_dwordx4 v[200:203], v1, s[4:7], s60 offen offset:2048 sc1
    v_mfma_f32_16x16x32_bf16 v[96:99], a[132:135], v[216:219], v[96:99]
    v_mfma_f32_16x16x32_bf16 v[100:103], a[160:163], v[216:219], v[100:103]
    ds_write_b128 v52, v[80:83] offset:2048
    v_mfma_f32_16x16x32_bf16 v[104:107], a[188:191], v[216:219], v[104:107]
    v_mfma_f32_16x16x32_bf16 v[108:111], a[216:219], v[216:219], v[108:111]
    ds_write_b128 v52, v[84:87] offset:3072
    s_waitcnt vmcnt(7)
    v_mfma_f32_16x16x32_bf16 v[92:95], a[108:111], v[220:223], v[92:95]
    buffer_load_dwordx4 v[204:207], v1, s[4:7], s60 offen offset:3072 sc1
    v_mfma_f32_16x16x32_bf16 v[96:99], a[136:139], v[220:223], v[96:99]
    v_mfma_f32_16x16x32_bf16 v[100:103], a[164:167], v[220:223], v[100:103]
    ds_write_b128 v52, v[88:91] offset:4096
    v_mfma_f32_16x16x32_bf16 v[104:107], a[192:195], v[220:223], v[104:107]
    v_mfma_f32_16x16x32_bf16 v[108:111], a[220:223], v[220:223], v[108:111]
    s_waitcnt vmcnt(7)
    v_mfma_f32_16x16x32_bf16 v[92:95], a[112:115], v[224:227], v[92:95]
    s_add_u32 s60, s60, 4096
    buffer_load_dwordx4 v[208:211], v1, s[4:7], s60 offen offset:0 sc1
    v_mfma_f32_16x16x32_bf16 v[96:99], a[140:143], v[224:227], v[96:99]
    v_mfma_f32_16x16x32_bf16 v[100:103], a[168:171], v[224:227], v[100:103]
    v_mfma_f32_16x16x32_bf16 v[104:107], a[196:199], v[224:227], v[104:107]
    v_mfma_f32_16x16x32_bf16 v[108:111], a[224:227], v[224:227], v[108:111]
    s_waitcnt vmcnt(7)
    v_mfma_f32_16x16x32_bf16 v[92:95], a[116:119], v[228:231], v[92:95]
    buffer_load_dwordx4 v[212:215], v1, s[4:7], s60 offen offset:1024 sc1
    v_mfma_f32_16x16x32_bf16 v[96:99], a[144:147], v[228:231], v[96:99]
    v_mfma_f32_16x16x32_bf16 v[100:103], a[172:175], v[228:231], v[100:103]
    v_mfma_f32_16x16x32_bf16 v[104:107], a[200:203], v[228:231], v[104:107]
    v_mfma_f32_16x16x32_bf16 v[108:111], a[228:231], v[228:231], v[108:111]
    s_waitcnt vmcnt(7)
    v_mfma_f32_16x16x32_bf16 v[92:95], a[120:123], v[184:187], v[92:95]
    buffer_load_dwordx4 v[216:219], v25, s[4:7], s60 offen offset:2048 sc1
    v_mfma_f32_16x16x32_bf16 v[96:99], a[148:151], v[184:187], v[96:99]
    v_mfma_f32_16x16x32_bf16 v[100:103], a[176:179], v[184:187], v[100:103]
    buffer_load_dword v29, v31, s[4:7], s66 offen offset:0 sc1
    v_mfma_f32_16x16x32_bf16 v[104:107], a[204:207], v[184:187], v[104:107]
    v_mfma_f32_16x16x32_bf16 v[108:111], a[232:235], v[184:187], v[108:111]
    s_waitcnt vmcnt(8)
    v_mfma_f32_16x16x32_bf16 v[92:95], a[124:127], v[188:191], v[92:95]
    buffer_load_dwordx4 v[220:223], v1, s[4:7], s61 offen offset:0 sc1
    v_mfma_f32_16x16x32_bf16 v[96:99], a[152:155], v[188:191], v[96:99]
    v_mfma_f32_16x16x32_bf16 v[100:103], a[180:183], v[188:191], v[100:103]
    v_mfma_f32_16x16x32_bf16 v[104:107], a[208:211], v[188:191], v[104:107]
    v_mfma_f32_16x16x32_bf16 v[108:111], a[236:239], v[188:191], v[108:111]
    s_waitcnt vmcnt(8)
    v_mfma_f32_16x16x32_bf16 v[72:75], a[100:103], v[192:195], 0
    buffer_load_dwordx4 v[224:227], v1, s[4:7], s61 offen offset:1024 sc1
    v_mfma_f32_16x16x32_bf16 v[76:79], a[128:131], v[192:195], 0
    v_mfma_f32_16x16x32_bf16 v[80:83], a[156:159], v[192:195], 0
    ds_write_b128 v53, v[92:95] offset:0
    v_mfma_f32_16x16x32_bf16 v[84:87], a[184:187], v[192:195], 0
    v_mfma_f32_16x16x32_bf16 v[88:91], a[212:215], v[192:195], 0
    ds_write_b128 v53, v[96:99] offset:1024
    s_waitcnt vmcnt(8)
    v_mfma_f32_16x16x32_bf16 v[72:75], a[104:107], v[196:199], v[72:75]
    buffer_load_dwordx4 v[228:231], v1, s[4:7], s61 offen offset:2048 sc1
    v_mfma_f32_16x16x32_bf16 v[76:79], a[132:135], v[196:199], v[76:79]
    v_mfma_f32_16x16x32_bf16 v[80:83], a[160:163], v[196:199], v[80:83]
    ds_write_b128 v53, v[100:103] offset:2048
    v_mfma_f32_16x16x32_bf16 v[84:87], a[188:191], v[196:199], v[84:87]
    v_mfma_f32_16x16x32_bf16 v[88:91], a[216:219], v[196:199], v[88:91]
    ds_write_b128 v53, v[104:107] offset:3072
    s_waitcnt vmcnt(8)
    v_mfma_f32_16x16x32_bf16 v[72:75], a[108:111], v[200:203], v[72:75]
    buffer_load_dwordx4 v[184:187], v1, s[4:7], s61 offen offset:3072 sc1
    v_mfma_f32_16x16x32_bf16 v[76:79], a[136:139], v[200:203], v[76:79]
    v_mfma_f32_16x16x32_bf16 v[80:83], a[164:167], v[200:203], v[80:83]
    ds_write_b128 v53, v[108:111] offset:4096
    v_mfma_f32_16x16x32_bf16 v[84:87], a[192:195], v[200:203], v[84:87]
    v_mfma_f32_16x16x32_bf16 v[88:91], a[220:223], v[200:203], v[88:91]
    s_waitcnt vmcnt(8)
    v_mfma_f32_16x16x32_bf16 v[72:75], a[112:115], v[204:207], v[72:75]
    s_add_u32 s61, s61, 4096
    buffer_load_dwordx4 v[188:191], v1, s[4:7], s61 offen offset:0 sc1
    v_mfma_f32_16x16x32_bf16 v[76:79], a[140:143], v[204:207], v[76:79]
    v_mfma_f32_16x16x32_bf16 v[80:83], a[168:171], v[204:207], v[80:83]
    s_waitcnt lgkmcnt(0)
    s_barrier
    v_mfma_f32_16x16x32_bf16 v[84:87], a[196:199], v[204:207], v[84:87]
    ds_read_b128 v[112:115], v55 offset:0
    v_mfma_f32_16x16x32_bf16 v[88:91], a[224:227], v[204:207], v[88:91]
    ds_read_b128 v[116:119], v55 offset:1024
    s_waitcnt vmcnt(8)
    v_mfma_f32_16x16x32_bf16 v[72:75], a[116:119], v[208:211], v[72:75]
    buffer_load_dwordx4 v[192:195], v1, s[4:7], s61 offen offset:1024 sc1
    v_mfma_f32_16x16x32_bf16 v[76:79], a[144:147], v[208:211], v[76:79]
    ds_read_b128 v[120:123], v55 offset:2048
    v_mfma_f32_16x16x32_bf16 v[80:83], a[172:175], v[208:211], v[80:83]
    ds_read_b128 v[124:127], v55 offset:3072
    v_mfma_f32_16x16x32_bf16 v[84:87], a[200:203], v[208:211], v[84:87]
    ds_read_b128 v[128:131], v55 offset:4096
    v_mfma_f32_16x16x32_bf16 v[88:91], a[228:231], v[208:211], v[88:91]
    ds_read_b128 v[132:135], v55 offset:5120
    s_waitcnt vmcnt(8)
    v_mfma_f32_16x16x32_bf16 v[72:75], a[120:123], v[212:215], v[72:75]
    buffer_load_dwordx4 v[196:199], v25, s[4:7], s61 offen offset:2048 sc1
    v_mfma_f32_16x16x32_bf16 v[76:79], a[148:151], v[212:215], v[76:79]
    ds_read_b128 v[136:139], v55 offset:6144
    v_mfma_f32_16x16x32_bf16 v[80:83], a[176:179], v[212:215], v[80:83]
    s_waitcnt vmcnt(7)
    v_sub_u32 v29, v29, v15
    v_subrev_u32_e64 v29, 13, v29
    v_cmp_lt_u32 vcc, 1, v29
    s_cbranch_vccz L_stok_253
L_poll_254:
    buffer_load_dword v29, v31, s[4:7], s66 offen offset:0 sc1
    s_waitcnt vmcnt(0)
    v_sub_u32 v29, v29, v15
    v_subrev_u32 v29, 13, v29
    v_cmp_lt_u32 vcc, 1, v29
    s_cbranch_vccz L_polled_255
    s_sub_u32 s44, s44, 1
    s_cbranch_scc0 L_poll_254
    s_mov_b32 s44, 0
L_polled_255:
L_stok_253:
    v_mfma_f32_16x16x32_bf16 v[84:87], a[204:207], v[212:215], v[84:87]
    ds_read_b128 v[140:143], v55 offset:7168
    v_mfma_f32_16x16x32_bf16 v[88:91], a[232:235], v[212:215], v[88:91]
    ds_read_b128 v[144:147], v55 offset:8192
    v_mfma_f32_16x16x32_bf16 v[72:75], a[124:127], v[216:219], v[72:75]
    s_add_u32 s58, s58, s57
    buffer_load_dwordx4 v[200:203], v1, s[4:7], s58 offen offset:0 sc1
    v_mfma_f32_16x16x32_bf16 v[76:79], a[152:155], v[216:219], v[76:79]
    ds_read_b128 v[148:151], v55 offset:9216
    v_mfma_f32_16x16x32_bf16 v[80:83], a[180:183], v[216:219], v[80:83]
    v_mfma_f32_16x16x32_bf16 v[84:87], a[208:211], v[216:219], v[84:87]
    v_mfma_f32_16x16x32_bf16 v[88:91], a[236:239], v[216:219], v[88:91]
    s_waitcnt vmcnt(7) lgkmcnt(5)
    v_mfma_f32_16x16x32_bf16 v[112:115], a[100:103], v[220:223], v[112:115]
    buffer_load_dwordx4 v[204:207], v1, s[4:7], s58 offen offset:1024 sc1
    v_mfma_f32_16x16x32_bf16 v[116:119], a[128:131], v[220:223], v[116:119]
    v_mfma_f32_16x16x32_bf16 v[120:123], a[156:159], v[220:223], v[120:123]
    ds_write_b128 v54, v[72:75] offset:0
    v_mfma_f32_16x16x32_bf16 v[124:127], a[184:187], v[220:223], v[124:127]
    v_mfma_f32_16x16x32_bf16 v[128:131], a[212:215], v[220:223], v[128:131]
    ds_write_b128 v54, v[76:79] offset:1024
    s_waitcnt vmcnt(7)
    v_mfma_f32_16x16x32_bf16 v[112:115], a[104:107], v[224:227], v[112:115]
    buffer_load_dwordx4 v[208:211], v1, s[4:7], s58 offen offset:2048 sc1
    v_mfma_f32_16x16x32_bf16 v[116:119], a[132:135], v[224:227], v[116:119]
    v_mfma_f32_16x16x32_bf16 v[120:123], a[160:163], v[224:227], v[120:123]
    ds_write_b128 v54, v[80:83] offset:2048
    v_mfma_f32_16x16x32_bf16 v[124:127], a[188:191], v[224:227], v[124:127]
    v_mfma_f32_16x16x32_bf16 v[128:131], a[216:219], v[224:227], v[128:131]
    ds_write_b128 v54, v[84:87] offset:3072
    s_waitcnt vmcnt(7)
    v_mfma_f32_16x16x32_bf16 v[112:115], a[108:111], v[228:231], v[112:115]
    buffer_load_dwordx4 v[212:215], v1, s[4:7], s58 offen offset:3072 sc1
    v_mfma_f32_16x16x32_bf16 v[116:119], a[136:139], v[228:231], v[116:119]
    v_mfma_f32_16x16x32_bf16 v[120:123], a[164:167], v[228:231], v[120:123]
    ds_write_b128 v54, v[88:91] offset:4096
    v_mfma_f32_16x16x32_bf16 v[124:127], a[192:195], v[228:231], v[124:127]
    v_mfma_f32_16x16x32_bf16 v[128:131], a[220:223], v[228:231], v[128:131]
    s_waitcnt vmcnt(7)
    v_mfma_f32_16x16x32_bf16 v[112:115], a[112:115], v[184:187], v[112:115]
    s_add_u32 s58, s58, 4096
    buffer_load_dwordx4 v[216:219], v1, s[4:7], s58 offen offset:0 sc1
    v_mfma_f32_16x16x32_bf16 v[116:119], a[140:143], v[184:187], v[116:119]
    v_mfma_f32_16x16x32_bf16 v[120:123], a[168:171], v[184:187], v[120:123]
    s_waitcnt lgkmcnt(0)
    s_barrier
    v_mfma_f32_16x16x32_bf16 v[124:127], a[196:199], v[184:187], v[124:127]
    ds_read_b128 v[152:155], v55 offset:10240
    v_mfma_f32_16x16x32_bf16 v[128:131], a[224:227], v[184:187], v[128:131]
    ds_read_b128 v[156:159], v55 offset:11264
    s_waitcnt vmcnt(7)
    v_mfma_f32_16x16x32_bf16 v[112:115], a[116:119], v[188:191], v[112:115]
    buffer_load_dwordx4 v[220:223], v1, s[4:7], s58 offen offset:1024 sc1
    v_mfma_f32_16x16x32_bf16 v[116:119], a[144:147], v[188:191], v[116:119]
    ds_read_b128 v[160:163], v55 offset:12288
    v_mfma_f32_16x16x32_bf16 v[120:123], a[172:175], v[188:191], v[120:123]
    ds_read_b128 v[164:167], v55 offset:13312
    v_mfma_f32_16x16x32_bf16 v[124:127], a[200:203], v[188:191], v[124:127]
    ds_read_b128 v[168:171], v55 offset:14336
    v_mfma_f32_16x16x32_bf16 v[128:131], a[228:231], v[188:191], v[128:131]
    s_waitcnt vmcnt(7)
    v_mfma_f32_16x16x32_bf16 v[112:115], a[120:123], v[192:195], v[112:115]
    buffer_load_dwordx4 v[224:227], v25, s[4:7], s58 offen offset:2048 sc1
    v_mfma_f32_16x16x32_bf16 v[116:119], a[148:151], v[192:195], v[116:119]
    s_waitcnt lgkmcnt(3)
    v_add_f32 v132, v132, v152
    v_add_f32 v133, v133, v153
    v_mfma_f32_16x16x32_bf16 v[120:123], a[176:179], v[192:195], v[120:123]
    v_add_f32 v134, v134, v154
    v_add_f32 v135, v135, v155
    v_mfma_f32_16x16x32_bf16 v[124:127], a[204:207], v[192:195], v[124:127]
    s_waitcnt lgkmcnt(2)
    v_add_f32 v136, v136, v156
    v_add_f32_e64 v137, v137, v157
    v_mfma_f32_16x16x32_bf16 v[128:131], a[232:235], v[192:195], v[128:131]
    v_add_f32_e64 v138, v138, v158
    v_add_f32 v139, v139, v159
    s_waitcnt vmcnt(7)
    v_mfma_f32_16x16x32_bf16 v[112:115], a[124:127], v[196:199], v[112:115]
    s_add_u32 s59, s59, s57
    buffer_load_dwordx4 v[228:231], v1, s[4:7], s59 offen offset:0 sc1
    v_mfma_f32_16x16x32_bf16 v[116:119], a[152:155], v[196:199], v[116:119]
    s_waitcnt lgkmcnt(1)
    v_add_f32 v140, v140, v160
    v_add_f32 v141, v141, v161
    v_mfma_f32_16x16x32_bf16 v[120:123], a[180:183], v[196:199], v[120:123]
    v_add_f32 v142, v142, v162
    v_add_f32 v143, v143, v163
    v_mfma_f32_16x16x32_bf16 v[124:127], a[208:211], v[196:199], v[124:127]
    s_waitcnt lgkmcnt(0)
    v_add_f32 v144, v144, v164
    v_add_f32_e64 v145, v145, v165
    v_mfma_f32_16x16x32_bf16 v[128:131], a[236:239], v[196:199], v[128:131]
    v_add_f32_e64 v146, v146, v166
    v_add_f32 v147, v147, v167
    s_waitcnt vmcnt(7)
    v_mfma_f32_16x16x32_bf16 v[72:75], a[100:103], v[200:203], 0
    buffer_load_dwordx4 v[184:187], v1, s[4:7], s59 offen offset:1024 sc1
    v_mfma_f32_16x16x32_bf16 v[76:79], a[128:131], v[200:203], 0
    v_add_f32 v148, v148, v168
    v_add_f32 v149, v149, v169
    v_mfma_f32_16x16x32_bf16 v[80:83], a[156:159], v[200:203], 0
    v_add_f32 v150, v150, v170
    v_add_f32 v151, v151, v171
    v_mfma_f32_16x16x32_bf16 v[84:87], a[184:187], v[200:203], 0
    v_add_f32 v112, v112, v132
    v_add_f32 v113, v113, v133
    v_mfma_f32_16x16x32_bf16 v[88:91], a[212:215], v[200:203], 0
    v_add_f32_e64 v114, v114, v134
    v_add_f32 v115, v115, v135
    s_waitcnt vmcnt(7)
    v_mfma_f32_16x16x32_bf16 v[72:75], a[104:107], v[204:207], v[72:75]
    buffer_load_dwordx4 v[188:191], v1, s[4:7], s59 offen offset:2048 sc1
    v_mfma_f32_16x16x32_bf16 v[76:79], a[132:135], v[204:207], v[76:79]
    v_add_f32 v116, v116, v136
    v_add_f32 v117, v117, v137
    v_mfma_f32_16x16x32_bf16 v[80:83], a[160:163], v[204:207], v[80:83]
    v_add_f32 v118, v118, v138
    v_add_f32 v119, v119, v139
    v_mfma_f32_16x16x32_bf16 v[84:87], a[188:191], v[204:207], v[84:87]
    v_add_f32 v120, v120, v140
    v_add_f32 v121, v121, v141
    v_mfma_f32_16x16x32_bf16 v[88:91], a[216:219], v[204:207], v[88:91]
    v_add_f32_e64 v122, v122, v142
    v_add_f32 v123, v123, v143
    s_waitcnt vmcnt(7)
    v_mfma_f32_16x16x32_bf16 v[72:75], a[108:111], v[208:211], v[72:75]
    buffer_load_dwordx4 v[192:195], v1, s[4:7], s59 offen offset:3072 sc1
    v_mfma_f32_16x16x32_bf16 v[76:79], a[136:139], v[208:211], v[76:79]
    v_add_f32 v124, v124, v144
    v_add_f32 v125, v125, v145
    v_mfma_f32_16x16x32_bf16 v[80:83], a[164:167], v[208:211], v[80:83]
    v_add_f32 v126, v126, v146
    v_add_f32 v127, v127, v147
    v_mfma_f32_16x16x32_bf16 v[84:87], a[192:195], v[208:211], v[84:87]
    v_add_f32 v128, v128, v148
    v_add_f32 v129, v129, v149
    v_mfma_f32_16x16x32_bf16 v[88:91], a[220:223], v[208:211], v[88:91]
    v_add_f32_e64 v130, v130, v150
    v_add_f32 v131, v131, v151
    s_waitcnt vmcnt(7)
    v_mfma_f32_16x16x32_bf16 v[72:75], a[112:115], v[212:215], v[72:75]
    s_add_u32 s59, s59, 4096
    buffer_load_dwordx4 v[196:199], v1, s[4:7], s59 offen offset:0 sc1
    v_mfma_f32_16x16x32_bf16 v[76:79], a[140:143], v[212:215], v[76:79]
    v_cvt_pk_bf16_f32 v172, v112, v113
    v_cvt_pk_bf16_f32 v173, v114, v115
    v_mfma_f32_16x16x32_bf16 v[80:83], a[168:171], v[212:215], v[80:83]
    v_cvt_pk_bf16_f32 v174, v116, v117
    v_cvt_pk_bf16_f32 v175, v118, v119
    v_mfma_f32_16x16x32_bf16 v[84:87], a[196:199], v[212:215], v[84:87]
    v_cvt_pk_bf16_f32 v176, v120, v121
    v_cvt_pk_bf16_f32 v177, v122, v123
    v_mfma_f32_16x16x32_bf16 v[88:91], a[224:227], v[212:215], v[88:91]
    s_cmp_eq_u32 s43, 0
    s_cbranch_scc1 L_safe_256
    buffer_store_dwordx4 v[172:175], v236, s[8:11], s55 offen offset:0
L_join_257:
    s_waitcnt vmcnt(8)
    v_mfma_f32_16x16x32_bf16 v[72:75], a[116:119], v[216:219], v[72:75]
    buffer_load_dwordx4 v[200:203], v1, s[4:7], s59 offen offset:1024 sc1
    v_mfma_f32_16x16x32_bf16 v[76:79], a[144:147], v[216:219], v[76:79]
    v_cvt_pk_bf16_f32 v178, v124, v125
    v_cvt_pk_bf16_f32 v179, v126, v127
    v_mfma_f32_16x16x32_bf16 v[80:83], a[172:175], v[216:219], v[80:83]
    v_cvt_pk_bf16_f32 v180, v128, v129
    v_cvt_pk_bf16_f32 v181, v130, v131
    v_mfma_f32_16x16x32_bf16 v[84:87], a[200:203], v[216:219], v[84:87]
    s_cmp_eq_u32 s43, 0
    s_cbranch_scc1 L_safe_258
    buffer_store_dwordx4 v[176:179], v236, s[8:11], s55 offen offset:64
L_join_259:
    v_mfma_f32_16x16x32_bf16 v[88:91], a[228:231], v[216:219], v[88:91]
    s_waitcnt vmcnt(9)
    v_mfma_f32_16x16x32_bf16 v[72:75], a[120:123], v[220:223], v[72:75]
    buffer_load_dwordx4 v[204:207], v25, s[4:7], s59 offen offset:2048 sc1
    v_mfma_f32_16x16x32_bf16 v[76:79], a[148:151], v[220:223], v[76:79]
    s_cmp_eq_u32 s43, 0
    s_cbranch_scc1 L_safe_260
    buffer_store_dwordx2 v[180:181], v237, s[8:11], s55 offen offset:128
L_join_261:
    v_mfma_f32_16x16x32_bf16 v[80:83], a[176:179], v[220:223], v[80:83]
    v_mfma_f32_16x16x32_bf16 v[84:87], a[204:207], v[220:223], v[84:87]
    v_mfma_f32_16x16x32_bf16 v[88:91], a[232:235], v[220:223], v[88:91]
    s_waitcnt vmcnt(10)
    v_mfma_f32_16x16x32_bf16 v[72:75], a[124:127], v[224:227], v[72:75]
    s_add_u32 s60, s60, s57
    buffer_load_dwordx4 v[208:211], v1, s[4:7], s60 offen offset:0 sc1
    v_mfma_f32_16x16x32_bf16 v[76:79], a[152:155], v[224:227], v[76:79]
    v_mfma_f32_16x16x32_bf16 v[80:83], a[180:183], v[224:227], v[80:83]
    v_mfma_f32_16x16x32_bf16 v[84:87], a[208:211], v[224:227], v[84:87]
    v_mfma_f32_16x16x32_bf16 v[88:91], a[236:239], v[224:227], v[88:91]
    s_waitcnt vmcnt(10)
    v_mfma_f32_16x16x32_bf16 v[92:95], a[100:103], v[228:231], 0
    buffer_load_dwordx4 v[212:215], v1, s[4:7], s60 offen offset:1024 sc1
    v_mfma_f32_16x16x32_bf16 v[96:99], a[128:131], v[228:231], 0
    v_mfma_f32_16x16x32_bf16 v[100:103], a[156:159], v[228:231], 0
    ds_write_b128 v52, v[72:75] offset:0
    v_mfma_f32_16x16x32_bf16 v[104:107], a[184:187], v[228:231], 0
    v_mfma_f32_16x16x32_bf16 v[108:111], a[212:215], v[228:231], 0
    ds_write_b128 v52, v[76:79] offset:1024
    s_waitcnt vmcnt(10)
    v_mfma_f32_16x16x32_bf16 v[92:95], a[104:107], v[184:187], v[92:95]
    buffer_load_dwordx4 v[216:219], v1, s[4:7], s60 offen offset:2048 sc1
    v_mfma_f32_16x16x32_bf16 v[96:99], a[132:135], v[184:187], v[96:99]
    v_mfma_f32_16x16x32_bf16 v[100:103], a[160:163], v[184:187], v[100:103]
    ds_write_b128 v52, v[80:83] offset:2048
    v_mfma_f32_16x16x32_bf16 v[104:107], a[188:191], v[184:187], v[104:107]
    v_mfma_f32_16x16x32_bf16 v[108:111], a[216:219], v[184:187], v[108:111]
    ds_write_b128 v52, v[84:87] offset:3072
    s_waitcnt vmcnt(10)
    v_mfma_f32_16x16x32_bf16 v[92:95], a[108:111], v[188:191], v[92:95]
    buffer_load_dwordx4 v[220:223], v1, s[4:7], s60 offen offset:3072 sc1
    v_mfma_f32_16x16x32_bf16 v[96:99], a[136:139], v[188:191], v[96:99]
    v_mfma_f32_16x16x32_bf16 v[100:103], a[164:167], v[188:191], v[100:103]
    ds_write_b128 v52, v[88:91] offset:4096
    v_mfma_f32_16x16x32_bf16 v[104:107], a[192:195], v[188:191], v[104:107]
    v_mfma_f32_16x16x32_bf16 v[108:111], a[220:223], v[188:191], v[108:111]
    s_waitcnt vmcnt(10)
    v_mfma_f32_16x16x32_bf16 v[92:95], a[112:115], v[192:195], v[92:95]
    s_add_u32 s60, s60, 4096
    buffer_load_dwordx4 v[224:227], v1, s[4:7], s60 offen offset:0 sc1
    v_mfma_f32_16x16x32_bf16 v[96:99], a[140:143], v[192:195], v[96:99]
    v_mfma_f32_16x16x32_bf16 v[100:103], a[168:171], v[192:195], v[100:103]
    v_mfma_f32_16x16x32_bf16 v[104:107], a[196:199], v[192:195], v[104:107]
    v_mfma_f32_16x16x32_bf16 v[108:111], a[224:227], v[192:195], v[108:111]
    s_waitcnt vmcnt(10)
    v_mfma_f32_16x16x32_bf16 v[92:95], a[116:119], v[196:199], v[92:95]
    buffer_load_dwordx4 v[228:231], v1, s[4:7], s60 offen offset:1024 sc1
    v_mfma_f32_16x16x32_bf16 v[96:99], a[144:147], v[196:199], v[96:99]
    s_waitcnt vmcnt(6)
    s_cmp_eq_u32 s43, 0
    s_cbranch_scc1 L_safe_262
    buffer_store_dword v0, v14, s[4:7], s53 offen offset:0
L_join_263:
    v_mfma_f32_16x16x32_bf16 v[100:103], a[172:175], v[196:199], v[100:103]
    v_mfma_f32_16x16x32_bf16 v[104:107], a[200:203], v[196:199], v[104:107]
    v_mfma_f32_16x16x32_bf16 v[108:111], a[228:231], v[196:199], v[108:111]
    v_mfma_f32_16x16x32_bf16 v[92:95], a[120:123], v[200:203], v[92:95]
    buffer_load_dwordx4 v[184:187], v25, s[4:7], s60 offen offset:2048 sc1
    v_mfma_f32_16x16x32_bf16 v[96:99], a[148:151], v[200:203], v[96:99]
    v_mfma_f32_16x16x32_bf16 v[100:103], a[176:179], v[200:203], v[100:103]
    v_mfma_f32_16x16x32_bf16 v[104:107], a[204:207], v[200:203], v[104:107]
    v_mfma_f32_16x16x32_bf16 v[108:111], a[232:235], v[200:203], v[108:111]
    v_mfma_f32_16x16x32_bf16 v[92:95], a[124:127], v[204:207], v[92:95]
    s_add_u32 s61, s61, s57
    buffer_load_dwordx4 v[188:191], v1, s[4:7], s61 offen offset:0 sc1
    v_mfma_f32_16x16x32_bf16 v[96:99], a[152:155], v[204:207], v[96:99]
    v_mfma_f32_16x16x32_bf16 v[100:103], a[180:183], v[204:207], v[100:103]
    v_mfma_f32_16x16x32_bf16 v[104:107], a[208:211], v[204:207], v[104:107]
    v_mfma_f32_16x16x32_bf16 v[108:111], a[236:239], v[204:207], v[108:111]
    s_waitcnt vmcnt(8)
    v_mfma_f32_16x16x32_bf16 v[72:75], a[100:103], v[208:211], 0
    buffer_load_dwordx4 v[192:195], v1, s[4:7], s61 offen offset:1024 sc1
    v_mfma_f32_16x16x32_bf16 v[76:79], a[128:131], v[208:211], 0
    v_mfma_f32_16x16x32_bf16 v[80:83], a[156:159], v[208:211], 0
    ds_write_b128 v53, v[92:95] offset:0
    v_mfma_f32_16x16x32_bf16 v[84:87], a[184:187], v[208:211], 0
    v_mfma_f32_16x16x32_bf16 v[88:91], a[212:215], v[208:211], 0
    ds_write_b128 v53, v[96:99] offset:1024
    s_waitcnt vmcnt(8)
    v_mfma_f32_16x16x32_bf16 v[72:75], a[104:107], v[212:215], v[72:75]
    buffer_load_dwordx4 v[196:199], v1, s[4:7], s61 offen offset:2048 sc1
    v_mfma_f32_16x16x32_bf16 v[76:79], a[132:135], v[212:215], v[76:79]
    v_mfma_f32_16x16x32_bf16 v[80:83], a[160:163], v[212:215], v[80:83]
    ds_write_b128 v53, v[100:103] offset:2048
    v_mfma_f32_16x16x32_bf16 v[84:87], a[188:191], v[212:215], v[84:87]
    v_mfma_f32_16x16x32_bf16 v[88:91], a[216:219], v[212:215], v[88:91]
    ds_write_b128 v53, v[104:107] offset:3072
    s_waitcnt vmcnt(8)
    v_mfma_f32_16x16x32_bf16 v[72:75], a[108:111], v[216:219], v[72:75]
    buffer_load_dwordx4 v[200:203], v1, s[4:7], s61 offen offset:3072 sc1
    v_mfma_f32_16x16x32_bf16 v[76:79], a[136:139], v[216:219], v[76:79]
    v_mfma_f32_16x16x32_bf16 v[80:83], a[164:167], v[216:219], v[80:83]
    buffer_load_dword v27, v14, s[4:7], s65 offen sc1
    ds_write_b128 v53, v[108:111] offset:4096
    v_mfma_f32_16x16x32_bf16 v[84:87], a[192:195], v[216:219], v[84:87]
    v_mfma_f32_16x16x32_bf16 v[88:91], a[220:223], v[216:219], v[88:91]
    s_waitcnt vmcnt(9)
    v_mfma_f32_16x16x32_bf16 v[72:75], a[112:115], v[220:223], v[72:75]
    s_add_u32 s61, s61, 4096
    buffer_load_dwordx4 v[204:207], v1, s[4:7], s61 offen offset:0 sc1
    v_mfma_f32_16x16x32_bf16 v[76:79], a[140:143], v[220:223], v[76:79]
    v_mfma_f32_16x16x32_bf16 v[80:83], a[168:171], v[220:223], v[80:83]
    s_waitcnt lgkmcnt(0)
    s_barrier
    v_mfma_f32_16x16x32_bf16 v[84:87], a[196:199], v[220:223], v[84:87]
    ds_read_b128 v[112:115], v55 offset:0
    v_mfma_f32_16x16x32_bf16 v[88:91], a[224:227], v[220:223], v[88:91]
    ds_read_b128 v[116:119], v55 offset:1024
    s_waitcnt vmcnt(9)
    v_mfma_f32_16x16x32_bf16 v[72:75], a[116:119], v[224:227], v[72:75]
    buffer_load_dwordx4 v[208:211], v1, s[4:7], s61 offen offset:1024 sc1
    v_mfma_f32_16x16x32_bf16 v[76:79], a[144:147], v[224:227], v[76:79]
    ds_read_b128 v[120:123], v55 offset:2048
    v_mfma_f32_16x16x32_bf16 v[80:83], a[172:175], v[224:227], v[80:83]
    ds_read_b128 v[124:127], v55 offset:3072
    v_mfma_f32_16x16x32_bf16 v[84:87], a[200:203], v[224:227], v[84:87]
    ds_read_b128 v[128:131], v55 offset:4096
    v_mfma_f32_16x16x32_bf16 v[88:91], a[228:231], v[224:227], v[88:91]
    ds_read_b128 v[132:135], v55 offset:5120
    s_waitcnt vmcnt(9)
    v_mfma_f32_16x16x32_bf16 v[72:75], a[120:123], v[228:231], v[72:75]
    buffer_load_dwordx4 v[212:215], v25, s[4:7], s61 offen offset:2048 sc1
    v_mfma_f32_16x16x32_bf16 v[76:79], a[148:151], v[228:231], v[76:79]
    ds_read_b128 v[136:139], v55 offset:6144
    v_mfma_f32_16x16x32_bf16 v[80:83], a[176:179], v[228:231], v[80:83]
    ds_read_b128 v[140:143], v55 offset:7168
    v_mfma_f32_16x16x32_bf16 v[84:87], a[204:207], v[228:231], v[84:87]
    ds_read_b128 v[144:147], v55 offset:8192
    v_mfma_f32_16x16x32_bf16 v[88:91], a[232:235], v[228:231], v[88:91]
    ds_read_b128 v[148:151], v55 offset:9216
    s_waitcnt vmcnt(8)
    v_mfma_f32_16x16x32_bf16 v[72:75], a[124:127], v[184:187], v[72:75]
    v_mfma_f32_16x16x32_bf16 v[76:79], a[152:155], v[184:187], v[76:79]
    v_mfma_f32_16x16x32_bf16 v[80:83], a[180:183], v[184:187], v[80:83]
    v_mfma_f32_16x16x32_bf16 v[84:87], a[208:211], v[184:187], v[84:87]
    v_mfma_f32_16x16x32_bf16 v[88:91], a[236:239], v[184:187], v[88:91]
    s_waitcnt vmcnt(7)
    v_mfma_f32_16x16x32_bf16 v[32:35], a[100:103], v[188:191], v[32:35]
    v_mfma_f32_16x16x32_bf16 v[36:39], a[128:131], v[188:191], v[36:39]
    s_waitcnt lgkmcnt(3)
    v_add_f32 v112, v112, v132
    v_add_f32 v113, v113, v133
    v_mfma_f32_16x16x32_bf16 v[40:43], a[156:159], v[188:191], v[40:43]
    s_waitcnt vmcnt(3)
    v_sub_u32 v27, v27, v15
    v_cmp_ne_u32 vcc, 14, v27
    s_nop 0
    s_and_b32 vcc_hi, vcc_lo, 1
    s_cbranch_scc0 L_pxok_264
L_poll_265:
    buffer_load_dword v26, v14, s[4:7], s65 offen offset:0 sc1
    s_waitcnt vmcnt(0)
    v_sub_u32 v26, v26, v15
    v_cmp_ne_u32_e64 vcc, 14, v26
    s_nop 0
    s_and_b32 vcc_hi, vcc_lo, 1
    s_cbranch_scc0 L_polled_266
    s_sub_u32 s44, s44, 1
    s_cbranch_scc0 L_poll_265
    s_mov_b32 s44, 0
L_polled_266:
L_pxok_264:
    buffer_load_dwordx4 v[172:175], v236, s[8:11], s54 offen offset:0 sc1
    buffer_load_dwordx4 v[176:179], v236, s[8:11], s54 offen offset:64 sc1
    buffer_load_dwordx2 v[180:181], v237, s[8:11], s54 offen offset:128 sc1
    v_add_u32_e64 v0, 15, v15
    s_branch L_over_465
L_chain6_1_3:
    s_branch L_chainret6
L_over_465:
    ds_write_b128 v54, v[72:75] offset:0
    v_mfma_f32_16x16x32_bf16 v[44:47], a[184:187], v[188:191], v[44:47]
    v_add_f32 v114, v114, v134
    v_add_f32 v115, v115, v135
    v_mfma_f32_16x16x32_bf16 v[48:51], a[212:215], v[188:191], v[48:51]
    ds_write_b128 v54, v[76:79] offset:1024
    v_mfma_f32_16x16x32_bf16 v[32:35], a[104:107], v[192:195], v[32:35]
    s_waitcnt lgkmcnt(4)
    v_add_f32 v116, v116, v136
    v_add_f32_e64 v117, v117, v137
    v_mfma_f32_16x16x32_bf16 v[36:39], a[132:135], v[192:195], v[36:39]
    v_add_f32 v118, v118, v138
    v_add_f32 v119, v119, v139
    v_mfma_f32_16x16x32_bf16 v[40:43], a[160:163], v[192:195], v[40:43]
    ds_write_b128 v54, v[80:83] offset:2048
    v_mfma_f32_16x16x32_bf16 v[44:47], a[188:191], v[192:195], v[44:47]
    s_waitcnt lgkmcnt(4)
    v_add_f32 v120, v120, v140
    v_add_f32_e64 v121, v121, v141
    v_mfma_f32_16x16x32_bf16 v[48:51], a[216:219], v[192:195], v[48:51]
    ds_write_b128 v54, v[84:87] offset:3072
    v_mfma_f32_16x16x32_bf16 v[32:35], a[108:111], v[196:199], v[32:35]
    v_add_f32 v122, v122, v142
    v_add_f32 v123, v123, v143
    v_mfma_f32_16x16x32_bf16 v[36:39], a[136:139], v[196:199], v[36:39]
    s_waitcnt lgkmcnt(4)
    v_add_f32 v124, v124, v144
    v_add_f32_e64 v125, v125, v145
    v_mfma_f32_16x16x32_bf16 v[40:43], a[164:167], v[196:199], v[40:43]
    ds_write_b128 v54, v[88:91] offset:4096
    v_mfma_f32_16x16x32_bf16 v[44:47], a[192:195], v[196:199], v[44:47]
    v_add_f32 v126, v126, v146
    v_add_f32 v127, v127, v147
    v_mfma_f32_16x16x32_bf16 v[48:51], a[220:223], v[196:199], v[48:51]
    v_add_f32 v128, v128, v148
    v_add_f32 v129, v129, v149
    v_mfma_f32_16x16x32_bf16 v[32:35], a[112:115], v[200:203], v[32:35]
    v_add_f32 v130, v130, v150
    v_add_f32 v131, v131, v151
    v_mfma_f32_16x16x32_bf16 v[36:39], a[140:143], v[200:203], v[36:39]
    v_mfma_f32_16x16x32_bf16 v[40:43], a[168:171], v[200:203], v[40:43]
    s_waitcnt lgkmcnt(0)
    s_barrier
    v_mfma_f32_16x16x32_bf16 v[44:47], a[196:199], v[200:203], v[44:47]
    ds_read_b128 v[152:155], v55 offset:10240
    v_mfma_f32_16x16x32_bf16 v[48:51], a[224:227], v[200:203], v[48:51]
    ds_read_b128 v[156:159], v55 offset:11264
    s_waitcnt vmcnt(5)
    v_mfma_f32_16x16x32_bf16 v[32:35], a[116:119], v[204:207], v[32:35]
    ds_read_b128 v[160:163], v55 offset:12288
    v_mfma_f32_16x16x32_bf16 v[36:39], a[144:147], v[204:207], v[36:39]
    ds_read_b128 v[164:167], v55 offset:13312
    v_mfma_f32_16x16x32_bf16 v[40:43], a[172:175], v[204:207], v[40:43]
    ds_read_b128 v[168:171], v55 offset:14336
    v_mfma_f32_16x16x32_bf16 v[44:47], a[200:203], v[204:207], v[44:47]
    v_mfma_f32_16x16x32_bf16 v[48:51], a[228:231], v[204:207], v[48:51]
    s_waitcnt vmcnt(4)
    v_mfma_f32_16x16x32_bf16 v[32:35], a[120:123], v[208:211], v[32:35]
    v_mfma_f32_16x16x32_bf16 v[36:39], a[148:151], v[208:211], v[36:39]
    s_waitcnt lgkmcnt(3)
    v_add_f32 v112, v112, v152
    v_add_f32_e64 v113, v113, v153
    v_mfma_f32_16x16x32_bf16 v[40:43], a[176:179], v[208:211], v[40:43]
    v_add_f32 v114, v114, v154
    v_add_f32 v115, v115, v155
    v_mfma_f32_16x16x32_bf16 v[44:47], a[204:207], v[208:211], v[44:47]
    s_waitcnt lgkmcnt(2)
    v_add_f32 v116, v116, v156
    v_add_f32_e64 v117, v117, v157
    v_mfma_f32_16x16x32_bf16 v[48:51], a[232:235], v[208:211], v[48:51]
    v_add_f32_e64 v118, v118, v158
    v_add_f32 v119, v119, v159
    s_waitcnt vmcnt(3)
    v_mfma_f32_16x16x32_bf16 v[32:35], a[124:127], v[212:215], v[32:35]
    s_waitcnt lgkmcnt(1)
    v_add_f32 v120, v120, v160
    v_add_f32_e64 v121, v121, v161
    v_mfma_f32_16x16x32_bf16 v[36:39], a[152:155], v[212:215], v[36:39]
    v_add_f32 v122, v122, v162
    v_add_f32 v123, v123, v163
    v_mfma_f32_16x16x32_bf16 v[40:43], a[180:183], v[212:215], v[40:43]
    s_waitcnt lgkmcnt(0)
    v_add_f32 v124, v124, v164
    v_add_f32_e64 v125, v125, v165
    v_mfma_f32_16x16x32_bf16 v[44:47], a[208:211], v[212:215], v[44:47]
    v_add_f32 v126, v126, v166
    v_add_f32 v127, v127, v167
    v_mfma_f32_16x16x32_bf16 v[48:51], a[236:239], v[212:215], v[48:51]
    v_add_f32_e64 v128, v128, v168
    v_add_f32 v129, v129, v169
    s_waitcnt vmcnt(0)
    v_mfma_f32_16x16x32_bf16 v[32:35], a[242:245], v[172:175], v[32:35]
    v_add_f32 v130, v130, v170
    v_add_f32 v131, v131, v171
    v_mfma_f32_16x16x32_bf16 v[36:39], a[240:243], v[172:175], v[36:39]
    v_mfma_f32_16x16x32_bf16 v[40:43], a[242:245], v[176:179], v[40:43]
    v_mfma_f32_16x16x32_bf16 v[44:47], a[240:243], v[176:179], v[44:47]
    v_mfma_f32_16x16x32_bf16 v[48:51], a[240:243], v[178:181], v[48:51]
    s_nop 1
    v_pk_add_f32 v[32:33], v[32:33], v[112:113]
    v_pk_add_f32 v[34:35], v[34:35], v[114:115]
    s_nop 0
    v_pk_add_f32 v[36:37], v[36:37], v[116:117]
    v_pk_add_f32 v[38:39], v[38:39], v[118:119]
    v_pk_add_f32 v[40:41], v[40:41], v[120:121]
    v_pk_add_f32 v[42:43], v[42:43], v[122:123]
    v_pk_add_f32 v[44:45], v[44:45], v[124:125]
    v_pk_add_f32 v[46:47], v[46:47], v[126:127]
    v_pk_add_f32 v[48:49], v[48:49], v[128:129]
    v_pk_add_f32 v[50:51], v[50:51], v[130:131]
    v_cvt_pk_bf16_f32 v56, v32, v33
    v_cvt_pk_bf16_f32 v57, v34, v35
    ds_write_b64 v239, v[56:57] offset:0
    v_cvt_pk_bf16_f32 v58, v36, v37
    v_cvt_pk_bf16_f32 v59, v38, v39
    ds_write_b64 v239, v[58:59] offset:32
    v_cvt_pk_bf16_f32 v60, v40, v41
    v_cvt_pk_bf16_f32 v61, v42, v43
    ds_write_b64 v239, v[60:61] offset:64
    v_cvt_pk_bf16_f32 v62, v44, v45
    v_cvt_pk_bf16_f32 v63, v46, v47
    ds_write_b64 v239, v[62:63] offset:96
    v_cvt_pk_bf16_f32 v64, v48, v49
    v_cvt_pk_bf16_f32 v65, v50, v51
    ds_write_b64 v239, v[64:65] offset:128
    ds_read_b128 v[68:71], v238
    ds_read_b128 v[72:75], v238 offset:64
    ds_read_b64 v[76:77], v240 offset:128
    s_waitcnt lgkmcnt(2)
    buffer_store_dwordx4 v[68:71], v236, s[8:11], s54 offen offset:0 nt
    s_waitcnt lgkmcnt(1)
    buffer_store_dwordx4 v[72:75], v236, s[8:11], s54 offen offset:64 nt
    s_waitcnt lgkmcnt(0)
    buffer_store_dwordx2 v[76:77], v237, s[8:11], s54 offen offset:128 nt
    s_cmp_lg_u32 s2, 0
    s_cbranch_scc1 L_noepo_267
    s_add_u32 s64, s48, 1
    v_mov_b32_e64 v27, s64
    buffer_store_dword v27, v14, s[4:7], 0 offen offset:0 sc1
L_noepo_267:
L_end:
    s_endpgm
L_hotend:
L_ph10:
L_ph11:
L_safe_42:
    buffer_store_dwordx4 v[172:175], v5, s[4:7], s54 offen offset:0 sc1
    buffer_store_dwordx2 v[176:177], v6, s[4:7], s54 offen offset:512 sc1
    s_branch L_join_43
L_safe_45:
    buffer_store_dword v0, v14, s[4:7], s41 offen offset:0 sc1
    s_branch L_join_46
L_safe_49:
    buffer_store_dwordx4 v[172:175], v5, s[4:7], s54 offen offset:0 sc1
    buffer_store_dwordx2 v[176:177], v6, s[4:7], s54 offen offset:512 sc1
    s_branch L_join_50
L_fallback_47:
    s_cmp_eq_u32 s37, 0
    s_cselect_b32 s63, 8, 0
    v_mov_b32 v184, 0xff800000
L_fbl_268:
    s_mul_i32 s62, s63, 3072
    v_add_u32 v180, s62, v16
    v_add_u32 v181, s62, v18
    v_add_u32 v182, s62, v19
    v_add_u32 v183, s62, v20
    ds_read_b128 v[136:139], v180
    ds_read_b64 v[140:141], v181
    ds_read_b64_tr_b16 v[152:153], v182 offset:0
    ds_read_b64_tr_b16 v[154:155], v183 offset:0
    ds_read_b64_tr_b16 v[156:157], v182 offset:256
    ds_read_b64_tr_b16 v[158:159], v183 offset:256
    s_waitcnt lgkmcnt(0)
    s_cmp_lg_u32 s63, 0
    s_cbranch_scc1 L_fbnf_269
    v_mfma_f32_32x32x16_bf16 v[88:103], v[136:139], v[240:243], v[208:223]
    s_branch L_fbgo_271
L_fbnf_269:
    s_cmp_lg_u32 s63, 8
    s_cbranch_scc1 L_fbnd_270
    v_mfma_f32_32x32x16_bf16 v[88:103], v[136:139], v[240:243], v[192:207]
    s_branch L_fbgo_271
L_fbnd_270:
    v_mfma_f32_32x32x16_bf16 v[88:103], v[136:139], v[240:243], 0
L_fbgo_271:
    v_mfma_f32_32x32x8bf16_1k v[88:103], v[140:141], v[244:245], v[88:103]
    s_nop 11
    v_max3_f32 v184, v88, v89, v184
    v_max3_f32 v184, v90, v91, v184
    v_max3_f32 v184, v92, v93, v184
    v_max3_f32 v184, v94, v95, v184
    v_max3_f32 v184, v96, v97, v184
    v_max3_f32 v184, v98, v99, v184
    v_max3_f32 v184, v100, v101, v184
    v_max3_f32 v184, v102, v103, v184
    s_add_u32 s63, s63, 1
    s_cmp_le_u32 s63, 8
    s_cbranch_scc1 L_fbl_268
    v_mov_b32 v185, v184
    s_nop 1
    v_permlane32_swap_b32 v184, v185
    v_max_f32 v184, v184, v185
    s_cmp_eq_u32 s37, 0
    s_cselect_b32 s63, 8, 0
    v_mov_b32 v56, 0
    v_mov_b32 v57, 0
    v_mov_b32 v58, 0
    v_mov_b32 v59, 0
    v_mov_b32 v60, 0
    v_mov_b32 v61, 0
    v_mov_b32 v62, 0
    v_mov_b32 v63, 0
    v_mov_b32 v64, 0
    v_mov_b32 v65, 0
    v_mov_b32 v66, 0
    v_mov_b32 v67, 0
    v_mov_b32 v68, 0
    v_mov_b32 v69, 0
    v_mov_b32 v70, 0
    v_mov_b32 v71, 0
L_fbl_272:
    s_mul_i32 s62, s63, 3072
    v_add_u32 v180, s62, v16
    v_add_u32 v181, s62, v18
    v_add_u32 v182, s62, v19
    v_add_u32 v183, s62, v20
    ds_read_b128 v[136:139], v180
    ds_read_b64 v[140:141], v181
    ds_read_b64_tr_b16 v[152:153], v182 offset:0
    ds_read_b64_tr_b16 v[154:155], v183 offset:0
    ds_read_b64_tr_b16 v[156:157], v182 offset:256
    ds_read_b64_tr_b16 v[158:159], v183 offset:256
    s_waitcnt lgkmcnt(0)
    s_cmp_lg_u32 s63, 0
    s_cbranch_scc1 L_fbnf_273
    v_mfma_f32_32x32x16_bf16 v[88:103], v[136:139], v[240:243], v[208:223]
    s_branch L_fbgo_275
L_fbnf_273:
    s_cmp_lg_u32 s63, 8
    s_cbranch_scc1 L_fbnd_274
    v_mfma_f32_32x32x16_bf16 v[88:103], v[136:139], v[240:243], v[192:207]
    s_branch L_fbgo_275
L_fbnd_274:
    v_mfma_f32_32x32x16_bf16 v[88:103], v[136:139], v[240:243], 0
L_fbgo_275:
    v_mfma_f32_32x32x8bf16_1k v[88:103], v[140:141], v[244:245], v[88:103]
    s_nop 11
    v_sub_f32 v88, v88, v184
    v_sub_f32 v89, v89, v184
    v_sub_f32 v90, v90, v184
    v_sub_f32 v91, v91, v184
    v_sub_f32 v92, v92, v184
    v_sub_f32 v93, v93, v184
    v_sub_f32 v94, v94, v184
    v_sub_f32 v95, v95, v184
    v_sub_f32 v96, v96, v184
    v_sub_f32 v97, v97, v184
    v_sub_f32 v98, v98, v184
    v_sub_f32 v99, v99, v184
    v_sub_f32 v100, v100, v184
    v_sub_f32 v101, v101, v184
    v_sub_f32 v102, v102, v184
    v_sub_f32 v103, v103, v184
    v_exp_f32 v88, v88
    v_exp_f32 v89, v89
    v_exp_f32 v90, v90
    v_exp_f32 v91, v91
    v_exp_f32 v92, v92
    v_exp_f32 v93, v93
    v_exp_f32 v94, v94
    v_exp_f32 v95, v95
    v_exp_f32 v96, v96
    v_exp_f32 v97, v97
    v_exp_f32 v98, v98
    v_exp_f32 v99, v99
    v_exp_f32 v100, v100
    v_exp_f32 v101, v101
    v_exp_f32 v102, v102
    v_exp_f32 v103, v103
    v_cvt_pk_bf16_f32 v120, v88, v89
    v_cvt_pk_bf16_f32 v121, v90, v91
    v_cvt_pk_bf16_f32 v122, v92, v93
    v_cvt_pk_bf16_f32 v123, v94, v95
    v_cvt_pk_bf16_f32 v124, v96, v97
    v_cvt_pk_bf16_f32 v125, v98, v99
    v_cvt_pk_bf16_f32 v126, v100, v101
    v_cvt_pk_bf16_f32 v127, v102, v103
    v_mfma_f32_32x32x16_bf16 v[56:71], v[152:155], v[120:123], v[56:71]
    s_nop 0
    v_mfma_f32_32x32x16_bf16 v[56:71], v[156:159], v[124:127], v[56:71]
    s_add_u32 s63, s63, 1
    s_cmp_le_u32 s63, 8
    s_cbranch_scc1 L_fbl_272
    s_cmp_eq_u32 s37, 0
    s_cselect_b32 s63, 8, 7
    v_mov_b32 v184, 0xff800000
L_fbl_276:
    s_mul_i32 s62, s63, 3072
    v_add_u32 v180, s62, v16
    v_add_u32 v181, s62, v18
    v_add_u32 v182, s62, v19
    v_add_u32 v183, s62, v20
    ds_read_b128 v[136:139], v180
    ds_read_b64 v[140:141], v181
    ds_read_b64_tr_b16 v[152:153], v182 offset:0
    ds_read_b64_tr_b16 v[154:155], v183 offset:0
    ds_read_b64_tr_b16 v[156:157], v182 offset:256
    ds_read_b64_tr_b16 v[158:159], v183 offset:256
    s_waitcnt lgkmcnt(0)
    s_cmp_lg_u32 s63, 7
    s_cbranch_scc1 L_fbnf_277
    v_mfma_f32_32x32x16_bf16 v[88:103], v[136:139], v[248:251], v[208:223]
    s_branch L_fbgo_279
L_fbnf_277:
    s_cmp_lg_u32 s63, 15
    s_cbranch_scc1 L_fbnd_278
    v_mfma_f32_32x32x16_bf16 v[88:103], v[136:139], v[248:251], v[192:207]
    s_branch L_fbgo_279
L_fbnd_278:
    v_mfma_f32_32x32x16_bf16 v[88:103], v[136:139], v[248:251], 0
L_fbgo_279:
    v_mfma_f32_32x32x8bf16_1k v[88:103], v[140:141], v[252:253], v[88:103]
    s_nop 11
    v_max3_f32 v184, v88, v89, v184
    v_max3_f32 v184, v90, v91, v184
    v_max3_f32 v184, v92, v93, v184
    v_max3_f32 v184, v94, v95, v184
    v_max3_f32 v184, v96, v97, v184
    v_max3_f32 v184, v98, v99, v184
    v_max3_f32 v184, v100, v101, v184
    v_max3_f32 v184, v102, v103, v184
    s_add_u32 s63, s63, 1
    s_cmp_le_u32 s63, 15
    s_cbranch_scc1 L_fbl_276
    v_mov_b32 v185, v184
    s_nop 1
    v_permlane32_swap_b32 v184, v185
    v_max_f32 v184, v184, v185
    s_cmp_eq_u32 s37, 0
    s_cselect_b32 s63, 8, 7
    v_mov_b32 v72, 0
    v_mov_b32 v73, 0
    v_mov_b32 v74, 0
    v_mov_b32 v75, 0
    v_mov_b32 v76, 0
    v_mov_b32 v77, 0
    v_mov_b32 v78, 0
    v_mov_b32 v79, 0
    v_mov_b32 v80, 0
    v_mov_b32 v81, 0
    v_mov_b32 v82, 0
    v_mov_b32 v83, 0
    v_mov_b32 v84, 0
    v_mov_b32 v85, 0
    v_mov_b32 v86, 0
    v_mov_b32 v87, 0
L_fbl_280:
    s_mul_i32 s62, s63, 3072
    v_add_u32 v180, s62, v16
    v_add_u32 v181, s62, v18
    v_add_u32 v182, s62, v19
    v_add_u32 v183, s62, v20
    ds_read_b128 v[136:139], v180
    ds_read_b64 v[140:141], v181
    ds_read_b64_tr_b16 v[152:153], v182 offset:0
    ds_read_b64_tr_b16 v[154:155], v183 offset:0
    ds_read_b64_tr_b16 v[156:157], v182 offset:256
    ds_read_b64_tr_b16 v[158:159], v183 offset:256
    s_waitcnt lgkmcnt(0)
    s_cmp_lg_u32 s63, 7
    s_cbranch_scc1 L_fbnf_281
    v_mfma_f32_32x32x16_bf16 v[88:103], v[136:139], v[248:251], v[208:223]
    s_branch L_fbgo_283
L_fbnf_281:
    s_cmp_lg_u32 s63, 15
    s_cbranch_scc1 L_fbnd_282
    v_mfma_f32_32x32x16_bf16 v[88:103], v[136:139], v[248:251], v[192:207]
    s_branch L_fbgo_283
L_fbnd_282:
    v_mfma_f32_32x32x16_bf16 v[88:103], v[136:139], v[248:251], 0
L_fbgo_283:
    v_mfma_f32_32x32x8bf16_1k v[88:103], v[140:141], v[252:253], v[88:103]
    s_nop 11
    v_sub_f32 v88, v88, v184
    v_sub_f32 v89, v89, v184
    v_sub_f32 v90, v90, v184
    v_sub_f32 v91, v91, v184
    v_sub_f32 v92, v92, v184
    v_sub_f32 v93, v93, v184
    v_sub_f32 v94, v94, v184
    v_sub_f32 v95, v95, v184
    v_sub_f32 v96, v96, v184
    v_sub_f32 v97, v97, v184
    v_sub_f32 v98, v98, v184
    v_sub_f32 v99, v99, v184
    v_sub_f32 v100, v100, v184
    v_sub_f32 v101, v101, v184
    v_sub_f32 v102, v102, v184
    v_sub_f32 v103, v103, v184
    v_exp_f32 v88, v88
    v_exp_f32 v89, v89
    v_exp_f32 v90, v90
    v_exp_f32 v91, v91
    v_exp_f32 v92, v92
    v_exp_f32 v93, v93
    v_exp_f32 v94, v94
    v_exp_f32 v95, v95
    v_exp_f32 v96, v96
    v_exp_f32 v97, v97
    v_exp_f32 v98, v98
    v_exp_f32 v99, v99
    v_exp_f32 v100, v100
    v_exp_f32 v101, v101
    v_exp_f32 v102, v102
    v_exp_f32 v103, v103
    v_cvt_pk_bf16_f32 v120, v88, v89
    v_cvt_pk_bf16_f32 v121, v90, v91
    v_cvt_pk_bf16_f32 v122, v92, v93
    v_cvt_pk_bf16_f32 v123, v94, v95
    v_cvt_pk_bf16_f32 v124, v96, v97
    v_cvt_pk_bf16_f32 v125, v98, v99
    v_cvt_pk_bf16_f32 v126, v100, v101
    v_cvt_pk_bf16_f32 v127, v102, v103
    v_mfma_f32_32x32x16_bf16 v[72:87], v[152:155], v[120:123], v[72:87]
    s_nop 0
    v_mfma_f32_32x32x16_bf16 v[72:87], v[156:159], v[124:127], v[72:87]
    s_add_u32 s63, s63, 1
    s_cmp_le_u32 s63, 15
    s_cbranch_scc1 L_fbl_280
    s_cmp_eq_u32 s26, 0
    s_cbranch_scc1 L_hikept_284
    s_nop 6
    v_rcp_f32 v86, v84
    s_add_u32 s54, s56, 8960
    v_pk_mul_f32 v[72:73], v[72:73], v[86:87] op_sel_hi:[1,0]
    v_pk_mul_f32 v[74:75], v[74:75], v[86:87] op_sel_hi:[1,0]
    v_pk_mul_f32 v[76:77], v[76:77], v[86:87] op_sel_hi:[1,0]
    v_pk_mul_f32 v[78:79], v[78:79], v[86:87] op_sel_hi:[1,0]
    v_pk_mul_f32 v[80:81], v[80:81], v[86:87] op_sel_hi:[1,0]
    v_pk_mul_f32 v[82:83], v[82:83], v[86:87] op_sel_hi:[1,0]
    v_cvt_pk_bf16_f32 v172, v72, v73
    v_cvt_pk_bf16_f32 v173, v74, v75
    v_cvt_pk_bf16_f32 v174, v76, v77
    v_cvt_pk_bf16_f32 v175, v78, v79
    v_cvt_pk_bf16_f32 v176, v80, v81
    v_cvt_pk_bf16_f32 v177, v82, v83
    s_cmp_eq_u32 s43, 0
    s_cbranch_scc1 L_safe_285
    buffer_store_dwordx4 v[172:175], v5, s[4:7], s54 offen offset:0
    buffer_store_dwordx2 v[176:177], v6, s[4:7], s54 offen offset:512
L_join_286:
L_hikept_284:
    v_rcp_f32 v70, v68
    s_add_u32 s54, s56, 0
    v_pk_mul_f32 v[56:57], v[56:57], v[70:71] op_sel_hi:[1,0]
    v_pk_mul_f32 v[58:59], v[58:59], v[70:71] op_sel_hi:[1,0]
    v_pk_mul_f32 v[60:61], v[60:61], v[70:71] op_sel_hi:[1,0]
    v_pk_mul_f32 v[62:63], v[62:63], v[70:71] op_sel_hi:[1,0]
    v_pk_mul_f32 v[64:65], v[64:65], v[70:71] op_sel_hi:[1,0]
    v_pk_mul_f32 v[66:67], v[66:67], v[70:71] op_sel_hi:[1,0]
    v_cvt_pk_bf16_f32 v172, v56, v57
    v_cvt_pk_bf16_f32 v173, v58, v59
    v_cvt_pk_bf16_f32 v174, v60, v61
    v_cvt_pk_bf16_f32 v175, v62, v63
    v_cvt_pk_bf16_f32 v176, v64, v65
    v_cvt_pk_bf16_f32 v177, v66, v67
    s_cmp_eq_u32 s43, 0
    s_cbranch_scc1 L_safe_287
    buffer_store_dwordx4 v[172:175], v5, s[4:7], s54 offen offset:0
    buffer_store_dwordx2 v[176:177], v6, s[4:7], s54 offen offset:512
L_join_288:
    s_branch L_fbdone_48
L_safe_59:
    buffer_store_dwordx4 v[172:175], v5, s[4:7], s54 offen offset:0 sc1
    buffer_store_dwordx2 v[176:177], v6, s[4:7], s54 offen offset:512 sc1
    s_branch L_join_60
L_safe_62:
    buffer_store_dword v0, v14, s[4:7], s41 offen offset:0 sc1
    s_branch L_join_63
L_safe_66:
    buffer_store_dwordx4 v[172:175], v5, s[4:7], s54 offen offset:0 sc1
    buffer_store_dwordx2 v[176:177], v6, s[4:7], s54 offen offset:512 sc1
    s_branch L_join_67
L_fallback_64:
    s_cmp_eq_u32 s37, 0
    s_cselect_b32 s63, 8, 1
    v_mov_b32 v184, 0xff800000
L_fbl_289:
    s_mul_i32 s62, s63, 3072
    v_add_u32 v180, s62, v16
    v_add_u32 v181, s62, v18
    v_add_u32 v182, s62, v19
    v_add_u32 v183, s62, v20
    ds_read_b128 v[136:139], v180
    ds_read_b64 v[140:141], v181
    ds_read_b64_tr_b16 v[152:153], v182 offset:0
    ds_read_b64_tr_b16 v[154:155], v183 offset:0
    ds_read_b64_tr_b16 v[156:157], v182 offset:256
    ds_read_b64_tr_b16 v[158:159], v183 offset:256
    s_waitcnt lgkmcnt(0)
    s_cmp_lg_u32 s63, 1
    s_cbranch_scc1 L_fbnf_290
    v_mfma_f32_32x32x16_bf16 v[88:103], v[136:139], v[240:243], v[208:223]
    s_branch L_fbgo_292
L_fbnf_290:
    s_cmp_lg_u32 s63, 9
    s_cbranch_scc1 L_fbnd_291
    v_mfma_f32_32x32x16_bf16 v[88:103], v[136:139], v[240:243], v[192:207]
    s_branch L_fbgo_292
L_fbnd_291:
    v_mfma_f32_32x32x16_bf16 v[88:103], v[136:139], v[240:243], 0
L_fbgo_292:
    v_mfma_f32_32x32x8bf16_1k v[88:103], v[140:141], v[244:245], v[88:103]
    s_nop 11
    v_max3_f32 v184, v88, v89, v184
    v_max3_f32 v184, v90, v91, v184
    v_max3_f32 v184, v92, v93, v184
    v_max3_f32 v184, v94, v95, v184
    v_max3_f32 v184, v96, v97, v184
    v_max3_f32 v184, v98, v99, v184
    v_max3_f32 v184, v100, v101, v184
    v_max3_f32 v184, v102, v103, v184
    s_add_u32 s63, s63, 1
    s_cmp_le_u32 s63, 9
    s_cbranch_scc1 L_fbl_289
    v_mov_b32 v185, v184
    s_nop 1
    v_permlane32_swap_b32 v184, v185
    v_max_f32 v184, v184, v185
    s_cmp_eq_u32 s37, 0
    s_cselect_b32 s63, 8, 1
    v_mov_b32 v56, 0
    v_mov_b32 v57, 0
    v_mov_b32 v58, 0
    v_mov_b32 v59, 0
    v_mov_b32 v60, 0
    v_mov_b32 v61, 0
    v_mov_b32 v62, 0
    v_mov_b32 v63, 0
    v_mov_b32 v64, 0
    v_mov_b32 v65, 0
    v_mov_b32 v66, 0
    v_mov_b32 v67, 0
    v_mov_b32 v68, 0
    v_mov_b32 v69, 0
    v_mov_b32 v70, 0
    v_mov_b32 v71, 0
L_fbl_293:
    s_mul_i32 s62, s63, 3072
    v_add_u32 v180, s62, v16
    v_add_u32 v181, s62, v18
    v_add_u32 v182, s62, v19
    v_add_u32 v183, s62, v20
    ds_read_b128 v[136:139], v180
    ds_read_b64 v[140:141], v181
    ds_read_b64_tr_b16 v[152:153], v182 offset:0
    ds_read_b64_tr_b16 v[154:155], v183 offset:0
    ds_read_b64_tr_b16 v[156:157], v182 offset:256
    ds_read_b64_tr_b16 v[158:159], v183 offset:256
    s_waitcnt lgkmcnt(0)
    s_cmp_lg_u32 s63, 1
    s_cbranch_scc1 L_fbnf_294
    v_mfma_f32_32x32x16_bf16 v[88:103], v[136:139], v[240:243], v[208:223]
    s_branch L_fbgo_296
L_fbnf_294:
    s_cmp_lg_u32 s63, 9
    s_cbranch_scc1 L_fbnd_295
    v_mfma_f32_32x32x16_bf16 v[88:103], v[136:139], v[240:243], v[192:207]
    s_branch L_fbgo_296
L_fbnd_295:
    v_mfma_f32_32x32x16_bf16 v[88:103], v[136:139], v[240:243], 0
L_fbgo_296:
    v_mfma_f32_32x32x8bf16_1k v[88:103], v[140:141], v[244:245], v[88:103]
    s_nop 11
    v_sub_f32 v88, v88, v184
    v_sub_f32 v89, v89, v184
    v_sub_f32 v90, v90, v184
    v_sub_f32 v91, v91, v184
    v_sub_f32 v92, v92, v184
    v_sub_f32 v93, v93, v184
    v_sub_f32 v94, v94, v184
    v_sub_f32 v95, v95, v184
    v_sub_f32 v96, v96, v184
    v_sub_f32 v97, v97, v184
    v_sub_f32 v98, v98, v184
    v_sub_f32 v99, v99, v184
    v_sub_f32 v100, v100, v184
    v_sub_f32 v101, v101, v184
    v_sub_f32 v102, v102, v184
    v_sub_f32 v103, v103, v184
    v_exp_f32 v88, v88
    v_exp_f32 v89, v89
    v_exp_f32 v90, v90
    v_exp_f32 v91, v91
    v_exp_f32 v92, v92
    v_exp_f32 v93, v93
    v_exp_f32 v94, v94
    v_exp_f32 v95, v95
    v_exp_f32 v96, v96
    v_exp_f32 v97, v97
    v_exp_f32 v98, v98
    v_exp_f32 v99, v99
    v_exp_f32 v100, v100
    v_exp_f32 v101, v101
    v_exp_f32 v102, v102
    v_exp_f32 v103, v103
    v_cvt_pk_bf16_f32 v120, v88, v89
    v_cvt_pk_bf16_f32 v121, v90, v91
    v_cvt_pk_bf16_f32 v122, v92, v93
    v_cvt_pk_bf16_f32 v123, v94, v95
    v_cvt_pk_bf16_f32 v124, v96, v97
    v_cvt_pk_bf16_f32 v125, v98, v99
    v_cvt_pk_bf16_f32 v126, v100, v101
    v_cvt_pk_bf16_f32 v127, v102, v103
    v_mfma_f32_32x32x16_bf16 v[56:71], v[152:155], v[120:123], v[56:71]
    s_nop 0
    v_mfma_f32_32x32x16_bf16 v[56:71], v[156:159], v[124:127], v[56:71]
    s_add_u32 s63, s63, 1
    s_cmp_le_u32 s63, 9
    s_cbranch_scc1 L_fbl_293
    s_cmp_eq_u32 s37, 0
    s_cselect_b32 s63, 8, 6
    v_mov_b32 v184, 0xff800000
L_fbl_297:
    s_mul_i32 s62, s63, 3072
    v_add_u32 v180, s62, v16
    v_add_u32 v181, s62, v18
    v_add_u32 v182, s62, v19
    v_add_u32 v183, s62, v20
    ds_read_b128 v[136:139], v180
    ds_read_b64 v[140:141], v181
    ds_read_b64_tr_b16 v[152:153], v182 offset:0
    ds_read_b64_tr_b16 v[154:155], v183 offset:0
    ds_read_b64_tr_b16 v[156:157], v182 offset:256
    ds_read_b64_tr_b16 v[158:159], v183 offset:256
    s_waitcnt lgkmcnt(0)
    s_cmp_lg_u32 s63, 6
    s_cbranch_scc1 L_fbnf_298
    v_mfma_f32_32x32x16_bf16 v[88:103], v[136:139], v[248:251], v[208:223]
    s_branch L_fbgo_300
L_fbnf_298:
    s_cmp_lg_u32 s63, 14
    s_cbranch_scc1 L_fbnd_299
    v_mfma_f32_32x32x16_bf16 v[88:103], v[136:139], v[248:251], v[192:207]
    s_branch L_fbgo_300
L_fbnd_299:
    v_mfma_f32_32x32x16_bf16 v[88:103], v[136:139], v[248:251], 0
L_fbgo_300:
    v_mfma_f32_32x32x8bf16_1k v[88:103], v[140:141], v[252:253], v[88:103]
    s_nop 11
    v_max3_f32 v184, v88, v89, v184
    v_max3_f32 v184, v90, v91, v184
    v_max3_f32 v184, v92, v93, v184
    v_max3_f32 v184, v94, v95, v184
    v_max3_f32 v184, v96, v97, v184
    v_max3_f32 v184, v98, v99, v184
    v_max3_f32 v184, v100, v101, v184
    v_max3_f32 v184, v102, v103, v184
    s_add_u32 s63, s63, 1
    s_cmp_le_u32 s63, 14
    s_cbranch_scc1 L_fbl_297
    v_mov_b32 v185, v184
    s_nop 1
    v_permlane32_swap_b32 v184, v185
    v_max_f32 v184, v184, v185
    s_cmp_eq_u32 s37, 0
    s_cselect_b32 s63, 8, 6
    v_mov_b32 v72, 0
    v_mov_b32 v73, 0
    v_mov_b32 v74, 0
    v_mov_b32 v75, 0
    v_mov_b32 v76, 0
    v_mov_b32 v77, 0
    v_mov_b32 v78, 0
    v_mov_b32 v79, 0
    v_mov_b32 v80, 0
    v_mov_b32 v81, 0
    v_mov_b32 v82, 0
    v_mov_b32 v83, 0
    v_mov_b32 v84, 0
    v_mov_b32 v85, 0
    v_mov_b32 v86, 0
    v_mov_b32 v87, 0
L_fbl_301:
    s_mul_i32 s62, s63, 3072
    v_add_u32 v180, s62, v16
    v_add_u32 v181, s62, v18
    v_add_u32 v182, s62, v19
    v_add_u32 v183, s62, v20
    ds_read_b128 v[136:139], v180
    ds_read_b64 v[140:141], v181
    ds_read_b64_tr_b16 v[152:153], v182 offset:0
    ds_read_b64_tr_b16 v[154:155], v183 offset:0
    ds_read_b64_tr_b16 v[156:157], v182 offset:256
    ds_read_b64_tr_b16 v[158:159], v183 offset:256
    s_waitcnt lgkmcnt(0)
    s_cmp_lg_u32 s63, 6
    s_cbranch_scc1 L_fbnf_302
    v_mfma_f32_32x32x16_bf16 v[88:103], v[136:139], v[248:251], v[208:223]
    s_branch L_fbgo_304
L_fbnf_302:
    s_cmp_lg_u32 s63, 14
    s_cbranch_scc1 L_fbnd_303
    v_mfma_f32_32x32x16_bf16 v[88:103], v[136:139], v[248:251], v[192:207]
    s_branch L_fbgo_304
L_fbnd_303:
    v_mfma_f32_32x32x16_bf16 v[88:103], v[136:139], v[248:251], 0
L_fbgo_304:
    v_mfma_f32_32x32x8bf16_1k v[88:103], v[140:141], v[252:253], v[88:103]
    s_nop 11
    v_sub_f32 v88, v88, v184
    v_sub_f32 v89, v89, v184
    v_sub_f32 v90, v90, v184
    v_sub_f32 v91, v91, v184
    v_sub_f32 v92, v92, v184
    v_sub_f32 v93, v93, v184
    v_sub_f32 v94, v94, v184
    v_sub_f32 v95, v95, v184
    v_sub_f32 v96, v96, v184
    v_sub_f32 v97, v97, v184
    v_sub_f32 v98, v98, v184
    v_sub_f32 v99, v99, v184
    v_sub_f32 v100, v100, v184
    v_sub_f32 v101, v101, v184
    v_sub_f32 v102, v102, v184
    v_sub_f32 v103, v103, v184
    v_exp_f32 v88, v88
    v_exp_f32 v89, v89
    v_exp_f32 v90, v90
    v_exp_f32 v91, v91
    v_exp_f32 v92, v92
    v_exp_f32 v93, v93
    v_exp_f32 v94, v94
    v_exp_f32 v95, v95
    v_exp_f32 v96, v96
    v_exp_f32 v97, v97
    v_exp_f32 v98, v98
    v_exp_f32 v99, v99
    v_exp_f32 v100, v100
    v_exp_f32 v101, v101
    v_exp_f32 v102, v102
    v_exp_f32 v103, v103
    v_cvt_pk_bf16_f32 v120, v88, v89
    v_cvt_pk_bf16_f32 v121, v90, v91
    v_cvt_pk_bf16_f32 v122, v92, v93
    v_cvt_pk_bf16_f32 v123, v94, v95
    v_cvt_pk_bf16_f32 v124, v96, v97
    v_cvt_pk_bf16_f32 v125, v98, v99
    v_cvt_pk_bf16_f32 v126, v100, v101
    v_cvt_pk_bf16_f32 v127, v102, v103
    v_mfma_f32_32x32x16_bf16 v[72:87], v[152:155], v[120:123], v[72:87]
    s_nop 0
    v_mfma_f32_32x32x16_bf16 v[72:87], v[156:159], v[124:127], v[72:87]
    s_add_u32 s63, s63, 1
    s_cmp_le_u32 s63, 14
    s_cbranch_scc1 L_fbl_301
    s_cmp_eq_u32 s26, 0
    s_cbranch_scc1 L_hikept_305
    s_nop 6
    v_rcp_f32 v86, v84
    s_add_u32 s54, s56, 7680
    v_pk_mul_f32 v[72:73], v[72:73], v[86:87] op_sel_hi:[1,0]
    v_pk_mul_f32 v[74:75], v[74:75], v[86:87] op_sel_hi:[1,0]
    v_pk_mul_f32 v[76:77], v[76:77], v[86:87] op_sel_hi:[1,0]
    v_pk_mul_f32 v[78:79], v[78:79], v[86:87] op_sel_hi:[1,0]
    v_pk_mul_f32 v[80:81], v[80:81], v[86:87] op_sel_hi:[1,0]
    v_pk_mul_f32 v[82:83], v[82:83], v[86:87] op_sel_hi:[1,0]
    v_cvt_pk_bf16_f32 v172, v72, v73
    v_cvt_pk_bf16_f32 v173, v74, v75
    v_cvt_pk_bf16_f32 v174, v76, v77
    v_cvt_pk_bf16_f32 v175, v78, v79
    v_cvt_pk_bf16_f32 v176, v80, v81
    v_cvt_pk_bf16_f32 v177, v82, v83
    s_cmp_eq_u32 s43, 0
    s_cbranch_scc1 L_safe_306
    buffer_store_dwordx4 v[172:175], v5, s[4:7], s54 offen offset:0
    buffer_store_dwordx2 v[176:177], v6, s[4:7], s54 offen offset:512
L_join_307:
L_hikept_305:
    v_rcp_f32 v70, v68
    s_add_u32 s54, s56, 1280
    v_pk_mul_f32 v[56:57], v[56:57], v[70:71] op_sel_hi:[1,0]
    v_pk_mul_f32 v[58:59], v[58:59], v[70:71] op_sel_hi:[1,0]
    v_pk_mul_f32 v[60:61], v[60:61], v[70:71] op_sel_hi:[1,0]
    v_pk_mul_f32 v[62:63], v[62:63], v[70:71] op_sel_hi:[1,0]
    v_pk_mul_f32 v[64:65], v[64:65], v[70:71] op_sel_hi:[1,0]
    v_pk_mul_f32 v[66:67], v[66:67], v[70:71] op_sel_hi:[1,0]
    v_cvt_pk_bf16_f32 v172, v56, v57
    v_cvt_pk_bf16_f32 v173, v58, v59
    v_cvt_pk_bf16_f32 v174, v60, v61
    v_cvt_pk_bf16_f32 v175, v62, v63
    v_cvt_pk_bf16_f32 v176, v64, v65
    v_cvt_pk_bf16_f32 v177, v66, v67
    s_cmp_eq_u32 s43, 0
    s_cbranch_scc1 L_safe_308
    buffer_store_dwordx4 v[172:175], v5, s[4:7], s54 offen offset:0
    buffer_store_dwordx2 v[176:177], v6, s[4:7], s54 offen offset:512
L_join_309:
    s_branch L_fbdone_65
L_safe_76:
    buffer_store_dwordx4 v[172:175], v5, s[4:7], s54 offen offset:0 sc1
    buffer_store_dwordx2 v[176:177], v6, s[4:7], s54 offen offset:512 sc1
    s_branch L_join_77
L_safe_79:
    buffer_store_dword v0, v14, s[4:7], s41 offen offset:0 sc1
    s_branch L_join_80
L_safe_83:
    buffer_store_dwordx4 v[172:175], v5, s[4:7], s54 offen offset:0 sc1
    buffer_store_dwordx2 v[176:177], v6, s[4:7], s54 offen offset:512 sc1
    s_branch L_join_84
L_fallback_81:
    s_cmp_eq_u32 s37, 0
    s_cselect_b32 s63, 8, 2
    v_mov_b32 v184, 0xff800000
L_fbl_310:
    s_mul_i32 s62, s63, 3072
    v_add_u32 v180, s62, v16
    v_add_u32 v181, s62, v18
    v_add_u32 v182, s62, v19
    v_add_u32 v183, s62, v20
    ds_read_b128 v[136:139], v180
    ds_read_b64 v[140:141], v181
    ds_read_b64_tr_b16 v[152:153], v182 offset:0
    ds_read_b64_tr_b16 v[154:155], v183 offset:0
    ds_read_b64_tr_b16 v[156:157], v182 offset:256
    ds_read_b64_tr_b16 v[158:159], v183 offset:256
    s_waitcnt lgkmcnt(0)
    s_cmp_lg_u32 s63, 2
    s_cbranch_scc1 L_fbnf_311
    v_mfma_f32_32x32x16_bf16 v[88:103], v[136:139], v[240:243], v[208:223]
    s_branch L_fbgo_313
L_fbnf_311:
    s_cmp_lg_u32 s63, 10
    s_cbranch_scc1 L_fbnd_312
    v_mfma_f32_32x32x16_bf16 v[88:103], v[136:139], v[240:243], v[192:207]
    s_branch L_fbgo_313
L_fbnd_312:
    v_mfma_f32_32x32x16_bf16 v[88:103], v[136:139], v[240:243], 0
L_fbgo_313:
    v_mfma_f32_32x32x8bf16_1k v[88:103], v[140:141], v[244:245], v[88:103]
    s_nop 11
    v_max3_f32 v184, v88, v89, v184
    v_max3_f32 v184, v90, v91, v184
    v_max3_f32 v184, v92, v93, v184
    v_max3_f32 v184, v94, v95, v184
    v_max3_f32 v184, v96, v97, v184
    v_max3_f32 v184, v98, v99, v184
    v_max3_f32 v184, v100, v101, v184
    v_max3_f32 v184, v102, v103, v184
    s_add_u32 s63, s63, 1
    s_cmp_le_u32 s63, 10
    s_cbranch_scc1 L_fbl_310
    v_mov_b32 v185, v184
    s_nop 1
    v_permlane32_swap_b32 v184, v185
    v_max_f32 v184, v184, v185
    s_cmp_eq_u32 s37, 0
    s_cselect_b32 s63, 8, 2
    v_mov_b32 v56, 0
    v_mov_b32 v57, 0
    v_mov_b32 v58, 0
    v_mov_b32 v59, 0
    v_mov_b32 v60, 0
    v_mov_b32 v61, 0
    v_mov_b32 v62, 0
    v_mov_b32 v63, 0
    v_mov_b32 v64, 0
    v_mov_b32 v65, 0
    v_mov_b32 v66, 0
    v_mov_b32 v67, 0
    v_mov_b32 v68, 0
    v_mov_b32 v69, 0
    v_mov_b32 v70, 0
    v_mov_b32 v71, 0
L_fbl_314:
    s_mul_i32 s62, s63, 3072
    v_add_u32 v180, s62, v16
    v_add_u32 v181, s62, v18
    v_add_u32 v182, s62, v19
    v_add_u32 v183, s62, v20
    ds_read_b128 v[136:139], v180
    ds_read_b64 v[140:141], v181
    ds_read_b64_tr_b16 v[152:153], v182 offset:0
    ds_read_b64_tr_b16 v[154:155], v183 offset:0
    ds_read_b64_tr_b16 v[156:157], v182 offset:256
    ds_read_b64_tr_b16 v[158:159], v183 offset:256
    s_waitcnt lgkmcnt(0)
    s_cmp_lg_u32 s63, 2
    s_cbranch_scc1 L_fbnf_315
    v_mfma_f32_32x32x16_bf16 v[88:103], v[136:139], v[240:243], v[208:223]
    s_branch L_fbgo_317
L_fbnf_315:
    s_cmp_lg_u32 s63, 10
    s_cbranch_scc1 L_fbnd_316
    v_mfma_f32_32x32x16_bf16 v[88:103], v[136:139], v[240:243], v[192:207]
    s_branch L_fbgo_317
L_fbnd_316:
    v_mfma_f32_32x32x16_bf16 v[88:103], v[136:139], v[240:243], 0
L_fbgo_317:
    v_mfma_f32_32x32x8bf16_1k v[88:103], v[140:141], v[244:245], v[88:103]
    s_nop 11
    v_sub_f32 v88, v88, v184
    v_sub_f32 v89, v89, v184
    v_sub_f32 v90, v90, v184
    v_sub_f32 v91, v91, v184
    v_sub_f32 v92, v92, v184
    v_sub_f32 v93, v93, v184
    v_sub_f32 v94, v94, v184
    v_sub_f32 v95, v95, v184
    v_sub_f32 v96, v96, v184
    v_sub_f32 v97, v97, v184
    v_sub_f32 v98, v98, v184
    v_sub_f32 v99, v99, v184
    v_sub_f32 v100, v100, v184
    v_sub_f32 v101, v101, v184
    v_sub_f32 v102, v102, v184
    v_sub_f32 v103, v103, v184
    v_exp_f32 v88, v88
    v_exp_f32 v89, v89
    v_exp_f32 v90, v90
    v_exp_f32 v91, v91
    v_exp_f32 v92, v92
    v_exp_f32 v93, v93
    v_exp_f32 v94, v94
    v_exp_f32 v95, v95
    v_exp_f32 v96, v96
    v_exp_f32 v97, v97
    v_exp_f32 v98, v98
    v_exp_f32 v99, v99
    v_exp_f32 v100, v100
    v_exp_f32 v101, v101
    v_exp_f32 v102, v102
    v_exp_f32 v103, v103
    v_cvt_pk_bf16_f32 v120, v88, v89
    v_cvt_pk_bf16_f32 v121, v90, v91
    v_cvt_pk_bf16_f32 v122, v92, v93
    v_cvt_pk_bf16_f32 v123, v94, v95
    v_cvt_pk_bf16_f32 v124, v96, v97
    v_cvt_pk_bf16_f32 v125, v98, v99
    v_cvt_pk_bf16_f32 v126, v100, v101
    v_cvt_pk_bf16_f32 v127, v102, v103
    v_mfma_f32_32x32x16_bf16 v[56:71], v[152:155], v[120:123], v[56:71]
    s_nop 0
    v_mfma_f32_32x32x16_bf16 v[56:71], v[156:159], v[124:127], v[56:71]
    s_add_u32 s63, s63, 1
    s_cmp_le_u32 s63, 10
    s_cbranch_scc1 L_fbl_314
    s_cmp_eq_u32 s37, 0
    s_cselect_b32 s63, 8, 5
    v_mov_b32 v184, 0xff800000
L_fbl_318:
    s_mul_i32 s62, s63, 3072
    v_add_u32 v180, s62, v16
    v_add_u32 v181, s62, v18
    v_add_u32 v182, s62, v19
    v_add_u32 v183, s62, v20
    ds_read_b128 v[136:139], v180
    ds_read_b64 v[140:141], v181
    ds_read_b64_tr_b16 v[152:153], v182 offset:0
    ds_read_b64_tr_b16 v[154:155], v183 offset:0
    ds_read_b64_tr_b16 v[156:157], v182 offset:256
    ds_read_b64_tr_b16 v[158:159], v183 offset:256
    s_waitcnt lgkmcnt(0)
    s_cmp_lg_u32 s63, 5
    s_cbranch_scc1 L_fbnf_319
    v_mfma_f32_32x32x16_bf16 v[88:103], v[136:139], v[248:251], v[208:223]
    s_branch L_fbgo_321
L_fbnf_319:
    s_cmp_lg_u32 s63, 13
    s_cbranch_scc1 L_fbnd_320
    v_mfma_f32_32x32x16_bf16 v[88:103], v[136:139], v[248:251], v[192:207]
    s_branch L_fbgo_321
L_fbnd_320:
    v_mfma_f32_32x32x16_bf16 v[88:103], v[136:139], v[248:251], 0
L_fbgo_321:
    v_mfma_f32_32x32x8bf16_1k v[88:103], v[140:141], v[252:253], v[88:103]
    s_nop 11
    v_max3_f32 v184, v88, v89, v184
    v_max3_f32 v184, v90, v91, v184
    v_max3_f32 v184, v92, v93, v184
    v_max3_f32 v184, v94, v95, v184
    v_max3_f32 v184, v96, v97, v184
    v_max3_f32 v184, v98, v99, v184
    v_max3_f32 v184, v100, v101, v184
    v_max3_f32 v184, v102, v103, v184
    s_add_u32 s63, s63, 1
    s_cmp_le_u32 s63, 13
    s_cbranch_scc1 L_fbl_318
    v_mov_b32 v185, v184
    s_nop 1
    v_permlane32_swap_b32 v184, v185
    v_max_f32 v184, v184, v185
    s_cmp_eq_u32 s37, 0
    s_cselect_b32 s63, 8, 5
    v_mov_b32 v72, 0
    v_mov_b32 v73, 0
    v_mov_b32 v74, 0
    v_mov_b32 v75, 0
    v_mov_b32 v76, 0
    v_mov_b32 v77, 0
    v_mov_b32 v78, 0
    v_mov_b32 v79, 0
    v_mov_b32 v80, 0
    v_mov_b32 v81, 0
    v_mov_b32 v82, 0
    v_mov_b32 v83, 0
    v_mov_b32 v84, 0
    v_mov_b32 v85, 0
    v_mov_b32 v86, 0
    v_mov_b32 v87, 0
L_fbl_322:
    s_mul_i32 s62, s63, 3072
    v_add_u32 v180, s62, v16
    v_add_u32 v181, s62, v18
    v_add_u32 v182, s62, v19
    v_add_u32 v183, s62, v20
    ds_read_b128 v[136:139], v180
    ds_read_b64 v[140:141], v181
    ds_read_b64_tr_b16 v[152:153], v182 offset:0
    ds_read_b64_tr_b16 v[154:155], v183 offset:0
    ds_read_b64_tr_b16 v[156:157], v182 offset:256
    ds_read_b64_tr_b16 v[158:159], v183 offset:256
    s_waitcnt lgkmcnt(0)
    s_cmp_lg_u32 s63, 5
    s_cbranch_scc1 L_fbnf_323
    v_mfma_f32_32x32x16_bf16 v[88:103], v[136:139], v[248:251], v[208:223]
    s_branch L_fbgo_325
L_fbnf_323:
    s_cmp_lg_u32 s63, 13
    s_cbranch_scc1 L_fbnd_324
    v_mfma_f32_32x32x16_bf16 v[88:103], v[136:139], v[248:251], v[192:207]
    s_branch L_fbgo_325
L_fbnd_324:
    v_mfma_f32_32x32x16_bf16 v[88:103], v[136:139], v[248:251], 0
L_fbgo_325:
    v_mfma_f32_32x32x8bf16_1k v[88:103], v[140:141], v[252:253], v[88:103]
    s_nop 11
    v_sub_f32 v88, v88, v184
    v_sub_f32 v89, v89, v184
    v_sub_f32 v90, v90, v184
    v_sub_f32 v91, v91, v184
    v_sub_f32 v92, v92, v184
    v_sub_f32 v93, v93, v184
    v_sub_f32 v94, v94, v184
    v_sub_f32 v95, v95, v184
    v_sub_f32 v96, v96, v184
    v_sub_f32 v97, v97, v184
    v_sub_f32 v98, v98, v184
    v_sub_f32 v99, v99, v184
    v_sub_f32 v100, v100, v184
    v_sub_f32 v101, v101, v184
    v_sub_f32 v102, v102, v184
    v_sub_f32 v103, v103, v184
    v_exp_f32 v88, v88
    v_exp_f32 v89, v89
    v_exp_f32 v90, v90
    v_exp_f32 v91, v91
    v_exp_f32 v92, v92
    v_exp_f32 v93, v93
    v_exp_f32 v94, v94
    v_exp_f32 v95, v95
    v_exp_f32 v96, v96
    v_exp_f32 v97, v97
    v_exp_f32 v98, v98
    v_exp_f32 v99, v99
    v_exp_f32 v100, v100
    v_exp_f32 v101, v101
    v_exp_f32 v102, v102
    v_exp_f32 v103, v103
    v_cvt_pk_bf16_f32 v120, v88, v89
    v_cvt_pk_bf16_f32 v121, v90, v91
    v_cvt_pk_bf16_f32 v122, v92, v93
    v_cvt_pk_bf16_f32 v123, v94, v95
    v_cvt_pk_bf16_f32 v124, v96, v97
    v_cvt_pk_bf16_f32 v125, v98, v99
    v_cvt_pk_bf16_f32 v126, v100, v101
    v_cvt_pk_bf16_f32 v127, v102, v103
    v_mfma_f32_32x32x16_bf16 v[72:87], v[152:155], v[120:123], v[72:87]
    s_nop 0
    v_mfma_f32_32x32x16_bf16 v[72:87], v[156:159], v[124:127], v[72:87]
    s_add_u32 s63, s63, 1
    s_cmp_le_u32 s63, 13
    s_cbranch_scc1 L_fbl_322
    s_cmp_eq_u32 s26, 0
    s_cbranch_scc1 L_hikept_326
    s_nop 6
    v_rcp_f32 v86, v84
    s_add_u32 s54, s56, 6400
    v_pk_mul_f32 v[72:73], v[72:73], v[86:87] op_sel_hi:[1,0]
    v_pk_mul_f32 v[74:75], v[74:75], v[86:87] op_sel_hi:[1,0]
    v_pk_mul_f32 v[76:77], v[76:77], v[86:87] op_sel_hi:[1,0]
    v_pk_mul_f32 v[78:79], v[78:79], v[86:87] op_sel_hi:[1,0]
    v_pk_mul_f32 v[80:81], v[80:81], v[86:87] op_sel_hi:[1,0]
    v_pk_mul_f32 v[82:83], v[82:83], v[86:87] op_sel_hi:[1,0]
    v_cvt_pk_bf16_f32 v172, v72, v73
    v_cvt_pk_bf16_f32 v173, v74, v75
    v_cvt_pk_bf16_f32 v174, v76, v77
    v_cvt_pk_bf16_f32 v175, v78, v79
    v_cvt_pk_bf16_f32 v176, v80, v81
    v_cvt_pk_bf16_f32 v177, v82, v83
    s_cmp_eq_u32 s43, 0
    s_cbranch_scc1 L_safe_327
    buffer_store_dwordx4 v[172:175], v5, s[4:7], s54 offen offset:0
    buffer_store_dwordx2 v[176:177], v6, s[4:7], s54 offen offset:512
L_join_328:
L_hikept_326:
    v_rcp_f32 v70, v68
    s_add_u32 s54, s56, 2560
    v_pk_mul_f32 v[56:57], v[56:57], v[70:71] op_sel_hi:[1,0]
    v_pk_mul_f32 v[58:59], v[58:59], v[70:71] op_sel_hi:[1,0]
    v_pk_mul_f32 v[60:61], v[60:61], v[70:71] op_sel_hi:[1,0]
    v_pk_mul_f32 v[62:63], v[62:63], v[70:71] op_sel_hi:[1,0]
    v_pk_mul_f32 v[64:65], v[64:65], v[70:71] op_sel_hi:[1,0]
    v_pk_mul_f32 v[66:67], v[66:67], v[70:71] op_sel_hi:[1,0]
    v_cvt_pk_bf16_f32 v172, v56, v57
    v_cvt_pk_bf16_f32 v173, v58, v59
    v_cvt_pk_bf16_f32 v174, v60, v61
    v_cvt_pk_bf16_f32 v175, v62, v63
    v_cvt_pk_bf16_f32 v176, v64, v65
    v_cvt_pk_bf16_f32 v177, v66, v67
    s_cmp_eq_u32 s43, 0
    s_cbranch_scc1 L_safe_329
    buffer_store_dwordx4 v[172:175], v5, s[4:7], s54 offen offset:0
    buffer_store_dwordx2 v[176:177], v6, s[4:7], s54 offen offset:512
L_join_330:
    s_branch L_fbdone_82
L_safe_93:
    buffer_store_dwordx4 v[172:175], v5, s[4:7], s54 offen offset:0 sc1
    buffer_store_dwordx2 v[176:177], v6, s[4:7], s54 offen offset:512 sc1
    s_branch L_join_94
L_safe_96:
    buffer_store_dword v0, v14, s[4:7], s41 offen offset:0 sc1
    s_branch L_join_97
L_safe_100:
    buffer_store_dwordx4 v[172:175], v5, s[4:7], s54 offen offset:0 sc1
    buffer_store_dwordx2 v[176:177], v6, s[4:7], s54 offen offset:512 sc1
    s_branch L_join_101
L_fallback_98:
    s_cmp_eq_u32 s37, 0
    s_cselect_b32 s63, 8, 3
    v_mov_b32 v184, 0xff800000
L_fbl_331:
    s_mul_i32 s62, s63, 3072
    v_add_u32 v180, s62, v16
    v_add_u32 v181, s62, v18
    v_add_u32 v182, s62, v19
    v_add_u32 v183, s62, v20
    ds_read_b128 v[136:139], v180
    ds_read_b64 v[140:141], v181
    ds_read_b64_tr_b16 v[152:153], v182 offset:0
    ds_read_b64_tr_b16 v[154:155], v183 offset:0
    ds_read_b64_tr_b16 v[156:157], v182 offset:256
    ds_read_b64_tr_b16 v[158:159], v183 offset:256
    s_waitcnt lgkmcnt(0)
    s_cmp_lg_u32 s63, 3
    s_cbranch_scc1 L_fbnf_332
    v_mfma_f32_32x32x16_bf16 v[88:103], v[136:139], v[240:243], v[208:223]
    s_branch L_fbgo_334
L_fbnf_332:
    s_cmp_lg_u32 s63, 11
    s_cbranch_scc1 L_fbnd_333
    v_mfma_f32_32x32x16_bf16 v[88:103], v[136:139], v[240:243], v[192:207]
    s_branch L_fbgo_334
L_fbnd_333:
    v_mfma_f32_32x32x16_bf16 v[88:103], v[136:139], v[240:243], 0
L_fbgo_334:
    v_mfma_f32_32x32x8bf16_1k v[88:103], v[140:141], v[244:245], v[88:103]
    s_nop 11
    v_max3_f32 v184, v88, v89, v184
    v_max3_f32 v184, v90, v91, v184
    v_max3_f32 v184, v92, v93, v184
    v_max3_f32 v184, v94, v95, v184
    v_max3_f32 v184, v96, v97, v184
    v_max3_f32 v184, v98, v99, v184
    v_max3_f32 v184, v100, v101, v184
    v_max3_f32 v184, v102, v103, v184
    s_add_u32 s63, s63, 1
    s_cmp_le_u32 s63, 11
    s_cbranch_scc1 L_fbl_331
    v_mov_b32 v185, v184
    s_nop 1
    v_permlane32_swap_b32 v184, v185
    v_max_f32 v184, v184, v185
    s_cmp_eq_u32 s37, 0
    s_cselect_b32 s63, 8, 3
    v_mov_b32 v56, 0
    v_mov_b32 v57, 0
    v_mov_b32 v58, 0
    v_mov_b32 v59, 0
    v_mov_b32 v60, 0
    v_mov_b32 v61, 0
    v_mov_b32 v62, 0
    v_mov_b32 v63, 0
    v_mov_b32 v64, 0
    v_mov_b32 v65, 0
    v_mov_b32 v66, 0
    v_mov_b32 v67, 0
    v_mov_b32 v68, 0
    v_mov_b32 v69, 0
    v_mov_b32 v70, 0
    v_mov_b32 v71, 0
L_fbl_335:
    s_mul_i32 s62, s63, 3072
    v_add_u32 v180, s62, v16
    v_add_u32 v181, s62, v18
    v_add_u32 v182, s62, v19
    v_add_u32 v183, s62, v20
    ds_read_b128 v[136:139], v180
    ds_read_b64 v[140:141], v181
    ds_read_b64_tr_b16 v[152:153], v182 offset:0
    ds_read_b64_tr_b16 v[154:155], v183 offset:0
    ds_read_b64_tr_b16 v[156:157], v182 offset:256
    ds_read_b64_tr_b16 v[158:159], v183 offset:256
    s_waitcnt lgkmcnt(0)
    s_cmp_lg_u32 s63, 3
    s_cbranch_scc1 L_fbnf_336
    v_mfma_f32_32x32x16_bf16 v[88:103], v[136:139], v[240:243], v[208:223]
    s_branch L_fbgo_338
L_fbnf_336:
    s_cmp_lg_u32 s63, 11
    s_cbranch_scc1 L_fbnd_337
    v_mfma_f32_32x32x16_bf16 v[88:103], v[136:139], v[240:243], v[192:207]
    s_branch L_fbgo_338
L_fbnd_337:
    v_mfma_f32_32x32x16_bf16 v[88:103], v[136:139], v[240:243], 0
L_fbgo_338:
    v_mfma_f32_32x32x8bf16_1k v[88:103], v[140:141], v[244:245], v[88:103]
    s_nop 11
    v_sub_f32 v88, v88, v184
    v_sub_f32 v89, v89, v184
    v_sub_f32 v90, v90, v184
    v_sub_f32 v91, v91, v184
    v_sub_f32 v92, v92, v184
    v_sub_f32 v93, v93, v184
    v_sub_f32 v94, v94, v184
    v_sub_f32 v95, v95, v184
    v_sub_f32 v96, v96, v184
    v_sub_f32 v97, v97, v184
    v_sub_f32 v98, v98, v184
    v_sub_f32 v99, v99, v184
    v_sub_f32 v100, v100, v184
    v_sub_f32 v101, v101, v184
    v_sub_f32 v102, v102, v184
    v_sub_f32 v103, v103, v184
    v_exp_f32 v88, v88
    v_exp_f32 v89, v89
    v_exp_f32 v90, v90
    v_exp_f32 v91, v91
    v_exp_f32 v92, v92
    v_exp_f32 v93, v93
    v_exp_f32 v94, v94
    v_exp_f32 v95, v95
    v_exp_f32 v96, v96
    v_exp_f32 v97, v97
    v_exp_f32 v98, v98
    v_exp_f32 v99, v99
    v_exp_f32 v100, v100
    v_exp_f32 v101, v101
    v_exp_f32 v102, v102
    v_exp_f32 v103, v103
    v_cvt_pk_bf16_f32 v120, v88, v89
    v_cvt_pk_bf16_f32 v121, v90, v91
    v_cvt_pk_bf16_f32 v122, v92, v93
    v_cvt_pk_bf16_f32 v123, v94, v95
    v_cvt_pk_bf16_f32 v124, v96, v97
    v_cvt_pk_bf16_f32 v125, v98, v99
    v_cvt_pk_bf16_f32 v126, v100, v101
    v_cvt_pk_bf16_f32 v127, v102, v103
    v_mfma_f32_32x32x16_bf16 v[56:71], v[152:155], v[120:123], v[56:71]
    s_nop 0
    v_mfma_f32_32x32x16_bf16 v[56:71], v[156:159], v[124:127], v[56:71]
    s_add_u32 s63, s63, 1
    s_cmp_le_u32 s63, 11
    s_cbranch_scc1 L_fbl_335
    s_cmp_eq_u32 s37, 0
    s_cselect_b32 s63, 8, 4
    v_mov_b32 v184, 0xff800000
L_fbl_339:
    s_mul_i32 s62, s63, 3072
    v_add_u32 v180, s62, v16
    v_add_u32 v181, s62, v18
    v_add_u32 v182, s62, v19
    v_add_u32 v183, s62, v20
    ds_read_b128 v[136:139], v180
    ds_read_b64 v[140:141], v181
    ds_read_b64_tr_b16 v[152:153], v182 offset:0
    ds_read_b64_tr_b16 v[154:155], v183 offset:0
    ds_read_b64_tr_b16 v[156:157], v182 offset:256
    ds_read_b64_tr_b16 v[158:159], v183 offset:256
    s_waitcnt lgkmcnt(0)
    s_cmp_lg_u32 s63, 4
    s_cbranch_scc1 L_fbnf_340
    v_mfma_f32_32x32x16_bf16 v[88:103], v[136:139], v[248:251], v[208:223]
    s_branch L_fbgo_342
L_fbnf_340:
    s_cmp_lg_u32 s63, 12
    s_cbranch_scc1 L_fbnd_341
    v_mfma_f32_32x32x16_bf16 v[88:103], v[136:139], v[248:251], v[192:207]
    s_branch L_fbgo_342
L_fbnd_341:
    v_mfma_f32_32x32x16_bf16 v[88:103], v[136:139], v[248:251], 0
L_fbgo_342:
    v_mfma_f32_32x32x8bf16_1k v[88:103], v[140:141], v[252:253], v[88:103]
    s_nop 11
    v_max3_f32 v184, v88, v89, v184
    v_max3_f32 v184, v90, v91, v184
    v_max3_f32 v184, v92, v93, v184
    v_max3_f32 v184, v94, v95, v184
    v_max3_f32 v184, v96, v97, v184
    v_max3_f32 v184, v98, v99, v184
    v_max3_f32 v184, v100, v101, v184
    v_max3_f32 v184, v102, v103, v184
    s_add_u32 s63, s63, 1
    s_cmp_le_u32 s63, 12
    s_cbranch_scc1 L_fbl_339
    v_mov_b32 v185, v184
    s_nop 1
    v_permlane32_swap_b32 v184, v185
    v_max_f32 v184, v184, v185
    s_cmp_eq_u32 s37, 0
    s_cselect_b32 s63, 8, 4
    v_mov_b32 v72, 0
    v_mov_b32 v73, 0
    v_mov_b32 v74, 0
    v_mov_b32 v75, 0
    v_mov_b32 v76, 0
    v_mov_b32 v77, 0
    v_mov_b32 v78, 0
    v_mov_b32 v79, 0
    v_mov_b32 v80, 0
    v_mov_b32 v81, 0
    v_mov_b32 v82, 0
    v_mov_b32 v83, 0
    v_mov_b32 v84, 0
    v_mov_b32 v85, 0
    v_mov_b32 v86, 0
    v_mov_b32 v87, 0
L_fbl_343:
    s_mul_i32 s62, s63, 3072
    v_add_u32 v180, s62, v16
    v_add_u32 v181, s62, v18
    v_add_u32 v182, s62, v19
    v_add_u32 v183, s62, v20
    ds_read_b128 v[136:139], v180
    ds_read_b64 v[140:141], v181
    ds_read_b64_tr_b16 v[152:153], v182 offset:0
    ds_read_b64_tr_b16 v[154:155], v183 offset:0
    ds_read_b64_tr_b16 v[156:157], v182 offset:256
    ds_read_b64_tr_b16 v[158:159], v183 offset:256
    s_waitcnt lgkmcnt(0)
    s_cmp_lg_u32 s63, 4
    s_cbranch_scc1 L_fbnf_344
    v_mfma_f32_32x32x16_bf16 v[88:103], v[136:139], v[248:251], v[208:223]
    s_branch L_fbgo_346
L_fbnf_344:
    s_cmp_lg_u32 s63, 12
    s_cbranch_scc1 L_fbnd_345
    v_mfma_f32_32x32x16_bf16 v[88:103], v[136:139], v[248:251], v[192:207]
    s_branch L_fbgo_346
L_fbnd_345:
    v_mfma_f32_32x32x16_bf16 v[88:103], v[136:139], v[248:251], 0
L_fbgo_346:
    v_mfma_f32_32x32x8bf16_1k v[88:103], v[140:141], v[252:253], v[88:103]
    s_nop 11
    v_sub_f32 v88, v88, v184
    v_sub_f32 v89, v89, v184
    v_sub_f32 v90, v90, v184
    v_sub_f32 v91, v91, v184
    v_sub_f32 v92, v92, v184
    v_sub_f32 v93, v93, v184
    v_sub_f32 v94, v94, v184
    v_sub_f32 v95, v95, v184
    v_sub_f32 v96, v96, v184
    v_sub_f32 v97, v97, v184
    v_sub_f32 v98, v98, v184
    v_sub_f32 v99, v99, v184
    v_sub_f32 v100, v100, v184
    v_sub_f32 v101, v101, v184
    v_sub_f32 v102, v102, v184
    v_sub_f32 v103, v103, v184
    v_exp_f32 v88, v88
    v_exp_f32 v89, v89
    v_exp_f32 v90, v90
    v_exp_f32 v91, v91
    v_exp_f32 v92, v92
    v_exp_f32 v93, v93
    v_exp_f32 v94, v94
    v_exp_f32 v95, v95
    v_exp_f32 v96, v96
    v_exp_f32 v97, v97
    v_exp_f32 v98, v98
    v_exp_f32 v99, v99
    v_exp_f32 v100, v100
    v_exp_f32 v101, v101
    v_exp_f32 v102, v102
    v_exp_f32 v103, v103
    v_cvt_pk_bf16_f32 v120, v88, v89
    v_cvt_pk_bf16_f32 v121, v90, v91
    v_cvt_pk_bf16_f32 v122, v92, v93
    v_cvt_pk_bf16_f32 v123, v94, v95
    v_cvt_pk_bf16_f32 v124, v96, v97
    v_cvt_pk_bf16_f32 v125, v98, v99
    v_cvt_pk_bf16_f32 v126, v100, v101
    v_cvt_pk_bf16_f32 v127, v102, v103
    v_mfma_f32_32x32x16_bf16 v[72:87], v[152:155], v[120:123], v[72:87]
    s_nop 0
    v_mfma_f32_32x32x16_bf16 v[72:87], v[156:159], v[124:127], v[72:87]
    s_add_u32 s63, s63, 1
    s_cmp_le_u32 s63, 12
    s_cbranch_scc1 L_fbl_343
    s_cmp_eq_u32 s26, 0
    s_cbranch_scc1 L_hikept_347
    s_nop 6
    v_rcp_f32 v86, v84
    s_add_u32 s54, s56, 5120
    v_pk_mul_f32 v[72:73], v[72:73], v[86:87] op_sel_hi:[1,0]
    v_pk_mul_f32 v[74:75], v[74:75], v[86:87] op_sel_hi:[1,0]
    v_pk_mul_f32 v[76:77], v[76:77], v[86:87] op_sel_hi:[1,0]
    v_pk_mul_f32 v[78:79], v[78:79], v[86:87] op_sel_hi:[1,0]
    v_pk_mul_f32 v[80:81], v[80:81], v[86:87] op_sel_hi:[1,0]
    v_pk_mul_f32 v[82:83], v[82:83], v[86:87] op_sel_hi:[1,0]
    v_cvt_pk_bf16_f32 v172, v72, v73
    v_cvt_pk_bf16_f32 v173, v74, v75
    v_cvt_pk_bf16_f32 v174, v76, v77
    v_cvt_pk_bf16_f32 v175, v78, v79
    v_cvt_pk_bf16_f32 v176, v80, v81
    v_cvt_pk_bf16_f32 v177, v82, v83
    s_cmp_eq_u32 s43, 0
    s_cbranch_scc1 L_safe_348
    buffer_store_dwordx4 v[172:175], v5, s[4:7], s54 offen offset:0
    buffer_store_dwordx2 v[176:177], v6, s[4:7], s54 offen offset:512
L_join_349:
L_hikept_347:
    v_rcp_f32 v70, v68
    s_add_u32 s54, s56, 3840
    v_pk_mul_f32 v[56:57], v[56:57], v[70:71] op_sel_hi:[1,0]
    v_pk_mul_f32 v[58:59], v[58:59], v[70:71] op_sel_hi:[1,0]
    v_pk_mul_f32 v[60:61], v[60:61], v[70:71] op_sel_hi:[1,0]
    v_pk_mul_f32 v[62:63], v[62:63], v[70:71] op_sel_hi:[1,0]
    v_pk_mul_f32 v[64:65], v[64:65], v[70:71] op_sel_hi:[1,0]
    v_pk_mul_f32 v[66:67], v[66:67], v[70:71] op_sel_hi:[1,0]
    v_cvt_pk_bf16_f32 v172, v56, v57
    v_cvt_pk_bf16_f32 v173, v58, v59
    v_cvt_pk_bf16_f32 v174, v60, v61
    v_cvt_pk_bf16_f32 v175, v62, v63
    v_cvt_pk_bf16_f32 v176, v64, v65
    v_cvt_pk_bf16_f32 v177, v66, v67
    s_cmp_eq_u32 s43, 0
    s_cbranch_scc1 L_safe_350
    buffer_store_dwordx4 v[172:175], v5, s[4:7], s54 offen offset:0
    buffer_store_dwordx2 v[176:177], v6, s[4:7], s54 offen offset:512
L_join_351:
    s_branch L_fbdone_99
L_safe_102:
    buffer_store_dword v0, v14, s[4:7], s41 offen offset:0 sc1
    s_branch L_join_103
L_safe_106:
    v_cvt_pk_bf16_f32 v56, v32, v33
    v_cvt_pk_bf16_f32 v58, v36, v37
    v_cvt_pk_bf16_f32 v57, v34, v35
    v_cvt_pk_bf16_f32 v59, v38, v39
    v_permlane16_swap_b32 v56, v58
    v_cvt_pk_bf16_f32 v60, v40, v41
    v_cvt_pk_bf16_f32 v62, v44, v45
    v_cvt_pk_bf16_f32 v61, v42, v43
    v_cvt_pk_bf16_f32 v63, v46, v47
    v_permlane16_swap_b32 v57, v59
    buffer_store_dwordx4 v[56:59], v3, s[8:11], s34 offen offset:0 sc1
    v_permlane16_swap_b32 v60, v62
    v_cvt_pk_bf16_f32 v64, v48, v49
    v_cvt_pk_bf16_f32 v66, v48, v49
    v_cvt_pk_bf16_f32 v65, v50, v51
    v_cvt_pk_bf16_f32 v67, v50, v51
    v_permlane16_swap_b32 v61, v63
    buffer_store_dwordx4 v[60:63], v3, s[8:11], s34 offen offset:1024 sc1
    v_permlane16_swap_b32 v64, v66
    v_permlane16_swap_b32 v65, v67
    buffer_store_dwordx4 v[64:67], v4, s[8:11], s34 offen offset:2048 sc1
    v_pk_add_f32 v[68:69], v[32:33], v[34:35]
    v_pk_mul_f32 v[70:71], v[32:33], v[32:33]
    v_pk_fma_f32 v[70:71], v[34:35], v[34:35], v[70:71]
    v_pk_add_f32 v[68:69], v[68:69], v[36:37]
    v_pk_fma_f32 v[70:71], v[36:37], v[36:37], v[70:71]
    v_pk_add_f32 v[68:69], v[68:69], v[38:39]
    v_pk_fma_f32 v[70:71], v[38:39], v[38:39], v[70:71]
    v_pk_add_f32 v[68:69], v[68:69], v[40:41]
    v_pk_fma_f32 v[70:71], v[40:41], v[40:41], v[70:71]
    v_pk_add_f32 v[68:69], v[68:69], v[42:43]
    v_pk_fma_f32 v[70:71], v[42:43], v[42:43], v[70:71]
    v_pk_add_f32 v[68:69], v[68:69], v[44:45]
    v_pk_fma_f32 v[70:71], v[44:45], v[44:45], v[70:71]
    v_pk_add_f32 v[68:69], v[68:69], v[46:47]
    v_pk_fma_f32 v[70:71], v[46:47], v[46:47], v[70:71]
    v_pk_add_f32 v[68:69], v[68:69], v[48:49]
    v_pk_fma_f32 v[70:71], v[48:49], v[48:49], v[70:71]
    v_pk_add_f32 v[68:69], v[68:69], v[50:51]
    v_pk_fma_f32 v[70:71], v[50:51], v[50:51], v[70:71]
    v_add_f32 v68, v68, v69
    v_add_f32 v69, v70, v71
    s_nop 1
    v_permlane16_swap_b32 v68, v69
    v_add_f32 v68, v68, v69
    v_mov_b32 v69, v68
    s_nop 1
    v_permlane32_swap_b32 v68, v69
    v_add_f32 v68, v68, v69
    v_mov_b32 v69, v68
    s_nop 1
    v_permlane16_swap_b32 v68, v69
    buffer_store_dwordx2 v[68:69], v8, s[4:7], s35 offen offset:0 sc1
    ds_read_b128 v[112:115], v237 offset:0
    ds_read_b128 v[116:119], v237 offset:1024
    ds_read_b128 v[120:123], v237 offset:2048
    ds_read_b128 v[124:127], v237 offset:3072
    ds_read_b128 v[128:131], v237 offset:4096
    ds_read_b128 v[132:135], v237 offset:5120
    ds_read_b128 v[136:139], v237 offset:6144
    s_waitcnt vmcnt(1)
    buffer_store_dword v0, v14, s[4:7], s49 offen offset:0 sc1
    s_branch L_join_107
L_safe_110:
    buffer_store_dword v0, v14, s[4:7], s49 offen offset:0 sc1
    s_branch L_join_111
L_safe_118:
    s_and_b32 s67, s38, 3
    s_cmp_eq_u32 s67, 3
    s_cbranch_scc1 L_six_352
    v_pk_mul_f32 v[140:141], v[80:81], v[168:169] op_sel:[0,1] op_sel_hi:[1,1]
    v_pk_mul_f32 v[142:143], v[82:83], v[168:169] op_sel:[0,1] op_sel_hi:[1,1]
    v_exp_f32 v140, v140
    v_exp_f32 v141, v141
    v_exp_f32 v142, v142
    v_exp_f32 v143, v143
    v_pk_fma_f32 v[140:141], v[140:141], v[170:171], v[170:171] op_sel_hi:[1,0,0]
    v_pk_fma_f32 v[142:143], v[142:143], v[170:171], v[170:171] op_sel_hi:[1,0,0]
    v_rcp_f32 v140, v140
    v_rcp_f32 v141, v141
    v_rcp_f32 v142, v142
    v_rcp_f32 v143, v143
    v_pk_mul_f32 v[80:81], v[80:81], v[140:141]
    v_pk_mul_f32 v[82:83], v[82:83], v[142:143]
    v_cvt_pk_bf16_f32 v156, v80, v81
    v_cvt_pk_bf16_f32 v158, v80, v81
    v_cvt_pk_bf16_f32 v157, v82, v83
    v_cvt_pk_bf16_f32 v159, v82, v83
    v_permlane16_swap_b32 v156, v158
    s_nop 0
    v_permlane16_swap_b32 v157, v159
    buffer_store_dwordx4 v[156:159], v4, s[4:7], s62 offen offset:3072 sc1
L_six_352:
    v_pk_mul_f32 v[148:149], v[56:57], v[168:169] op_sel:[0,1] op_sel_hi:[1,1]
    v_pk_mul_f32 v[150:151], v[58:59], v[168:169] op_sel:[0,1] op_sel_hi:[1,1]
    v_pk_mul_f32 v[152:153], v[60:61], v[168:169] op_sel:[0,1] op_sel_hi:[1,1]
    v_pk_mul_f32 v[154:155], v[62:63], v[168:169] op_sel:[0,1] op_sel_hi:[1,1]
    v_exp_f32 v148, v148
    v_exp_f32 v149, v149
    v_exp_f32 v150, v150
    v_exp_f32 v151, v151
    v_exp_f32 v152, v152
    v_exp_f32 v153, v153
    v_exp_f32 v154, v154
    v_exp_f32 v155, v155
    v_pk_fma_f32 v[148:149], v[148:149], v[170:171], v[170:171] op_sel_hi:[1,0,0]
    v_pk_fma_f32 v[150:151], v[150:151], v[170:171], v[170:171] op_sel_hi:[1,0,0]
    v_pk_fma_f32 v[152:153], v[152:153], v[170:171], v[170:171] op_sel_hi:[1,0,0]
    v_pk_fma_f32 v[154:155], v[154:155], v[170:171], v[170:171] op_sel_hi:[1,0,0]
    v_rcp_f32 v148, v148
    v_rcp_f32 v149, v149
    v_rcp_f32 v150, v150
    v_rcp_f32 v151, v151
    v_rcp_f32 v152, v152
    v_rcp_f32 v153, v153
    v_rcp_f32 v154, v154
    v_rcp_f32 v155, v155
    v_pk_mul_f32 v[56:57], v[56:57], v[148:149]
    v_pk_mul_f32 v[58:59], v[58:59], v[150:151]
    v_pk_mul_f32 v[60:61], v[60:61], v[152:153]
    v_pk_mul_f32 v[62:63], v[62:63], v[154:155]
    v_cvt_pk_bf16_f32 v160, v56, v57
    v_cvt_pk_bf16_f32 v162, v60, v61
    v_cvt_pk_bf16_f32 v161, v58, v59
    v_cvt_pk_bf16_f32 v163, v62, v63
    v_permlane16_swap_b32 v160, v162
    s_nop 0
    v_permlane16_swap_b32 v161, v163
    buffer_store_dwordx4 v[160:163], v3, s[4:7], s62 offen offset:0 sc1
    v_pk_mul_f32 v[140:141], v[64:65], v[168:169] op_sel:[0,1] op_sel_hi:[1,1]
    v_pk_mul_f32 v[142:143], v[66:67], v[168:169] op_sel:[0,1] op_sel_hi:[1,1]
    v_pk_mul_f32 v[144:145], v[68:69], v[168:169] op_sel:[0,1] op_sel_hi:[1,1]
    v_pk_mul_f32 v[146:147], v[70:71], v[168:169] op_sel:[0,1] op_sel_hi:[1,1]
    v_exp_f32 v140, v140
    v_exp_f32 v141, v141
    v_exp_f32 v142, v142
    v_exp_f32 v143, v143
    v_exp_f32 v144, v144
    v_exp_f32 v145, v145
    v_exp_f32 v146, v146
    v_exp_f32 v147, v147
    v_pk_fma_f32 v[140:141], v[140:141], v[170:171], v[170:171] op_sel_hi:[1,0,0]
    v_pk_fma_f32 v[142:143], v[142:143], v[170:171], v[170:171] op_sel_hi:[1,0,0]
    v_pk_fma_f32 v[144:145], v[144:145], v[170:171], v[170:171] op_sel_hi:[1,0,0]
    v_pk_fma_f32 v[146:147], v[146:147], v[170:171], v[170:171] op_sel_hi:[1,0,0]
    v_rcp_f32 v140, v140
    v_rcp_f32 v141, v141
    v_rcp_f32 v142, v142
    v_rcp_f32 v143, v143
    v_rcp_f32 v144, v144
    v_rcp_f32 v145, v145
    v_rcp_f32 v146, v146
    v_rcp_f32 v147, v147
    v_pk_mul_f32 v[64:65], v[64:65], v[140:141]
    v_pk_mul_f32 v[66:67], v[66:67], v[142:143]
    v_pk_mul_f32 v[68:69], v[68:69], v[144:145]
    v_pk_mul_f32 v[70:71], v[70:71], v[146:147]
    v_cvt_pk_bf16_f32 v156, v64, v65
    v_cvt_pk_bf16_f32 v158, v68, v69
    v_cvt_pk_bf16_f32 v157, v66, v67
    v_cvt_pk_bf16_f32 v159, v70, v71
    v_permlane16_swap_b32 v156, v158
    s_nop 0
    v_permlane16_swap_b32 v157, v159
    buffer_store_dwordx4 v[156:159], v3, s[4:7], s62 offen offset:1024 sc1
    v_pk_mul_f32 v[148:149], v[72:73], v[168:169] op_sel:[0,1] op_sel_hi:[1,1]
    v_pk_mul_f32 v[150:151], v[74:75], v[168:169] op_sel:[0,1] op_sel_hi:[1,1]
    v_pk_mul_f32 v[152:153], v[76:77], v[168:169] op_sel:[0,1] op_sel_hi:[1,1]
    v_pk_mul_f32 v[154:155], v[78:79], v[168:169] op_sel:[0,1] op_sel_hi:[1,1]
    v_exp_f32 v148, v148
    v_exp_f32 v149, v149
    v_exp_f32 v150, v150
    v_exp_f32 v151, v151
    v_exp_f32 v152, v152
    v_exp_f32 v153, v153
    v_exp_f32 v154, v154
    v_exp_f32 v155, v155
    v_pk_fma_f32 v[148:149], v[148:149], v[170:171], v[170:171] op_sel_hi:[1,0,0]
    v_pk_fma_f32 v[150:151], v[150:151], v[170:171], v[170:171] op_sel_hi:[1,0,0]
    v_pk_fma_f32 v[152:153], v[152:153], v[170:171], v[170:171] op_sel_hi:[1,0,0]
    v_pk_fma_f32 v[154:155], v[154:155], v[170:171], v[170:171] op_sel_hi:[1,0,0]
    v_rcp_f32 v148, v148
    v_rcp_f32 v149, v149
    v_rcp_f32 v150, v150
    v_rcp_f32 v151, v151
    v_rcp_f32 v152, v152
    v_rcp_f32 v153, v153
    v_rcp_f32 v154, v154
    v_rcp_f32 v155, v155
    v_pk_mul_f32 v[72:73], v[72:73], v[148:149]
    v_pk_mul_f32 v[74:75], v[74:75], v[150:151]
    v_pk_mul_f32 v[76:77], v[76:77], v[152:153]
    v_pk_mul_f32 v[78:79], v[78:79], v[154:155]
    v_cvt_pk_bf16_f32 v160, v72, v73
    v_cvt_pk_bf16_f32 v162, v76, v77
    v_cvt_pk_bf16_f32 v161, v74, v75
    v_cvt_pk_bf16_f32 v163, v78, v79
    v_permlane16_swap_b32 v160, v162
    s_nop 0
    v_permlane16_swap_b32 v161, v163
    buffer_store_dwordx4 v[160:163], v3, s[4:7], s62 offen offset:2048 sc1
    s_and_b32 s67, s38, 3
    s_cmp_eq_u32 s67, 3
    s_cbranch_scc1 L_six_353
    v_pk_mul_f32 v[140:141], v[108:109], v[172:173] op_sel:[0,1] op_sel_hi:[1,1]
    v_pk_mul_f32 v[142:143], v[110:111], v[172:173] op_sel:[0,1] op_sel_hi:[1,1]
    v_exp_f32 v140, v140
    v_exp_f32 v141, v141
    v_exp_f32 v142, v142
    v_exp_f32 v143, v143
    v_pk_fma_f32 v[140:141], v[140:141], v[174:175], v[174:175] op_sel_hi:[1,0,0]
    v_pk_fma_f32 v[142:143], v[142:143], v[174:175], v[174:175] op_sel_hi:[1,0,0]
    v_rcp_f32 v140, v140
    v_rcp_f32 v141, v141
    v_rcp_f32 v142, v142
    v_rcp_f32 v143, v143
    v_pk_mul_f32 v[108:109], v[108:109], v[140:141]
    v_pk_mul_f32 v[110:111], v[110:111], v[142:143]
    v_cvt_pk_bf16_f32 v156, v108, v109
    v_cvt_pk_bf16_f32 v158, v108, v109
    v_cvt_pk_bf16_f32 v157, v110, v111
    v_cvt_pk_bf16_f32 v159, v110, v111
    v_permlane16_swap_b32 v156, v158
    s_nop 0
    v_permlane16_swap_b32 v157, v159
    buffer_store_dwordx4 v[156:159], v4, s[4:7], s63 offen offset:3072 sc1
L_six_353:
    v_pk_mul_f32 v[148:149], v[84:85], v[172:173] op_sel:[0,1] op_sel_hi:[1,1]
    v_pk_mul_f32 v[150:151], v[86:87], v[172:173] op_sel:[0,1] op_sel_hi:[1,1]
    v_pk_mul_f32 v[152:153], v[88:89], v[172:173] op_sel:[0,1] op_sel_hi:[1,1]
    v_pk_mul_f32 v[154:155], v[90:91], v[172:173] op_sel:[0,1] op_sel_hi:[1,1]
    v_exp_f32 v148, v148
    v_exp_f32 v149, v149
    v_exp_f32 v150, v150
    v_exp_f32 v151, v151
    v_exp_f32 v152, v152
    v_exp_f32 v153, v153
    v_exp_f32 v154, v154
    v_exp_f32 v155, v155
    v_pk_fma_f32 v[148:149], v[148:149], v[174:175], v[174:175] op_sel_hi:[1,0,0]
    v_pk_fma_f32 v[150:151], v[150:151], v[174:175], v[174:175] op_sel_hi:[1,0,0]
    v_pk_fma_f32 v[152:153], v[152:153], v[174:175], v[174:175] op_sel_hi:[1,0,0]
    v_pk_fma_f32 v[154:155], v[154:155], v[174:175], v[174:175] op_sel_hi:[1,0,0]
    v_rcp_f32 v148, v148
    v_rcp_f32 v149, v149
    v_rcp_f32 v150, v150
    v_rcp_f32 v151, v151
    v_rcp_f32 v152, v152
    v_rcp_f32 v153, v153
    v_rcp_f32 v154, v154
    v_rcp_f32 v155, v155
    v_pk_mul_f32 v[84:85], v[84:85], v[148:149]
    v_pk_mul_f32 v[86:87], v[86:87], v[150:151]
    v_pk_mul_f32 v[88:89], v[88:89], v[152:153]
    v_pk_mul_f32 v[90:91], v[90:91], v[154:155]
    v_cvt_pk_bf16_f32 v160, v84, v85
    v_cvt_pk_bf16_f32 v162, v88, v89
    v_cvt_pk_bf16_f32 v161, v86, v87
    v_cvt_pk_bf16_f32 v163, v90, v91
    v_permlane16_swap_b32 v160, v162
    s_nop 0
    v_permlane16_swap_b32 v161, v163
    buffer_store_dwordx4 v[160:163], v3, s[4:7], s63 offen offset:0 sc1
    s_waitcnt vmcnt(1)
    buffer_store_dword v0, v14, s[4:7], s53 offen offset:0 sc1
    v_pk_mul_f32 v[140:141], v[92:93], v[172:173] op_sel:[0,1] op_sel_hi:[1,1]
    v_pk_mul_f32 v[142:143], v[94:95], v[172:173] op_sel:[0,1] op_sel_hi:[1,1]
    v_pk_mul_f32 v[144:145], v[96:97], v[172:173] op_sel:[0,1] op_sel_hi:[1,1]
    v_pk_mul_f32 v[146:147], v[98:99], v[172:173] op_sel:[0,1] op_sel_hi:[1,1]
    v_exp_f32 v140, v140
    v_exp_f32 v141, v141
    v_exp_f32 v142, v142
    v_exp_f32 v143, v143
    v_exp_f32 v144, v144
    v_exp_f32 v145, v145
    v_exp_f32 v146, v146
    v_exp_f32 v147, v147
    v_pk_fma_f32 v[140:141], v[140:141], v[174:175], v[174:175] op_sel_hi:[1,0,0]
    v_pk_fma_f32 v[142:143], v[142:143], v[174:175], v[174:175] op_sel_hi:[1,0,0]
    v_pk_fma_f32 v[144:145], v[144:145], v[174:175], v[174:175] op_sel_hi:[1,0,0]
    v_pk_fma_f32 v[146:147], v[146:147], v[174:175], v[174:175] op_sel_hi:[1,0,0]
    v_rcp_f32 v140, v140
    v_rcp_f32 v141, v141
    v_rcp_f32 v142, v142
    v_rcp_f32 v143, v143
    v_rcp_f32 v144, v144
    v_rcp_f32 v145, v145
    v_rcp_f32 v146, v146
    v_rcp_f32 v147, v147
    v_pk_mul_f32 v[92:93], v[92:93], v[140:141]
    v_pk_mul_f32 v[94:95], v[94:95], v[142:143]
    v_pk_mul_f32 v[96:97], v[96:97], v[144:145]
    v_pk_mul_f32 v[98:99], v[98:99], v[146:147]
    v_cvt_pk_bf16_f32 v156, v92, v93
    v_cvt_pk_bf16_f32 v158, v96, v97
    v_cvt_pk_bf16_f32 v157, v94, v95
    v_cvt_pk_bf16_f32 v159, v98, v99
    v_permlane16_swap_b32 v156, v158
    s_nop 0
    v_permlane16_swap_b32 v157, v159
    buffer_store_dwordx4 v[156:159], v3, s[4:7], s63 offen offset:1024 sc1
    buffer_load_dword v29, v24, s[4:7], s56 offen offset:0 sc1
    v_pk_mul_f32 v[148:149], v[100:101], v[172:173] op_sel:[0,1] op_sel_hi:[1,1]
    v_pk_mul_f32 v[150:151], v[102:103], v[172:173] op_sel:[0,1] op_sel_hi:[1,1]
    v_pk_mul_f32 v[152:153], v[104:105], v[172:173] op_sel:[0,1] op_sel_hi:[1,1]
    v_pk_mul_f32 v[154:155], v[106:107], v[172:173] op_sel:[0,1] op_sel_hi:[1,1]
    v_exp_f32 v148, v148
    v_exp_f32 v149, v149
    v_exp_f32 v150, v150
    v_exp_f32 v151, v151
    v_exp_f32 v152, v152
    v_exp_f32 v153, v153
    v_exp_f32 v154, v154
    v_exp_f32 v155, v155
    v_pk_fma_f32 v[148:149], v[148:149], v[174:175], v[174:175] op_sel_hi:[1,0,0]
    v_pk_fma_f32 v[150:151], v[150:151], v[174:175], v[174:175] op_sel_hi:[1,0,0]
    v_pk_fma_f32 v[152:153], v[152:153], v[174:175], v[174:175] op_sel_hi:[1,0,0]
    v_pk_fma_f32 v[154:155], v[154:155], v[174:175], v[174:175] op_sel_hi:[1,0,0]
    v_rcp_f32 v148, v148
    v_rcp_f32 v149, v149
    v_rcp_f32 v150, v150
    v_rcp_f32 v151, v151
    v_rcp_f32 v152, v152
    v_rcp_f32 v153, v153
    v_rcp_f32 v154, v154
    v_rcp_f32 v155, v155
    v_pk_mul_f32 v[100:101], v[100:101], v[148:149]
    v_pk_mul_f32 v[102:103], v[102:103], v[150:151]
    v_pk_mul_f32 v[104:105], v[104:105], v[152:153]
    v_pk_mul_f32 v[106:107], v[106:107], v[154:155]
    v_cvt_pk_bf16_f32 v160, v100, v101
    v_cvt_pk_bf16_f32 v162, v104, v105
    v_cvt_pk_bf16_f32 v161, v102, v103
    v_cvt_pk_bf16_f32 v163, v106, v107
    v_permlane16_swap_b32 v160, v162
    s_nop 0
    v_permlane16_swap_b32 v161, v163
    buffer_store_dwordx4 v[160:163], v3, s[4:7], s63 offen offset:2048 sc1
    s_branch L_join_119
L_safe_125:
    buffer_store_dword v0, v14, s[4:7], s53 offen offset:0 sc1
    s_branch L_join_126
L_safe_130:
    buffer_store_dwordx4 v[172:175], v1, s[8:11], s64 offen offset:0 sc1
    s_branch L_join_131
L_safe_132:
    buffer_store_dwordx4 v[176:179], v1, s[8:11], s64 offen offset:1024 sc1
    s_branch L_join_133
L_safe_134:
    buffer_store_dwordx2 v[180:181], v9, s[8:11], s64 offen offset:2048 sc1
    s_branch L_join_135
L_safe_136:
    buffer_store_dword v0, v14, s[4:7], s53 offen offset:0 sc1
    s_branch L_join_137
L_safe_141:
    v_cvt_pk_bf16_f32 v56, v32, v33
    v_cvt_pk_bf16_f32 v58, v36, v37
    v_cvt_pk_bf16_f32 v57, v34, v35
    v_cvt_pk_bf16_f32 v59, v38, v39
    v_permlane16_swap_b32 v56, v58
    v_cvt_pk_bf16_f32 v60, v40, v41
    v_cvt_pk_bf16_f32 v62, v44, v45
    v_cvt_pk_bf16_f32 v61, v42, v43
    v_cvt_pk_bf16_f32 v63, v46, v47
    v_permlane16_swap_b32 v57, v59
    buffer_store_dwordx4 v[56:59], v3, s[8:11], s34 offen offset:0 sc1
    v_permlane16_swap_b32 v60, v62
    v_cvt_pk_bf16_f32 v64, v48, v49
    v_cvt_pk_bf16_f32 v66, v48, v49
    v_cvt_pk_bf16_f32 v65, v50, v51
    v_cvt_pk_bf16_f32 v67, v50, v51
    v_permlane16_swap_b32 v61, v63
    buffer_store_dwordx4 v[60:63], v3, s[8:11], s34 offen offset:1024 sc1
    v_permlane16_swap_b32 v64, v66
    v_permlane16_swap_b32 v65, v67
    buffer_store_dwordx4 v[64:67], v4, s[8:11], s34 offen offset:2048 sc1
    v_pk_add_f32 v[68:69], v[32:33], v[34:35]
    v_pk_mul_f32 v[70:71], v[32:33], v[32:33]
    v_pk_fma_f32 v[70:71], v[34:35], v[34:35], v[70:71]
    v_pk_add_f32 v[68:69], v[68:69], v[36:37]
    v_pk_fma_f32 v[70:71], v[36:37], v[36:37], v[70:71]
    v_pk_add_f32 v[68:69], v[68:69], v[38:39]
    v_pk_fma_f32 v[70:71], v[38:39], v[38:39], v[70:71]
    v_pk_add_f32 v[68:69], v[68:69], v[40:41]
    v_pk_fma_f32 v[70:71], v[40:41], v[40:41], v[70:71]
    v_pk_add_f32 v[68:69], v[68:69], v[42:43]
    v_pk_fma_f32 v[70:71], v[42:43], v[42:43], v[70:71]
    v_pk_add_f32 v[68:69], v[68:69], v[44:45]
    v_pk_fma_f32 v[70:71], v[44:45], v[44:45], v[70:71]
    v_pk_add_f32 v[68:69], v[68:69], v[46:47]
    v_pk_fma_f32 v[70:71], v[46:47], v[46:47], v[70:71]
    v_pk_add_f32 v[68:69], v[68:69], v[48:49]
    v_pk_fma_f32 v[70:71], v[48:49], v[48:49], v[70:71]
    v_pk_add_f32 v[68:69], v[68:69], v[50:51]
    v_pk_fma_f32 v[70:71], v[50:51], v[50:51], v[70:71]
    v_add_f32 v68, v68, v69
    v_add_f32 v69, v70, v71
    s_nop 1
    v_permlane16_swap_b32 v68, v69
    v_add_f32 v68, v68, v69
    v_mov_b32 v69, v68
    s_nop 1
    v_permlane32_swap_b32 v68, v69
    v_add_f32 v68, v68, v69
    v_mov_b32 v69, v68
    s_nop 1
    v_permlane16_swap_b32 v68, v69
    buffer_store_dwordx2 v[68:69], v8, s[4:7], s35 offen offset:0 sc1
    ds_read_b128 v[120:123], v236 offset:0
    ds_read_b128 v[124:127], v236 offset:1024
    ds_read_b128 v[128:131], v236 offset:2048
    ds_read_b128 v[132:135], v236 offset:3072
    s_waitcnt vmcnt(4)
    v_sub_u32 v28, v28, v15
    v_subrev_u32 v28, 7, v28
    v_cmp_lt_u32 vcc, 1, v28
    s_nop 0
    s_and_b32 vcc_hi, vcc_lo, 4294901760
    s_cbranch_scc0 L_xearly_354
    s_waitcnt vmcnt(1)
    buffer_store_dword v0, v14, s[4:7], s49 offen offset:0 sc1
L_poll_356:
    buffer_load_dword v26, v12, s[4:7], s46 offen offset:2048 sc1
    s_waitcnt vmcnt(0)
    v_sub_u32 v26, v26, v15
    v_subrev_u32 v26, 7, v26
    v_cmp_lt_u32 vcc, 1, v26
    s_nop 0
    s_and_b32 vcc_hi, vcc_lo, 4294901760
    s_cbranch_scc0 L_polled_357
    s_sub_u32 s44, s44, 1
    s_cbranch_scc0 L_poll_356
    s_mov_b32 s44, 0
L_polled_357:
    buffer_load_dwordx4 v[144:147], v2, s[8:11], s31 offen offset:0 sc1
    buffer_load_dwordx4 v[148:151], v2, s[8:11], s31 offen offset:512 sc1
    buffer_load_dwordx4 v[152:155], v2, s[8:11], s31 offen offset:1024 sc1
    buffer_load_dwordx4 v[156:159], v2, s[8:11], s31 offen offset:1536 sc1
    buffer_load_dwordx4 v[160:163], v2, s[8:11], s31 offen offset:2048 sc1
    s_branch L_xjoin_355
L_xearly_354:
    buffer_load_dwordx4 v[144:147], v2, s[8:11], s31 offen offset:0 sc1
    buffer_load_dwordx4 v[148:151], v2, s[8:11], s31 offen offset:512 sc1
    buffer_load_dwordx4 v[152:155], v2, s[8:11], s31 offen offset:1024 sc1
    buffer_load_dwordx4 v[156:159], v2, s[8:11], s31 offen offset:1536 sc1
    buffer_load_dwordx4 v[160:163], v2, s[8:11], s31 offen offset:2048 sc1
    s_waitcnt vmcnt(6)
    buffer_store_dword v0, v14, s[4:7], s49 offen offset:0 sc1
L_xjoin_355:
    s_branch L_join_142
L_safe_147:
    buffer_store_dword v0, v14, s[4:7], s49 offen offset:0 sc1
    s_branch L_join_148
L_safe_168:
    buffer_store_dwordx4 v[172:175], v5, s[4:7], s54 offen offset:0 sc1
    buffer_store_dwordx2 v[176:177], v6, s[4:7], s54 offen offset:512 sc1
    s_branch L_join_169
L_safe_171:
    buffer_store_dword v0, v14, s[4:7], s41 offen offset:0 sc1
    s_branch L_join_172
L_safe_175:
    buffer_store_dwordx4 v[172:175], v5, s[4:7], s54 offen offset:0 sc1
    buffer_store_dwordx2 v[176:177], v6, s[4:7], s54 offen offset:512 sc1
    s_branch L_join_176
L_fallback_173:
    s_cmp_eq_u32 s37, 0
    s_cselect_b32 s63, 8, 0
    v_mov_b32 v184, 0xff800000
L_fbl_358:
    s_mul_i32 s62, s63, 3072
    v_add_u32 v180, s62, v16
    v_add_u32 v181, s62, v18
    v_add_u32 v182, s62, v19
    v_add_u32 v183, s62, v20
    ds_read_b128 v[136:139], v180
    ds_read_b64 v[140:141], v181
    ds_read_b64_tr_b16 v[152:153], v182 offset:0
    ds_read_b64_tr_b16 v[154:155], v183 offset:0
    ds_read_b64_tr_b16 v[156:157], v182 offset:256
    ds_read_b64_tr_b16 v[158:159], v183 offset:256
    s_waitcnt lgkmcnt(0)
    s_cmp_lg_u32 s63, 0
    s_cbranch_scc1 L_fbnf_359
    v_mfma_f32_32x32x16_bf16 v[88:103], v[136:139], v[240:243], v[208:223]
    s_branch L_fbgo_361
L_fbnf_359:
    s_cmp_lg_u32 s63, 8
    s_cbranch_scc1 L_fbnd_360
    v_mfma_f32_32x32x16_bf16 v[88:103], v[136:139], v[240:243], v[192:207]
    s_branch L_fbgo_361
L_fbnd_360:
    v_mfma_f32_32x32x16_bf16 v[88:103], v[136:139], v[240:243], 0
L_fbgo_361:
    v_mfma_f32_32x32x8bf16_1k v[88:103], v[140:141], v[244:245], v[88:103]
    s_nop 11
    v_max3_f32 v184, v88, v89, v184
    v_max3_f32 v184, v90, v91, v184
    v_max3_f32 v184, v92, v93, v184
    v_max3_f32 v184, v94, v95, v184
    v_max3_f32 v184, v96, v97, v184
    v_max3_f32 v184, v98, v99, v184
    v_max3_f32 v184, v100, v101, v184
    v_max3_f32 v184, v102, v103, v184
    s_add_u32 s63, s63, 1
    s_cmp_le_u32 s63, 8
    s_cbranch_scc1 L_fbl_358
    v_mov_b32 v185, v184
    s_nop 1
    v_permlane32_swap_b32 v184, v185
    v_max_f32 v184, v184, v185
    s_cmp_eq_u32 s37, 0
    s_cselect_b32 s63, 8, 0
    v_mov_b32 v56, 0
    v_mov_b32 v57, 0
    v_mov_b32 v58, 0
    v_mov_b32 v59, 0
    v_mov_b32 v60, 0
    v_mov_b32 v61, 0
    v_mov_b32 v62, 0
    v_mov_b32 v63, 0
    v_mov_b32 v64, 0
    v_mov_b32 v65, 0
    v_mov_b32 v66, 0
    v_mov_b32 v67, 0
    v_mov_b32 v68, 0
    v_mov_b32 v69, 0
    v_mov_b32 v70, 0
    v_mov_b32 v71, 0
L_fbl_362:
    s_mul_i32 s62, s63, 3072
    v_add_u32 v180, s62, v16
    v_add_u32 v181, s62, v18
    v_add_u32 v182, s62, v19
    v_add_u32 v183, s62, v20
    ds_read_b128 v[136:139], v180
    ds_read_b64 v[140:141], v181
    ds_read_b64_tr_b16 v[152:153], v182 offset:0
    ds_read_b64_tr_b16 v[154:155], v183 offset:0
    ds_read_b64_tr_b16 v[156:157], v182 offset:256
    ds_read_b64_tr_b16 v[158:159], v183 offset:256
    s_waitcnt lgkmcnt(0)
    s_cmp_lg_u32 s63, 0
    s_cbranch_scc1 L_fbnf_363
    v_mfma_f32_32x32x16_bf16 v[88:103], v[136:139], v[240:243], v[208:223]
    s_branch L_fbgo_365
L_fbnf_363:
    s_cmp_lg_u32 s63, 8
    s_cbranch_scc1 L_fbnd_364
    v_mfma_f32_32x32x16_bf16 v[88:103], v[136:139], v[240:243], v[192:207]
    s_branch L_fbgo_365
L_fbnd_364:
    v_mfma_f32_32x32x16_bf16 v[88:103], v[136:139], v[240:243], 0
L_fbgo_365:
    v_mfma_f32_32x32x8bf16_1k v[88:103], v[140:141], v[244:245], v[88:103]
    s_nop 11
    v_sub_f32 v88, v88, v184
    v_sub_f32 v89, v89, v184
    v_sub_f32 v90, v90, v184
    v_sub_f32 v91, v91, v184
    v_sub_f32 v92, v92, v184
    v_sub_f32 v93, v93, v184
    v_sub_f32 v94, v94, v184
    v_sub_f32 v95, v95, v184
    v_sub_f32 v96, v96, v184
    v_sub_f32 v97, v97, v184
    v_sub_f32 v98, v98, v184
    v_sub_f32 v99, v99, v184
    v_sub_f32 v100, v100, v184
    v_sub_f32 v101, v101, v184
    v_sub_f32 v102, v102, v184
    v_sub_f32 v103, v103, v184
    v_exp_f32 v88, v88
    v_exp_f32 v89, v89
    v_exp_f32 v90, v90
    v_exp_f32 v91, v91
    v_exp_f32 v92, v92
    v_exp_f32 v93, v93
    v_exp_f32 v94, v94
    v_exp_f32 v95, v95
    v_exp_f32 v96, v96
    v_exp_f32 v97, v97
    v_exp_f32 v98, v98
    v_exp_f32 v99, v99
    v_exp_f32 v100, v100
    v_exp_f32 v101, v101
    v_exp_f32 v102, v102
    v_exp_f32 v103, v103
    v_cvt_pk_bf16_f32 v120, v88, v89
    v_cvt_pk_bf16_f32 v121, v90, v91
    v_cvt_pk_bf16_f32 v122, v92, v93
    v_cvt_pk_bf16_f32 v123, v94, v95
    v_cvt_pk_bf16_f32 v124, v96, v97
    v_cvt_pk_bf16_f32 v125, v98, v99
    v_cvt_pk_bf16_f32 v126, v100, v101
    v_cvt_pk_bf16_f32 v127, v102, v103
    v_mfma_f32_32x32x16_bf16 v[56:71], v[152:155], v[120:123], v[56:71]
    s_nop 0
    v_mfma_f32_32x32x16_bf16 v[56:71], v[156:159], v[124:127], v[56:71]
    s_add_u32 s63, s63, 1
    s_cmp_le_u32 s63, 8
    s_cbranch_scc1 L_fbl_362
    s_cmp_eq_u32 s37, 0
    s_cselect_b32 s63, 8, 7
    v_mov_b32 v184, 0xff800000
L_fbl_366:
    s_mul_i32 s62, s63, 3072
    v_add_u32 v180, s62, v16
    v_add_u32 v181, s62, v18
    v_add_u32 v182, s62, v19
    v_add_u32 v183, s62, v20
    ds_read_b128 v[136:139], v180
    ds_read_b64 v[140:141], v181
    ds_read_b64_tr_b16 v[152:153], v182 offset:0
    ds_read_b64_tr_b16 v[154:155], v183 offset:0
    ds_read_b64_tr_b16 v[156:157], v182 offset:256
    ds_read_b64_tr_b16 v[158:159], v183 offset:256
    s_waitcnt lgkmcnt(0)
    s_cmp_lg_u32 s63, 7
    s_cbranch_scc1 L_fbnf_367
    v_mfma_f32_32x32x16_bf16 v[88:103], v[136:139], v[248:251], v[208:223]
    s_branch L_fbgo_369
L_fbnf_367:
    s_cmp_lg_u32 s63, 15
    s_cbranch_scc1 L_fbnd_368
    v_mfma_f32_32x32x16_bf16 v[88:103], v[136:139], v[248:251], v[192:207]
    s_branch L_fbgo_369
L_fbnd_368:
    v_mfma_f32_32x32x16_bf16 v[88:103], v[136:139], v[248:251], 0
L_fbgo_369:
    v_mfma_f32_32x32x8bf16_1k v[88:103], v[140:141], v[252:253], v[88:103]
    s_nop 11
    v_max3_f32 v184, v88, v89, v184
    v_max3_f32 v184, v90, v91, v184
    v_max3_f32 v184, v92, v93, v184
    v_max3_f32 v184, v94, v95, v184
    v_max3_f32 v184, v96, v97, v184
    v_max3_f32 v184, v98, v99, v184
    v_max3_f32 v184, v100, v101, v184
    v_max3_f32 v184, v102, v103, v184
    s_add_u32 s63, s63, 1
    s_cmp_le_u32 s63, 15
    s_cbranch_scc1 L_fbl_366
    v_mov_b32 v185, v184
    s_nop 1
    v_permlane32_swap_b32 v184, v185
    v_max_f32 v184, v184, v185
    s_cmp_eq_u32 s37, 0
    s_cselect_b32 s63, 8, 7
    v_mov_b32 v72, 0
    v_mov_b32 v73, 0
    v_mov_b32 v74, 0
    v_mov_b32 v75, 0
    v_mov_b32 v76, 0
    v_mov_b32 v77, 0
    v_mov_b32 v78, 0
    v_mov_b32 v79, 0
    v_mov_b32 v80, 0
    v_mov_b32 v81, 0
    v_mov_b32 v82, 0
    v_mov_b32 v83, 0
    v_mov_b32 v84, 0
    v_mov_b32 v85, 0
    v_mov_b32 v86, 0
    v_mov_b32 v87, 0
L_fbl_370:
    s_mul_i32 s62, s63, 3072
    v_add_u32 v180, s62, v16
    v_add_u32 v181, s62, v18
    v_add_u32 v182, s62, v19
    v_add_u32 v183, s62, v20
    ds_read_b128 v[136:139], v180
    ds_read_b64 v[140:141], v181
    ds_read_b64_tr_b16 v[152:153], v182 offset:0
    ds_read_b64_tr_b16 v[154:155], v183 offset:0
    ds_read_b64_tr_b16 v[156:157], v182 offset:256
    ds_read_b64_tr_b16 v[158:159], v183 offset:256
    s_waitcnt lgkmcnt(0)
    s_cmp_lg_u32 s63, 7
    s_cbranch_scc1 L_fbnf_371
    v_mfma_f32_32x32x16_bf16 v[88:103], v[136:139], v[248:251], v[208:223]
    s_branch L_fbgo_373
L_fbnf_371:
    s_cmp_lg_u32 s63, 15
    s_cbranch_scc1 L_fbnd_372
    v_mfma_f32_32x32x16_bf16 v[88:103], v[136:139], v[248:251], v[192:207]
    s_branch L_fbgo_373
L_fbnd_372:
    v_mfma_f32_32x32x16_bf16 v[88:103], v[136:139], v[248:251], 0
L_fbgo_373:
    v_mfma_f32_32x32x8bf16_1k v[88:103], v[140:141], v[252:253], v[88:103]
    s_nop 11
    v_sub_f32 v88, v88, v184
    v_sub_f32 v89, v89, v184
    v_sub_f32 v90, v90, v184
    v_sub_f32 v91, v91, v184
    v_sub_f32 v92, v92, v184
    v_sub_f32 v93, v93, v184
    v_sub_f32 v94, v94, v184
    v_sub_f32 v95, v95, v184
    v_sub_f32 v96, v96, v184
    v_sub_f32 v97, v97, v184
    v_sub_f32 v98, v98, v184
    v_sub_f32 v99, v99, v184
    v_sub_f32 v100, v100, v184
    v_sub_f32 v101, v101, v184
    v_sub_f32 v102, v102, v184
    v_sub_f32 v103, v103, v184
    v_exp_f32 v88, v88
    v_exp_f32 v89, v89
    v_exp_f32 v90, v90
    v_exp_f32 v91, v91
    v_exp_f32 v92, v92
    v_exp_f32 v93, v93
    v_exp_f32 v94, v94
    v_exp_f32 v95, v95
    v_exp_f32 v96, v96
    v_exp_f32 v97, v97
    v_exp_f32 v98, v98
    v_exp_f32 v99, v99
    v_exp_f32 v100, v100
    v_exp_f32 v101, v101
    v_exp_f32 v102, v102
    v_exp_f32 v103, v103
    v_cvt_pk_bf16_f32 v120, v88, v89
    v_cvt_pk_bf16_f32 v121, v90, v91
    v_cvt_pk_bf16_f32 v122, v92, v93
    v_cvt_pk_bf16_f32 v123, v94, v95
    v_cvt_pk_bf16_f32 v124, v96, v97
    v_cvt_pk_bf16_f32 v125, v98, v99
    v_cvt_pk_bf16_f32 v126, v100, v101
    v_cvt_pk_bf16_f32 v127, v102, v103
    v_mfma_f32_32x32x16_bf16 v[72:87], v[152:155], v[120:123], v[72:87]
    s_nop 0
    v_mfma_f32_32x32x16_bf16 v[72:87], v[156:159], v[124:127], v[72:87]
    s_add_u32 s63, s63, 1
    s_cmp_le_u32 s63, 15
    s_cbranch_scc1 L_fbl_370
    s_cmp_eq_u32 s26, 0
    s_cbranch_scc1 L_hikept_374
    s_nop 6
    v_rcp_f32 v86, v84
    s_add_u32 s54, s56, 8960
    v_pk_mul_f32 v[72:73], v[72:73], v[86:87] op_sel_hi:[1,0]
    v_pk_mul_f32 v[74:75], v[74:75], v[86:87] op_sel_hi:[1,0]
    v_pk_mul_f32 v[76:77], v[76:77], v[86:87] op_sel_hi:[1,0]
    v_pk_mul_f32 v[78:79], v[78:79], v[86:87] op_sel_hi:[1,0]
    v_pk_mul_f32 v[80:81], v[80:81], v[86:87] op_sel_hi:[1,0]
    v_pk_mul_f32 v[82:83], v[82:83], v[86:87] op_sel_hi:[1,0]
    v_cvt_pk_bf16_f32 v172, v72, v73
    v_cvt_pk_bf16_f32 v173, v74, v75
    v_cvt_pk_bf16_f32 v174, v76, v77
    v_cvt_pk_bf16_f32 v175, v78, v79
    v_cvt_pk_bf16_f32 v176, v80, v81
    v_cvt_pk_bf16_f32 v177, v82, v83
    s_cmp_eq_u32 s43, 0
    s_cbranch_scc1 L_safe_375
    buffer_store_dwordx4 v[172:175], v5, s[4:7], s54 offen offset:0
    buffer_store_dwordx2 v[176:177], v6, s[4:7], s54 offen offset:512
L_join_376:
L_hikept_374:
    v_rcp_f32 v70, v68
    s_add_u32 s54, s56, 0
    v_pk_mul_f32 v[56:57], v[56:57], v[70:71] op_sel_hi:[1,0]
    v_pk_mul_f32 v[58:59], v[58:59], v[70:71] op_sel_hi:[1,0]
    v_pk_mul_f32 v[60:61], v[60:61], v[70:71] op_sel_hi:[1,0]
    v_pk_mul_f32 v[62:63], v[62:63], v[70:71] op_sel_hi:[1,0]
    v_pk_mul_f32 v[64:65], v[64:65], v[70:71] op_sel_hi:[1,0]
    v_pk_mul_f32 v[66:67], v[66:67], v[70:71] op_sel_hi:[1,0]
    v_cvt_pk_bf16_f32 v172, v56, v57
    v_cvt_pk_bf16_f32 v173, v58, v59
    v_cvt_pk_bf16_f32 v174, v60, v61
    v_cvt_pk_bf16_f32 v175, v62, v63
    v_cvt_pk_bf16_f32 v176, v64, v65
    v_cvt_pk_bf16_f32 v177, v66, v67
    s_cmp_eq_u32 s43, 0
    s_cbranch_scc1 L_safe_377
    buffer_store_dwordx4 v[172:175], v5, s[4:7], s54 offen offset:0
    buffer_store_dwordx2 v[176:177], v6, s[4:7], s54 offen offset:512
L_join_378:
    s_branch L_fbdone_174
L_safe_185:
    buffer_store_dwordx4 v[172:175], v5, s[4:7], s54 offen offset:0 sc1
    buffer_store_dwordx2 v[176:177], v6, s[4:7], s54 offen offset:512 sc1
    s_branch L_join_186
L_safe_188:
    buffer_store_dword v0, v14, s[4:7], s41 offen offset:0 sc1
    s_branch L_join_189
L_safe_192:
    buffer_store_dwordx4 v[172:175], v5, s[4:7], s54 offen offset:0 sc1
    buffer_store_dwordx2 v[176:177], v6, s[4:7], s54 offen offset:512 sc1
    s_branch L_join_193
L_fallback_190:
    s_cmp_eq_u32 s37, 0
    s_cselect_b32 s63, 8, 1
    v_mov_b32 v184, 0xff800000
L_fbl_379:
    s_mul_i32 s62, s63, 3072
    v_add_u32 v180, s62, v16
    v_add_u32 v181, s62, v18
    v_add_u32 v182, s62, v19
    v_add_u32 v183, s62, v20
    ds_read_b128 v[136:139], v180
    ds_read_b64 v[140:141], v181
    ds_read_b64_tr_b16 v[152:153], v182 offset:0
    ds_read_b64_tr_b16 v[154:155], v183 offset:0
    ds_read_b64_tr_b16 v[156:157], v182 offset:256
    ds_read_b64_tr_b16 v[158:159], v183 offset:256
    s_waitcnt lgkmcnt(0)
    s_cmp_lg_u32 s63, 1
    s_cbranch_scc1 L_fbnf_380
    v_mfma_f32_32x32x16_bf16 v[88:103], v[136:139], v[240:243], v[208:223]
    s_branch L_fbgo_382
L_fbnf_380:
    s_cmp_lg_u32 s63, 9
    s_cbranch_scc1 L_fbnd_381
    v_mfma_f32_32x32x16_bf16 v[88:103], v[136:139], v[240:243], v[192:207]
    s_branch L_fbgo_382
L_fbnd_381:
    v_mfma_f32_32x32x16_bf16 v[88:103], v[136:139], v[240:243], 0
L_fbgo_382:
    v_mfma_f32_32x32x8bf16_1k v[88:103], v[140:141], v[244:245], v[88:103]
    s_nop 11
    v_max3_f32 v184, v88, v89, v184
    v_max3_f32 v184, v90, v91, v184
    v_max3_f32 v184, v92, v93, v184
    v_max3_f32 v184, v94, v95, v184
    v_max3_f32 v184, v96, v97, v184
    v_max3_f32 v184, v98, v99, v184
    v_max3_f32 v184, v100, v101, v184
    v_max3_f32 v184, v102, v103, v184
    s_add_u32 s63, s63, 1
    s_cmp_le_u32 s63, 9
    s_cbranch_scc1 L_fbl_379
    v_mov_b32 v185, v184
    s_nop 1
    v_permlane32_swap_b32 v184, v185
    v_max_f32 v184, v184, v185
    s_cmp_eq_u32 s37, 0
    s_cselect_b32 s63, 8, 1
    v_mov_b32 v56, 0
    v_mov_b32 v57, 0
    v_mov_b32 v58, 0
    v_mov_b32 v59, 0
    v_mov_b32 v60, 0
    v_mov_b32 v61, 0
    v_mov_b32 v62, 0
    v_mov_b32 v63, 0
    v_mov_b32 v64, 0
    v_mov_b32 v65, 0
    v_mov_b32 v66, 0
    v_mov_b32 v67, 0
    v_mov_b32 v68, 0
    v_mov_b32 v69, 0
    v_mov_b32 v70, 0
    v_mov_b32 v71, 0
L_fbl_383:
    s_mul_i32 s62, s63, 3072
    v_add_u32 v180, s62, v16
    v_add_u32 v181, s62, v18
    v_add_u32 v182, s62, v19
    v_add_u32 v183, s62, v20
    ds_read_b128 v[136:139], v180
    ds_read_b64 v[140:141], v181
    ds_read_b64_tr_b16 v[152:153], v182 offset:0
    ds_read_b64_tr_b16 v[154:155], v183 offset:0
    ds_read_b64_tr_b16 v[156:157], v182 offset:256
    ds_read_b64_tr_b16 v[158:159], v183 offset:256
    s_waitcnt lgkmcnt(0)
    s_cmp_lg_u32 s63, 1
    s_cbranch_scc1 L_fbnf_384
    v_mfma_f32_32x32x16_bf16 v[88:103], v[136:139], v[240:243], v[208:223]
    s_branch L_fbgo_386
L_fbnf_384:
    s_cmp_lg_u32 s63, 9
    s_cbranch_scc1 L_fbnd_385
    v_mfma_f32_32x32x16_bf16 v[88:103], v[136:139], v[240:243], v[192:207]
    s_branch L_fbgo_386
L_fbnd_385:
    v_mfma_f32_32x32x16_bf16 v[88:103], v[136:139], v[240:243], 0
L_fbgo_386:
    v_mfma_f32_32x32x8bf16_1k v[88:103], v[140:141], v[244:245], v[88:103]
    s_nop 11
    v_sub_f32 v88, v88, v184
    v_sub_f32 v89, v89, v184
    v_sub_f32 v90, v90, v184
    v_sub_f32 v91, v91, v184
    v_sub_f32 v92, v92, v184
    v_sub_f32 v93, v93, v184
    v_sub_f32 v94, v94, v184
    v_sub_f32 v95, v95, v184
    v_sub_f32 v96, v96, v184
    v_sub_f32 v97, v97, v184
    v_sub_f32 v98, v98, v184
    v_sub_f32 v99, v99, v184
    v_sub_f32 v100, v100, v184
    v_sub_f32 v101, v101, v184
    v_sub_f32 v102, v102, v184
    v_sub_f32 v103, v103, v184
    v_exp_f32 v88, v88
    v_exp_f32 v89, v89
    v_exp_f32 v90, v90
    v_exp_f32 v91, v91
    v_exp_f32 v92, v92
    v_exp_f32 v93, v93
    v_exp_f32 v94, v94
    v_exp_f32 v95, v95
    v_exp_f32 v96, v96
    v_exp_f32 v97, v97
    v_exp_f32 v98, v98
    v_exp_f32 v99, v99
    v_exp_f32 v100, v100
    v_exp_f32 v101, v101
    v_exp_f32 v102, v102
    v_exp_f32 v103, v103
    v_cvt_pk_bf16_f32 v120, v88, v89
    v_cvt_pk_bf16_f32 v121, v90, v91
    v_cvt_pk_bf16_f32 v122, v92, v93
    v_cvt_pk_bf16_f32 v123, v94, v95
    v_cvt_pk_bf16_f32 v124, v96, v97
    v_cvt_pk_bf16_f32 v125, v98, v99
    v_cvt_pk_bf16_f32 v126, v100, v101
    v_cvt_pk_bf16_f32 v127, v102, v103
    v_mfma_f32_32x32x16_bf16 v[56:71], v[152:155], v[120:123], v[56:71]
    s_nop 0
    v_mfma_f32_32x32x16_bf16 v[56:71], v[156:159], v[124:127], v[56:71]
    s_add_u32 s63, s63, 1
    s_cmp_le_u32 s63, 9
    s_cbranch_scc1 L_fbl_383
    s_cmp_eq_u32 s37, 0
    s_cselect_b32 s63, 8, 6
    v_mov_b32 v184, 0xff800000
L_fbl_387:
    s_mul_i32 s62, s63, 3072
    v_add_u32 v180, s62, v16
    v_add_u32 v181, s62, v18
    v_add_u32 v182, s62, v19
    v_add_u32 v183, s62, v20
    ds_read_b128 v[136:139], v180
    ds_read_b64 v[140:141], v181
    ds_read_b64_tr_b16 v[152:153], v182 offset:0
    ds_read_b64_tr_b16 v[154:155], v183 offset:0
    ds_read_b64_tr_b16 v[156:157], v182 offset:256
    ds_read_b64_tr_b16 v[158:159], v183 offset:256
    s_waitcnt lgkmcnt(0)
    s_cmp_lg_u32 s63, 6
    s_cbranch_scc1 L_fbnf_388
    v_mfma_f32_32x32x16_bf16 v[88:103], v[136:139], v[248:251], v[208:223]
    s_branch L_fbgo_390
L_fbnf_388:
    s_cmp_lg_u32 s63, 14
    s_cbranch_scc1 L_fbnd_389
    v_mfma_f32_32x32x16_bf16 v[88:103], v[136:139], v[248:251], v[192:207]
    s_branch L_fbgo_390
L_fbnd_389:
    v_mfma_f32_32x32x16_bf16 v[88:103], v[136:139], v[248:251], 0
L_fbgo_390:
    v_mfma_f32_32x32x8bf16_1k v[88:103], v[140:141], v[252:253], v[88:103]
    s_nop 11
    v_max3_f32 v184, v88, v89, v184
    v_max3_f32 v184, v90, v91, v184
    v_max3_f32 v184, v92, v93, v184
    v_max3_f32 v184, v94, v95, v184
    v_max3_f32 v184, v96, v97, v184
    v_max3_f32 v184, v98, v99, v184
    v_max3_f32 v184, v100, v101, v184
    v_max3_f32 v184, v102, v103, v184
    s_add_u32 s63, s63, 1
    s_cmp_le_u32 s63, 14
    s_cbranch_scc1 L_fbl_387
    v_mov_b32 v185, v184
    s_nop 1
    v_permlane32_swap_b32 v184, v185
    v_max_f32 v184, v184, v185
    s_cmp_eq_u32 s37, 0
    s_cselect_b32 s63, 8, 6
    v_mov_b32 v72, 0
    v_mov_b32 v73, 0
    v_mov_b32 v74, 0
    v_mov_b32 v75, 0
    v_mov_b32 v76, 0
    v_mov_b32 v77, 0
    v_mov_b32 v78, 0
    v_mov_b32 v79, 0
    v_mov_b32 v80, 0
    v_mov_b32 v81, 0
    v_mov_b32 v82, 0
    v_mov_b32 v83, 0
    v_mov_b32 v84, 0
    v_mov_b32 v85, 0
    v_mov_b32 v86, 0
    v_mov_b32 v87, 0
L_fbl_391:
    s_mul_i32 s62, s63, 3072
    v_add_u32 v180, s62, v16
    v_add_u32 v181, s62, v18
    v_add_u32 v182, s62, v19
    v_add_u32 v183, s62, v20
    ds_read_b128 v[136:139], v180
    ds_read_b64 v[140:141], v181
    ds_read_b64_tr_b16 v[152:153], v182 offset:0
    ds_read_b64_tr_b16 v[154:155], v183 offset:0
    ds_read_b64_tr_b16 v[156:157], v182 offset:256
    ds_read_b64_tr_b16 v[158:159], v183 offset:256
    s_waitcnt lgkmcnt(0)
    s_cmp_lg_u32 s63, 6
    s_cbranch_scc1 L_fbnf_392
    v_mfma_f32_32x32x16_bf16 v[88:103], v[136:139], v[248:251], v[208:223]
    s_branch L_fbgo_394
L_fbnf_392:
    s_cmp_lg_u32 s63, 14
    s_cbranch_scc1 L_fbnd_393
    v_mfma_f32_32x32x16_bf16 v[88:103], v[136:139], v[248:251], v[192:207]
    s_branch L_fbgo_394
L_fbnd_393:
    v_mfma_f32_32x32x16_bf16 v[88:103], v[136:139], v[248:251], 0
L_fbgo_394:
    v_mfma_f32_32x32x8bf16_1k v[88:103], v[140:141], v[252:253], v[88:103]
    s_nop 11
    v_sub_f32 v88, v88, v184
    v_sub_f32 v89, v89, v184
    v_sub_f32 v90, v90, v184
    v_sub_f32 v91, v91, v184
    v_sub_f32 v92, v92, v184
    v_sub_f32 v93, v93, v184
    v_sub_f32 v94, v94, v184
    v_sub_f32 v95, v95, v184
    v_sub_f32 v96, v96, v184
    v_sub_f32 v97, v97, v184
    v_sub_f32 v98, v98, v184
    v_sub_f32 v99, v99, v184
    v_sub_f32 v100, v100, v184
    v_sub_f32 v101, v101, v184
    v_sub_f32 v102, v102, v184
    v_sub_f32 v103, v103, v184
    v_exp_f32 v88, v88
    v_exp_f32 v89, v89
    v_exp_f32 v90, v90
    v_exp_f32 v91, v91
    v_exp_f32 v92, v92
    v_exp_f32 v93, v93
    v_exp_f32 v94, v94
    v_exp_f32 v95, v95
    v_exp_f32 v96, v96
    v_exp_f32 v97, v97
    v_exp_f32 v98, v98
    v_exp_f32 v99, v99
    v_exp_f32 v100, v100
    v_exp_f32 v101, v101
    v_exp_f32 v102, v102
    v_exp_f32 v103, v103
    v_cvt_pk_bf16_f32 v120, v88, v89
    v_cvt_pk_bf16_f32 v121, v90, v91
    v_cvt_pk_bf16_f32 v122, v92, v93
    v_cvt_pk_bf16_f32 v123, v94, v95
    v_cvt_pk_bf16_f32 v124, v96, v97
    v_cvt_pk_bf16_f32 v125, v98, v99
    v_cvt_pk_bf16_f32 v126, v100, v101
    v_cvt_pk_bf16_f32 v127, v102, v103
    v_mfma_f32_32x32x16_bf16 v[72:87], v[152:155], v[120:123], v[72:87]
    s_nop 0
    v_mfma_f32_32x32x16_bf16 v[72:87], v[156:159], v[124:127], v[72:87]
    s_add_u32 s63, s63, 1
    s_cmp_le_u32 s63, 14
    s_cbranch_scc1 L_fbl_391
    s_cmp_eq_u32 s26, 0
    s_cbranch_scc1 L_hikept_395
    s_nop 6
    v_rcp_f32 v86, v84
    s_add_u32 s54, s56, 7680
    v_pk_mul_f32 v[72:73], v[72:73], v[86:87] op_sel_hi:[1,0]
    v_pk_mul_f32 v[74:75], v[74:75], v[86:87] op_sel_hi:[1,0]
    v_pk_mul_f32 v[76:77], v[76:77], v[86:87] op_sel_hi:[1,0]
    v_pk_mul_f32 v[78:79], v[78:79], v[86:87] op_sel_hi:[1,0]
    v_pk_mul_f32 v[80:81], v[80:81], v[86:87] op_sel_hi:[1,0]
    v_pk_mul_f32 v[82:83], v[82:83], v[86:87] op_sel_hi:[1,0]
    v_cvt_pk_bf16_f32 v172, v72, v73
    v_cvt_pk_bf16_f32 v173, v74, v75
    v_cvt_pk_bf16_f32 v174, v76, v77
    v_cvt_pk_bf16_f32 v175, v78, v79
    v_cvt_pk_bf16_f32 v176, v80, v81
    v_cvt_pk_bf16_f32 v177, v82, v83
    s_cmp_eq_u32 s43, 0
    s_cbranch_scc1 L_safe_396
    buffer_store_dwordx4 v[172:175], v5, s[4:7], s54 offen offset:0
    buffer_store_dwordx2 v[176:177], v6, s[4:7], s54 offen offset:512
L_join_397:
L_hikept_395:
    v_rcp_f32 v70, v68
    s_add_u32 s54, s56, 1280
    v_pk_mul_f32 v[56:57], v[56:57], v[70:71] op_sel_hi:[1,0]
    v_pk_mul_f32 v[58:59], v[58:59], v[70:71] op_sel_hi:[1,0]
    v_pk_mul_f32 v[60:61], v[60:61], v[70:71] op_sel_hi:[1,0]
    v_pk_mul_f32 v[62:63], v[62:63], v[70:71] op_sel_hi:[1,0]
    v_pk_mul_f32 v[64:65], v[64:65], v[70:71] op_sel_hi:[1,0]
    v_pk_mul_f32 v[66:67], v[66:67], v[70:71] op_sel_hi:[1,0]
    v_cvt_pk_bf16_f32 v172, v56, v57
    v_cvt_pk_bf16_f32 v173, v58, v59
    v_cvt_pk_bf16_f32 v174, v60, v61
    v_cvt_pk_bf16_f32 v175, v62, v63
    v_cvt_pk_bf16_f32 v176, v64, v65
    v_cvt_pk_bf16_f32 v177, v66, v67
    s_cmp_eq_u32 s43, 0
    s_cbranch_scc1 L_safe_398
    buffer_store_dwordx4 v[172:175], v5, s[4:7], s54 offen offset:0
    buffer_store_dwordx2 v[176:177], v6, s[4:7], s54 offen offset:512
L_join_399:
    s_branch L_fbdone_191
L_safe_202:
    buffer_store_dwordx4 v[172:175], v5, s[4:7], s54 offen offset:0 sc1
    buffer_store_dwordx2 v[176:177], v6, s[4:7], s54 offen offset:512 sc1
    s_branch L_join_203
L_safe_205:
    buffer_store_dword v0, v14, s[4:7], s41 offen offset:0 sc1
    s_branch L_join_206
L_safe_209:
    buffer_store_dwordx4 v[172:175], v5, s[4:7], s54 offen offset:0 sc1
    buffer_store_dwordx2 v[176:177], v6, s[4:7], s54 offen offset:512 sc1
    s_branch L_join_210
L_fallback_207:
    s_cmp_eq_u32 s37, 0
    s_cselect_b32 s63, 8, 2
    v_mov_b32 v184, 0xff800000
L_fbl_400:
    s_mul_i32 s62, s63, 3072
    v_add_u32 v180, s62, v16
    v_add_u32 v181, s62, v18
    v_add_u32 v182, s62, v19
    v_add_u32 v183, s62, v20
    ds_read_b128 v[136:139], v180
    ds_read_b64 v[140:141], v181
    ds_read_b64_tr_b16 v[152:153], v182 offset:0
    ds_read_b64_tr_b16 v[154:155], v183 offset:0
    ds_read_b64_tr_b16 v[156:157], v182 offset:256
    ds_read_b64_tr_b16 v[158:159], v183 offset:256
    s_waitcnt lgkmcnt(0)
    s_cmp_lg_u32 s63, 2
    s_cbranch_scc1 L_fbnf_401
    v_mfma_f32_32x32x16_bf16 v[88:103], v[136:139], v[240:243], v[208:223]
    s_branch L_fbgo_403
L_fbnf_401:
    s_cmp_lg_u32 s63, 10
    s_cbranch_scc1 L_fbnd_402
    v_mfma_f32_32x32x16_bf16 v[88:103], v[136:139], v[240:243], v[192:207]
    s_branch L_fbgo_403
L_fbnd_402:
    v_mfma_f32_32x32x16_bf16 v[88:103], v[136:139], v[240:243], 0
L_fbgo_403:
    v_mfma_f32_32x32x8bf16_1k v[88:103], v[140:141], v[244:245], v[88:103]
    s_nop 11
    v_max3_f32 v184, v88, v89, v184
    v_max3_f32 v184, v90, v91, v184
    v_max3_f32 v184, v92, v93, v184
    v_max3_f32 v184, v94, v95, v184
    v_max3_f32 v184, v96, v97, v184
    v_max3_f32 v184, v98, v99, v184
    v_max3_f32 v184, v100, v101, v184
    v_max3_f32 v184, v102, v103, v184
    s_add_u32 s63, s63, 1
    s_cmp_le_u32 s63, 10
    s_cbranch_scc1 L_fbl_400
    v_mov_b32 v185, v184
    s_nop 1
    v_permlane32_swap_b32 v184, v185
    v_max_f32 v184, v184, v185
    s_cmp_eq_u32 s37, 0
    s_cselect_b32 s63, 8, 2
    v_mov_b32 v56, 0
    v_mov_b32 v57, 0
    v_mov_b32 v58, 0
    v_mov_b32 v59, 0
    v_mov_b32 v60, 0
    v_mov_b32 v61, 0
    v_mov_b32 v62, 0
    v_mov_b32 v63, 0
    v_mov_b32 v64, 0
    v_mov_b32 v65, 0
    v_mov_b32 v66, 0
    v_mov_b32 v67, 0
    v_mov_b32 v68, 0
    v_mov_b32 v69, 0
    v_mov_b32 v70, 0
    v_mov_b32 v71, 0
L_fbl_404:
    s_mul_i32 s62, s63, 3072
    v_add_u32 v180, s62, v16
    v_add_u32 v181, s62, v18
    v_add_u32 v182, s62, v19
    v_add_u32 v183, s62, v20
    ds_read_b128 v[136:139], v180
    ds_read_b64 v[140:141], v181
    ds_read_b64_tr_b16 v[152:153], v182 offset:0
    ds_read_b64_tr_b16 v[154:155], v183 offset:0
    ds_read_b64_tr_b16 v[156:157], v182 offset:256
    ds_read_b64_tr_b16 v[158:159], v183 offset:256
    s_waitcnt lgkmcnt(0)
    s_cmp_lg_u32 s63, 2
    s_cbranch_scc1 L_fbnf_405
    v_mfma_f32_32x32x16_bf16 v[88:103], v[136:139], v[240:243], v[208:223]
    s_branch L_fbgo_407
L_fbnf_405:
    s_cmp_lg_u32 s63, 10
    s_cbranch_scc1 L_fbnd_406
    v_mfma_f32_32x32x16_bf16 v[88:103], v[136:139], v[240:243], v[192:207]
    s_branch L_fbgo_407
L_fbnd_406:
    v_mfma_f32_32x32x16_bf16 v[88:103], v[136:139], v[240:243], 0
L_fbgo_407:
    v_mfma_f32_32x32x8bf16_1k v[88:103], v[140:141], v[244:245], v[88:103]
    s_nop 11
    v_sub_f32 v88, v88, v184
    v_sub_f32 v89, v89, v184
    v_sub_f32 v90, v90, v184
    v_sub_f32 v91, v91, v184
    v_sub_f32 v92, v92, v184
    v_sub_f32 v93, v93, v184
    v_sub_f32 v94, v94, v184
    v_sub_f32 v95, v95, v184
    v_sub_f32 v96, v96, v184
    v_sub_f32 v97, v97, v184
    v_sub_f32 v98, v98, v184
    v_sub_f32 v99, v99, v184
    v_sub_f32 v100, v100, v184
    v_sub_f32 v101, v101, v184
    v_sub_f32 v102, v102, v184
    v_sub_f32 v103, v103, v184
    v_exp_f32 v88, v88
    v_exp_f32 v89, v89
    v_exp_f32 v90, v90
    v_exp_f32 v91, v91
    v_exp_f32 v92, v92
    v_exp_f32 v93, v93
    v_exp_f32 v94, v94
    v_exp_f32 v95, v95
    v_exp_f32 v96, v96
    v_exp_f32 v97, v97
    v_exp_f32 v98, v98
    v_exp_f32 v99, v99
    v_exp_f32 v100, v100
    v_exp_f32 v101, v101
    v_exp_f32 v102, v102
    v_exp_f32 v103, v103
    v_cvt_pk_bf16_f32 v120, v88, v89
    v_cvt_pk_bf16_f32 v121, v90, v91
    v_cvt_pk_bf16_f32 v122, v92, v93
    v_cvt_pk_bf16_f32 v123, v94, v95
    v_cvt_pk_bf16_f32 v124, v96, v97
    v_cvt_pk_bf16_f32 v125, v98, v99
    v_cvt_pk_bf16_f32 v126, v100, v101
    v_cvt_pk_bf16_f32 v127, v102, v103
    v_mfma_f32_32x32x16_bf16 v[56:71], v[152:155], v[120:123], v[56:71]
    s_nop 0
    v_mfma_f32_32x32x16_bf16 v[56:71], v[156:159], v[124:127], v[56:71]
    s_add_u32 s63, s63, 1
    s_cmp_le_u32 s63, 10
    s_cbranch_scc1 L_fbl_404
    s_cmp_eq_u32 s37, 0
    s_cselect_b32 s63, 8, 5
    v_mov_b32 v184, 0xff800000
L_fbl_408:
    s_mul_i32 s62, s63, 3072
    v_add_u32 v180, s62, v16
    v_add_u32 v181, s62, v18
    v_add_u32 v182, s62, v19
    v_add_u32 v183, s62, v20
    ds_read_b128 v[136:139], v180
    ds_read_b64 v[140:141], v181
    ds_read_b64_tr_b16 v[152:153], v182 offset:0
    ds_read_b64_tr_b16 v[154:155], v183 offset:0
    ds_read_b64_tr_b16 v[156:157], v182 offset:256
    ds_read_b64_tr_b16 v[158:159], v183 offset:256
    s_waitcnt lgkmcnt(0)
    s_cmp_lg_u32 s63, 5
    s_cbranch_scc1 L_fbnf_409
    v_mfma_f32_32x32x16_bf16 v[88:103], v[136:139], v[248:251], v[208:223]
    s_branch L_fbgo_411
L_fbnf_409:
    s_cmp_lg_u32 s63, 13
    s_cbranch_scc1 L_fbnd_410
    v_mfma_f32_32x32x16_bf16 v[88:103], v[136:139], v[248:251], v[192:207]
    s_branch L_fbgo_411
L_fbnd_410:
    v_mfma_f32_32x32x16_bf16 v[88:103], v[136:139], v[248:251], 0
L_fbgo_411:
    v_mfma_f32_32x32x8bf16_1k v[88:103], v[140:141], v[252:253], v[88:103]
    s_nop 11
    v_max3_f32 v184, v88, v89, v184
    v_max3_f32 v184, v90, v91, v184
    v_max3_f32 v184, v92, v93, v184
    v_max3_f32 v184, v94, v95, v184
    v_max3_f32 v184, v96, v97, v184
    v_max3_f32 v184, v98, v99, v184
    v_max3_f32 v184, v100, v101, v184
    v_max3_f32 v184, v102, v103, v184
    s_add_u32 s63, s63, 1
    s_cmp_le_u32 s63, 13
    s_cbranch_scc1 L_fbl_408
    v_mov_b32 v185, v184
    s_nop 1
    v_permlane32_swap_b32 v184, v185
    v_max_f32 v184, v184, v185
    s_cmp_eq_u32 s37, 0
    s_cselect_b32 s63, 8, 5
    v_mov_b32 v72, 0
    v_mov_b32 v73, 0
    v_mov_b32 v74, 0
    v_mov_b32 v75, 0
    v_mov_b32 v76, 0
    v_mov_b32 v77, 0
    v_mov_b32 v78, 0
    v_mov_b32 v79, 0
    v_mov_b32 v80, 0
    v_mov_b32 v81, 0
    v_mov_b32 v82, 0
    v_mov_b32 v83, 0
    v_mov_b32 v84, 0
    v_mov_b32 v85, 0
    v_mov_b32 v86, 0
    v_mov_b32 v87, 0
L_fbl_412:
    s_mul_i32 s62, s63, 3072
    v_add_u32 v180, s62, v16
    v_add_u32 v181, s62, v18
    v_add_u32 v182, s62, v19
    v_add_u32 v183, s62, v20
    ds_read_b128 v[136:139], v180
    ds_read_b64 v[140:141], v181
    ds_read_b64_tr_b16 v[152:153], v182 offset:0
    ds_read_b64_tr_b16 v[154:155], v183 offset:0
    ds_read_b64_tr_b16 v[156:157], v182 offset:256
    ds_read_b64_tr_b16 v[158:159], v183 offset:256
    s_waitcnt lgkmcnt(0)
    s_cmp_lg_u32 s63, 5
    s_cbranch_scc1 L_fbnf_413
    v_mfma_f32_32x32x16_bf16 v[88:103], v[136:139], v[248:251], v[208:223]
    s_branch L_fbgo_415
L_fbnf_413:
    s_cmp_lg_u32 s63, 13
    s_cbranch_scc1 L_fbnd_414
    v_mfma_f32_32x32x16_bf16 v[88:103], v[136:139], v[248:251], v[192:207]
    s_branch L_fbgo_415
L_fbnd_414:
    v_mfma_f32_32x32x16_bf16 v[88:103], v[136:139], v[248:251], 0
L_fbgo_415:
    v_mfma_f32_32x32x8bf16_1k v[88:103], v[140:141], v[252:253], v[88:103]
    s_nop 11
    v_sub_f32 v88, v88, v184
    v_sub_f32 v89, v89, v184
    v_sub_f32 v90, v90, v184
    v_sub_f32 v91, v91, v184
    v_sub_f32 v92, v92, v184
    v_sub_f32 v93, v93, v184
    v_sub_f32 v94, v94, v184
    v_sub_f32 v95, v95, v184
    v_sub_f32 v96, v96, v184
    v_sub_f32 v97, v97, v184
    v_sub_f32 v98, v98, v184
    v_sub_f32 v99, v99, v184
    v_sub_f32 v100, v100, v184
    v_sub_f32 v101, v101, v184
    v_sub_f32 v102, v102, v184
    v_sub_f32 v103, v103, v184
    v_exp_f32 v88, v88
    v_exp_f32 v89, v89
    v_exp_f32 v90, v90
    v_exp_f32 v91, v91
    v_exp_f32 v92, v92
    v_exp_f32 v93, v93
    v_exp_f32 v94, v94
    v_exp_f32 v95, v95
    v_exp_f32 v96, v96
    v_exp_f32 v97, v97
    v_exp_f32 v98, v98
    v_exp_f32 v99, v99
    v_exp_f32 v100, v100
    v_exp_f32 v101, v101
    v_exp_f32 v102, v102
    v_exp_f32 v103, v103
    v_cvt_pk_bf16_f32 v120, v88, v89
    v_cvt_pk_bf16_f32 v121, v90, v91
    v_cvt_pk_bf16_f32 v122, v92, v93
    v_cvt_pk_bf16_f32 v123, v94, v95
    v_cvt_pk_bf16_f32 v124, v96, v97
    v_cvt_pk_bf16_f32 v125, v98, v99
    v_cvt_pk_bf16_f32 v126, v100, v101
    v_cvt_pk_bf16_f32 v127, v102, v103
    v_mfma_f32_32x32x16_bf16 v[72:87], v[152:155], v[120:123], v[72:87]
    s_nop 0
    v_mfma_f32_32x32x16_bf16 v[72:87], v[156:159], v[124:127], v[72:87]
    s_add_u32 s63, s63, 1
    s_cmp_le_u32 s63, 13
    s_cbranch_scc1 L_fbl_412
    s_cmp_eq_u32 s26, 0
    s_cbranch_scc1 L_hikept_416
    s_nop 6
    v_rcp_f32 v86, v84
    s_add_u32 s54, s56, 6400
    v_pk_mul_f32 v[72:73], v[72:73], v[86:87] op_sel_hi:[1,0]
    v_pk_mul_f32 v[74:75], v[74:75], v[86:87] op_sel_hi:[1,0]
    v_pk_mul_f32 v[76:77], v[76:77], v[86:87] op_sel_hi:[1,0]
    v_pk_mul_f32 v[78:79], v[78:79], v[86:87] op_sel_hi:[1,0]
    v_pk_mul_f32 v[80:81], v[80:81], v[86:87] op_sel_hi:[1,0]
    v_pk_mul_f32 v[82:83], v[82:83], v[86:87] op_sel_hi:[1,0]
    v_cvt_pk_bf16_f32 v172, v72, v73
    v_cvt_pk_bf16_f32 v173, v74, v75
    v_cvt_pk_bf16_f32 v174, v76, v77
    v_cvt_pk_bf16_f32 v175, v78, v79
    v_cvt_pk_bf16_f32 v176, v80, v81
    v_cvt_pk_bf16_f32 v177, v82, v83
    s_cmp_eq_u32 s43, 0
    s_cbranch_scc1 L_safe_417
    buffer_store_dwordx4 v[172:175], v5, s[4:7], s54 offen offset:0
    buffer_store_dwordx2 v[176:177], v6, s[4:7], s54 offen offset:512
L_join_418:
L_hikept_416:
    v_rcp_f32 v70, v68
    s_add_u32 s54, s56, 2560
    v_pk_mul_f32 v[56:57], v[56:57], v[70:71] op_sel_hi:[1,0]
    v_pk_mul_f32 v[58:59], v[58:59], v[70:71] op_sel_hi:[1,0]
    v_pk_mul_f32 v[60:61], v[60:61], v[70:71] op_sel_hi:[1,0]
    v_pk_mul_f32 v[62:63], v[62:63], v[70:71] op_sel_hi:[1,0]
    v_pk_mul_f32 v[64:65], v[64:65], v[70:71] op_sel_hi:[1,0]
    v_pk_mul_f32 v[66:67], v[66:67], v[70:71] op_sel_hi:[1,0]
    v_cvt_pk_bf16_f32 v172, v56, v57
    v_cvt_pk_bf16_f32 v173, v58, v59
    v_cvt_pk_bf16_f32 v174, v60, v61
    v_cvt_pk_bf16_f32 v175, v62, v63
    v_cvt_pk_bf16_f32 v176, v64, v65
    v_cvt_pk_bf16_f32 v177, v66, v67
    s_cmp_eq_u32 s43, 0
    s_cbranch_scc1 L_safe_419
    buffer_store_dwordx4 v[172:175], v5, s[4:7], s54 offen offset:0
    buffer_store_dwordx2 v[176:177], v6, s[4:7], s54 offen offset:512
L_join_420:
    s_branch L_fbdone_208
L_safe_219:
    buffer_store_dwordx4 v[172:175], v5, s[4:7], s54 offen offset:0 sc1
    buffer_store_dwordx2 v[176:177], v6, s[4:7], s54 offen offset:512 sc1
    s_branch L_join_220
L_safe_222:
    buffer_store_dword v0, v14, s[4:7], s41 offen offset:0 sc1
    s_branch L_join_223
L_safe_226:
    buffer_store_dwordx4 v[172:175], v5, s[4:7], s54 offen offset:0 sc1
    buffer_store_dwordx2 v[176:177], v6, s[4:7], s54 offen offset:512 sc1
    s_branch L_join_227
L_fallback_224:
    s_cmp_eq_u32 s37, 0
    s_cselect_b32 s63, 8, 3
    v_mov_b32 v184, 0xff800000
L_fbl_421:
    s_mul_i32 s62, s63, 3072
    v_add_u32 v180, s62, v16
    v_add_u32 v181, s62, v18
    v_add_u32 v182, s62, v19
    v_add_u32 v183, s62, v20
    ds_read_b128 v[136:139], v180
    ds_read_b64 v[140:141], v181
    ds_read_b64_tr_b16 v[152:153], v182 offset:0
    ds_read_b64_tr_b16 v[154:155], v183 offset:0
    ds_read_b64_tr_b16 v[156:157], v182 offset:256
    ds_read_b64_tr_b16 v[158:159], v183 offset:256
    s_waitcnt lgkmcnt(0)
    s_cmp_lg_u32 s63, 3
    s_cbranch_scc1 L_fbnf_422
    v_mfma_f32_32x32x16_bf16 v[88:103], v[136:139], v[240:243], v[208:223]
    s_branch L_fbgo_424
L_fbnf_422:
    s_cmp_lg_u32 s63, 11
    s_cbranch_scc1 L_fbnd_423
    v_mfma_f32_32x32x16_bf16 v[88:103], v[136:139], v[240:243], v[192:207]
    s_branch L_fbgo_424
L_fbnd_423:
    v_mfma_f32_32x32x16_bf16 v[88:103], v[136:139], v[240:243], 0
L_fbgo_424:
    v_mfma_f32_32x32x8bf16_1k v[88:103], v[140:141], v[244:245], v[88:103]
    s_nop 11
    v_max3_f32 v184, v88, v89, v184
    v_max3_f32 v184, v90, v91, v184
    v_max3_f32 v184, v92, v93, v184
    v_max3_f32 v184, v94, v95, v184
    v_max3_f32 v184, v96, v97, v184
    v_max3_f32 v184, v98, v99, v184
    v_max3_f32 v184, v100, v101, v184
    v_max3_f32 v184, v102, v103, v184
    s_add_u32 s63, s63, 1
    s_cmp_le_u32 s63, 11
    s_cbranch_scc1 L_fbl_421
    v_mov_b32 v185, v184
    s_nop 1
    v_permlane32_swap_b32 v184, v185
    v_max_f32 v184, v184, v185
    s_cmp_eq_u32 s37, 0
    s_cselect_b32 s63, 8, 3
    v_mov_b32 v56, 0
    v_mov_b32 v57, 0
    v_mov_b32 v58, 0
    v_mov_b32 v59, 0
    v_mov_b32 v60, 0
    v_mov_b32 v61, 0
    v_mov_b32 v62, 0
    v_mov_b32 v63, 0
    v_mov_b32 v64, 0
    v_mov_b32 v65, 0
    v_mov_b32 v66, 0
    v_mov_b32 v67, 0
    v_mov_b32 v68, 0
    v_mov_b32 v69, 0
    v_mov_b32 v70, 0
    v_mov_b32 v71, 0
L_fbl_425:
    s_mul_i32 s62, s63, 3072
    v_add_u32 v180, s62, v16
    v_add_u32 v181, s62, v18
    v_add_u32 v182, s62, v19
    v_add_u32 v183, s62, v20
    ds_read_b128 v[136:139], v180
    ds_read_b64 v[140:141], v181
    ds_read_b64_tr_b16 v[152:153], v182 offset:0
    ds_read_b64_tr_b16 v[154:155], v183 offset:0
    ds_read_b64_tr_b16 v[156:157], v182 offset:256
    ds_read_b64_tr_b16 v[158:159], v183 offset:256
    s_waitcnt lgkmcnt(0)
    s_cmp_lg_u32 s63, 3
    s_cbranch_scc1 L_fbnf_426
    v_mfma_f32_32x32x16_bf16 v[88:103], v[136:139], v[240:243], v[208:223]
    s_branch L_fbgo_428
L_fbnf_426:
    s_cmp_lg_u32 s63, 11
    s_cbranch_scc1 L_fbnd_427
    v_mfma_f32_32x32x16_bf16 v[88:103], v[136:139], v[240:243], v[192:207]
    s_branch L_fbgo_428
L_fbnd_427:
    v_mfma_f32_32x32x16_bf16 v[88:103], v[136:139], v[240:243], 0
L_fbgo_428:
    v_mfma_f32_32x32x8bf16_1k v[88:103], v[140:141], v[244:245], v[88:103]
    s_nop 11
    v_sub_f32 v88, v88, v184
    v_sub_f32 v89, v89, v184
    v_sub_f32 v90, v90, v184
    v_sub_f32 v91, v91, v184
    v_sub_f32 v92, v92, v184
    v_sub_f32 v93, v93, v184
    v_sub_f32 v94, v94, v184
    v_sub_f32 v95, v95, v184
    v_sub_f32 v96, v96, v184
    v_sub_f32 v97, v97, v184
    v_sub_f32 v98, v98, v184
    v_sub_f32 v99, v99, v184
    v_sub_f32 v100, v100, v184
    v_sub_f32 v101, v101, v184
    v_sub_f32 v102, v102, v184
    v_sub_f32 v103, v103, v184
    v_exp_f32 v88, v88
    v_exp_f32 v89, v89
    v_exp_f32 v90, v90
    v_exp_f32 v91, v91
    v_exp_f32 v92, v92
    v_exp_f32 v93, v93
    v_exp_f32 v94, v94
    v_exp_f32 v95, v95
    v_exp_f32 v96, v96
    v_exp_f32 v97, v97
    v_exp_f32 v98, v98
    v_exp_f32 v99, v99
    v_exp_f32 v100, v100
    v_exp_f32 v101, v101
    v_exp_f32 v102, v102
    v_exp_f32 v103, v103
    v_cvt_pk_bf16_f32 v120, v88, v89
    v_cvt_pk_bf16_f32 v121, v90, v91
    v_cvt_pk_bf16_f32 v122, v92, v93
    v_cvt_pk_bf16_f32 v123, v94, v95
    v_cvt_pk_bf16_f32 v124, v96, v97
    v_cvt_pk_bf16_f32 v125, v98, v99
    v_cvt_pk_bf16_f32 v126, v100, v101
    v_cvt_pk_bf16_f32 v127, v102, v103
    v_mfma_f32_32x32x16_bf16 v[56:71], v[152:155], v[120:123], v[56:71]
    s_nop 0
    v_mfma_f32_32x32x16_bf16 v[56:71], v[156:159], v[124:127], v[56:71]
    s_add_u32 s63, s63, 1
    s_cmp_le_u32 s63, 11
    s_cbranch_scc1 L_fbl_425
    s_cmp_eq_u32 s37, 0
    s_cselect_b32 s63, 8, 4
    v_mov_b32 v184, 0xff800000
L_fbl_429:
    s_mul_i32 s62, s63, 3072
    v_add_u32 v180, s62, v16
    v_add_u32 v181, s62, v18
    v_add_u32 v182, s62, v19
    v_add_u32 v183, s62, v20
    ds_read_b128 v[136:139], v180
    ds_read_b64 v[140:141], v181
    ds_read_b64_tr_b16 v[152:153], v182 offset:0
    ds_read_b64_tr_b16 v[154:155], v183 offset:0
    ds_read_b64_tr_b16 v[156:157], v182 offset:256
    ds_read_b64_tr_b16 v[158:159], v183 offset:256
    s_waitcnt lgkmcnt(0)
    s_cmp_lg_u32 s63, 4
    s_cbranch_scc1 L_fbnf_430
    v_mfma_f32_32x32x16_bf16 v[88:103], v[136:139], v[248:251], v[208:223]
    s_branch L_fbgo_432
L_fbnf_430:
    s_cmp_lg_u32 s63, 12
    s_cbranch_scc1 L_fbnd_431
    v_mfma_f32_32x32x16_bf16 v[88:103], v[136:139], v[248:251], v[192:207]
    s_branch L_fbgo_432
L_fbnd_431:
    v_mfma_f32_32x32x16_bf16 v[88:103], v[136:139], v[248:251], 0
L_fbgo_432:
    v_mfma_f32_32x32x8bf16_1k v[88:103], v[140:141], v[252:253], v[88:103]
    s_nop 11
    v_max3_f32 v184, v88, v89, v184
    v_max3_f32 v184, v90, v91, v184
    v_max3_f32 v184, v92, v93, v184
    v_max3_f32 v184, v94, v95, v184
    v_max3_f32 v184, v96, v97, v184
    v_max3_f32 v184, v98, v99, v184
    v_max3_f32 v184, v100, v101, v184
    v_max3_f32 v184, v102, v103, v184
    s_add_u32 s63, s63, 1
    s_cmp_le_u32 s63, 12
    s_cbranch_scc1 L_fbl_429
    v_mov_b32 v185, v184
    s_nop 1
    v_permlane32_swap_b32 v184, v185
    v_max_f32 v184, v184, v185
    s_cmp_eq_u32 s37, 0
    s_cselect_b32 s63, 8, 4
    v_mov_b32 v72, 0
    v_mov_b32 v73, 0
    v_mov_b32 v74, 0
    v_mov_b32 v75, 0
    v_mov_b32 v76, 0
    v_mov_b32 v77, 0
    v_mov_b32 v78, 0
    v_mov_b32 v79, 0
    v_mov_b32 v80, 0
    v_mov_b32 v81, 0
    v_mov_b32 v82, 0
    v_mov_b32 v83, 0
    v_mov_b32 v84, 0
    v_mov_b32 v85, 0
    v_mov_b32 v86, 0
    v_mov_b32 v87, 0
L_fbl_433:
    s_mul_i32 s62, s63, 3072
    v_add_u32 v180, s62, v16
    v_add_u32 v181, s62, v18
    v_add_u32 v182, s62, v19
    v_add_u32 v183, s62, v20
    ds_read_b128 v[136:139], v180
    ds_read_b64 v[140:141], v181
    ds_read_b64_tr_b16 v[152:153], v182 offset:0
    ds_read_b64_tr_b16 v[154:155], v183 offset:0
    ds_read_b64_tr_b16 v[156:157], v182 offset:256
    ds_read_b64_tr_b16 v[158:159], v183 offset:256
    s_waitcnt lgkmcnt(0)
    s_cmp_lg_u32 s63, 4
    s_cbranch_scc1 L_fbnf_434
    v_mfma_f32_32x32x16_bf16 v[88:103], v[136:139], v[248:251], v[208:223]
    s_branch L_fbgo_436
L_fbnf_434:
    s_cmp_lg_u32 s63, 12
    s_cbranch_scc1 L_fbnd_435
    v_mfma_f32_32x32x16_bf16 v[88:103], v[136:139], v[248:251], v[192:207]
    s_branch L_fbgo_436
L_fbnd_435:
    v_mfma_f32_32x32x16_bf16 v[88:103], v[136:139], v[248:251], 0
L_fbgo_436:
    v_mfma_f32_32x32x8bf16_1k v[88:103], v[140:141], v[252:253], v[88:103]
    s_nop 11
    v_sub_f32 v88, v88, v184
    v_sub_f32 v89, v89, v184
    v_sub_f32 v90, v90, v184
    v_sub_f32 v91, v91, v184
    v_sub_f32 v92, v92, v184
    v_sub_f32 v93, v93, v184
    v_sub_f32 v94, v94, v184
    v_sub_f32 v95, v95, v184
    v_sub_f32 v96, v96, v184
    v_sub_f32 v97, v97, v184
    v_sub_f32 v98, v98, v184
    v_sub_f32 v99, v99, v184
    v_sub_f32 v100, v100, v184
    v_sub_f32 v101, v101, v184
    v_sub_f32 v102, v102, v184
    v_sub_f32 v103, v103, v184
    v_exp_f32 v88, v88
    v_exp_f32 v89, v89
    v_exp_f32 v90, v90
    v_exp_f32 v91, v91
    v_exp_f32 v92, v92
    v_exp_f32 v93, v93
    v_exp_f32 v94, v94
    v_exp_f32 v95, v95
    v_exp_f32 v96, v96
    v_exp_f32 v97, v97
    v_exp_f32 v98, v98
    v_exp_f32 v99, v99
    v_exp_f32 v100, v100
    v_exp_f32 v101, v101
    v_exp_f32 v102, v102
    v_exp_f32 v103, v103
    v_cvt_pk_bf16_f32 v120, v88, v89
    v_cvt_pk_bf16_f32 v121, v90, v91
    v_cvt_pk_bf16_f32 v122, v92, v93
    v_cvt_pk_bf16_f32 v123, v94, v95
    v_cvt_pk_bf16_f32 v124, v96, v97
    v_cvt_pk_bf16_f32 v125, v98, v99
    v_cvt_pk_bf16_f32 v126, v100, v101
    v_cvt_pk_bf16_f32 v127, v102, v103
    v_mfma_f32_32x32x16_bf16 v[72:87], v[152:155], v[120:123], v[72:87]
    s_nop 0
    v_mfma_f32_32x32x16_bf16 v[72:87], v[156:159], v[124:127], v[72:87]
    s_add_u32 s63, s63, 1
    s_cmp_le_u32 s63, 12
    s_cbranch_scc1 L_fbl_433
    s_cmp_eq_u32 s26, 0
    s_cbranch_scc1 L_hikept_437
    s_nop 6
    v_rcp_f32 v86, v84
    s_add_u32 s54, s56, 5120
    v_pk_mul_f32 v[72:73], v[72:73], v[86:87] op_sel_hi:[1,0]
    v_pk_mul_f32 v[74:75], v[74:75], v[86:87] op_sel_hi:[1,0]
    v_pk_mul_f32 v[76:77], v[76:77], v[86:87] op_sel_hi:[1,0]
    v_pk_mul_f32 v[78:79], v[78:79], v[86:87] op_sel_hi:[1,0]
    v_pk_mul_f32 v[80:81], v[80:81], v[86:87] op_sel_hi:[1,0]
    v_pk_mul_f32 v[82:83], v[82:83], v[86:87] op_sel_hi:[1,0]
    v_cvt_pk_bf16_f32 v172, v72, v73
    v_cvt_pk_bf16_f32 v173, v74, v75
    v_cvt_pk_bf16_f32 v174, v76, v77
    v_cvt_pk_bf16_f32 v175, v78, v79
    v_cvt_pk_bf16_f32 v176, v80, v81
    v_cvt_pk_bf16_f32 v177, v82, v83
    s_cmp_eq_u32 s43, 0
    s_cbranch_scc1 L_safe_438
    buffer_store_dwordx4 v[172:175], v5, s[4:7], s54 offen offset:0
    buffer_store_dwordx2 v[176:177], v6, s[4:7], s54 offen offset:512
L_join_439:
L_hikept_437:
    v_rcp_f32 v70, v68
    s_add_u32 s54, s56, 3840
    v_pk_mul_f32 v[56:57], v[56:57], v[70:71] op_sel_hi:[1,0]
    v_pk_mul_f32 v[58:59], v[58:59], v[70:71] op_sel_hi:[1,0]
    v_pk_mul_f32 v[60:61], v[60:61], v[70:71] op_sel_hi:[1,0]
    v_pk_mul_f32 v[62:63], v[62:63], v[70:71] op_sel_hi:[1,0]
    v_pk_mul_f32 v[64:65], v[64:65], v[70:71] op_sel_hi:[1,0]
    v_pk_mul_f32 v[66:67], v[66:67], v[70:71] op_sel_hi:[1,0]
    v_cvt_pk_bf16_f32 v172, v56, v57
    v_cvt_pk_bf16_f32 v173, v58, v59
    v_cvt_pk_bf16_f32 v174, v60, v61
    v_cvt_pk_bf16_f32 v175, v62, v63
    v_cvt_pk_bf16_f32 v176, v64, v65
    v_cvt_pk_bf16_f32 v177, v66, v67
    s_cmp_eq_u32 s43, 0
    s_cbranch_scc1 L_safe_440
    buffer_store_dwordx4 v[172:175], v5, s[4:7], s54 offen offset:0
    buffer_store_dwordx2 v[176:177], v6, s[4:7], s54 offen offset:512
L_join_441:
    s_branch L_fbdone_225
L_safe_228:
    buffer_store_dword v0, v14, s[4:7], s41 offen offset:0 sc1
    s_branch L_join_229
L_safe_232:
    v_cvt_pk_bf16_f32 v56, v32, v33
    v_cvt_pk_bf16_f32 v58, v36, v37
    v_cvt_pk_bf16_f32 v57, v34, v35
    v_cvt_pk_bf16_f32 v59, v38, v39
    v_permlane16_swap_b32 v56, v58
    v_cvt_pk_bf16_f32 v60, v40, v41
    v_cvt_pk_bf16_f32 v62, v44, v45
    v_cvt_pk_bf16_f32 v61, v42, v43
    v_cvt_pk_bf16_f32 v63, v46, v47
    v_permlane16_swap_b32 v57, v59
    buffer_store_dwordx4 v[56:59], v3, s[8:11], s34 offen offset:0 sc1
    v_permlane16_swap_b32 v60, v62
    v_cvt_pk_bf16_f32 v64, v48, v49
    v_cvt_pk_bf16_f32 v66, v48, v49
    v_cvt_pk_bf16_f32 v65, v50, v51
    v_cvt_pk_bf16_f32 v67, v50, v51
    v_permlane16_swap_b32 v61, v63
    buffer_store_dwordx4 v[60:63], v3, s[8:11], s34 offen offset:1024 sc1
    v_permlane16_swap_b32 v64, v66
    v_permlane16_swap_b32 v65, v67
    buffer_store_dwordx4 v[64:67], v4, s[8:11], s34 offen offset:2048 sc1
    v_pk_add_f32 v[68:69], v[32:33], v[34:35]
    v_pk_mul_f32 v[70:71], v[32:33], v[32:33]
    v_pk_fma_f32 v[70:71], v[34:35], v[34:35], v[70:71]
    v_pk_add_f32 v[68:69], v[68:69], v[36:37]
    v_pk_fma_f32 v[70:71], v[36:37], v[36:37], v[70:71]
    v_pk_add_f32 v[68:69], v[68:69], v[38:39]
    v_pk_fma_f32 v[70:71], v[38:39], v[38:39], v[70:71]
    v_pk_add_f32 v[68:69], v[68:69], v[40:41]
    v_pk_fma_f32 v[70:71], v[40:41], v[40:41], v[70:71]
    v_pk_add_f32 v[68:69], v[68:69], v[42:43]
    v_pk_fma_f32 v[70:71], v[42:43], v[42:43], v[70:71]
    v_pk_add_f32 v[68:69], v[68:69], v[44:45]
    v_pk_fma_f32 v[70:71], v[44:45], v[44:45], v[70:71]
    v_pk_add_f32 v[68:69], v[68:69], v[46:47]
    v_pk_fma_f32 v[70:71], v[46:47], v[46:47], v[70:71]
    v_pk_add_f32 v[68:69], v[68:69], v[48:49]
    v_pk_fma_f32 v[70:71], v[48:49], v[48:49], v[70:71]
    v_pk_add_f32 v[68:69], v[68:69], v[50:51]
    v_pk_fma_f32 v[70:71], v[50:51], v[50:51], v[70:71]
    v_add_f32 v68, v68, v69
    v_add_f32 v69, v70, v71
    s_nop 1
    v_permlane16_swap_b32 v68, v69
    v_add_f32 v68, v68, v69
    v_mov_b32 v69, v68
    s_nop 1
    v_permlane32_swap_b32 v68, v69
    v_add_f32 v68, v68, v69
    v_mov_b32 v69, v68
    s_nop 1
    v_permlane16_swap_b32 v68, v69
    buffer_store_dwordx2 v[68:69], v8, s[4:7], s35 offen offset:0 sc1
    ds_read_b128 v[112:115], v236 offset:1024
    ds_read_b128 v[116:119], v236 offset:2048
    ds_read_b128 v[120:123], v236 offset:3072
    ds_read_b128 v[124:127], v236 offset:4096
    ds_read_b128 v[128:131], v236 offset:5120
    ds_read_b128 v[132:135], v236 offset:6144
    ds_read_b128 v[136:139], v236 offset:7168
    s_waitcnt vmcnt(1)
    buffer_store_dword v0, v14, s[4:7], s49 offen offset:0 sc1
    s_branch L_join_233
L_safe_236:
    buffer_store_dword v0, v14, s[4:7], s49 offen offset:0 sc1
    s_branch L_join_237
L_safe_244:
    s_and_b32 s67, s38, 3
    s_cmp_eq_u32 s67, 3
    s_cbranch_scc1 L_six_442
    v_pk_mul_f32 v[140:141], v[80:81], v[168:169] op_sel:[0,1] op_sel_hi:[1,1]
    v_pk_mul_f32 v[142:143], v[82:83], v[168:169] op_sel:[0,1] op_sel_hi:[1,1]
    v_exp_f32 v140, v140
    v_exp_f32 v141, v141
    v_exp_f32 v142, v142
    v_exp_f32 v143, v143
    v_pk_fma_f32 v[140:141], v[140:141], v[170:171], v[170:171] op_sel_hi:[1,0,0]
    v_pk_fma_f32 v[142:143], v[142:143], v[170:171], v[170:171] op_sel_hi:[1,0,0]
    v_rcp_f32 v140, v140
    v_rcp_f32 v141, v141
    v_rcp_f32 v142, v142
    v_rcp_f32 v143, v143
    v_pk_mul_f32 v[80:81], v[80:81], v[140:141]
    v_pk_mul_f32 v[82:83], v[82:83], v[142:143]
    v_cvt_pk_bf16_f32 v156, v80, v81
    v_cvt_pk_bf16_f32 v158, v80, v81
    v_cvt_pk_bf16_f32 v157, v82, v83
    v_cvt_pk_bf16_f32 v159, v82, v83
    v_permlane16_swap_b32 v156, v158
    s_nop 0
    v_permlane16_swap_b32 v157, v159
    buffer_store_dwordx4 v[156:159], v4, s[4:7], s62 offen offset:3072 sc1
L_six_442:
    v_pk_mul_f32 v[148:149], v[56:57], v[168:169] op_sel:[0,1] op_sel_hi:[1,1]
    v_pk_mul_f32 v[150:151], v[58:59], v[168:169] op_sel:[0,1] op_sel_hi:[1,1]
    v_pk_mul_f32 v[152:153], v[60:61], v[168:169] op_sel:[0,1] op_sel_hi:[1,1]
    v_pk_mul_f32 v[154:155], v[62:63], v[168:169] op_sel:[0,1] op_sel_hi:[1,1]
    v_exp_f32 v148, v148
    v_exp_f32 v149, v149
    v_exp_f32 v150, v150
    v_exp_f32 v151, v151
    v_exp_f32 v152, v152
    v_exp_f32 v153, v153
    v_exp_f32 v154, v154
    v_exp_f32 v155, v155
    v_pk_fma_f32 v[148:149], v[148:149], v[170:171], v[170:171] op_sel_hi:[1,0,0]
    v_pk_fma_f32 v[150:151], v[150:151], v[170:171], v[170:171] op_sel_hi:[1,0,0]
    v_pk_fma_f32 v[152:153], v[152:153], v[170:171], v[170:171] op_sel_hi:[1,0,0]
    v_pk_fma_f32 v[154:155], v[154:155], v[170:171], v[170:171] op_sel_hi:[1,0,0]
    v_rcp_f32 v148, v148
    v_rcp_f32 v149, v149
    v_rcp_f32 v150, v150
    v_rcp_f32 v151, v151
    v_rcp_f32 v152, v152
    v_rcp_f32 v153, v153
    v_rcp_f32 v154, v154
    v_rcp_f32 v155, v155
    v_pk_mul_f32 v[56:57], v[56:57], v[148:149]
    v_pk_mul_f32 v[58:59], v[58:59], v[150:151]
    v_pk_mul_f32 v[60:61], v[60:61], v[152:153]
    v_pk_mul_f32 v[62:63], v[62:63], v[154:155]
    v_cvt_pk_bf16_f32 v160, v56, v57
    v_cvt_pk_bf16_f32 v162, v60, v61
    v_cvt_pk_bf16_f32 v161, v58, v59
    v_cvt_pk_bf16_f32 v163, v62, v63
    v_permlane16_swap_b32 v160, v162
    s_nop 0
    v_permlane16_swap_b32 v161, v163
    buffer_store_dwordx4 v[160:163], v3, s[4:7], s62 offen offset:0 sc1
    v_pk_mul_f32 v[140:141], v[64:65], v[168:169] op_sel:[0,1] op_sel_hi:[1,1]
    v_pk_mul_f32 v[142:143], v[66:67], v[168:169] op_sel:[0,1] op_sel_hi:[1,1]
    v_pk_mul_f32 v[144:145], v[68:69], v[168:169] op_sel:[0,1] op_sel_hi:[1,1]
    v_pk_mul_f32 v[146:147], v[70:71], v[168:169] op_sel:[0,1] op_sel_hi:[1,1]
    v_exp_f32 v140, v140
    v_exp_f32 v141, v141
    v_exp_f32 v142, v142
    v_exp_f32 v143, v143
    v_exp_f32 v144, v144
    v_exp_f32 v145, v145
    v_exp_f32 v146, v146
    v_exp_f32 v147, v147
    v_pk_fma_f32 v[140:141], v[140:141], v[170:171], v[170:171] op_sel_hi:[1,0,0]
    v_pk_fma_f32 v[142:143], v[142:143], v[170:171], v[170:171] op_sel_hi:[1,0,0]
    v_pk_fma_f32 v[144:145], v[144:145], v[170:171], v[170:171] op_sel_hi:[1,0,0]
    v_pk_fma_f32 v[146:147], v[146:147], v[170:171], v[170:171] op_sel_hi:[1,0,0]
    v_rcp_f32 v140, v140
    v_rcp_f32 v141, v141
    v_rcp_f32 v142, v142
    v_rcp_f32 v143, v143
    v_rcp_f32 v144, v144
    v_rcp_f32 v145, v145
    v_rcp_f32 v146, v146
    v_rcp_f32 v147, v147
    v_pk_mul_f32 v[64:65], v[64:65], v[140:141]
    v_pk_mul_f32 v[66:67], v[66:67], v[142:143]
    v_pk_mul_f32 v[68:69], v[68:69], v[144:145]
    v_pk_mul_f32 v[70:71], v[70:71], v[146:147]
    v_cvt_pk_bf16_f32 v156, v64, v65
    v_cvt_pk_bf16_f32 v158, v68, v69
    v_cvt_pk_bf16_f32 v157, v66, v67
    v_cvt_pk_bf16_f32 v159, v70, v71
    v_permlane16_swap_b32 v156, v158
    s_nop 0
    v_permlane16_swap_b32 v157, v159
    buffer_store_dwordx4 v[156:159], v3, s[4:7], s62 offen offset:1024 sc1
    v_pk_mul_f32 v[148:149], v[72:73], v[168:169] op_sel:[0,1] op_sel_hi:[1,1]
    v_pk_mul_f32 v[150:151], v[74:75], v[168:169] op_sel:[0,1] op_sel_hi:[1,1]
    v_pk_mul_f32 v[152:153], v[76:77], v[168:169] op_sel:[0,1] op_sel_hi:[1,1]
    v_pk_mul_f32 v[154:155], v[78:79], v[168:169] op_sel:[0,1] op_sel_hi:[1,1]
    v_exp_f32 v148, v148
    v_exp_f32 v149, v149
    v_exp_f32 v150, v150
    v_exp_f32 v151, v151
    v_exp_f32 v152, v152
    v_exp_f32 v153, v153
    v_exp_f32 v154, v154
    v_exp_f32 v155, v155
    v_pk_fma_f32 v[148:149], v[148:149], v[170:171], v[170:171] op_sel_hi:[1,0,0]
    v_pk_fma_f32 v[150:151], v[150:151], v[170:171], v[170:171] op_sel_hi:[1,0,0]
    v_pk_fma_f32 v[152:153], v[152:153], v[170:171], v[170:171] op_sel_hi:[1,0,0]
    v_pk_fma_f32 v[154:155], v[154:155], v[170:171], v[170:171] op_sel_hi:[1,0,0]
    v_rcp_f32 v148, v148
    v_rcp_f32 v149, v149
    v_rcp_f32 v150, v150
    v_rcp_f32 v151, v151
    v_rcp_f32 v152, v152
    v_rcp_f32 v153, v153
    v_rcp_f32 v154, v154
    v_rcp_f32 v155, v155
    v_pk_mul_f32 v[72:73], v[72:73], v[148:149]
    v_pk_mul_f32 v[74:75], v[74:75], v[150:151]
    v_pk_mul_f32 v[76:77], v[76:77], v[152:153]
    v_pk_mul_f32 v[78:79], v[78:79], v[154:155]
    v_cvt_pk_bf16_f32 v160, v72, v73
    v_cvt_pk_bf16_f32 v162, v76, v77
    v_cvt_pk_bf16_f32 v161, v74, v75
    v_cvt_pk_bf16_f32 v163, v78, v79
    v_permlane16_swap_b32 v160, v162
    s_nop 0
    v_permlane16_swap_b32 v161, v163
    buffer_store_dwordx4 v[160:163], v3, s[4:7], s62 offen offset:2048 sc1
    s_and_b32 s67, s38, 3
    s_cmp_eq_u32 s67, 3
    s_cbranch_scc1 L_six_443
    v_pk_mul_f32 v[140:141], v[108:109], v[172:173] op_sel:[0,1] op_sel_hi:[1,1]
    v_pk_mul_f32 v[142:143], v[110:111], v[172:173] op_sel:[0,1] op_sel_hi:[1,1]
    v_exp_f32 v140, v140
    v_exp_f32 v141, v141
    v_exp_f32 v142, v142
    v_exp_f32 v143, v143
    v_pk_fma_f32 v[140:141], v[140:141], v[174:175], v[174:175] op_sel_hi:[1,0,0]
    v_pk_fma_f32 v[142:143], v[142:143], v[174:175], v[174:175] op_sel_hi:[1,0,0]
    v_rcp_f32 v140, v140
    v_rcp_f32 v141, v141
    v_rcp_f32 v142, v142
    v_rcp_f32 v143, v143
    v_pk_mul_f32 v[108:109], v[108:109], v[140:141]
    v_pk_mul_f32 v[110:111], v[110:111], v[142:143]
    v_cvt_pk_bf16_f32 v156, v108, v109
    v_cvt_pk_bf16_f32 v158, v108, v109
    v_cvt_pk_bf16_f32 v157, v110, v111
    v_cvt_pk_bf16_f32 v159, v110, v111
    v_permlane16_swap_b32 v156, v158
    s_nop 0
    v_permlane16_swap_b32 v157, v159
    buffer_store_dwordx4 v[156:159], v4, s[4:7], s63 offen offset:3072 sc1
L_six_443:
    v_pk_mul_f32 v[148:149], v[84:85], v[172:173] op_sel:[0,1] op_sel_hi:[1,1]
    v_pk_mul_f32 v[150:151], v[86:87], v[172:173] op_sel:[0,1] op_sel_hi:[1,1]
    v_pk_mul_f32 v[152:153], v[88:89], v[172:173] op_sel:[0,1] op_sel_hi:[1,1]
    v_pk_mul_f32 v[154:155], v[90:91], v[172:173] op_sel:[0,1] op_sel_hi:[1,1]
    v_exp_f32 v148, v148
    v_exp_f32 v149, v149
    v_exp_f32 v150, v150
    v_exp_f32 v151, v151
    v_exp_f32 v152, v152
    v_exp_f32 v153, v153
    v_exp_f32 v154, v154
    v_exp_f32 v155, v155
    v_pk_fma_f32 v[148:149], v[148:149], v[174:175], v[174:175] op_sel_hi:[1,0,0]
    v_pk_fma_f32 v[150:151], v[150:151], v[174:175], v[174:175] op_sel_hi:[1,0,0]
    v_pk_fma_f32 v[152:153], v[152:153], v[174:175], v[174:175] op_sel_hi:[1,0,0]
    v_pk_fma_f32 v[154:155], v[154:155], v[174:175], v[174:175] op_sel_hi:[1,0,0]
    v_rcp_f32 v148, v148
    v_rcp_f32 v149, v149
    v_rcp_f32 v150, v150
    v_rcp_f32 v151, v151
    v_rcp_f32 v152, v152
    v_rcp_f32 v153, v153
    v_rcp_f32 v154, v154
    v_rcp_f32 v155, v155
    v_pk_mul_f32 v[84:85], v[84:85], v[148:149]
    v_pk_mul_f32 v[86:87], v[86:87], v[150:151]
    v_pk_mul_f32 v[88:89], v[88:89], v[152:153]
    v_pk_mul_f32 v[90:91], v[90:91], v[154:155]
    v_cvt_pk_bf16_f32 v160, v84, v85
    v_cvt_pk_bf16_f32 v162, v88, v89
    v_cvt_pk_bf16_f32 v161, v86, v87
    v_cvt_pk_bf16_f32 v163, v90, v91
    v_permlane16_swap_b32 v160, v162
    s_nop 0
    v_permlane16_swap_b32 v161, v163
    buffer_store_dwordx4 v[160:163], v3, s[4:7], s63 offen offset:0 sc1
    s_waitcnt vmcnt(1)
    buffer_store_dword v0, v14, s[4:7], s53 offen offset:0 sc1
    v_pk_mul_f32 v[140:141], v[92:93], v[172:173] op_sel:[0,1] op_sel_hi:[1,1]
    v_pk_mul_f32 v[142:143], v[94:95], v[172:173] op_sel:[0,1] op_sel_hi:[1,1]
    v_pk_mul_f32 v[144:145], v[96:97], v[172:173] op_sel:[0,1] op_sel_hi:[1,1]
    v_pk_mul_f32 v[146:147], v[98:99], v[172:173] op_sel:[0,1] op_sel_hi:[1,1]
    v_exp_f32 v140, v140
    v_exp_f32 v141, v141
    v_exp_f32 v142, v142
    v_exp_f32 v143, v143
    v_exp_f32 v144, v144
    v_exp_f32 v145, v145
    v_exp_f32 v146, v146
    v_exp_f32 v147, v147
    v_pk_fma_f32 v[140:141], v[140:141], v[174:175], v[174:175] op_sel_hi:[1,0,0]
    v_pk_fma_f32 v[142:143], v[142:143], v[174:175], v[174:175] op_sel_hi:[1,0,0]
    v_pk_fma_f32 v[144:145], v[144:145], v[174:175], v[174:175] op_sel_hi:[1,0,0]
    v_pk_fma_f32 v[146:147], v[146:147], v[174:175], v[174:175] op_sel_hi:[1,0,0]
    v_rcp_f32 v140, v140
    v_rcp_f32 v141, v141
    v_rcp_f32 v142, v142
    v_rcp_f32 v143, v143
    v_rcp_f32 v144, v144
    v_rcp_f32 v145, v145
    v_rcp_f32 v146, v146
    v_rcp_f32 v147, v147
    v_pk_mul_f32 v[92:93], v[92:93], v[140:141]
    v_pk_mul_f32 v[94:95], v[94:95], v[142:143]
    v_pk_mul_f32 v[96:97], v[96:97], v[144:145]
    v_pk_mul_f32 v[98:99], v[98:99], v[146:147]
    v_cvt_pk_bf16_f32 v156, v92, v93
    v_cvt_pk_bf16_f32 v158, v96, v97
    v_cvt_pk_bf16_f32 v157, v94, v95
    v_cvt_pk_bf16_f32 v159, v98, v99
    v_permlane16_swap_b32 v156, v158
    s_nop 0
    v_permlane16_swap_b32 v157, v159
    buffer_store_dwordx4 v[156:159], v3, s[4:7], s63 offen offset:1024 sc1
    buffer_load_dword v29, v24, s[4:7], s56 offen offset:0 sc1
    v_pk_mul_f32 v[148:149], v[100:101], v[172:173] op_sel:[0,1] op_sel_hi:[1,1]
    v_pk_mul_f32 v[150:151], v[102:103], v[172:173] op_sel:[0,1] op_sel_hi:[1,1]
    v_pk_mul_f32 v[152:153], v[104:105], v[172:173] op_sel:[0,1] op_sel_hi:[1,1]
    v_pk_mul_f32 v[154:155], v[106:107], v[172:173] op_sel:[0,1] op_sel_hi:[1,1]
    v_exp_f32 v148, v148
    v_exp_f32 v149, v149
    v_exp_f32 v150, v150
    v_exp_f32 v151, v151
    v_exp_f32 v152, v152
    v_exp_f32 v153, v153
    v_exp_f32 v154, v154
    v_exp_f32 v155, v155
    v_pk_fma_f32 v[148:149], v[148:149], v[174:175], v[174:175] op_sel_hi:[1,0,0]
    v_pk_fma_f32 v[150:151], v[150:151], v[174:175], v[174:175] op_sel_hi:[1,0,0]
    v_pk_fma_f32 v[152:153], v[152:153], v[174:175], v[174:175] op_sel_hi:[1,0,0]
    v_pk_fma_f32 v[154:155], v[154:155], v[174:175], v[174:175] op_sel_hi:[1,0,0]
    v_rcp_f32 v148, v148
    v_rcp_f32 v149, v149
    v_rcp_f32 v150, v150
    v_rcp_f32 v151, v151
    v_rcp_f32 v152, v152
    v_rcp_f32 v153, v153
    v_rcp_f32 v154, v154
    v_rcp_f32 v155, v155
    v_pk_mul_f32 v[100:101], v[100:101], v[148:149]
    v_pk_mul_f32 v[102:103], v[102:103], v[150:151]
    v_pk_mul_f32 v[104:105], v[104:105], v[152:153]
    v_pk_mul_f32 v[106:107], v[106:107], v[154:155]
    v_cvt_pk_bf16_f32 v160, v100, v101
    v_cvt_pk_bf16_f32 v162, v104, v105
    v_cvt_pk_bf16_f32 v161, v102, v103
    v_cvt_pk_bf16_f32 v163, v106, v107
    v_permlane16_swap_b32 v160, v162
    s_nop 0
    v_permlane16_swap_b32 v161, v163
    buffer_store_dwordx4 v[160:163], v3, s[4:7], s63 offen offset:2048 sc1
    s_branch L_join_245
L_safe_251:
    buffer_store_dword v0, v14, s[4:7], s53 offen offset:0 sc1
    s_branch L_join_252
L_safe_256:
    buffer_store_dwordx4 v[172:175], v236, s[8:11], s55 offen offset:0 sc1
    s_branch L_join_257
L_safe_258:
    buffer_store_dwordx4 v[176:179], v236, s[8:11], s55 offen offset:64 sc1
    s_branch L_join_259
L_safe_260:
    buffer_store_dwordx2 v[180:181], v237, s[8:11], s55 offen offset:128 sc1
    s_branch L_join_261
L_safe_262:
    buffer_store_dword v0, v14, s[4:7], s53 offen offset:0 sc1
    s_branch L_join_263
L_safe_285:
    buffer_store_dwordx4 v[172:175], v5, s[4:7], s54 offen offset:0 sc1
    buffer_store_dwordx2 v[176:177], v6, s[4:7], s54 offen offset:512 sc1
    s_branch L_join_286
L_safe_287:
    buffer_store_dwordx4 v[172:175], v5, s[4:7], s54 offen offset:0 sc1
    buffer_store_dwordx2 v[176:177], v6, s[4:7], s54 offen offset:512 sc1
    s_branch L_join_288
L_safe_306:
    buffer_store_dwordx4 v[172:175], v5, s[4:7], s54 offen offset:0 sc1
    buffer_store_dwordx2 v[176:177], v6, s[4:7], s54 offen offset:512 sc1
    s_branch L_join_307
L_safe_308:
    buffer_store_dwordx4 v[172:175], v5, s[4:7], s54 offen offset:0 sc1
    buffer_store_dwordx2 v[176:177], v6, s[4:7], s54 offen offset:512 sc1
    s_branch L_join_309
L_safe_327:
    buffer_store_dwordx4 v[172:175], v5, s[4:7], s54 offen offset:0 sc1
    buffer_store_dwordx2 v[176:177], v6, s[4:7], s54 offen offset:512 sc1
    s_branch L_join_328
L_safe_329:
    buffer_store_dwordx4 v[172:175], v5, s[4:7], s54 offen offset:0 sc1
    buffer_store_dwordx2 v[176:177], v6, s[4:7], s54 offen offset:512 sc1
    s_branch L_join_330
L_safe_348:
    buffer_store_dwordx4 v[172:175], v5, s[4:7], s54 offen offset:0 sc1
    buffer_store_dwordx2 v[176:177], v6, s[4:7], s54 offen offset:512 sc1
    s_branch L_join_349
L_safe_350:
    buffer_store_dwordx4 v[172:175], v5, s[4:7], s54 offen offset:0 sc1
    buffer_store_dwordx2 v[176:177], v6, s[4:7], s54 offen offset:512 sc1
    s_branch L_join_351
L_safe_375:
    buffer_store_dwordx4 v[172:175], v5, s[4:7], s54 offen offset:0 sc1
    buffer_store_dwordx2 v[176:177], v6, s[4:7], s54 offen offset:512 sc1
    s_branch L_join_376
L_safe_377:
    buffer_store_dwordx4 v[172:175], v5, s[4:7], s54 offen offset:0 sc1
    buffer_store_dwordx2 v[176:177], v6, s[4:7], s54 offen offset:512 sc1
    s_branch L_join_378
L_safe_396:
    buffer_store_dwordx4 v[172:175], v5, s[4:7], s54 offen offset:0 sc1
    buffer_store_dwordx2 v[176:177], v6, s[4:7], s54 offen offset:512 sc1
    s_branch L_join_397
L_safe_398:
    buffer_store_dwordx4 v[172:175], v5, s[4:7], s54 offen offset:0 sc1
    buffer_store_dwordx2 v[176:177], v6, s[4:7], s54 offen offset:512 sc1
    s_branch L_join_399
L_safe_417:
    buffer_store_dwordx4 v[172:175], v5, s[4:7], s54 offen offset:0 sc1
    buffer_store_dwordx2 v[176:177], v6, s[4:7], s54 offen offset:512 sc1
    s_branch L_join_418
L_safe_419:
    buffer_store_dwordx4 v[172:175], v5, s[4:7], s54 offen offset:0 sc1
    buffer_store_dwordx2 v[176:177], v6, s[4:7], s54 offen offset:512 sc1
    s_branch L_join_420
L_safe_438:
    buffer_store_dwordx4 v[172:175], v5, s[4:7], s54 offen offset:0 sc1
    buffer_store_dwordx2 v[176:177], v6, s[4:7], s54 offen offset:512 sc1
    s_branch L_join_439
L_safe_440:
    buffer_store_dwordx4 v[172:175], v5, s[4:7], s54 offen offset:0 sc1
    buffer_store_dwordx2 v[176:177], v6, s[4:7], s54 offen offset:512 sc1
    s_branch L_join_441
.section .rodata,"a"
.p2align 6
.amdhsa_kernel interleave_layers__sliding_block__dense_activation_silu__prompt_kernel
  .amdhsa_next_free_vgpr 512
  .amdhsa_next_free_sgpr 102
  .amdhsa_accum_offset 256
  .amdhsa_group_segment_fixed_size 0
  .amdhsa_kernarg_size 72
  .amdhsa_user_sgpr_count 2
  .amdhsa_user_sgpr_kernarg_segment_ptr 1
  .amdhsa_system_sgpr_workgroup_id_x 1
.end_amdhsa_kernel
```
